```python
import torch

def _softmax(x, axis=-1):
    return torch.softmax(x, dim=axis)
def _gelu(x):
    return torch.nn.functional.gelu(x, approximate="tanh")
def _silu(x):
    return torch.nn.functional.silu(x)
def _sigmoid(x):
    return torch.sigmoid(x)
def _layernorm(x, axis=-1, eps=1e-5):
    m = x.mean(dim=axis, keepdim=True)
    v = x.var(dim=axis, keepdim=True, unbiased=False)
    return (x - m) / torch.sqrt(v + eps)
def _scatter_add(tgt, idx, src, axis=0):
    return tgt.clone().index_add_(axis, idx, src)
def _segment_sum(src, seg, n):
    out = torch.zeros((n,) + src.shape[1:], dtype=src.dtype)
    return out.index_add_(0, seg, src)
def _pad(x, pw):
    flat = tuple(v for pair in reversed(pw) for v in pair)
    return torch.nn.functional.pad(x, flat)

kernel_name = 'parallel_sum__softmax_full_mha__glu_gated_glu__prompt'

def setup_inputs():

    _w = (lambda a: (lambda t: t.to(torch.bfloat16) if t.is_floating_point() else t)(torch.as_tensor(a)))
    def _A_setup():
        B, S, D = 1, 2048, 1024
        return {
            "x": _w((lambda *s: torch.randn(*s, dtype=torch.bfloat16) * 0.05)(B, S, D)),
            "wqkv": _w((lambda *s: torch.randn(*s, dtype=torch.bfloat16) * 0.05)(D, 3 * D)),
            "wo": _w((lambda *s: torch.randn(*s, dtype=torch.bfloat16) * 0.05)(D, D)),
        }
    _A_in = _A_setup()

    def _B_setup():
        B, S, D, F = 1, 2048, 1024, 3584
        return {
            "x": _w((lambda *s: torch.randn(*s, dtype=torch.bfloat16) * 0.05)(B, S, D)),
            "w_gate": _w((lambda *s: torch.randn(*s, dtype=torch.bfloat16) * 0.05)(D, F)),
            "w_up": _w((lambda *s: torch.randn(*s, dtype=torch.bfloat16) * 0.05)(D, F)),
            "w_down": _w((lambda *s: torch.randn(*s, dtype=torch.bfloat16) * 0.05)(F, D)),
        }
    _B_in = _B_setup()

    return {
        "A_x": _A_in["x"],
        "A_wqkv": _A_in["wqkv"],
        "A_wo": _A_in["wo"],
        "B_x": _B_in["x"],
        "B_w_gate": _B_in["w_gate"],
        "B_w_up": _B_in["w_up"],
        "B_w_down": _B_in["w_down"],
    }

def reference(A_x, A_wqkv, A_wo, B_x, B_w_gate, B_w_up, B_w_down):
    def _A_ref(x, wqkv, wo):
        B, S, D = x.shape
        H = 32; Dh = D // H
        qkv = (lambda x, *d: x.permute(*d))((x @ wqkv).reshape(B, S, 3, H, Dh), 2, 0, 3, 1, 4)
        q, k, v = qkv[0], qkv[1], qkv[2]
        scale = Dh ** -0.5
        scores = torch.einsum("bhqd,bhkd->bhqk", q, k) * scale
        p = _softmax(scores, axis=-1)
        o = torch.einsum("bhqk,bhkd->bhqd", p, v)
        return (lambda x, *d: x.permute(*d))(o, 0, 2, 1, 3).reshape(B, S, D) @ wo

    def _B_ref(x, w_gate, w_up, w_down):
        g = torch.einsum("bsd,df->bsf", x, w_gate)
        u = torch.einsum("bsd,df->bsf", x, w_up)
        h = _sigmoid(g) * u
        return torch.einsum("bsf,fd->bsd", h, w_down)

    x = A_x
    xn = _layernorm(x, axis=-1)
    return x + _A_ref(xn, A_wqkv, A_wo) + _B_ref(xn, B_w_gate, B_w_up, B_w_down)
```

```asm
; @launch kernel=mg_kernel grid=(256,1,1) block=(512,1,1) lds=163840
.amdgcn_target "amdgcn-amd-amdhsa--gfx950"
.text
.globl mg_kernel
.p2align 8
.type mg_kernel,@function
mg_kernel:
s_cmp_ge_u32 s2,256
s_cbranch_scc1 g2_exit
s_mov_b32 s100,-1
s_mov_b32 s101,s2
g2_re:
s_load_dwordx4 s[4:7],s[0:1],0
s_load_dwordx4 s[8:11],s[0:1],32
s_load_dwordx2 s[12:13],s[0:1],72
s_load_dwordx2 s[14:15],s[0:1],16
s_load_dwordx2 s[16:17],s[0:1],48
s_load_dwordx2 s[18:19],s[0:1],64
v_lshrrev_b32 v12,6,v0
v_and_b32 v0,63,v0
v_readfirstlane_b32 s40,v12
s_and_b32 s50,s2,7
s_lshr_b32 s51,s2,3
s_lshl_b32 s44,s50,2
s_and_b32 s50,s51,3
s_add_u32 s44,s44,s50
s_lshr_b32 s43,s51,2
s_lshr_b32 s45,s44,1
s_xor_b32 s46,s44,s45
s_and_b32 s46,s46,1
s_mul_i32 s47,s45,224
s_lshl_b32 s50,s46,5
s_add_u32 s50,s50,96
s_bitcmp1_b32 s44,0
s_cselect_b32 s50,s50,0
s_add_u32 s47,s47,s50
s_and_b32 s41,s40,3
s_lshr_b32 s42,s40,2
v_lshlrev_b32 v95,4,v0
s_lshl_b32 s52,s2,3
s_add_u32 s52,s52,s40
s_lshl_b32 s53,s52,11
s_cmp_eq_u32 s43,0
s_cselect_b32 s64,1,0
s_lshl_b32 s99,s46,1
s_add_u32 s99,s99,s42
s_cmp_eq_u32 s99,1
s_cbranch_scc1 g2_v1
s_cmp_eq_u32 s99,2
s_cbranch_scc1 g2_v2
s_cmp_eq_u32 s99,3
s_cbranch_scc1 g2_v3
g2_v0:
s_lshl_b32 s50,s41,6
s_lshl_b32 s54,s41,10
s_add_u32 s51,s50,0
v_add_u32 v12,s51,v0
v_lshrrev_b32 v13,3,v12
v_and_b32 v14,7,v12
v_and_b32 v15,2,v13
v_xor_b32 v14,v14,v15
v_bfe_u32 v15,v13,3,1
v_lshlrev_b32 v15,2,v15
v_xor_b32 v14,v14,v15
v_mul_u32_u24 v13,6144,v13
v_lshl_add_u32 v88,v14,4,v13
s_add_u32 s51,s50,0
v_add_u32 v12,s51,v0
v_lshrrev_b32 v13,4,v12
v_and_b32 v14,15,v12
v_and_b32 v15,3,v13
v_lshlrev_b32 v15,1,v15
v_xor_b32 v14,v14,v15
v_and_b32 v15,8,v13
v_xor_b32 v14,v14,v15
v_mul_u32_u24 v13,7168,v13
v_lshl_add_u32 v89,v14,4,v13
s_add_u32 s51,s50,256
v_add_u32 v12,s51,v0
v_lshrrev_b32 v13,4,v12
v_and_b32 v14,15,v12
v_and_b32 v15,3,v13
v_lshlrev_b32 v15,1,v15
v_xor_b32 v14,v14,v15
v_and_b32 v15,8,v13
v_xor_b32 v14,v14,v15
v_mul_u32_u24 v13,7168,v13
v_lshl_add_u32 v90,v14,4,v13
s_add_u32 s51,s50,0
v_add_u32 v12,s51,v0
v_lshrrev_b32 v13,4,v12
v_and_b32 v14,15,v12
v_and_b32 v15,3,v13
v_lshlrev_b32 v15,1,v15
v_xor_b32 v14,v14,v15
v_and_b32 v15,8,v13
v_xor_b32 v14,v14,v15
v_mul_u32_u24 v13,7168,v13
v_lshl_add_u32 v91,v14,4,v13
s_add_u32 s51,s50,256
v_add_u32 v12,s51,v0
v_lshrrev_b32 v13,4,v12
v_and_b32 v14,15,v12
v_and_b32 v15,3,v13
v_lshlrev_b32 v15,1,v15
v_xor_b32 v14,v14,v15
v_and_b32 v15,8,v13
v_xor_b32 v14,v14,v15
v_mul_u32_u24 v13,7168,v13
v_lshl_add_u32 v92,v14,4,v13
s_lshl_b32 s65,s45,7
s_add_u32 s65,s65,4096
s_lshl_b32 s66,s47,1
s_and_b32 s50,s64,7
s_lshr_b32 s64,s64,4
s_mul_i32 s48,s50,786432
s_add_u32 s48,s48,s65
s_mul_i32 s49,s50,917504
s_add_u32 s49,s49,s66
s_waitcnt lgkmcnt(0)
s_mov_b32 s56,s4
s_and_b32 s57,s5,0xffff
s_mov_b32 s58,4194304
s_mov_b32 s59,0x00020000
buffer_load_dwordx4 v[96:99],v95,s[56:59],s53 offen offset:0
buffer_load_dwordx4 v[100:103],v95,s[56:59],s53 offen offset:1024
s_mov_b32 s20,s6
s_and_b32 s21,s7,0xffff
s_mov_b32 s22,6291456
s_mov_b32 s23,0x00020000
s_mov_b32 s24,s8
s_and_b32 s25,s9,0xffff
s_mov_b32 s26,7340032
s_mov_b32 s27,0x00020000
s_mov_b32 s28,s10
s_and_b32 s29,s11,0xffff
s_mov_b32 s30,7340032
s_mov_b32 s31,0x00020000
s_add_u32 m0,s54,0
s_nop 0
buffer_load_dwordx4 v88,s[20:23],s48 offen lds
s_add_u32 m0,s54,4096
s_nop 0
buffer_load_dwordx4 v89,s[24:27],s49 offen lds
s_add_u32 m0,s54,8192
s_nop 0
buffer_load_dwordx4 v90,s[24:27],s49 offen lds
s_add_u32 m0,s54,12288
s_nop 0
buffer_load_dwordx4 v91,s[28:31],s49 offen lds
s_add_u32 m0,s54,16384
s_nop 0
buffer_load_dwordx4 v92,s[28:31],s49 offen lds
s_add_u32 s48,s48,196608
s_add_u32 s49,s49,229376
s_cmp_eq_u32 s43,0
s_cselect_b32 s64,0x17654320,s64
s_cmp_eq_u32 s43,1
s_cselect_b32 s64,0x17654321,s64
s_cmp_eq_u32 s43,2
s_cselect_b32 s64,0x27654321,s64
s_cmp_eq_u32 s43,3
s_cselect_b32 s64,0x37654321,s64
s_cmp_eq_u32 s43,4
s_cselect_b32 s64,0x37653421,s64
s_cmp_eq_u32 s43,5
s_cselect_b32 s64,0x37643521,s64
s_cmp_eq_u32 s43,6
s_cselect_b32 s64,0x37543621,s64
s_cmp_eq_u32 s43,7
s_cselect_b32 s64,0x36543721,s64
s_lshr_b32 s67,s64,28
s_sub_u32 s67,7,s67
s_sub_u32 s96,s67,1
s_add_u32 m0,s54,20480
s_nop 0
buffer_load_dwordx4 v88,s[20:23],s48 offen lds
s_add_u32 m0,s54,24576
s_nop 0
buffer_load_dwordx4 v89,s[24:27],s49 offen lds
s_add_u32 m0,s54,28672
s_nop 0
buffer_load_dwordx4 v90,s[24:27],s49 offen lds
s_add_u32 m0,s54,32768
s_nop 0
buffer_load_dwordx4 v91,s[28:31],s49 offen lds
s_add_u32 m0,s54,36864
s_nop 0
buffer_load_dwordx4 v92,s[28:31],s49 offen lds
s_add_u32 s48,s48,196608
s_add_u32 s49,s49,229376
s_mov_b32 s36,s12
s_and_b32 s37,s13,0xffff
s_mov_b32 s38,50331648
s_mov_b32 s39,0x00020000
s_mov_b32 s60,s18
s_and_b32 s61,s19,0xffff
s_mov_b32 s62,256
s_mov_b32 s63,0x00020000
s_lshl_b32 s68,0x11111111,s41
s_mov_b32 s69,0xffff0000
s_cmp_eq_u32 s40,0
s_cselect_b32 s97,s96,99
s_cmp_eq_u32 s100,-1
s_cselect_b32 s97,s97,99
s_lshl_b32 s98,s44,14
s_lshl_b32 s50,s40,11
s_add_u32 s98,s98,s50
s_add_u32 s98,s98,44040192
s_lshl_b32 s50,s40,8
s_add_u32 s50,s50,147456
v_lshl_add_u32 v12,v0,2,s50
v_mov_b32 v13,0
ds_write_b32 v12,v13 offset:4096
v_lshlrev_b32 v12,2,v0
v_add_u32 v12,161792,v12
ds_write_b32 v12,v13
v_bfe_u32 v12,v0,2,2
v_lshrrev_b32 v13,4,v0
v_lshl_add_u32 v14,v13,3,v12
v_and_b32 v15,3,v0
v_lshlrev_b32 v15,3,v15
v_and_b32 v13,1,v13
v_lshrrev_b32 v93,1,v12
v_lshl_add_u32 v93,v13,1,v93
v_lshlrev_b32 v93,5,v93
v_mul_u32_u24 v94,128,v14
v_add_u32 v94,v94,v15
v_xor_b32 v11,0,v93
v_add_u32 v11,0,v11
v_add_u32 v1,v94,v11
v_xor_b32 v11,32,v93
v_add_u32 v11,0,v11
v_add_u32 v2,v94,v11
v_lshl_add_u32 v93,v13,2,v12
v_lshlrev_b32 v93,5,v93
v_mul_u32_u24 v94,256,v14
v_add_u32 v94,v94,v15
v_xor_b32 v11,0,v93
v_add_u32 v11,4096,v11
v_add_u32 v3,v94,v11
v_xor_b32 v11,32,v93
v_add_u32 v11,4096,v11
v_add_u32 v4,v94,v11
v_xor_b32 v11,0,v93
v_add_u32 v11,12288,v11
v_add_u32 v5,v94,v11
v_xor_b32 v11,32,v93
v_add_u32 v11,12288,v11
v_add_u32 v6,v94,v11
v_xor_b32 v11,64,v93
v_add_u32 v11,4096,v11
v_add_u32 v7,v94,v11
v_xor_b32 v11,96,v93
v_add_u32 v11,4096,v11
v_add_u32 v8,v94,v11
v_xor_b32 v11,64,v93
v_add_u32 v11,12288,v11
v_add_u32 v9,v94,v11
v_xor_b32 v11,96,v93
v_add_u32 v11,12288,v11
v_add_u32 v10,v94,v11
s_lshl_b32 s50,s41,13
s_add_u32 s50,s50,81920
v_and_b32 v12,15,v0
v_lshrrev_b32 v13,1,v12
v_lshrrev_b32 v14,4,v0
v_xor_b32 v13,v13,v14
v_lshl_add_u32 v14,v12,7,s50
v_lshl_add_u32 v11,v13,4,v14
v_xor_b32 v94,64,v11
s_waitcnt vmcnt(10)
v_lshlrev_b32 v108,16,v96
v_and_b32 v109,0xffff0000,v96
v_mov_b32 v104,v108
v_mov_b32 v106,v109
v_mul_f32 v105,v108,v108
v_mul_f32 v107,v109,v109
v_lshlrev_b32 v108,16,v97
v_and_b32 v109,0xffff0000,v97
v_add_f32 v104,v104,v108
v_add_f32 v106,v106,v109
v_fmac_f32 v105,v108,v108
v_fmac_f32 v107,v109,v109
v_lshlrev_b32 v108,16,v98
v_and_b32 v109,0xffff0000,v98
v_add_f32 v104,v104,v108
v_add_f32 v106,v106,v109
v_fmac_f32 v105,v108,v108
v_fmac_f32 v107,v109,v109
v_lshlrev_b32 v108,16,v99
v_and_b32 v109,0xffff0000,v99
v_add_f32 v104,v104,v108
v_add_f32 v106,v106,v109
v_fmac_f32 v105,v108,v108
v_fmac_f32 v107,v109,v109
v_lshlrev_b32 v108,16,v100
v_and_b32 v109,0xffff0000,v100
v_add_f32 v104,v104,v108
v_add_f32 v106,v106,v109
v_fmac_f32 v105,v108,v108
v_fmac_f32 v107,v109,v109
v_lshlrev_b32 v108,16,v101
v_and_b32 v109,0xffff0000,v101
v_add_f32 v104,v104,v108
v_add_f32 v106,v106,v109
v_fmac_f32 v105,v108,v108
v_fmac_f32 v107,v109,v109
v_lshlrev_b32 v108,16,v102
v_and_b32 v109,0xffff0000,v102
v_add_f32 v104,v104,v108
v_add_f32 v106,v106,v109
v_fmac_f32 v105,v108,v108
v_fmac_f32 v107,v109,v109
v_lshlrev_b32 v108,16,v103
v_and_b32 v109,0xffff0000,v103
v_add_f32 v104,v104,v108
v_add_f32 v106,v106,v109
v_fmac_f32 v105,v108,v108
v_fmac_f32 v107,v109,v109
v_add_f32 v104,v104,v106
v_add_f32 v105,v105,v107
s_nop 0
s_nop 0
v_add_f32_dpp v104,v104,v104 row_ror:8 row_mask:0xf bank_mask:0xf
v_add_f32_dpp v105,v105,v105 row_ror:8 row_mask:0xf bank_mask:0xf
s_nop 0
v_add_f32_dpp v104,v104,v104 row_ror:4 row_mask:0xf bank_mask:0xf
v_add_f32_dpp v105,v105,v105 row_ror:4 row_mask:0xf bank_mask:0xf
s_nop 0
v_add_f32_dpp v104,v104,v104 row_ror:2 row_mask:0xf bank_mask:0xf
v_add_f32_dpp v105,v105,v105 row_ror:2 row_mask:0xf bank_mask:0xf
s_nop 0
v_add_f32_dpp v104,v104,v104 row_ror:1 row_mask:0xf bank_mask:0xf
v_add_f32_dpp v105,v105,v105 row_ror:1 row_mask:0xf bank_mask:0xf
v_mov_b32 v106,v104
v_mov_b32 v107,v105
s_nop 0
v_permlane16_swap_b32 v104,v106
v_permlane16_swap_b32 v105,v107
v_add_f32 v104,v104,v106
v_add_f32 v105,v105,v107
v_mov_b32 v106,v104
v_mov_b32 v107,v105
s_nop 0
v_permlane32_swap_b32 v104,v106
v_permlane32_swap_b32 v105,v107
v_add_f32 v104,v104,v106
v_add_f32 v105,v105,v107
v_mul_f32 v104,0xba800000,v104
v_mul_f32 v105,0x3a800000,v105
v_fma_f32 v105,-v104,v104,v105
v_max_f32 v105,0,v105
v_cvt_pk_bf16_f32 v104,v104,v105
v_and_b32 v105,0xffff0000,v104
v_lshlrev_b32 v104,16,v104
v_add_f32 v105,0x3727c5ac,v105
v_cvt_pk_bf16_f32 v105,v105,v105
v_and_b32 v105,0xffff0000,v105
v_sqrt_f32 v105,v105
s_nop 0
v_cvt_pk_bf16_f32 v105,v105,v105
v_and_b32 v105,0xffff0000,v105
v_cmp_eq_u32 vcc,0,v0
v_lshlrev_b32 v106,13,v0
s_lshl_b32 s50,s52,2
s_add_u32 s50,s50,42991616
v_cndmask_b32 v104,v105,v104,vcc
s_mov_b64 exec,3
buffer_store_dword v104,v106,s[36:39],s50 offen sc1
s_mov_b64 exec,-1
s_cmp_eq_u32 s97,99
s_cbranch_scc1 g2_nr0
v_mov_b32 v105,0
v_lshlrev_b32 v106,2,v0
s_bfe_u32 s50,s2,0x20001
s_lshl_b32 s50,s50,2
s_and_b32 s51,s44,3
s_add_u32 s50,s50,s51
s_lshl_b32 s50,s50,1
s_and_b32 s51,s2,1
s_add_u32 s50,s50,s51
s_lshl_b32 s50,s50,3
s_add_u32 s50,s50,s43
s_lshl_b32 s50,s50,9
s_add_u32 s50,s50,41943040
buffer_store_dword v105,v106,s[36:39],s50 offen sc1
s_lshl_b32 s50,s43,1
s_and_b32 s51,s44,1
s_add_u32 s50,s50,s51
s_lshl_b32 s51,s45,4
s_add_u32 s50,s50,s51
s_lshl_b32 s50,s50,9
s_add_u32 s50,s50,42074112
buffer_store_dword v105,v106,s[36:39],s50 offen sc1
g2_nr0:
s_waitcnt vmcnt(6) lgkmcnt(0)
s_barrier
ds_read_b128 v[56:59],v11 offset:0
ds_read_b128 v[60:63],v11 offset:2048
ds_read_b128 v[64:67],v11 offset:4096
ds_read_b128 v[68:71],v11 offset:6144
ds_read_b64_tr_b16 v[16:17],v1 offset:0
ds_read_b64_tr_b16 v[18:19],v1 offset:512
ds_read_b64_tr_b16 v[20:21],v2 offset:0
ds_read_b64_tr_b16 v[22:23],v2 offset:512
ds_read_b64_tr_b16 v[24:25],v3 offset:0
ds_read_b64_tr_b16 v[26:27],v3 offset:1024
ds_read_b64_tr_b16 v[28:29],v4 offset:0
ds_read_b64_tr_b16 v[30:31],v4 offset:1024
ds_read_b64_tr_b16 v[32:33],v5 offset:0
ds_read_b64_tr_b16 v[34:35],v5 offset:1024
ds_read_b64_tr_b16 v[36:37],v6 offset:0
ds_read_b64_tr_b16 v[38:39],v6 offset:1024
ds_read_b64_tr_b16 v[40:41],v7 offset:0
ds_read_b64_tr_b16 v[42:43],v7 offset:1024
ds_read_b64_tr_b16 v[44:45],v8 offset:0
ds_read_b64_tr_b16 v[46:47],v8 offset:1024
ds_read_b64_tr_b16 v[48:49],v9 offset:0
ds_read_b64_tr_b16 v[50:51],v9 offset:1024
ds_read_b64_tr_b16 v[52:53],v10 offset:0
ds_read_b64_tr_b16 v[54:55],v10 offset:1024
s_add_u32 m0,s54,40960
s_nop 0
buffer_load_dwordx4 v88,s[20:23],s48 offen lds
s_add_u32 m0,s54,45056
s_nop 0
buffer_load_dwordx4 v89,s[24:27],s49 offen lds
s_add_u32 m0,s54,49152
s_nop 0
buffer_load_dwordx4 v90,s[24:27],s49 offen lds
s_add_u32 m0,s54,53248
s_nop 0
buffer_load_dwordx4 v91,s[28:31],s49 offen lds
s_add_u32 m0,s54,57344
s_nop 0
buffer_load_dwordx4 v92,s[28:31],s49 offen lds
s_add_u32 s48,s48,196608
s_add_u32 s49,s49,229376
s_waitcnt lgkmcnt(15)
v_mfma_f32_16x16x32_bf16 v[96:99],v[56:59],v[16:19],0
v_mfma_f32_16x16x32_bf16 v[100:103],v[60:63],v[16:19],0
v_mfma_f32_16x16x32_bf16 v[104:107],v[64:67],v[16:19],0
v_mfma_f32_16x16x32_bf16 v[108:111],v[68:71],v[16:19],0
s_waitcnt vmcnt(6) lgkmcnt(0)
s_barrier
ds_read_b64_tr_b16 v[16:17],v1 offset:20480
v_mfma_f32_16x16x32_bf16 v[112:115],v[56:59],v[20:23],0
ds_read_b64_tr_b16 v[18:19],v1 offset:20992
v_mfma_f32_16x16x32_bf16 v[116:119],v[60:63],v[20:23],0
ds_read_b128 v[72:75],v94 offset:0
v_mfma_f32_16x16x32_bf16 v[120:123],v[64:67],v[20:23],0
ds_read_b128 v[76:79],v94 offset:2048
v_mfma_f32_16x16x32_bf16 v[124:127],v[68:71],v[20:23],0
ds_read_b64_tr_b16 v[20:21],v2 offset:20480
v_mfma_f32_16x16x32_bf16 v[128:131],v[24:27],v[56:59],0
ds_read_b64_tr_b16 v[22:23],v2 offset:20992
v_mfma_f32_16x16x32_bf16 v[132:135],v[24:27],v[60:63],0
ds_read_b128 v[80:83],v94 offset:4096
v_mfma_f32_16x16x32_bf16 v[136:139],v[24:27],v[64:67],0
ds_read_b128 v[84:87],v94 offset:6144
v_mfma_f32_16x16x32_bf16 v[140:143],v[24:27],v[68:71],0
ds_read_b64_tr_b16 v[24:25],v3 offset:20480
v_mfma_f32_16x16x32_bf16 v[144:147],v[28:31],v[56:59],0
ds_read_b64_tr_b16 v[26:27],v3 offset:21504
v_mfma_f32_16x16x32_bf16 v[148:151],v[28:31],v[60:63],0
s_add_u32 m0,s54,61440
s_nop 0
buffer_load_dwordx4 v88,s[20:23],s48 offen lds
v_mfma_f32_16x16x32_bf16 v[152:155],v[28:31],v[64:67],0
s_add_u32 m0,s54,65536
s_nop 0
buffer_load_dwordx4 v89,s[24:27],s49 offen lds
v_mfma_f32_16x16x32_bf16 v[156:159],v[28:31],v[68:71],0
ds_read_b64_tr_b16 v[28:29],v4 offset:20480
v_mfma_f32_16x16x32_bf16 v[160:163],v[32:35],v[56:59],0
ds_read_b64_tr_b16 v[30:31],v4 offset:21504
v_mfma_f32_16x16x32_bf16 v[164:167],v[32:35],v[60:63],0
s_add_u32 m0,s54,69632
s_nop 0
buffer_load_dwordx4 v90,s[24:27],s49 offen lds
v_mfma_f32_16x16x32_bf16 v[168:171],v[32:35],v[64:67],0
s_add_u32 m0,s54,73728
s_nop 0
buffer_load_dwordx4 v91,s[28:31],s49 offen lds
v_mfma_f32_16x16x32_bf16 v[172:175],v[32:35],v[68:71],0
ds_read_b64_tr_b16 v[32:33],v5 offset:20480
v_mfma_f32_16x16x32_bf16 v[176:179],v[36:39],v[56:59],0
ds_read_b64_tr_b16 v[34:35],v5 offset:21504
v_mfma_f32_16x16x32_bf16 v[180:183],v[36:39],v[60:63],0
s_add_u32 m0,s54,77824
s_nop 0
buffer_load_dwordx4 v92,s[28:31],s49 offen lds
s_and_b32 s50,s64,7
s_lshr_b32 s64,s64,4
s_mul_i32 s48,s50,786432
s_add_u32 s48,s48,s65
s_mul_i32 s49,s50,917504
s_add_u32 s49,s49,s66
v_mfma_f32_16x16x32_bf16 v[184:187],v[36:39],v[64:67],0
s_add_u32 m0,s54,0
s_nop 0
buffer_load_dwordx4 v88,s[20:23],s48 offen lds
v_mfma_f32_16x16x32_bf16 v[188:191],v[36:39],v[68:71],0
ds_read_b64_tr_b16 v[36:37],v6 offset:20480
v_mfma_f32_16x16x32_bf16 v[192:195],v[40:43],v[56:59],0
ds_read_b64_tr_b16 v[38:39],v6 offset:21504
v_mfma_f32_16x16x32_bf16 v[196:199],v[40:43],v[60:63],0
s_add_u32 m0,s54,4096
s_nop 0
buffer_load_dwordx4 v89,s[24:27],s49 offen lds
v_mfma_f32_16x16x32_bf16 v[200:203],v[40:43],v[64:67],0
s_add_u32 m0,s54,8192
s_nop 0
buffer_load_dwordx4 v90,s[24:27],s49 offen lds
v_mfma_f32_16x16x32_bf16 v[204:207],v[40:43],v[68:71],0
ds_read_b64_tr_b16 v[40:41],v7 offset:20480
v_mfma_f32_16x16x32_bf16 v[208:211],v[44:47],v[56:59],0
ds_read_b64_tr_b16 v[42:43],v7 offset:21504
v_mfma_f32_16x16x32_bf16 v[212:215],v[44:47],v[60:63],0
s_add_u32 m0,s54,12288
s_nop 0
buffer_load_dwordx4 v91,s[28:31],s49 offen lds
v_mfma_f32_16x16x32_bf16 v[216:219],v[44:47],v[64:67],0
s_add_u32 m0,s54,16384
s_nop 0
buffer_load_dwordx4 v92,s[28:31],s49 offen lds
s_add_u32 s48,s48,196608
s_add_u32 s49,s49,229376
v_mfma_f32_16x16x32_bf16 v[220:223],v[44:47],v[68:71],0
ds_read_b64_tr_b16 v[44:45],v8 offset:20480
v_mfma_f32_16x16x32_bf16 v[224:227],v[48:51],v[56:59],0
ds_read_b64_tr_b16 v[46:47],v8 offset:21504
v_mfma_f32_16x16x32_bf16 v[228:231],v[48:51],v[60:63],0
v_mfma_f32_16x16x32_bf16 v[232:235],v[48:51],v[64:67],0
v_mfma_f32_16x16x32_bf16 v[236:239],v[48:51],v[68:71],0
ds_read_b64_tr_b16 v[48:49],v9 offset:20480
v_mfma_f32_16x16x32_bf16 v[240:243],v[52:55],v[56:59],0
ds_read_b64_tr_b16 v[50:51],v9 offset:21504
v_mfma_f32_16x16x32_bf16 v[244:247],v[52:55],v[60:63],0
v_mfma_f32_16x16x32_bf16 v[248:251],v[52:55],v[64:67],0
v_mfma_f32_16x16x32_bf16 v[252:255],v[52:55],v[68:71],0
ds_read_b64_tr_b16 v[52:53],v10 offset:20480
ds_read_b64_tr_b16 v[54:55],v10 offset:21504
s_waitcnt lgkmcnt(15)
v_mfma_f32_16x16x32_bf16 v[96:99],v[72:75],v[16:19],v[96:99]
v_mfma_f32_16x16x32_bf16 v[100:103],v[76:79],v[16:19],v[100:103]
v_mfma_f32_16x16x32_bf16 v[104:107],v[80:83],v[16:19],v[104:107]
v_mfma_f32_16x16x32_bf16 v[108:111],v[84:87],v[16:19],v[108:111]
s_waitcnt vmcnt(10) lgkmcnt(0)
s_barrier
ds_read_b64_tr_b16 v[16:17],v1 offset:40960
v_mfma_f32_16x16x32_bf16 v[112:115],v[72:75],v[20:23],v[112:115]
ds_read_b64_tr_b16 v[18:19],v1 offset:41472
v_mfma_f32_16x16x32_bf16 v[116:119],v[76:79],v[20:23],v[116:119]
ds_read_b128 v[56:59],v11 offset:32768
v_mfma_f32_16x16x32_bf16 v[120:123],v[80:83],v[20:23],v[120:123]
ds_read_b128 v[60:63],v11 offset:34816
v_mfma_f32_16x16x32_bf16 v[124:127],v[84:87],v[20:23],v[124:127]
ds_read_b64_tr_b16 v[20:21],v2 offset:40960
v_mfma_f32_16x16x32_bf16 v[128:131],v[24:27],v[72:75],v[128:131]
ds_read_b64_tr_b16 v[22:23],v2 offset:41472
v_mfma_f32_16x16x32_bf16 v[132:135],v[24:27],v[76:79],v[132:135]
ds_read_b128 v[64:67],v11 offset:36864
v_mfma_f32_16x16x32_bf16 v[136:139],v[24:27],v[80:83],v[136:139]
ds_read_b128 v[68:71],v11 offset:38912
v_mfma_f32_16x16x32_bf16 v[140:143],v[24:27],v[84:87],v[140:143]
ds_read_b64_tr_b16 v[24:25],v3 offset:40960
v_mfma_f32_16x16x32_bf16 v[144:147],v[28:31],v[72:75],v[144:147]
ds_read_b64_tr_b16 v[26:27],v3 offset:41984
v_mfma_f32_16x16x32_bf16 v[148:151],v[28:31],v[76:79],v[148:151]
s_add_u32 m0,s54,20480
s_nop 0
buffer_load_dwordx4 v88,s[20:23],s48 offen lds
v_mfma_f32_16x16x32_bf16 v[152:155],v[28:31],v[80:83],v[152:155]
v_mfma_f32_16x16x32_bf16 v[156:159],v[28:31],v[84:87],v[156:159]
ds_read_b64_tr_b16 v[28:29],v4 offset:40960
v_mfma_f32_16x16x32_bf16 v[160:163],v[32:35],v[72:75],v[160:163]
ds_read_b64_tr_b16 v[30:31],v4 offset:41984
v_mfma_f32_16x16x32_bf16 v[164:167],v[32:35],v[76:79],v[164:167]
s_add_u32 m0,s54,24576
s_nop 0
buffer_load_dwordx4 v89,s[24:27],s49 offen lds
v_mfma_f32_16x16x32_bf16 v[168:171],v[32:35],v[80:83],v[168:171]
v_mfma_f32_16x16x32_bf16 v[172:175],v[32:35],v[84:87],v[172:175]
ds_read_b64_tr_b16 v[32:33],v5 offset:40960
v_mfma_f32_16x16x32_bf16 v[176:179],v[36:39],v[72:75],v[176:179]
ds_read_b64_tr_b16 v[34:35],v5 offset:41984
v_mfma_f32_16x16x32_bf16 v[180:183],v[36:39],v[76:79],v[180:183]
s_add_u32 m0,s54,28672
s_nop 0
buffer_load_dwordx4 v90,s[24:27],s49 offen lds
v_mfma_f32_16x16x32_bf16 v[184:187],v[36:39],v[80:83],v[184:187]
v_mfma_f32_16x16x32_bf16 v[188:191],v[36:39],v[84:87],v[188:191]
ds_read_b64_tr_b16 v[36:37],v6 offset:40960
v_mfma_f32_16x16x32_bf16 v[192:195],v[40:43],v[72:75],v[192:195]
ds_read_b64_tr_b16 v[38:39],v6 offset:41984
v_mfma_f32_16x16x32_bf16 v[196:199],v[40:43],v[76:79],v[196:199]
s_add_u32 m0,s54,32768
s_nop 0
buffer_load_dwordx4 v91,s[28:31],s49 offen lds
v_mfma_f32_16x16x32_bf16 v[200:203],v[40:43],v[80:83],v[200:203]
v_mfma_f32_16x16x32_bf16 v[204:207],v[40:43],v[84:87],v[204:207]
ds_read_b64_tr_b16 v[40:41],v7 offset:40960
v_mfma_f32_16x16x32_bf16 v[208:211],v[44:47],v[72:75],v[208:211]
ds_read_b64_tr_b16 v[42:43],v7 offset:41984
v_mfma_f32_16x16x32_bf16 v[212:215],v[44:47],v[76:79],v[212:215]
s_add_u32 m0,s54,36864
s_nop 0
buffer_load_dwordx4 v92,s[28:31],s49 offen lds
s_add_u32 s48,s48,196608
s_add_u32 s49,s49,229376
v_mfma_f32_16x16x32_bf16 v[216:219],v[44:47],v[80:83],v[216:219]
v_mfma_f32_16x16x32_bf16 v[220:223],v[44:47],v[84:87],v[220:223]
ds_read_b64_tr_b16 v[44:45],v8 offset:40960
v_mfma_f32_16x16x32_bf16 v[224:227],v[48:51],v[72:75],v[224:227]
ds_read_b64_tr_b16 v[46:47],v8 offset:41984
v_mfma_f32_16x16x32_bf16 v[228:231],v[48:51],v[76:79],v[228:231]
v_mfma_f32_16x16x32_bf16 v[232:235],v[48:51],v[80:83],v[232:235]
v_mfma_f32_16x16x32_bf16 v[236:239],v[48:51],v[84:87],v[236:239]
ds_read_b64_tr_b16 v[48:49],v9 offset:40960
v_mfma_f32_16x16x32_bf16 v[240:243],v[52:55],v[72:75],v[240:243]
ds_read_b64_tr_b16 v[50:51],v9 offset:41984
v_mfma_f32_16x16x32_bf16 v[244:247],v[52:55],v[76:79],v[244:247]
v_mfma_f32_16x16x32_bf16 v[248:251],v[52:55],v[80:83],v[248:251]
v_mfma_f32_16x16x32_bf16 v[252:255],v[52:55],v[84:87],v[252:255]
ds_read_b64_tr_b16 v[52:53],v10 offset:40960
ds_read_b64_tr_b16 v[54:55],v10 offset:41984
s_waitcnt lgkmcnt(15)
v_mfma_f32_16x16x32_bf16 v[96:99],v[56:59],v[16:19],v[96:99]
v_mfma_f32_16x16x32_bf16 v[100:103],v[60:63],v[16:19],v[100:103]
v_mfma_f32_16x16x32_bf16 v[104:107],v[64:67],v[16:19],v[104:107]
v_mfma_f32_16x16x32_bf16 v[108:111],v[68:71],v[16:19],v[108:111]
s_waitcnt vmcnt(10) lgkmcnt(0)
s_barrier
ds_read_b64_tr_b16 v[16:17],v1 offset:61440
v_mfma_f32_16x16x32_bf16 v[112:115],v[56:59],v[20:23],v[112:115]
ds_read_b64_tr_b16 v[18:19],v1 offset:61952
v_mfma_f32_16x16x32_bf16 v[116:119],v[60:63],v[20:23],v[116:119]
ds_read_b128 v[72:75],v94 offset:32768
v_mfma_f32_16x16x32_bf16 v[120:123],v[64:67],v[20:23],v[120:123]
ds_read_b128 v[76:79],v94 offset:34816
v_mfma_f32_16x16x32_bf16 v[124:127],v[68:71],v[20:23],v[124:127]
ds_read_b64_tr_b16 v[20:21],v2 offset:61440
v_mfma_f32_16x16x32_bf16 v[128:131],v[24:27],v[56:59],v[128:131]
ds_read_b64_tr_b16 v[22:23],v2 offset:61952
v_mfma_f32_16x16x32_bf16 v[132:135],v[24:27],v[60:63],v[132:135]
ds_read_b128 v[80:83],v94 offset:36864
v_mfma_f32_16x16x32_bf16 v[136:139],v[24:27],v[64:67],v[136:139]
ds_read_b128 v[84:87],v94 offset:38912
v_mfma_f32_16x16x32_bf16 v[140:143],v[24:27],v[68:71],v[140:143]
ds_read_b64_tr_b16 v[24:25],v3 offset:61440
v_mfma_f32_16x16x32_bf16 v[144:147],v[28:31],v[56:59],v[144:147]
ds_read_b64_tr_b16 v[26:27],v3 offset:62464
v_mfma_f32_16x16x32_bf16 v[148:151],v[28:31],v[60:63],v[148:151]
s_add_u32 m0,s54,40960
s_nop 0
buffer_load_dwordx4 v88,s[20:23],s48 offen lds
v_mfma_f32_16x16x32_bf16 v[152:155],v[28:31],v[64:67],v[152:155]
v_mfma_f32_16x16x32_bf16 v[156:159],v[28:31],v[68:71],v[156:159]
ds_read_b64_tr_b16 v[28:29],v4 offset:61440
v_mfma_f32_16x16x32_bf16 v[160:163],v[32:35],v[56:59],v[160:163]
ds_read_b64_tr_b16 v[30:31],v4 offset:62464
v_mfma_f32_16x16x32_bf16 v[164:167],v[32:35],v[60:63],v[164:167]
s_add_u32 m0,s54,45056
s_nop 0
buffer_load_dwordx4 v89,s[24:27],s49 offen lds
v_mfma_f32_16x16x32_bf16 v[168:171],v[32:35],v[64:67],v[168:171]
v_mfma_f32_16x16x32_bf16 v[172:175],v[32:35],v[68:71],v[172:175]
ds_read_b64_tr_b16 v[32:33],v5 offset:61440
v_mfma_f32_16x16x32_bf16 v[176:179],v[36:39],v[56:59],v[176:179]
ds_read_b64_tr_b16 v[34:35],v5 offset:62464
v_mfma_f32_16x16x32_bf16 v[180:183],v[36:39],v[60:63],v[180:183]
s_add_u32 m0,s54,49152
s_nop 0
buffer_load_dwordx4 v90,s[24:27],s49 offen lds
v_mfma_f32_16x16x32_bf16 v[184:187],v[36:39],v[64:67],v[184:187]
v_mfma_f32_16x16x32_bf16 v[188:191],v[36:39],v[68:71],v[188:191]
ds_read_b64_tr_b16 v[36:37],v6 offset:61440
v_mfma_f32_16x16x32_bf16 v[192:195],v[40:43],v[56:59],v[192:195]
ds_read_b64_tr_b16 v[38:39],v6 offset:62464
v_mfma_f32_16x16x32_bf16 v[196:199],v[40:43],v[60:63],v[196:199]
s_add_u32 m0,s54,53248
s_nop 0
buffer_load_dwordx4 v91,s[28:31],s49 offen lds
v_mfma_f32_16x16x32_bf16 v[200:203],v[40:43],v[64:67],v[200:203]
v_mfma_f32_16x16x32_bf16 v[204:207],v[40:43],v[68:71],v[204:207]
ds_read_b64_tr_b16 v[40:41],v7 offset:61440
v_mfma_f32_16x16x32_bf16 v[208:211],v[44:47],v[56:59],v[208:211]
ds_read_b64_tr_b16 v[42:43],v7 offset:62464
v_mfma_f32_16x16x32_bf16 v[212:215],v[44:47],v[60:63],v[212:215]
s_add_u32 m0,s54,57344
s_nop 0
buffer_load_dwordx4 v92,s[28:31],s49 offen lds
s_add_u32 s48,s48,196608
s_add_u32 s49,s49,229376
v_mfma_f32_16x16x32_bf16 v[216:219],v[44:47],v[64:67],v[216:219]
v_mfma_f32_16x16x32_bf16 v[220:223],v[44:47],v[68:71],v[220:223]
ds_read_b64_tr_b16 v[44:45],v8 offset:61440
v_mfma_f32_16x16x32_bf16 v[224:227],v[48:51],v[56:59],v[224:227]
ds_read_b64_tr_b16 v[46:47],v8 offset:62464
v_mfma_f32_16x16x32_bf16 v[228:231],v[48:51],v[60:63],v[228:231]
v_mfma_f32_16x16x32_bf16 v[232:235],v[48:51],v[64:67],v[232:235]
v_mfma_f32_16x16x32_bf16 v[236:239],v[48:51],v[68:71],v[236:239]
ds_read_b64_tr_b16 v[48:49],v9 offset:61440
v_mfma_f32_16x16x32_bf16 v[240:243],v[52:55],v[56:59],v[240:243]
ds_read_b64_tr_b16 v[50:51],v9 offset:62464
v_mfma_f32_16x16x32_bf16 v[244:247],v[52:55],v[60:63],v[244:247]
v_mfma_f32_16x16x32_bf16 v[248:251],v[52:55],v[64:67],v[248:251]
v_mfma_f32_16x16x32_bf16 v[252:255],v[52:55],v[68:71],v[252:255]
ds_read_b64_tr_b16 v[52:53],v10 offset:61440
ds_read_b64_tr_b16 v[54:55],v10 offset:62464
s_waitcnt lgkmcnt(15)
v_mfma_f32_16x16x32_bf16 v[96:99],v[72:75],v[16:19],v[96:99]
v_mfma_f32_16x16x32_bf16 v[100:103],v[76:79],v[16:19],v[100:103]
v_mfma_f32_16x16x32_bf16 v[104:107],v[80:83],v[16:19],v[104:107]
v_mfma_f32_16x16x32_bf16 v[108:111],v[84:87],v[16:19],v[108:111]
s_waitcnt vmcnt(10) lgkmcnt(0)
s_barrier
ds_read_b64_tr_b16 v[16:17],v1 offset:0
v_mfma_f32_16x16x32_bf16 v[112:115],v[72:75],v[20:23],v[112:115]
ds_read_b64_tr_b16 v[18:19],v1 offset:512
v_mfma_f32_16x16x32_bf16 v[116:119],v[76:79],v[20:23],v[116:119]
ds_read_b128 v[56:59],v11 offset:0
v_mfma_f32_16x16x32_bf16 v[120:123],v[80:83],v[20:23],v[120:123]
ds_read_b128 v[60:63],v11 offset:2048
v_mfma_f32_16x16x32_bf16 v[124:127],v[84:87],v[20:23],v[124:127]
ds_read_b64_tr_b16 v[20:21],v2 offset:0
v_mfma_f32_16x16x32_bf16 v[128:131],v[24:27],v[72:75],v[128:131]
ds_read_b64_tr_b16 v[22:23],v2 offset:512
v_mfma_f32_16x16x32_bf16 v[132:135],v[24:27],v[76:79],v[132:135]
ds_read_b128 v[64:67],v11 offset:4096
v_mfma_f32_16x16x32_bf16 v[136:139],v[24:27],v[80:83],v[136:139]
ds_read_b128 v[68:71],v11 offset:6144
v_mfma_f32_16x16x32_bf16 v[140:143],v[24:27],v[84:87],v[140:143]
ds_read_b64_tr_b16 v[24:25],v3 offset:0
v_mfma_f32_16x16x32_bf16 v[144:147],v[28:31],v[72:75],v[144:147]
ds_read_b64_tr_b16 v[26:27],v3 offset:1024
v_mfma_f32_16x16x32_bf16 v[148:151],v[28:31],v[76:79],v[148:151]
s_add_u32 m0,s54,61440
s_nop 0
buffer_load_dwordx4 v88,s[20:23],s48 offen lds
v_mfma_f32_16x16x32_bf16 v[152:155],v[28:31],v[80:83],v[152:155]
v_mfma_f32_16x16x32_bf16 v[156:159],v[28:31],v[84:87],v[156:159]
ds_read_b64_tr_b16 v[28:29],v4 offset:0
v_mfma_f32_16x16x32_bf16 v[160:163],v[32:35],v[72:75],v[160:163]
ds_read_b64_tr_b16 v[30:31],v4 offset:1024
v_mfma_f32_16x16x32_bf16 v[164:167],v[32:35],v[76:79],v[164:167]
s_add_u32 m0,s54,65536
s_nop 0
buffer_load_dwordx4 v89,s[24:27],s49 offen lds
v_mfma_f32_16x16x32_bf16 v[168:171],v[32:35],v[80:83],v[168:171]
v_mfma_f32_16x16x32_bf16 v[172:175],v[32:35],v[84:87],v[172:175]
ds_read_b64_tr_b16 v[32:33],v5 offset:0
v_mfma_f32_16x16x32_bf16 v[176:179],v[36:39],v[72:75],v[176:179]
ds_read_b64_tr_b16 v[34:35],v5 offset:1024
v_mfma_f32_16x16x32_bf16 v[180:183],v[36:39],v[76:79],v[180:183]
s_add_u32 m0,s54,69632
s_nop 0
buffer_load_dwordx4 v90,s[24:27],s49 offen lds
v_mfma_f32_16x16x32_bf16 v[184:187],v[36:39],v[80:83],v[184:187]
v_mfma_f32_16x16x32_bf16 v[188:191],v[36:39],v[84:87],v[188:191]
ds_read_b64_tr_b16 v[36:37],v6 offset:0
v_mfma_f32_16x16x32_bf16 v[192:195],v[40:43],v[72:75],v[192:195]
ds_read_b64_tr_b16 v[38:39],v6 offset:1024
v_mfma_f32_16x16x32_bf16 v[196:199],v[40:43],v[76:79],v[196:199]
s_add_u32 m0,s54,73728
s_nop 0
buffer_load_dwordx4 v91,s[28:31],s49 offen lds
v_mfma_f32_16x16x32_bf16 v[200:203],v[40:43],v[80:83],v[200:203]
v_mfma_f32_16x16x32_bf16 v[204:207],v[40:43],v[84:87],v[204:207]
ds_read_b64_tr_b16 v[40:41],v7 offset:0
v_mfma_f32_16x16x32_bf16 v[208:211],v[44:47],v[72:75],v[208:211]
ds_read_b64_tr_b16 v[42:43],v7 offset:1024
v_mfma_f32_16x16x32_bf16 v[212:215],v[44:47],v[76:79],v[212:215]
s_add_u32 m0,s54,77824
s_nop 0
buffer_load_dwordx4 v92,s[28:31],s49 offen lds
s_and_b32 s50,s64,7
s_lshr_b32 s64,s64,4
s_mul_i32 s48,s50,786432
s_add_u32 s48,s48,s65
s_mul_i32 s49,s50,917504
s_add_u32 s49,s49,s66
v_mfma_f32_16x16x32_bf16 v[216:219],v[44:47],v[80:83],v[216:219]
v_mfma_f32_16x16x32_bf16 v[220:223],v[44:47],v[84:87],v[220:223]
ds_read_b64_tr_b16 v[44:45],v8 offset:0
v_mfma_f32_16x16x32_bf16 v[224:227],v[48:51],v[72:75],v[224:227]
ds_read_b64_tr_b16 v[46:47],v8 offset:1024
v_mfma_f32_16x16x32_bf16 v[228:231],v[48:51],v[76:79],v[228:231]
v_mfma_f32_16x16x32_bf16 v[232:235],v[48:51],v[80:83],v[232:235]
v_mfma_f32_16x16x32_bf16 v[236:239],v[48:51],v[84:87],v[236:239]
ds_read_b64_tr_b16 v[48:49],v9 offset:0
v_mfma_f32_16x16x32_bf16 v[240:243],v[52:55],v[72:75],v[240:243]
ds_read_b64_tr_b16 v[50:51],v9 offset:1024
v_mfma_f32_16x16x32_bf16 v[244:247],v[52:55],v[76:79],v[244:247]
v_mfma_f32_16x16x32_bf16 v[248:251],v[52:55],v[80:83],v[248:251]
v_mfma_f32_16x16x32_bf16 v[252:255],v[52:55],v[84:87],v[252:255]
ds_read_b64_tr_b16 v[52:53],v10 offset:0
ds_read_b64_tr_b16 v[54:55],v10 offset:1024
s_mov_b32 s53,6
.p2align 6
g2_loop0:
s_cmp_eq_u32 s53,s67
s_cbranch_scc1 g2_sp0
s_waitcnt lgkmcnt(15)
v_mfma_f32_16x16x32_bf16 v[96:99],v[56:59],v[16:19],v[96:99]
v_mfma_f32_16x16x32_bf16 v[100:103],v[60:63],v[16:19],v[100:103]
v_mfma_f32_16x16x32_bf16 v[104:107],v[64:67],v[16:19],v[104:107]
v_mfma_f32_16x16x32_bf16 v[108:111],v[68:71],v[16:19],v[108:111]
s_waitcnt vmcnt(10) lgkmcnt(0)
s_barrier
s_cmp_eq_u32 s53,s96
s_cbranch_scc1 g2_pub0
g2_pubr0:
ds_read_b64_tr_b16 v[16:17],v1 offset:20480
v_mfma_f32_16x16x32_bf16 v[112:115],v[56:59],v[20:23],v[112:115]
ds_read_b64_tr_b16 v[18:19],v1 offset:20992
v_mfma_f32_16x16x32_bf16 v[116:119],v[60:63],v[20:23],v[116:119]
ds_read_b128 v[72:75],v94 offset:0
v_mfma_f32_16x16x32_bf16 v[120:123],v[64:67],v[20:23],v[120:123]
ds_read_b128 v[76:79],v94 offset:2048
v_mfma_f32_16x16x32_bf16 v[124:127],v[68:71],v[20:23],v[124:127]
ds_read_b64_tr_b16 v[20:21],v2 offset:20480
v_mfma_f32_16x16x32_bf16 v[128:131],v[24:27],v[56:59],v[128:131]
ds_read_b64_tr_b16 v[22:23],v2 offset:20992
v_mfma_f32_16x16x32_bf16 v[132:135],v[24:27],v[60:63],v[132:135]
ds_read_b128 v[80:83],v94 offset:4096
v_mfma_f32_16x16x32_bf16 v[136:139],v[24:27],v[64:67],v[136:139]
ds_read_b128 v[84:87],v94 offset:6144
v_mfma_f32_16x16x32_bf16 v[140:143],v[24:27],v[68:71],v[140:143]
ds_read_b64_tr_b16 v[24:25],v3 offset:20480
v_mfma_f32_16x16x32_bf16 v[144:147],v[28:31],v[56:59],v[144:147]
ds_read_b64_tr_b16 v[26:27],v3 offset:21504
v_mfma_f32_16x16x32_bf16 v[148:151],v[28:31],v[60:63],v[148:151]
s_add_u32 m0,s54,0
s_nop 0
buffer_load_dwordx4 v88,s[20:23],s48 offen lds
v_mfma_f32_16x16x32_bf16 v[152:155],v[28:31],v[64:67],v[152:155]
v_mfma_f32_16x16x32_bf16 v[156:159],v[28:31],v[68:71],v[156:159]
ds_read_b64_tr_b16 v[28:29],v4 offset:20480
v_mfma_f32_16x16x32_bf16 v[160:163],v[32:35],v[56:59],v[160:163]
ds_read_b64_tr_b16 v[30:31],v4 offset:21504
v_mfma_f32_16x16x32_bf16 v[164:167],v[32:35],v[60:63],v[164:167]
s_add_u32 m0,s54,4096
s_nop 0
buffer_load_dwordx4 v89,s[24:27],s49 offen lds
v_mfma_f32_16x16x32_bf16 v[168:171],v[32:35],v[64:67],v[168:171]
v_mfma_f32_16x16x32_bf16 v[172:175],v[32:35],v[68:71],v[172:175]
ds_read_b64_tr_b16 v[32:33],v5 offset:20480
v_mfma_f32_16x16x32_bf16 v[176:179],v[36:39],v[56:59],v[176:179]
ds_read_b64_tr_b16 v[34:35],v5 offset:21504
v_mfma_f32_16x16x32_bf16 v[180:183],v[36:39],v[60:63],v[180:183]
s_add_u32 m0,s54,8192
s_nop 0
buffer_load_dwordx4 v90,s[24:27],s49 offen lds
v_mfma_f32_16x16x32_bf16 v[184:187],v[36:39],v[64:67],v[184:187]
v_mfma_f32_16x16x32_bf16 v[188:191],v[36:39],v[68:71],v[188:191]
ds_read_b64_tr_b16 v[36:37],v6 offset:20480
v_mfma_f32_16x16x32_bf16 v[192:195],v[40:43],v[56:59],v[192:195]
ds_read_b64_tr_b16 v[38:39],v6 offset:21504
v_mfma_f32_16x16x32_bf16 v[196:199],v[40:43],v[60:63],v[196:199]
s_add_u32 m0,s54,12288
s_nop 0
buffer_load_dwordx4 v91,s[28:31],s49 offen lds
v_mfma_f32_16x16x32_bf16 v[200:203],v[40:43],v[64:67],v[200:203]
v_mfma_f32_16x16x32_bf16 v[204:207],v[40:43],v[68:71],v[204:207]
ds_read_b64_tr_b16 v[40:41],v7 offset:20480
v_mfma_f32_16x16x32_bf16 v[208:211],v[44:47],v[56:59],v[208:211]
ds_read_b64_tr_b16 v[42:43],v7 offset:21504
v_mfma_f32_16x16x32_bf16 v[212:215],v[44:47],v[60:63],v[212:215]
s_add_u32 m0,s54,16384
s_nop 0
buffer_load_dwordx4 v92,s[28:31],s49 offen lds
s_add_u32 s48,s48,196608
s_add_u32 s49,s49,229376
v_mfma_f32_16x16x32_bf16 v[216:219],v[44:47],v[64:67],v[216:219]
v_mfma_f32_16x16x32_bf16 v[220:223],v[44:47],v[68:71],v[220:223]
ds_read_b64_tr_b16 v[44:45],v8 offset:20480
v_mfma_f32_16x16x32_bf16 v[224:227],v[48:51],v[56:59],v[224:227]
ds_read_b64_tr_b16 v[46:47],v8 offset:21504
v_mfma_f32_16x16x32_bf16 v[228:231],v[48:51],v[60:63],v[228:231]
v_mfma_f32_16x16x32_bf16 v[232:235],v[48:51],v[64:67],v[232:235]
v_mfma_f32_16x16x32_bf16 v[236:239],v[48:51],v[68:71],v[236:239]
ds_read_b64_tr_b16 v[48:49],v9 offset:20480
v_mfma_f32_16x16x32_bf16 v[240:243],v[52:55],v[56:59],v[240:243]
ds_read_b64_tr_b16 v[50:51],v9 offset:21504
v_mfma_f32_16x16x32_bf16 v[244:247],v[52:55],v[60:63],v[244:247]
v_mfma_f32_16x16x32_bf16 v[248:251],v[52:55],v[64:67],v[248:251]
v_mfma_f32_16x16x32_bf16 v[252:255],v[52:55],v[68:71],v[252:255]
ds_read_b64_tr_b16 v[52:53],v10 offset:20480
ds_read_b64_tr_b16 v[54:55],v10 offset:21504
s_waitcnt lgkmcnt(15)
v_mfma_f32_16x16x32_bf16 v[96:99],v[72:75],v[16:19],v[96:99]
v_mfma_f32_16x16x32_bf16 v[100:103],v[76:79],v[16:19],v[100:103]
v_mfma_f32_16x16x32_bf16 v[104:107],v[80:83],v[16:19],v[104:107]
v_mfma_f32_16x16x32_bf16 v[108:111],v[84:87],v[16:19],v[108:111]
s_waitcnt vmcnt(10) lgkmcnt(0)
s_barrier
ds_read_b64_tr_b16 v[16:17],v1 offset:40960
v_mfma_f32_16x16x32_bf16 v[112:115],v[72:75],v[20:23],v[112:115]
ds_read_b64_tr_b16 v[18:19],v1 offset:41472
v_mfma_f32_16x16x32_bf16 v[116:119],v[76:79],v[20:23],v[116:119]
ds_read_b128 v[56:59],v11 offset:32768
v_mfma_f32_16x16x32_bf16 v[120:123],v[80:83],v[20:23],v[120:123]
ds_read_b128 v[60:63],v11 offset:34816
v_mfma_f32_16x16x32_bf16 v[124:127],v[84:87],v[20:23],v[124:127]
ds_read_b64_tr_b16 v[20:21],v2 offset:40960
v_mfma_f32_16x16x32_bf16 v[128:131],v[24:27],v[72:75],v[128:131]
ds_read_b64_tr_b16 v[22:23],v2 offset:41472
v_mfma_f32_16x16x32_bf16 v[132:135],v[24:27],v[76:79],v[132:135]
ds_read_b128 v[64:67],v11 offset:36864
v_mfma_f32_16x16x32_bf16 v[136:139],v[24:27],v[80:83],v[136:139]
ds_read_b128 v[68:71],v11 offset:38912
v_mfma_f32_16x16x32_bf16 v[140:143],v[24:27],v[84:87],v[140:143]
ds_read_b64_tr_b16 v[24:25],v3 offset:40960
v_mfma_f32_16x16x32_bf16 v[144:147],v[28:31],v[72:75],v[144:147]
ds_read_b64_tr_b16 v[26:27],v3 offset:41984
v_mfma_f32_16x16x32_bf16 v[148:151],v[28:31],v[76:79],v[148:151]
s_add_u32 m0,s54,20480
s_nop 0
buffer_load_dwordx4 v88,s[20:23],s48 offen lds
v_mfma_f32_16x16x32_bf16 v[152:155],v[28:31],v[80:83],v[152:155]
v_mfma_f32_16x16x32_bf16 v[156:159],v[28:31],v[84:87],v[156:159]
ds_read_b64_tr_b16 v[28:29],v4 offset:40960
v_mfma_f32_16x16x32_bf16 v[160:163],v[32:35],v[72:75],v[160:163]
ds_read_b64_tr_b16 v[30:31],v4 offset:41984
v_mfma_f32_16x16x32_bf16 v[164:167],v[32:35],v[76:79],v[164:167]
s_add_u32 m0,s54,24576
s_nop 0
buffer_load_dwordx4 v89,s[24:27],s49 offen lds
v_mfma_f32_16x16x32_bf16 v[168:171],v[32:35],v[80:83],v[168:171]
v_mfma_f32_16x16x32_bf16 v[172:175],v[32:35],v[84:87],v[172:175]
ds_read_b64_tr_b16 v[32:33],v5 offset:40960
v_mfma_f32_16x16x32_bf16 v[176:179],v[36:39],v[72:75],v[176:179]
ds_read_b64_tr_b16 v[34:35],v5 offset:41984
v_mfma_f32_16x16x32_bf16 v[180:183],v[36:39],v[76:79],v[180:183]
s_add_u32 m0,s54,28672
s_nop 0
buffer_load_dwordx4 v90,s[24:27],s49 offen lds
v_mfma_f32_16x16x32_bf16 v[184:187],v[36:39],v[80:83],v[184:187]
v_mfma_f32_16x16x32_bf16 v[188:191],v[36:39],v[84:87],v[188:191]
ds_read_b64_tr_b16 v[36:37],v6 offset:40960
v_mfma_f32_16x16x32_bf16 v[192:195],v[40:43],v[72:75],v[192:195]
ds_read_b64_tr_b16 v[38:39],v6 offset:41984
v_mfma_f32_16x16x32_bf16 v[196:199],v[40:43],v[76:79],v[196:199]
s_add_u32 m0,s54,32768
s_nop 0
buffer_load_dwordx4 v91,s[28:31],s49 offen lds
v_mfma_f32_16x16x32_bf16 v[200:203],v[40:43],v[80:83],v[200:203]
v_mfma_f32_16x16x32_bf16 v[204:207],v[40:43],v[84:87],v[204:207]
ds_read_b64_tr_b16 v[40:41],v7 offset:40960
v_mfma_f32_16x16x32_bf16 v[208:211],v[44:47],v[72:75],v[208:211]
ds_read_b64_tr_b16 v[42:43],v7 offset:41984
v_mfma_f32_16x16x32_bf16 v[212:215],v[44:47],v[76:79],v[212:215]
s_add_u32 m0,s54,36864
s_nop 0
buffer_load_dwordx4 v92,s[28:31],s49 offen lds
s_add_u32 s48,s48,196608
s_add_u32 s49,s49,229376
v_mfma_f32_16x16x32_bf16 v[216:219],v[44:47],v[80:83],v[216:219]
v_mfma_f32_16x16x32_bf16 v[220:223],v[44:47],v[84:87],v[220:223]
ds_read_b64_tr_b16 v[44:45],v8 offset:40960
v_mfma_f32_16x16x32_bf16 v[224:227],v[48:51],v[72:75],v[224:227]
ds_read_b64_tr_b16 v[46:47],v8 offset:41984
v_mfma_f32_16x16x32_bf16 v[228:231],v[48:51],v[76:79],v[228:231]
v_mfma_f32_16x16x32_bf16 v[232:235],v[48:51],v[80:83],v[232:235]
v_mfma_f32_16x16x32_bf16 v[236:239],v[48:51],v[84:87],v[236:239]
ds_read_b64_tr_b16 v[48:49],v9 offset:40960
v_mfma_f32_16x16x32_bf16 v[240:243],v[52:55],v[72:75],v[240:243]
ds_read_b64_tr_b16 v[50:51],v9 offset:41984
v_mfma_f32_16x16x32_bf16 v[244:247],v[52:55],v[76:79],v[244:247]
v_mfma_f32_16x16x32_bf16 v[248:251],v[52:55],v[80:83],v[248:251]
v_mfma_f32_16x16x32_bf16 v[252:255],v[52:55],v[84:87],v[252:255]
ds_read_b64_tr_b16 v[52:53],v10 offset:40960
ds_read_b64_tr_b16 v[54:55],v10 offset:41984
s_waitcnt lgkmcnt(15)
v_mfma_f32_16x16x32_bf16 v[96:99],v[56:59],v[16:19],v[96:99]
v_mfma_f32_16x16x32_bf16 v[100:103],v[60:63],v[16:19],v[100:103]
v_mfma_f32_16x16x32_bf16 v[104:107],v[64:67],v[16:19],v[104:107]
v_mfma_f32_16x16x32_bf16 v[108:111],v[68:71],v[16:19],v[108:111]
s_waitcnt vmcnt(10) lgkmcnt(0)
s_barrier
ds_read_b64_tr_b16 v[16:17],v1 offset:61440
v_mfma_f32_16x16x32_bf16 v[112:115],v[56:59],v[20:23],v[112:115]
ds_read_b64_tr_b16 v[18:19],v1 offset:61952
v_mfma_f32_16x16x32_bf16 v[116:119],v[60:63],v[20:23],v[116:119]
ds_read_b128 v[72:75],v94 offset:32768
v_mfma_f32_16x16x32_bf16 v[120:123],v[64:67],v[20:23],v[120:123]
ds_read_b128 v[76:79],v94 offset:34816
v_mfma_f32_16x16x32_bf16 v[124:127],v[68:71],v[20:23],v[124:127]
ds_read_b64_tr_b16 v[20:21],v2 offset:61440
v_mfma_f32_16x16x32_bf16 v[128:131],v[24:27],v[56:59],v[128:131]
ds_read_b64_tr_b16 v[22:23],v2 offset:61952
v_mfma_f32_16x16x32_bf16 v[132:135],v[24:27],v[60:63],v[132:135]
ds_read_b128 v[80:83],v94 offset:36864
v_mfma_f32_16x16x32_bf16 v[136:139],v[24:27],v[64:67],v[136:139]
ds_read_b128 v[84:87],v94 offset:38912
v_mfma_f32_16x16x32_bf16 v[140:143],v[24:27],v[68:71],v[140:143]
ds_read_b64_tr_b16 v[24:25],v3 offset:61440
v_mfma_f32_16x16x32_bf16 v[144:147],v[28:31],v[56:59],v[144:147]
ds_read_b64_tr_b16 v[26:27],v3 offset:62464
v_mfma_f32_16x16x32_bf16 v[148:151],v[28:31],v[60:63],v[148:151]
s_add_u32 m0,s54,40960
s_nop 0
buffer_load_dwordx4 v88,s[20:23],s48 offen lds
v_mfma_f32_16x16x32_bf16 v[152:155],v[28:31],v[64:67],v[152:155]
v_mfma_f32_16x16x32_bf16 v[156:159],v[28:31],v[68:71],v[156:159]
ds_read_b64_tr_b16 v[28:29],v4 offset:61440
v_mfma_f32_16x16x32_bf16 v[160:163],v[32:35],v[56:59],v[160:163]
ds_read_b64_tr_b16 v[30:31],v4 offset:62464
v_mfma_f32_16x16x32_bf16 v[164:167],v[32:35],v[60:63],v[164:167]
s_add_u32 m0,s54,45056
s_nop 0
buffer_load_dwordx4 v89,s[24:27],s49 offen lds
v_mfma_f32_16x16x32_bf16 v[168:171],v[32:35],v[64:67],v[168:171]
v_mfma_f32_16x16x32_bf16 v[172:175],v[32:35],v[68:71],v[172:175]
ds_read_b64_tr_b16 v[32:33],v5 offset:61440
v_mfma_f32_16x16x32_bf16 v[176:179],v[36:39],v[56:59],v[176:179]
ds_read_b64_tr_b16 v[34:35],v5 offset:62464
v_mfma_f32_16x16x32_bf16 v[180:183],v[36:39],v[60:63],v[180:183]
s_add_u32 m0,s54,49152
s_nop 0
buffer_load_dwordx4 v90,s[24:27],s49 offen lds
v_mfma_f32_16x16x32_bf16 v[184:187],v[36:39],v[64:67],v[184:187]
v_mfma_f32_16x16x32_bf16 v[188:191],v[36:39],v[68:71],v[188:191]
ds_read_b64_tr_b16 v[36:37],v6 offset:61440
v_mfma_f32_16x16x32_bf16 v[192:195],v[40:43],v[56:59],v[192:195]
ds_read_b64_tr_b16 v[38:39],v6 offset:62464
v_mfma_f32_16x16x32_bf16 v[196:199],v[40:43],v[60:63],v[196:199]
s_add_u32 m0,s54,53248
s_nop 0
buffer_load_dwordx4 v91,s[28:31],s49 offen lds
v_mfma_f32_16x16x32_bf16 v[200:203],v[40:43],v[64:67],v[200:203]
v_mfma_f32_16x16x32_bf16 v[204:207],v[40:43],v[68:71],v[204:207]
ds_read_b64_tr_b16 v[40:41],v7 offset:61440
v_mfma_f32_16x16x32_bf16 v[208:211],v[44:47],v[56:59],v[208:211]
ds_read_b64_tr_b16 v[42:43],v7 offset:62464
v_mfma_f32_16x16x32_bf16 v[212:215],v[44:47],v[60:63],v[212:215]
s_add_u32 m0,s54,57344
s_nop 0
buffer_load_dwordx4 v92,s[28:31],s49 offen lds
s_add_u32 s48,s48,196608
s_add_u32 s49,s49,229376
v_mfma_f32_16x16x32_bf16 v[216:219],v[44:47],v[64:67],v[216:219]
v_mfma_f32_16x16x32_bf16 v[220:223],v[44:47],v[68:71],v[220:223]
ds_read_b64_tr_b16 v[44:45],v8 offset:61440
v_mfma_f32_16x16x32_bf16 v[224:227],v[48:51],v[56:59],v[224:227]
ds_read_b64_tr_b16 v[46:47],v8 offset:62464
v_mfma_f32_16x16x32_bf16 v[228:231],v[48:51],v[60:63],v[228:231]
v_mfma_f32_16x16x32_bf16 v[232:235],v[48:51],v[64:67],v[232:235]
v_mfma_f32_16x16x32_bf16 v[236:239],v[48:51],v[68:71],v[236:239]
ds_read_b64_tr_b16 v[48:49],v9 offset:61440
v_mfma_f32_16x16x32_bf16 v[240:243],v[52:55],v[56:59],v[240:243]
ds_read_b64_tr_b16 v[50:51],v9 offset:62464
v_mfma_f32_16x16x32_bf16 v[244:247],v[52:55],v[60:63],v[244:247]
v_mfma_f32_16x16x32_bf16 v[248:251],v[52:55],v[64:67],v[248:251]
v_mfma_f32_16x16x32_bf16 v[252:255],v[52:55],v[68:71],v[252:255]
ds_read_b64_tr_b16 v[52:53],v10 offset:61440
ds_read_b64_tr_b16 v[54:55],v10 offset:62464
s_waitcnt lgkmcnt(15)
v_mfma_f32_16x16x32_bf16 v[96:99],v[72:75],v[16:19],v[96:99]
v_mfma_f32_16x16x32_bf16 v[100:103],v[76:79],v[16:19],v[100:103]
v_mfma_f32_16x16x32_bf16 v[104:107],v[80:83],v[16:19],v[104:107]
v_mfma_f32_16x16x32_bf16 v[108:111],v[84:87],v[16:19],v[108:111]
s_waitcnt vmcnt(10) lgkmcnt(0)
s_barrier
s_cmp_eq_u32 s53,s97
s_cbranch_scc1 g2_sig0
g2_sigr0:
ds_read_b64_tr_b16 v[16:17],v1 offset:0
v_mfma_f32_16x16x32_bf16 v[112:115],v[72:75],v[20:23],v[112:115]
ds_read_b64_tr_b16 v[18:19],v1 offset:512
v_mfma_f32_16x16x32_bf16 v[116:119],v[76:79],v[20:23],v[116:119]
ds_read_b128 v[56:59],v11 offset:0
v_mfma_f32_16x16x32_bf16 v[120:123],v[80:83],v[20:23],v[120:123]
ds_read_b128 v[60:63],v11 offset:2048
v_mfma_f32_16x16x32_bf16 v[124:127],v[84:87],v[20:23],v[124:127]
ds_read_b64_tr_b16 v[20:21],v2 offset:0
v_mfma_f32_16x16x32_bf16 v[128:131],v[24:27],v[72:75],v[128:131]
ds_read_b64_tr_b16 v[22:23],v2 offset:512
v_mfma_f32_16x16x32_bf16 v[132:135],v[24:27],v[76:79],v[132:135]
ds_read_b128 v[64:67],v11 offset:4096
v_mfma_f32_16x16x32_bf16 v[136:139],v[24:27],v[80:83],v[136:139]
ds_read_b128 v[68:71],v11 offset:6144
v_mfma_f32_16x16x32_bf16 v[140:143],v[24:27],v[84:87],v[140:143]
ds_read_b64_tr_b16 v[24:25],v3 offset:0
v_mfma_f32_16x16x32_bf16 v[144:147],v[28:31],v[72:75],v[144:147]
ds_read_b64_tr_b16 v[26:27],v3 offset:1024
v_mfma_f32_16x16x32_bf16 v[148:151],v[28:31],v[76:79],v[148:151]
s_add_u32 m0,s54,61440
s_nop 0
buffer_load_dwordx4 v88,s[20:23],s48 offen lds
v_mfma_f32_16x16x32_bf16 v[152:155],v[28:31],v[80:83],v[152:155]
v_mfma_f32_16x16x32_bf16 v[156:159],v[28:31],v[84:87],v[156:159]
ds_read_b64_tr_b16 v[28:29],v4 offset:0
v_mfma_f32_16x16x32_bf16 v[160:163],v[32:35],v[72:75],v[160:163]
ds_read_b64_tr_b16 v[30:31],v4 offset:1024
v_mfma_f32_16x16x32_bf16 v[164:167],v[32:35],v[76:79],v[164:167]
s_add_u32 m0,s54,65536
s_nop 0
buffer_load_dwordx4 v89,s[24:27],s49 offen lds
v_mfma_f32_16x16x32_bf16 v[168:171],v[32:35],v[80:83],v[168:171]
v_mfma_f32_16x16x32_bf16 v[172:175],v[32:35],v[84:87],v[172:175]
ds_read_b64_tr_b16 v[32:33],v5 offset:0
v_mfma_f32_16x16x32_bf16 v[176:179],v[36:39],v[72:75],v[176:179]
ds_read_b64_tr_b16 v[34:35],v5 offset:1024
v_mfma_f32_16x16x32_bf16 v[180:183],v[36:39],v[76:79],v[180:183]
s_add_u32 m0,s54,69632
s_nop 0
buffer_load_dwordx4 v90,s[24:27],s49 offen lds
v_mfma_f32_16x16x32_bf16 v[184:187],v[36:39],v[80:83],v[184:187]
v_mfma_f32_16x16x32_bf16 v[188:191],v[36:39],v[84:87],v[188:191]
ds_read_b64_tr_b16 v[36:37],v6 offset:0
v_mfma_f32_16x16x32_bf16 v[192:195],v[40:43],v[72:75],v[192:195]
ds_read_b64_tr_b16 v[38:39],v6 offset:1024
v_mfma_f32_16x16x32_bf16 v[196:199],v[40:43],v[76:79],v[196:199]
s_add_u32 m0,s54,73728
s_nop 0
buffer_load_dwordx4 v91,s[28:31],s49 offen lds
v_mfma_f32_16x16x32_bf16 v[200:203],v[40:43],v[80:83],v[200:203]
v_mfma_f32_16x16x32_bf16 v[204:207],v[40:43],v[84:87],v[204:207]
ds_read_b64_tr_b16 v[40:41],v7 offset:0
v_mfma_f32_16x16x32_bf16 v[208:211],v[44:47],v[72:75],v[208:211]
ds_read_b64_tr_b16 v[42:43],v7 offset:1024
v_mfma_f32_16x16x32_bf16 v[212:215],v[44:47],v[76:79],v[212:215]
s_add_u32 m0,s54,77824
s_nop 0
buffer_load_dwordx4 v92,s[28:31],s49 offen lds
s_and_b32 s50,s64,7
s_lshr_b32 s64,s64,4
s_mul_i32 s48,s50,786432
s_add_u32 s48,s48,s65
s_mul_i32 s49,s50,917504
s_add_u32 s49,s49,s66
v_mfma_f32_16x16x32_bf16 v[216:219],v[44:47],v[80:83],v[216:219]
v_mfma_f32_16x16x32_bf16 v[220:223],v[44:47],v[84:87],v[220:223]
ds_read_b64_tr_b16 v[44:45],v8 offset:0
v_mfma_f32_16x16x32_bf16 v[224:227],v[48:51],v[72:75],v[224:227]
ds_read_b64_tr_b16 v[46:47],v8 offset:1024
v_mfma_f32_16x16x32_bf16 v[228:231],v[48:51],v[76:79],v[228:231]
v_mfma_f32_16x16x32_bf16 v[232:235],v[48:51],v[80:83],v[232:235]
v_mfma_f32_16x16x32_bf16 v[236:239],v[48:51],v[84:87],v[236:239]
ds_read_b64_tr_b16 v[48:49],v9 offset:0
v_mfma_f32_16x16x32_bf16 v[240:243],v[52:55],v[72:75],v[240:243]
ds_read_b64_tr_b16 v[50:51],v9 offset:1024
v_mfma_f32_16x16x32_bf16 v[244:247],v[52:55],v[76:79],v[244:247]
v_mfma_f32_16x16x32_bf16 v[248:251],v[52:55],v[80:83],v[248:251]
v_mfma_f32_16x16x32_bf16 v[252:255],v[52:55],v[84:87],v[252:255]
ds_read_b64_tr_b16 v[52:53],v10 offset:0
ds_read_b64_tr_b16 v[54:55],v10 offset:1024
s_sub_u32 s53,s53,1
s_cmp_lg_u32 s53,0
s_cbranch_scc1 g2_loop0
s_waitcnt lgkmcnt(15)
v_mfma_f32_16x16x32_bf16 v[96:99],v[56:59],v[16:19],v[96:99]
v_mfma_f32_16x16x32_bf16 v[100:103],v[60:63],v[16:19],v[100:103]
v_mfma_f32_16x16x32_bf16 v[104:107],v[64:67],v[16:19],v[104:107]
v_mfma_f32_16x16x32_bf16 v[108:111],v[68:71],v[16:19],v[108:111]
s_waitcnt vmcnt(10) lgkmcnt(0)
s_barrier
ds_read_b64_tr_b16 v[16:17],v1 offset:20480
v_mfma_f32_16x16x32_bf16 v[112:115],v[56:59],v[20:23],v[112:115]
ds_read_b64_tr_b16 v[18:19],v1 offset:20992
v_mfma_f32_16x16x32_bf16 v[116:119],v[60:63],v[20:23],v[116:119]
ds_read_b128 v[72:75],v94 offset:0
v_mfma_f32_16x16x32_bf16 v[120:123],v[64:67],v[20:23],v[120:123]
ds_read_b128 v[76:79],v94 offset:2048
v_mfma_f32_16x16x32_bf16 v[124:127],v[68:71],v[20:23],v[124:127]
ds_read_b64_tr_b16 v[20:21],v2 offset:20480
v_mfma_f32_16x16x32_bf16 v[128:131],v[24:27],v[56:59],v[128:131]
ds_read_b64_tr_b16 v[22:23],v2 offset:20992
v_mfma_f32_16x16x32_bf16 v[132:135],v[24:27],v[60:63],v[132:135]
ds_read_b128 v[80:83],v94 offset:4096
v_mfma_f32_16x16x32_bf16 v[136:139],v[24:27],v[64:67],v[136:139]
ds_read_b128 v[84:87],v94 offset:6144
v_mfma_f32_16x16x32_bf16 v[140:143],v[24:27],v[68:71],v[140:143]
ds_read_b64_tr_b16 v[24:25],v3 offset:20480
v_mfma_f32_16x16x32_bf16 v[144:147],v[28:31],v[56:59],v[144:147]
ds_read_b64_tr_b16 v[26:27],v3 offset:21504
v_mfma_f32_16x16x32_bf16 v[148:151],v[28:31],v[60:63],v[148:151]
buffer_load_dword v93,off,s[60:63],0 sc1
v_mfma_f32_16x16x32_bf16 v[152:155],v[28:31],v[64:67],v[152:155]
v_mfma_f32_16x16x32_bf16 v[156:159],v[28:31],v[68:71],v[156:159]
ds_read_b64_tr_b16 v[28:29],v4 offset:20480
v_mfma_f32_16x16x32_bf16 v[160:163],v[32:35],v[56:59],v[160:163]
ds_read_b64_tr_b16 v[30:31],v4 offset:21504
v_mfma_f32_16x16x32_bf16 v[164:167],v[32:35],v[60:63],v[164:167]
v_mfma_f32_16x16x32_bf16 v[168:171],v[32:35],v[64:67],v[168:171]
v_mfma_f32_16x16x32_bf16 v[172:175],v[32:35],v[68:71],v[172:175]
ds_read_b64_tr_b16 v[32:33],v5 offset:20480
v_mfma_f32_16x16x32_bf16 v[176:179],v[36:39],v[56:59],v[176:179]
ds_read_b64_tr_b16 v[34:35],v5 offset:21504
v_mfma_f32_16x16x32_bf16 v[180:183],v[36:39],v[60:63],v[180:183]
v_mfma_f32_16x16x32_bf16 v[184:187],v[36:39],v[64:67],v[184:187]
v_mfma_f32_16x16x32_bf16 v[188:191],v[36:39],v[68:71],v[188:191]
ds_read_b64_tr_b16 v[36:37],v6 offset:20480
v_mfma_f32_16x16x32_bf16 v[192:195],v[40:43],v[56:59],v[192:195]
ds_read_b64_tr_b16 v[38:39],v6 offset:21504
v_mfma_f32_16x16x32_bf16 v[196:199],v[40:43],v[60:63],v[196:199]
v_mfma_f32_16x16x32_bf16 v[200:203],v[40:43],v[64:67],v[200:203]
v_mfma_f32_16x16x32_bf16 v[204:207],v[40:43],v[68:71],v[204:207]
ds_read_b64_tr_b16 v[40:41],v7 offset:20480
v_mfma_f32_16x16x32_bf16 v[208:211],v[44:47],v[56:59],v[208:211]
ds_read_b64_tr_b16 v[42:43],v7 offset:21504
v_mfma_f32_16x16x32_bf16 v[212:215],v[44:47],v[60:63],v[212:215]
v_mfma_f32_16x16x32_bf16 v[216:219],v[44:47],v[64:67],v[216:219]
v_mfma_f32_16x16x32_bf16 v[220:223],v[44:47],v[68:71],v[220:223]
ds_read_b64_tr_b16 v[44:45],v8 offset:20480
v_mfma_f32_16x16x32_bf16 v[224:227],v[48:51],v[56:59],v[224:227]
ds_read_b64_tr_b16 v[46:47],v8 offset:21504
v_mfma_f32_16x16x32_bf16 v[228:231],v[48:51],v[60:63],v[228:231]
v_mfma_f32_16x16x32_bf16 v[232:235],v[48:51],v[64:67],v[232:235]
v_mfma_f32_16x16x32_bf16 v[236:239],v[48:51],v[68:71],v[236:239]
ds_read_b64_tr_b16 v[48:49],v9 offset:20480
v_mfma_f32_16x16x32_bf16 v[240:243],v[52:55],v[56:59],v[240:243]
ds_read_b64_tr_b16 v[50:51],v9 offset:21504
v_mfma_f32_16x16x32_bf16 v[244:247],v[52:55],v[60:63],v[244:247]
v_mfma_f32_16x16x32_bf16 v[248:251],v[52:55],v[64:67],v[248:251]
v_mfma_f32_16x16x32_bf16 v[252:255],v[52:55],v[68:71],v[252:255]
ds_read_b64_tr_b16 v[52:53],v10 offset:20480
ds_read_b64_tr_b16 v[54:55],v10 offset:21504
s_waitcnt lgkmcnt(15)
v_mfma_f32_16x16x32_bf16 v[96:99],v[72:75],v[16:19],v[96:99]
v_mfma_f32_16x16x32_bf16 v[100:103],v[76:79],v[16:19],v[100:103]
v_mfma_f32_16x16x32_bf16 v[104:107],v[80:83],v[16:19],v[104:107]
v_mfma_f32_16x16x32_bf16 v[108:111],v[84:87],v[16:19],v[108:111]
s_waitcnt vmcnt(0) lgkmcnt(0)
s_barrier
v_readfirstlane_b32 s50,v93
s_nop 0
s_cmp_lg_u32 s50,256
s_cbranch_scc1 g2_bad0
g2_badr0:
ds_read_b64_tr_b16 v[16:17],v1 offset:40960
v_mfma_f32_16x16x32_bf16 v[112:115],v[72:75],v[20:23],v[112:115]
ds_read_b64_tr_b16 v[18:19],v1 offset:41472
v_mfma_f32_16x16x32_bf16 v[116:119],v[76:79],v[20:23],v[116:119]
ds_read_b128 v[56:59],v11 offset:32768
v_mfma_f32_16x16x32_bf16 v[120:123],v[80:83],v[20:23],v[120:123]
ds_read_b128 v[60:63],v11 offset:34816
v_mfma_f32_16x16x32_bf16 v[124:127],v[84:87],v[20:23],v[124:127]
ds_read_b64_tr_b16 v[20:21],v2 offset:40960
v_mfma_f32_16x16x32_bf16 v[128:131],v[24:27],v[72:75],v[128:131]
ds_read_b64_tr_b16 v[22:23],v2 offset:41472
v_mfma_f32_16x16x32_bf16 v[132:135],v[24:27],v[76:79],v[132:135]
ds_read_b128 v[64:67],v11 offset:36864
v_mfma_f32_16x16x32_bf16 v[136:139],v[24:27],v[80:83],v[136:139]
ds_read_b128 v[68:71],v11 offset:38912
v_mfma_f32_16x16x32_bf16 v[140:143],v[24:27],v[84:87],v[140:143]
ds_read_b64_tr_b16 v[24:25],v3 offset:40960
v_mfma_f32_16x16x32_bf16 v[144:147],v[28:31],v[72:75],v[144:147]
ds_read_b64_tr_b16 v[26:27],v3 offset:41984
v_mfma_f32_16x16x32_bf16 v[148:151],v[28:31],v[76:79],v[148:151]
v_lshlrev_b32 v92,5,v0
buffer_load_dwordx4 v[12:15],v92,s[36:39],s98 offen sc1
v_mfma_f32_16x16x32_bf16 v[152:155],v[28:31],v[80:83],v[152:155]
v_mfma_f32_16x16x32_bf16 v[156:159],v[28:31],v[84:87],v[156:159]
ds_read_b64_tr_b16 v[28:29],v4 offset:40960
v_mfma_f32_16x16x32_bf16 v[160:163],v[32:35],v[72:75],v[160:163]
ds_read_b64_tr_b16 v[30:31],v4 offset:41984
v_mfma_f32_16x16x32_bf16 v[164:167],v[32:35],v[76:79],v[164:167]
buffer_load_dwordx4 v[88:91],v92,s[36:39],s98 offen offset:16 sc1
v_mfma_f32_16x16x32_bf16 v[168:171],v[32:35],v[80:83],v[168:171]
v_mfma_f32_16x16x32_bf16 v[172:175],v[32:35],v[84:87],v[172:175]
ds_read_b64_tr_b16 v[32:33],v5 offset:40960
v_mfma_f32_16x16x32_bf16 v[176:179],v[36:39],v[72:75],v[176:179]
ds_read_b64_tr_b16 v[34:35],v5 offset:41984
v_mfma_f32_16x16x32_bf16 v[180:183],v[36:39],v[76:79],v[180:183]
v_lshrrev_b32 v93,5,v0
v_mul_u32_u24 v93,8064,v93
v_lshl_add_u32 v93,v0,2,v93
s_lshl_b32 s50,s40,8
s_add_u32 m0,s50,149504
s_lshr_b32 s50,s50,1
s_lshl_b32 s51,s43,10
s_add_u32 s50,s50,s51
s_add_u32 s50,s50,42991616
buffer_load_dword v93,s[36:39],s50 offen sc1 lds
v_mfma_f32_16x16x32_bf16 v[184:187],v[36:39],v[80:83],v[184:187]
v_mfma_f32_16x16x32_bf16 v[188:191],v[36:39],v[84:87],v[188:191]
ds_read_b64_tr_b16 v[36:37],v6 offset:40960
v_mfma_f32_16x16x32_bf16 v[192:195],v[40:43],v[72:75],v[192:195]
ds_read_b64_tr_b16 v[38:39],v6 offset:41984
v_mfma_f32_16x16x32_bf16 v[196:199],v[40:43],v[76:79],v[196:199]
v_mfma_f32_16x16x32_bf16 v[200:203],v[40:43],v[80:83],v[200:203]
v_mfma_f32_16x16x32_bf16 v[204:207],v[40:43],v[84:87],v[204:207]
ds_read_b64_tr_b16 v[40:41],v7 offset:40960
v_mfma_f32_16x16x32_bf16 v[208:211],v[44:47],v[72:75],v[208:211]
ds_read_b64_tr_b16 v[42:43],v7 offset:41984
v_mfma_f32_16x16x32_bf16 v[212:215],v[44:47],v[76:79],v[212:215]
v_mfma_f32_16x16x32_bf16 v[216:219],v[44:47],v[80:83],v[216:219]
v_mfma_f32_16x16x32_bf16 v[220:223],v[44:47],v[84:87],v[220:223]
ds_read_b64_tr_b16 v[44:45],v8 offset:40960
v_mfma_f32_16x16x32_bf16 v[224:227],v[48:51],v[72:75],v[224:227]
ds_read_b64_tr_b16 v[46:47],v8 offset:41984
v_mfma_f32_16x16x32_bf16 v[228:231],v[48:51],v[76:79],v[228:231]
v_mfma_f32_16x16x32_bf16 v[232:235],v[48:51],v[80:83],v[232:235]
v_mfma_f32_16x16x32_bf16 v[236:239],v[48:51],v[84:87],v[236:239]
ds_read_b64_tr_b16 v[48:49],v9 offset:40960
v_mfma_f32_16x16x32_bf16 v[240:243],v[52:55],v[72:75],v[240:243]
ds_read_b64_tr_b16 v[50:51],v9 offset:41984
v_mfma_f32_16x16x32_bf16 v[244:247],v[52:55],v[76:79],v[244:247]
v_mfma_f32_16x16x32_bf16 v[248:251],v[52:55],v[80:83],v[248:251]
v_mfma_f32_16x16x32_bf16 v[252:255],v[52:55],v[84:87],v[252:255]
ds_read_b64_tr_b16 v[52:53],v10 offset:40960
ds_read_b64_tr_b16 v[54:55],v10 offset:41984
s_waitcnt lgkmcnt(15)
v_mfma_f32_16x16x32_bf16 v[96:99],v[56:59],v[16:19],v[96:99]
v_mfma_f32_16x16x32_bf16 v[100:103],v[60:63],v[16:19],v[100:103]
v_mfma_f32_16x16x32_bf16 v[104:107],v[64:67],v[16:19],v[104:107]
v_mfma_f32_16x16x32_bf16 v[108:111],v[68:71],v[16:19],v[108:111]
s_waitcnt vmcnt(0) lgkmcnt(0)
s_barrier
ds_read_b64_tr_b16 v[16:17],v1 offset:61440
v_mfma_f32_16x16x32_bf16 v[112:115],v[56:59],v[20:23],v[112:115]
ds_read_b64_tr_b16 v[18:19],v1 offset:61952
v_mfma_f32_16x16x32_bf16 v[116:119],v[60:63],v[20:23],v[116:119]
ds_read_b128 v[72:75],v94 offset:32768
v_mfma_f32_16x16x32_bf16 v[120:123],v[64:67],v[20:23],v[120:123]
ds_read_b128 v[76:79],v94 offset:34816
v_mfma_f32_16x16x32_bf16 v[124:127],v[68:71],v[20:23],v[124:127]
ds_read_b64_tr_b16 v[20:21],v2 offset:61440
v_mfma_f32_16x16x32_bf16 v[128:131],v[24:27],v[56:59],v[128:131]
ds_read_b64_tr_b16 v[22:23],v2 offset:61952
v_mfma_f32_16x16x32_bf16 v[132:135],v[24:27],v[60:63],v[132:135]
ds_read_b128 v[80:83],v94 offset:36864
v_mfma_f32_16x16x32_bf16 v[136:139],v[24:27],v[64:67],v[136:139]
ds_read_b128 v[84:87],v94 offset:38912
v_mfma_f32_16x16x32_bf16 v[140:143],v[24:27],v[68:71],v[140:143]
ds_read_b64_tr_b16 v[24:25],v3 offset:61440
v_mfma_f32_16x16x32_bf16 v[144:147],v[28:31],v[56:59],v[144:147]
ds_read_b64_tr_b16 v[26:27],v3 offset:62464
v_mfma_f32_16x16x32_bf16 v[148:151],v[28:31],v[60:63],v[148:151]
v_add_f32 v12,v12,v88
v_add_f32 v13,v13,v89
v_add_f32 v14,v14,v90
v_add_f32 v15,v15,v91
v_add_f32 v12,v12,v13
v_add_f32 v14,v14,v15
v_add_f32 v12,v12,v14
s_lshl_b32 s50,s40,8
s_add_u32 s50,s50,147456
v_lshl_add_u32 v92,v0,2,s50
ds_write_b32 v92,v12
v_mfma_f32_16x16x32_bf16 v[152:155],v[28:31],v[64:67],v[152:155]
v_mfma_f32_16x16x32_bf16 v[156:159],v[28:31],v[68:71],v[156:159]
ds_read_b64_tr_b16 v[28:29],v4 offset:61440
v_mfma_f32_16x16x32_bf16 v[160:163],v[32:35],v[56:59],v[160:163]
ds_read_b64_tr_b16 v[30:31],v4 offset:62464
v_mfma_f32_16x16x32_bf16 v[164:167],v[32:35],v[60:63],v[164:167]
v_mfma_f32_16x16x32_bf16 v[168:171],v[32:35],v[64:67],v[168:171]
v_mfma_f32_16x16x32_bf16 v[172:175],v[32:35],v[68:71],v[172:175]
ds_read_b64_tr_b16 v[32:33],v5 offset:61440
v_mfma_f32_16x16x32_bf16 v[176:179],v[36:39],v[56:59],v[176:179]
ds_read_b64_tr_b16 v[34:35],v5 offset:62464
v_mfma_f32_16x16x32_bf16 v[180:183],v[36:39],v[60:63],v[180:183]
v_mfma_f32_16x16x32_bf16 v[184:187],v[36:39],v[64:67],v[184:187]
v_mfma_f32_16x16x32_bf16 v[188:191],v[36:39],v[68:71],v[188:191]
ds_read_b64_tr_b16 v[36:37],v6 offset:61440
v_mfma_f32_16x16x32_bf16 v[192:195],v[40:43],v[56:59],v[192:195]
ds_read_b64_tr_b16 v[38:39],v6 offset:62464
v_mfma_f32_16x16x32_bf16 v[196:199],v[40:43],v[60:63],v[196:199]
v_mfma_f32_16x16x32_bf16 v[200:203],v[40:43],v[64:67],v[200:203]
v_mfma_f32_16x16x32_bf16 v[204:207],v[40:43],v[68:71],v[204:207]
ds_read_b64_tr_b16 v[40:41],v7 offset:61440
v_mfma_f32_16x16x32_bf16 v[208:211],v[44:47],v[56:59],v[208:211]
ds_read_b64_tr_b16 v[42:43],v7 offset:62464
v_mfma_f32_16x16x32_bf16 v[212:215],v[44:47],v[60:63],v[212:215]
v_mfma_f32_16x16x32_bf16 v[216:219],v[44:47],v[64:67],v[216:219]
v_mfma_f32_16x16x32_bf16 v[220:223],v[44:47],v[68:71],v[220:223]
ds_read_b64_tr_b16 v[44:45],v8 offset:61440
v_mfma_f32_16x16x32_bf16 v[224:227],v[48:51],v[56:59],v[224:227]
ds_read_b64_tr_b16 v[46:47],v8 offset:62464
v_mfma_f32_16x16x32_bf16 v[228:231],v[48:51],v[60:63],v[228:231]
v_mfma_f32_16x16x32_bf16 v[232:235],v[48:51],v[64:67],v[232:235]
v_mfma_f32_16x16x32_bf16 v[236:239],v[48:51],v[68:71],v[236:239]
ds_read_b64_tr_b16 v[48:49],v9 offset:61440
v_mfma_f32_16x16x32_bf16 v[240:243],v[52:55],v[56:59],v[240:243]
ds_read_b64_tr_b16 v[50:51],v9 offset:62464
v_mfma_f32_16x16x32_bf16 v[244:247],v[52:55],v[60:63],v[244:247]
v_mfma_f32_16x16x32_bf16 v[248:251],v[52:55],v[64:67],v[248:251]
v_mfma_f32_16x16x32_bf16 v[252:255],v[52:55],v[68:71],v[252:255]
ds_read_b64_tr_b16 v[52:53],v10 offset:61440
ds_read_b64_tr_b16 v[54:55],v10 offset:62464
s_waitcnt lgkmcnt(15)
v_mfma_f32_16x16x32_bf16 v[96:99],v[72:75],v[16:19],v[96:99]
v_lshrrev_b32 v92,4,v0
v_lshlrev_b32 v92,4,v92
v_and_b32 v93,15,v0
v_lshlrev_b32 v93,2,v93
s_lshl_b32 s50,s41,9
v_mfma_f32_16x16x32_bf16 v[100:103],v[76:79],v[16:19],v[100:103]
s_add_u32 s50,s50,149504
v_add_u32 v94,s50,v93
v_add_u32 v95,s50,v92
v_add_u32 v92,147456,v92
v_add_u32 v93,147456,v93
v_mfma_f32_16x16x32_bf16 v[104:107],v[80:83],v[16:19],v[104:107]
v_mfma_f32_16x16x32_bf16 v[108:111],v[84:87],v[16:19],v[108:111]
s_waitcnt lgkmcnt(0)
s_barrier
ds_read_b32 v16,v93 offset:0
v_mfma_f32_16x16x32_bf16 v[112:115],v[72:75],v[20:23],v[112:115]
v_mfma_f32_16x16x32_bf16 v[116:119],v[76:79],v[20:23],v[116:119]
ds_read_b32 v2,v93 offset:4096
v_mfma_f32_16x16x32_bf16 v[120:123],v[80:83],v[20:23],v[120:123]
ds_read2_b32 v[56:57],v94 offset0:0 offset1:32
v_mfma_f32_16x16x32_bf16 v[124:127],v[84:87],v[20:23],v[124:127]
ds_read_b32 v20,v93 offset:64
v_mfma_f32_16x16x32_bf16 v[128:131],v[24:27],v[72:75],v[128:131]
v_mfma_f32_16x16x32_bf16 v[132:135],v[24:27],v[76:79],v[132:135]
ds_read2_b32 v[58:59],v94 offset0:16 offset1:48
v_mfma_f32_16x16x32_bf16 v[136:139],v[24:27],v[80:83],v[136:139]
ds_read2_b32 v[60:61],v94 offset0:64 offset1:96
v_mfma_f32_16x16x32_bf16 v[140:143],v[24:27],v[84:87],v[140:143]
ds_read_b128 v[24:27],v92 offset:256
v_mfma_f32_16x16x32_bf16 v[144:147],v[28:31],v[72:75],v[144:147]
v_mfma_f32_16x16x32_bf16 v[148:151],v[28:31],v[76:79],v[148:151]
ds_read2_b32 v[62:63],v94 offset0:80 offset1:112
v_mfma_f32_16x16x32_bf16 v[152:155],v[28:31],v[80:83],v[152:155]
ds_read_b128 v[4:7],v95 offset:128
v_mfma_f32_16x16x32_bf16 v[156:159],v[28:31],v[84:87],v[156:159]
ds_read_b128 v[28:31],v92 offset:320
v_mfma_f32_16x16x32_bf16 v[160:163],v[32:35],v[72:75],v[160:163]
v_mfma_f32_16x16x32_bf16 v[164:167],v[32:35],v[76:79],v[164:167]
ds_read_b128 v[8:11],v95 offset:192
v_mfma_f32_16x16x32_bf16 v[168:171],v[32:35],v[80:83],v[168:171]
ds_read_b128 v[12:15],v95 offset:384
v_mfma_f32_16x16x32_bf16 v[172:175],v[32:35],v[84:87],v[172:175]
ds_read_b128 v[32:35],v92 offset:768
v_mfma_f32_16x16x32_bf16 v[176:179],v[36:39],v[72:75],v[176:179]
v_mfma_f32_16x16x32_bf16 v[180:183],v[36:39],v[76:79],v[180:183]
ds_read_b128 v[88:91],v95 offset:448
v_mfma_f32_16x16x32_bf16 v[184:187],v[36:39],v[80:83],v[184:187]
v_mfma_f32_16x16x32_bf16 v[188:191],v[36:39],v[84:87],v[188:191]
ds_read_b128 v[36:39],v92 offset:832
v_mfma_f32_16x16x32_bf16 v[192:195],v[40:43],v[72:75],v[192:195]
v_mfma_f32_16x16x32_bf16 v[196:199],v[40:43],v[76:79],v[196:199]
v_mfma_f32_16x16x32_bf16 v[200:203],v[40:43],v[80:83],v[200:203]
v_mfma_f32_16x16x32_bf16 v[204:207],v[40:43],v[84:87],v[204:207]
ds_read_b128 v[40:43],v92 offset:384
v_mfma_f32_16x16x32_bf16 v[208:211],v[44:47],v[72:75],v[208:211]
v_mfma_f32_16x16x32_bf16 v[212:215],v[44:47],v[76:79],v[212:215]
v_mfma_f32_16x16x32_bf16 v[216:219],v[44:47],v[80:83],v[216:219]
v_mfma_f32_16x16x32_bf16 v[220:223],v[44:47],v[84:87],v[220:223]
ds_read_b128 v[44:47],v92 offset:448
v_mfma_f32_16x16x32_bf16 v[224:227],v[48:51],v[72:75],v[224:227]
v_mfma_f32_16x16x32_bf16 v[228:231],v[48:51],v[76:79],v[228:231]
v_mfma_f32_16x16x32_bf16 v[232:235],v[48:51],v[80:83],v[232:235]
v_mfma_f32_16x16x32_bf16 v[236:239],v[48:51],v[84:87],v[236:239]
ds_read_b128 v[48:51],v92 offset:896
v_mfma_f32_16x16x32_bf16 v[240:243],v[52:55],v[72:75],v[240:243]
v_mfma_f32_16x16x32_bf16 v[244:247],v[52:55],v[76:79],v[244:247]
v_mfma_f32_16x16x32_bf16 v[248:251],v[52:55],v[80:83],v[248:251]
v_mfma_f32_16x16x32_bf16 v[252:255],v[52:55],v[84:87],v[252:255]
ds_read_b128 v[52:55],v92 offset:960
s_waitcnt lgkmcnt(4)
v_readfirstlane_b32 s50,v2
v_lshlrev_b32 v1,4,v0
s_cmp_lg_u32 s50,0
s_cbranch_scc1 g2_rec
g2_ep0:
s_load_dwordx2 s[10:11],s[0:1],56
s_mov_b64 s[6:7],s[14:15]
s_mov_b64 s[8:9],s[16:17]
s_setprio 3
ds_read_b128 v[72:75],v95 offset:0
ds_read_b128 v[76:79],v95 offset:64
ds_read_b128 v[80:83],v95 offset:256
ds_read_b128 v[84:87],v95 offset:320
v_rcp_f32 v65,v57
v_rcp_f32 v67,v59
v_rcp_f32 v69,v61
v_rcp_f32 v71,v63
v_rcp_f32 v4,v4
v_rcp_f32 v5,v5
v_rcp_f32 v6,v6
v_rcp_f32 v7,v7
v_rcp_f32 v8,v8
v_rcp_f32 v9,v9
v_rcp_f32 v10,v10
v_rcp_f32 v11,v11
v_rcp_f32 v12,v12
v_rcp_f32 v13,v13
v_rcp_f32 v14,v14
v_rcp_f32 v15,v15
v_rcp_f32 v88,v88
v_rcp_f32 v89,v89
v_rcp_f32 v90,v90
v_rcp_f32 v91,v91
s_lshl_b32 s50,s43,3
s_lshl_b32 s51,s41,1
s_add_u32 s50,s50,s51
s_lshl_b32 s48,s50,11
s_lshl_b32 s51,s45,18
s_add_u32 s48,s48,s51
s_mul_i32 s49,s50,294912
s_lshl_b32 s51,s47,5
s_add_u32 s49,s49,s51
s_add_u32 s49,s49,12582912
v_mul_f32 v64,0xbfb8aa3b,v65
v_mul_f32 v66,0xbfb8aa3b,v67
v_mul_f32 v68,0xbfb8aa3b,v69
v_mul_f32 v70,0xbfb8aa3b,v71
s_waitcnt lgkmcnt(0)
s_add_u32 s50,s48,8388608
v_pk_fma_f32 v[96:97],v[72:73],v[16:17],v[96:97] op_sel:[0,0,0] op_sel_hi:[1,0,1]
v_pk_fma_f32 v[98:99],v[74:75],v[16:17],v[98:99] op_sel:[0,0,0] op_sel_hi:[1,0,1]
v_pk_fma_f32 v[100:101],v[76:77],v[16:17],v[100:101] op_sel:[0,0,0] op_sel_hi:[1,0,1]
v_pk_fma_f32 v[102:103],v[78:79],v[16:17],v[102:103] op_sel:[0,0,0] op_sel_hi:[1,0,1]
v_pk_mul_f32 v[96:97],v[96:97],v[4:5] op_sel:[0,0] op_sel_hi:[1,1]
v_pk_mul_f32 v[98:99],v[98:99],v[6:7] op_sel:[0,0] op_sel_hi:[1,1]
v_pk_mul_f32 v[100:101],v[100:101],v[8:9] op_sel:[0,0] op_sel_hi:[1,1]
v_pk_mul_f32 v[102:103],v[102:103],v[10:11] op_sel:[0,0] op_sel_hi:[1,1]
v_cvt_pk_bf16_f32 v96,v96,v97
v_cvt_pk_bf16_f32 v97,v98,v99
v_cvt_pk_bf16_f32 v98,v100,v101
v_cvt_pk_bf16_f32 v99,v102,v103
buffer_store_dwordx4 v[96:99],v1,s[36:39],s50 offen offset:0 sc1
v_pk_fma_f32 v[104:105],v[80:81],v[16:17],v[104:105] op_sel:[0,0,0] op_sel_hi:[1,0,1]
v_pk_fma_f32 v[106:107],v[82:83],v[16:17],v[106:107] op_sel:[0,0,0] op_sel_hi:[1,0,1]
v_pk_fma_f32 v[108:109],v[84:85],v[16:17],v[108:109] op_sel:[0,0,0] op_sel_hi:[1,0,1]
v_pk_fma_f32 v[110:111],v[86:87],v[16:17],v[110:111] op_sel:[0,0,0] op_sel_hi:[1,0,1]
v_pk_mul_f32 v[104:105],v[104:105],v[12:13] op_sel:[0,0] op_sel_hi:[1,1]
v_pk_mul_f32 v[106:107],v[106:107],v[14:15] op_sel:[0,0] op_sel_hi:[1,1]
v_pk_mul_f32 v[108:109],v[108:109],v[88:89] op_sel:[0,0] op_sel_hi:[1,1]
v_pk_mul_f32 v[110:111],v[110:111],v[90:91] op_sel:[0,0] op_sel_hi:[1,1]
v_cvt_pk_bf16_f32 v104,v104,v105
v_cvt_pk_bf16_f32 v105,v106,v107
v_cvt_pk_bf16_f32 v106,v108,v109
v_cvt_pk_bf16_f32 v107,v110,v111
buffer_store_dwordx4 v[104:107],v1,s[36:39],s50 offen offset:2048 sc1
v_pk_fma_f32 v[112:113],v[72:73],v[20:21],v[112:113] op_sel:[0,0,0] op_sel_hi:[1,0,1]
v_pk_fma_f32 v[114:115],v[74:75],v[20:21],v[114:115] op_sel:[0,0,0] op_sel_hi:[1,0,1]
v_pk_fma_f32 v[116:117],v[76:77],v[20:21],v[116:117] op_sel:[0,0,0] op_sel_hi:[1,0,1]
v_pk_fma_f32 v[118:119],v[78:79],v[20:21],v[118:119] op_sel:[0,0,0] op_sel_hi:[1,0,1]
v_pk_mul_f32 v[112:113],v[112:113],v[4:5] op_sel:[0,0] op_sel_hi:[1,1]
v_pk_mul_f32 v[114:115],v[114:115],v[6:7] op_sel:[0,0] op_sel_hi:[1,1]
v_pk_mul_f32 v[116:117],v[116:117],v[8:9] op_sel:[0,0] op_sel_hi:[1,1]
v_pk_mul_f32 v[118:119],v[118:119],v[10:11] op_sel:[0,0] op_sel_hi:[1,1]
v_cvt_pk_bf16_f32 v112,v112,v113
v_cvt_pk_bf16_f32 v113,v114,v115
v_cvt_pk_bf16_f32 v114,v116,v117
v_cvt_pk_bf16_f32 v115,v118,v119
buffer_store_dwordx4 v[112:115],v1,s[36:39],s50 offen offset:1024 sc1
v_pk_fma_f32 v[120:121],v[80:81],v[20:21],v[120:121] op_sel:[0,0,0] op_sel_hi:[1,0,1]
v_pk_fma_f32 v[122:123],v[82:83],v[20:21],v[122:123] op_sel:[0,0,0] op_sel_hi:[1,0,1]
v_pk_fma_f32 v[124:125],v[84:85],v[20:21],v[124:125] op_sel:[0,0,0] op_sel_hi:[1,0,1]
v_pk_fma_f32 v[126:127],v[86:87],v[20:21],v[126:127] op_sel:[0,0,0] op_sel_hi:[1,0,1]
v_pk_mul_f32 v[120:121],v[120:121],v[12:13] op_sel:[0,0] op_sel_hi:[1,1]
v_pk_mul_f32 v[122:123],v[122:123],v[14:15] op_sel:[0,0] op_sel_hi:[1,1]
v_pk_mul_f32 v[124:125],v[124:125],v[88:89] op_sel:[0,0] op_sel_hi:[1,1]
v_pk_mul_f32 v[126:127],v[126:127],v[90:91] op_sel:[0,0] op_sel_hi:[1,1]
v_cvt_pk_bf16_f32 v120,v120,v121
v_cvt_pk_bf16_f32 v121,v122,v123
v_cvt_pk_bf16_f32 v122,v124,v125
v_cvt_pk_bf16_f32 v123,v126,v127
buffer_store_dwordx4 v[120:123],v1,s[36:39],s50 offen offset:3072 sc1
s_setprio 2
v_mov_b32 v72,v57
v_mov_b32 v74,v59
v_mov_b32 v76,v61
v_mov_b32 v78,v63
v_pk_fma_f32 v[128:129],v[24:25],v[56:57],v[128:129] op_sel:[0,0,0] op_sel_hi:[1,0,1]
v_pk_fma_f32 v[130:131],v[26:27],v[56:57],v[130:131] op_sel:[0,0,0] op_sel_hi:[1,0,1]
v_pk_fma_f32 v[144:145],v[28:29],v[56:57],v[144:145] op_sel:[0,0,0] op_sel_hi:[1,0,1]
v_pk_fma_f32 v[146:147],v[30:31],v[56:57],v[146:147] op_sel:[0,0,0] op_sel_hi:[1,0,1]
v_pk_mul_f32 v[128:129],v[128:129],v[64:65] op_sel:[0,0] op_sel_hi:[1,0]
v_pk_mul_f32 v[130:131],v[130:131],v[64:65] op_sel:[0,0] op_sel_hi:[1,0]
v_pk_mul_f32 v[144:145],v[144:145],v[64:65] op_sel:[0,0] op_sel_hi:[1,0]
v_pk_mul_f32 v[146:147],v[146:147],v[64:65] op_sel:[0,0] op_sel_hi:[1,0]
v_exp_f32 v128,v128
v_exp_f32 v129,v129
v_exp_f32 v130,v130
v_exp_f32 v131,v131
v_exp_f32 v144,v144
v_exp_f32 v145,v145
v_exp_f32 v146,v146
v_exp_f32 v147,v147
v_pk_fma_f32 v[160:161],v[32:33],v[56:57],v[160:161] op_sel:[0,0,0] op_sel_hi:[1,0,1]
v_pk_fma_f32 v[162:163],v[34:35],v[56:57],v[162:163] op_sel:[0,0,0] op_sel_hi:[1,0,1]
v_pk_fma_f32 v[176:177],v[36:37],v[56:57],v[176:177] op_sel:[0,0,0] op_sel_hi:[1,0,1]
v_pk_fma_f32 v[178:179],v[38:39],v[56:57],v[178:179] op_sel:[0,0,0] op_sel_hi:[1,0,1]
v_pk_fma_f32 v[128:129],v[128:129],v[72:73],v[72:73] op_sel:[0,0,0] op_sel_hi:[1,0,0]
v_pk_fma_f32 v[130:131],v[130:131],v[72:73],v[72:73] op_sel:[0,0,0] op_sel_hi:[1,0,0]
v_pk_fma_f32 v[144:145],v[144:145],v[72:73],v[72:73] op_sel:[0,0,0] op_sel_hi:[1,0,0]
v_pk_fma_f32 v[146:147],v[146:147],v[72:73],v[72:73] op_sel:[0,0,0] op_sel_hi:[1,0,0]
v_rcp_f32 v128,v128
v_rcp_f32 v129,v129
v_rcp_f32 v130,v130
v_rcp_f32 v131,v131
v_rcp_f32 v144,v144
v_rcp_f32 v145,v145
v_rcp_f32 v146,v146
v_rcp_f32 v147,v147
s_nop 0
v_pk_mul_f32 v[128:129],v[128:129],v[160:161] op_sel:[0,0] op_sel_hi:[1,1]
v_pk_mul_f32 v[130:131],v[130:131],v[162:163] op_sel:[0,0] op_sel_hi:[1,1]
v_pk_mul_f32 v[144:145],v[144:145],v[176:177] op_sel:[0,0] op_sel_hi:[1,1]
v_pk_mul_f32 v[146:147],v[146:147],v[178:179] op_sel:[0,0] op_sel_hi:[1,1]
v_cvt_pk_bf16_f32 v128,v128,v129
v_cvt_pk_bf16_f32 v129,v130,v131
v_cvt_pk_bf16_f32 v130,v144,v145
v_cvt_pk_bf16_f32 v131,v146,v147
v_pk_fma_f32 v[132:133],v[24:25],v[58:59],v[132:133] op_sel:[0,0,0] op_sel_hi:[1,0,1]
v_pk_fma_f32 v[134:135],v[26:27],v[58:59],v[134:135] op_sel:[0,0,0] op_sel_hi:[1,0,1]
v_pk_fma_f32 v[148:149],v[28:29],v[58:59],v[148:149] op_sel:[0,0,0] op_sel_hi:[1,0,1]
v_pk_fma_f32 v[150:151],v[30:31],v[58:59],v[150:151] op_sel:[0,0,0] op_sel_hi:[1,0,1]
v_pk_mul_f32 v[132:133],v[132:133],v[66:67] op_sel:[0,0] op_sel_hi:[1,0]
v_pk_mul_f32 v[134:135],v[134:135],v[66:67] op_sel:[0,0] op_sel_hi:[1,0]
v_pk_mul_f32 v[148:149],v[148:149],v[66:67] op_sel:[0,0] op_sel_hi:[1,0]
v_pk_mul_f32 v[150:151],v[150:151],v[66:67] op_sel:[0,0] op_sel_hi:[1,0]
v_exp_f32 v132,v132
v_exp_f32 v133,v133
v_exp_f32 v134,v134
v_exp_f32 v135,v135
v_exp_f32 v148,v148
v_exp_f32 v149,v149
v_exp_f32 v150,v150
v_exp_f32 v151,v151
v_pk_fma_f32 v[164:165],v[32:33],v[58:59],v[164:165] op_sel:[0,0,0] op_sel_hi:[1,0,1]
v_pk_fma_f32 v[166:167],v[34:35],v[58:59],v[166:167] op_sel:[0,0,0] op_sel_hi:[1,0,1]
v_pk_fma_f32 v[180:181],v[36:37],v[58:59],v[180:181] op_sel:[0,0,0] op_sel_hi:[1,0,1]
v_pk_fma_f32 v[182:183],v[38:39],v[58:59],v[182:183] op_sel:[0,0,0] op_sel_hi:[1,0,1]
v_pk_fma_f32 v[132:133],v[132:133],v[74:75],v[74:75] op_sel:[0,0,0] op_sel_hi:[1,0,0]
v_pk_fma_f32 v[134:135],v[134:135],v[74:75],v[74:75] op_sel:[0,0,0] op_sel_hi:[1,0,0]
v_pk_fma_f32 v[148:149],v[148:149],v[74:75],v[74:75] op_sel:[0,0,0] op_sel_hi:[1,0,0]
v_pk_fma_f32 v[150:151],v[150:151],v[74:75],v[74:75] op_sel:[0,0,0] op_sel_hi:[1,0,0]
v_rcp_f32 v132,v132
v_rcp_f32 v133,v133
v_rcp_f32 v134,v134
v_rcp_f32 v135,v135
v_rcp_f32 v148,v148
v_rcp_f32 v149,v149
v_rcp_f32 v150,v150
v_rcp_f32 v151,v151
s_nop 0
v_pk_mul_f32 v[132:133],v[132:133],v[164:165] op_sel:[0,0] op_sel_hi:[1,1]
v_pk_mul_f32 v[134:135],v[134:135],v[166:167] op_sel:[0,0] op_sel_hi:[1,1]
v_pk_mul_f32 v[148:149],v[148:149],v[180:181] op_sel:[0,0] op_sel_hi:[1,1]
v_pk_mul_f32 v[150:151],v[150:151],v[182:183] op_sel:[0,0] op_sel_hi:[1,1]
v_cvt_pk_bf16_f32 v132,v132,v133
v_cvt_pk_bf16_f32 v133,v134,v135
v_cvt_pk_bf16_f32 v134,v148,v149
v_cvt_pk_bf16_f32 v135,v150,v151
v_pk_fma_f32 v[136:137],v[24:25],v[60:61],v[136:137] op_sel:[0,0,0] op_sel_hi:[1,0,1]
v_pk_fma_f32 v[138:139],v[26:27],v[60:61],v[138:139] op_sel:[0,0,0] op_sel_hi:[1,0,1]
v_pk_fma_f32 v[152:153],v[28:29],v[60:61],v[152:153] op_sel:[0,0,0] op_sel_hi:[1,0,1]
v_pk_fma_f32 v[154:155],v[30:31],v[60:61],v[154:155] op_sel:[0,0,0] op_sel_hi:[1,0,1]
v_pk_mul_f32 v[136:137],v[136:137],v[68:69] op_sel:[0,0] op_sel_hi:[1,0]
v_pk_mul_f32 v[138:139],v[138:139],v[68:69] op_sel:[0,0] op_sel_hi:[1,0]
v_pk_mul_f32 v[152:153],v[152:153],v[68:69] op_sel:[0,0] op_sel_hi:[1,0]
v_pk_mul_f32 v[154:155],v[154:155],v[68:69] op_sel:[0,0] op_sel_hi:[1,0]
v_exp_f32 v136,v136
v_exp_f32 v137,v137
v_exp_f32 v138,v138
v_exp_f32 v139,v139
v_exp_f32 v152,v152
v_exp_f32 v153,v153
v_exp_f32 v154,v154
v_exp_f32 v155,v155
v_pk_fma_f32 v[168:169],v[32:33],v[60:61],v[168:169] op_sel:[0,0,0] op_sel_hi:[1,0,1]
v_pk_fma_f32 v[170:171],v[34:35],v[60:61],v[170:171] op_sel:[0,0,0] op_sel_hi:[1,0,1]
v_pk_fma_f32 v[184:185],v[36:37],v[60:61],v[184:185] op_sel:[0,0,0] op_sel_hi:[1,0,1]
v_pk_fma_f32 v[186:187],v[38:39],v[60:61],v[186:187] op_sel:[0,0,0] op_sel_hi:[1,0,1]
v_pk_fma_f32 v[136:137],v[136:137],v[76:77],v[76:77] op_sel:[0,0,0] op_sel_hi:[1,0,0]
v_pk_fma_f32 v[138:139],v[138:139],v[76:77],v[76:77] op_sel:[0,0,0] op_sel_hi:[1,0,0]
v_pk_fma_f32 v[152:153],v[152:153],v[76:77],v[76:77] op_sel:[0,0,0] op_sel_hi:[1,0,0]
v_pk_fma_f32 v[154:155],v[154:155],v[76:77],v[76:77] op_sel:[0,0,0] op_sel_hi:[1,0,0]
v_rcp_f32 v136,v136
v_rcp_f32 v137,v137
v_rcp_f32 v138,v138
v_rcp_f32 v139,v139
v_rcp_f32 v152,v152
v_rcp_f32 v153,v153
v_rcp_f32 v154,v154
v_rcp_f32 v155,v155
s_nop 0
v_pk_mul_f32 v[136:137],v[136:137],v[168:169] op_sel:[0,0] op_sel_hi:[1,1]
v_pk_mul_f32 v[138:139],v[138:139],v[170:171] op_sel:[0,0] op_sel_hi:[1,1]
v_pk_mul_f32 v[152:153],v[152:153],v[184:185] op_sel:[0,0] op_sel_hi:[1,1]
v_pk_mul_f32 v[154:155],v[154:155],v[186:187] op_sel:[0,0] op_sel_hi:[1,1]
v_cvt_pk_bf16_f32 v136,v136,v137
v_cvt_pk_bf16_f32 v137,v138,v139
v_cvt_pk_bf16_f32 v138,v152,v153
v_cvt_pk_bf16_f32 v139,v154,v155
v_pk_fma_f32 v[140:141],v[24:25],v[62:63],v[140:141] op_sel:[0,0,0] op_sel_hi:[1,0,1]
v_pk_fma_f32 v[142:143],v[26:27],v[62:63],v[142:143] op_sel:[0,0,0] op_sel_hi:[1,0,1]
v_pk_fma_f32 v[156:157],v[28:29],v[62:63],v[156:157] op_sel:[0,0,0] op_sel_hi:[1,0,1]
v_pk_fma_f32 v[158:159],v[30:31],v[62:63],v[158:159] op_sel:[0,0,0] op_sel_hi:[1,0,1]
v_pk_mul_f32 v[140:141],v[140:141],v[70:71] op_sel:[0,0] op_sel_hi:[1,0]
v_pk_mul_f32 v[142:143],v[142:143],v[70:71] op_sel:[0,0] op_sel_hi:[1,0]
v_pk_mul_f32 v[156:157],v[156:157],v[70:71] op_sel:[0,0] op_sel_hi:[1,0]
v_pk_mul_f32 v[158:159],v[158:159],v[70:71] op_sel:[0,0] op_sel_hi:[1,0]
v_exp_f32 v140,v140
v_exp_f32 v141,v141
v_exp_f32 v142,v142
v_exp_f32 v143,v143
v_exp_f32 v156,v156
v_exp_f32 v157,v157
v_exp_f32 v158,v158
v_exp_f32 v159,v159
v_pk_fma_f32 v[172:173],v[32:33],v[62:63],v[172:173] op_sel:[0,0,0] op_sel_hi:[1,0,1]
v_pk_fma_f32 v[174:175],v[34:35],v[62:63],v[174:175] op_sel:[0,0,0] op_sel_hi:[1,0,1]
v_pk_fma_f32 v[188:189],v[36:37],v[62:63],v[188:189] op_sel:[0,0,0] op_sel_hi:[1,0,1]
v_pk_fma_f32 v[190:191],v[38:39],v[62:63],v[190:191] op_sel:[0,0,0] op_sel_hi:[1,0,1]
v_pk_fma_f32 v[140:141],v[140:141],v[78:79],v[78:79] op_sel:[0,0,0] op_sel_hi:[1,0,0]
v_pk_fma_f32 v[142:143],v[142:143],v[78:79],v[78:79] op_sel:[0,0,0] op_sel_hi:[1,0,0]
v_pk_fma_f32 v[156:157],v[156:157],v[78:79],v[78:79] op_sel:[0,0,0] op_sel_hi:[1,0,0]
v_pk_fma_f32 v[158:159],v[158:159],v[78:79],v[78:79] op_sel:[0,0,0] op_sel_hi:[1,0,0]
v_rcp_f32 v140,v140
v_rcp_f32 v141,v141
v_rcp_f32 v142,v142
v_rcp_f32 v143,v143
v_rcp_f32 v156,v156
v_rcp_f32 v157,v157
v_rcp_f32 v158,v158
v_rcp_f32 v159,v159
s_nop 0
v_pk_mul_f32 v[140:141],v[140:141],v[172:173] op_sel:[0,0] op_sel_hi:[1,1]
v_pk_mul_f32 v[142:143],v[142:143],v[174:175] op_sel:[0,0] op_sel_hi:[1,1]
v_pk_mul_f32 v[156:157],v[156:157],v[188:189] op_sel:[0,0] op_sel_hi:[1,1]
v_pk_mul_f32 v[158:159],v[158:159],v[190:191] op_sel:[0,0] op_sel_hi:[1,1]
v_cvt_pk_bf16_f32 v140,v140,v141
v_cvt_pk_bf16_f32 v141,v142,v143
v_cvt_pk_bf16_f32 v142,v156,v157
v_cvt_pk_bf16_f32 v143,v158,v159
v_mov_b32 v2,161792
v_mov_b32 v3,1
s_waitcnt vmcnt(0)
s_mov_b64 exec,1
ds_add_rtn_u32 v3,v2,v3 offset:48
s_mov_b64 exec,-1
s_add_u32 s50,s49,0
buffer_store_dwordx4 v[128:131],v1,s[36:39],s50 offen sc1
s_add_u32 s50,s49,147456
buffer_store_dwordx4 v[132:135],v1,s[36:39],s50 offen sc1
s_add_u32 s50,s49,294912
buffer_store_dwordx4 v[136:139],v1,s[36:39],s50 offen sc1
s_add_u32 s50,s49,442368
buffer_store_dwordx4 v[140:143],v1,s[36:39],s50 offen sc1
s_lshl_b32 s51,s43,1
s_and_b32 s52,s44,1
s_add_u32 s51,s51,s52
s_lshl_b32 s51,s51,2
s_lshl_b32 s52,s45,13
s_add_u32 s51,s51,s52
s_add_u32 s51,s51,42074112
s_waitcnt lgkmcnt(0)
v_readfirstlane_b32 s52,v3
v_lshlrev_b32 v3,9,v0
s_cmp_lg_u32 s52,7
s_cbranch_scc1 g2_nq0
s_mov_b64 exec,0xffff
buffer_store_dword v2,v3,s[36:39],s51 offen sc1
s_mov_b64 exec,-1
g2_nq0:
v_pk_fma_f32 v[192:193],v[40:41],v[56:57],v[192:193] op_sel:[0,0,0] op_sel_hi:[1,0,1]
v_pk_fma_f32 v[194:195],v[42:43],v[56:57],v[194:195] op_sel:[0,0,0] op_sel_hi:[1,0,1]
v_pk_fma_f32 v[208:209],v[44:45],v[56:57],v[208:209] op_sel:[0,0,0] op_sel_hi:[1,0,1]
v_pk_fma_f32 v[210:211],v[46:47],v[56:57],v[210:211] op_sel:[0,0,0] op_sel_hi:[1,0,1]
v_pk_mul_f32 v[192:193],v[192:193],v[64:65] op_sel:[0,0] op_sel_hi:[1,0]
v_pk_mul_f32 v[194:195],v[194:195],v[64:65] op_sel:[0,0] op_sel_hi:[1,0]
v_pk_mul_f32 v[208:209],v[208:209],v[64:65] op_sel:[0,0] op_sel_hi:[1,0]
v_pk_mul_f32 v[210:211],v[210:211],v[64:65] op_sel:[0,0] op_sel_hi:[1,0]
v_exp_f32 v192,v192
v_exp_f32 v193,v193
v_exp_f32 v194,v194
v_exp_f32 v195,v195
v_exp_f32 v208,v208
v_exp_f32 v209,v209
v_exp_f32 v210,v210
v_exp_f32 v211,v211
v_pk_fma_f32 v[224:225],v[48:49],v[56:57],v[224:225] op_sel:[0,0,0] op_sel_hi:[1,0,1]
v_pk_fma_f32 v[226:227],v[50:51],v[56:57],v[226:227] op_sel:[0,0,0] op_sel_hi:[1,0,1]
v_pk_fma_f32 v[240:241],v[52:53],v[56:57],v[240:241] op_sel:[0,0,0] op_sel_hi:[1,0,1]
v_pk_fma_f32 v[242:243],v[54:55],v[56:57],v[242:243] op_sel:[0,0,0] op_sel_hi:[1,0,1]
v_pk_fma_f32 v[192:193],v[192:193],v[72:73],v[72:73] op_sel:[0,0,0] op_sel_hi:[1,0,0]
v_pk_fma_f32 v[194:195],v[194:195],v[72:73],v[72:73] op_sel:[0,0,0] op_sel_hi:[1,0,0]
v_pk_fma_f32 v[208:209],v[208:209],v[72:73],v[72:73] op_sel:[0,0,0] op_sel_hi:[1,0,0]
v_pk_fma_f32 v[210:211],v[210:211],v[72:73],v[72:73] op_sel:[0,0,0] op_sel_hi:[1,0,0]
v_rcp_f32 v192,v192
v_rcp_f32 v193,v193
v_rcp_f32 v194,v194
v_rcp_f32 v195,v195
v_rcp_f32 v208,v208
v_rcp_f32 v209,v209
v_rcp_f32 v210,v210
v_rcp_f32 v211,v211
s_add_u32 s50,s49,1024
v_pk_mul_f32 v[192:193],v[192:193],v[224:225] op_sel:[0,0] op_sel_hi:[1,1]
v_pk_mul_f32 v[194:195],v[194:195],v[226:227] op_sel:[0,0] op_sel_hi:[1,1]
v_pk_mul_f32 v[208:209],v[208:209],v[240:241] op_sel:[0,0] op_sel_hi:[1,1]
v_pk_mul_f32 v[210:211],v[210:211],v[242:243] op_sel:[0,0] op_sel_hi:[1,1]
v_cvt_pk_bf16_f32 v192,v192,v193
v_cvt_pk_bf16_f32 v193,v194,v195
v_cvt_pk_bf16_f32 v194,v208,v209
v_cvt_pk_bf16_f32 v195,v210,v211
buffer_store_dwordx4 v[192:195],v1,s[36:39],s50 offen sc1
v_pk_fma_f32 v[196:197],v[40:41],v[58:59],v[196:197] op_sel:[0,0,0] op_sel_hi:[1,0,1]
v_pk_fma_f32 v[198:199],v[42:43],v[58:59],v[198:199] op_sel:[0,0,0] op_sel_hi:[1,0,1]
v_pk_fma_f32 v[212:213],v[44:45],v[58:59],v[212:213] op_sel:[0,0,0] op_sel_hi:[1,0,1]
v_pk_fma_f32 v[214:215],v[46:47],v[58:59],v[214:215] op_sel:[0,0,0] op_sel_hi:[1,0,1]
v_pk_mul_f32 v[196:197],v[196:197],v[66:67] op_sel:[0,0] op_sel_hi:[1,0]
v_pk_mul_f32 v[198:199],v[198:199],v[66:67] op_sel:[0,0] op_sel_hi:[1,0]
v_pk_mul_f32 v[212:213],v[212:213],v[66:67] op_sel:[0,0] op_sel_hi:[1,0]
v_pk_mul_f32 v[214:215],v[214:215],v[66:67] op_sel:[0,0] op_sel_hi:[1,0]
v_exp_f32 v196,v196
v_exp_f32 v197,v197
v_exp_f32 v198,v198
v_exp_f32 v199,v199
v_exp_f32 v212,v212
v_exp_f32 v213,v213
v_exp_f32 v214,v214
v_exp_f32 v215,v215
v_pk_fma_f32 v[228:229],v[48:49],v[58:59],v[228:229] op_sel:[0,0,0] op_sel_hi:[1,0,1]
v_pk_fma_f32 v[230:231],v[50:51],v[58:59],v[230:231] op_sel:[0,0,0] op_sel_hi:[1,0,1]
v_pk_fma_f32 v[244:245],v[52:53],v[58:59],v[244:245] op_sel:[0,0,0] op_sel_hi:[1,0,1]
v_pk_fma_f32 v[246:247],v[54:55],v[58:59],v[246:247] op_sel:[0,0,0] op_sel_hi:[1,0,1]
v_pk_fma_f32 v[196:197],v[196:197],v[74:75],v[74:75] op_sel:[0,0,0] op_sel_hi:[1,0,0]
v_pk_fma_f32 v[198:199],v[198:199],v[74:75],v[74:75] op_sel:[0,0,0] op_sel_hi:[1,0,0]
v_pk_fma_f32 v[212:213],v[212:213],v[74:75],v[74:75] op_sel:[0,0,0] op_sel_hi:[1,0,0]
v_pk_fma_f32 v[214:215],v[214:215],v[74:75],v[74:75] op_sel:[0,0,0] op_sel_hi:[1,0,0]
v_rcp_f32 v196,v196
v_rcp_f32 v197,v197
v_rcp_f32 v198,v198
v_rcp_f32 v199,v199
v_rcp_f32 v212,v212
v_rcp_f32 v213,v213
v_rcp_f32 v214,v214
v_rcp_f32 v215,v215
s_add_u32 s50,s49,148480
v_pk_mul_f32 v[196:197],v[196:197],v[228:229] op_sel:[0,0] op_sel_hi:[1,1]
v_pk_mul_f32 v[198:199],v[198:199],v[230:231] op_sel:[0,0] op_sel_hi:[1,1]
v_pk_mul_f32 v[212:213],v[212:213],v[244:245] op_sel:[0,0] op_sel_hi:[1,1]
v_pk_mul_f32 v[214:215],v[214:215],v[246:247] op_sel:[0,0] op_sel_hi:[1,1]
v_cvt_pk_bf16_f32 v196,v196,v197
v_cvt_pk_bf16_f32 v197,v198,v199
v_cvt_pk_bf16_f32 v198,v212,v213
v_cvt_pk_bf16_f32 v199,v214,v215
buffer_store_dwordx4 v[196:199],v1,s[36:39],s50 offen sc1
v_pk_fma_f32 v[200:201],v[40:41],v[60:61],v[200:201] op_sel:[0,0,0] op_sel_hi:[1,0,1]
v_pk_fma_f32 v[202:203],v[42:43],v[60:61],v[202:203] op_sel:[0,0,0] op_sel_hi:[1,0,1]
v_pk_fma_f32 v[216:217],v[44:45],v[60:61],v[216:217] op_sel:[0,0,0] op_sel_hi:[1,0,1]
v_pk_fma_f32 v[218:219],v[46:47],v[60:61],v[218:219] op_sel:[0,0,0] op_sel_hi:[1,0,1]
v_pk_mul_f32 v[200:201],v[200:201],v[68:69] op_sel:[0,0] op_sel_hi:[1,0]
v_pk_mul_f32 v[202:203],v[202:203],v[68:69] op_sel:[0,0] op_sel_hi:[1,0]
v_pk_mul_f32 v[216:217],v[216:217],v[68:69] op_sel:[0,0] op_sel_hi:[1,0]
v_pk_mul_f32 v[218:219],v[218:219],v[68:69] op_sel:[0,0] op_sel_hi:[1,0]
v_exp_f32 v200,v200
v_exp_f32 v201,v201
v_exp_f32 v202,v202
v_exp_f32 v203,v203
v_exp_f32 v216,v216
v_exp_f32 v217,v217
v_exp_f32 v218,v218
v_exp_f32 v219,v219
v_pk_fma_f32 v[232:233],v[48:49],v[60:61],v[232:233] op_sel:[0,0,0] op_sel_hi:[1,0,1]
v_pk_fma_f32 v[234:235],v[50:51],v[60:61],v[234:235] op_sel:[0,0,0] op_sel_hi:[1,0,1]
v_pk_fma_f32 v[248:249],v[52:53],v[60:61],v[248:249] op_sel:[0,0,0] op_sel_hi:[1,0,1]
v_pk_fma_f32 v[250:251],v[54:55],v[60:61],v[250:251] op_sel:[0,0,0] op_sel_hi:[1,0,1]
v_pk_fma_f32 v[200:201],v[200:201],v[76:77],v[76:77] op_sel:[0,0,0] op_sel_hi:[1,0,0]
v_pk_fma_f32 v[202:203],v[202:203],v[76:77],v[76:77] op_sel:[0,0,0] op_sel_hi:[1,0,0]
v_pk_fma_f32 v[216:217],v[216:217],v[76:77],v[76:77] op_sel:[0,0,0] op_sel_hi:[1,0,0]
v_pk_fma_f32 v[218:219],v[218:219],v[76:77],v[76:77] op_sel:[0,0,0] op_sel_hi:[1,0,0]
v_rcp_f32 v200,v200
v_rcp_f32 v201,v201
v_rcp_f32 v202,v202
v_rcp_f32 v203,v203
v_rcp_f32 v216,v216
v_rcp_f32 v217,v217
v_rcp_f32 v218,v218
v_rcp_f32 v219,v219
s_add_u32 s50,s49,295936
v_pk_mul_f32 v[200:201],v[200:201],v[232:233] op_sel:[0,0] op_sel_hi:[1,1]
v_pk_mul_f32 v[202:203],v[202:203],v[234:235] op_sel:[0,0] op_sel_hi:[1,1]
v_pk_mul_f32 v[216:217],v[216:217],v[248:249] op_sel:[0,0] op_sel_hi:[1,1]
v_pk_mul_f32 v[218:219],v[218:219],v[250:251] op_sel:[0,0] op_sel_hi:[1,1]
v_cvt_pk_bf16_f32 v200,v200,v201
v_cvt_pk_bf16_f32 v201,v202,v203
v_cvt_pk_bf16_f32 v202,v216,v217
v_cvt_pk_bf16_f32 v203,v218,v219
buffer_store_dwordx4 v[200:203],v1,s[36:39],s50 offen sc1
v_pk_fma_f32 v[204:205],v[40:41],v[62:63],v[204:205] op_sel:[0,0,0] op_sel_hi:[1,0,1]
v_pk_fma_f32 v[206:207],v[42:43],v[62:63],v[206:207] op_sel:[0,0,0] op_sel_hi:[1,0,1]
v_pk_fma_f32 v[220:221],v[44:45],v[62:63],v[220:221] op_sel:[0,0,0] op_sel_hi:[1,0,1]
v_pk_fma_f32 v[222:223],v[46:47],v[62:63],v[222:223] op_sel:[0,0,0] op_sel_hi:[1,0,1]
v_pk_mul_f32 v[204:205],v[204:205],v[70:71] op_sel:[0,0] op_sel_hi:[1,0]
v_pk_mul_f32 v[206:207],v[206:207],v[70:71] op_sel:[0,0] op_sel_hi:[1,0]
v_pk_mul_f32 v[220:221],v[220:221],v[70:71] op_sel:[0,0] op_sel_hi:[1,0]
v_pk_mul_f32 v[222:223],v[222:223],v[70:71] op_sel:[0,0] op_sel_hi:[1,0]
v_exp_f32 v204,v204
v_exp_f32 v205,v205
v_exp_f32 v206,v206
v_exp_f32 v207,v207
v_exp_f32 v220,v220
v_exp_f32 v221,v221
v_exp_f32 v222,v222
v_exp_f32 v223,v223
v_pk_fma_f32 v[236:237],v[48:49],v[62:63],v[236:237] op_sel:[0,0,0] op_sel_hi:[1,0,1]
v_pk_fma_f32 v[238:239],v[50:51],v[62:63],v[238:239] op_sel:[0,0,0] op_sel_hi:[1,0,1]
v_pk_fma_f32 v[252:253],v[52:53],v[62:63],v[252:253] op_sel:[0,0,0] op_sel_hi:[1,0,1]
v_pk_fma_f32 v[254:255],v[54:55],v[62:63],v[254:255] op_sel:[0,0,0] op_sel_hi:[1,0,1]
v_pk_fma_f32 v[204:205],v[204:205],v[78:79],v[78:79] op_sel:[0,0,0] op_sel_hi:[1,0,0]
v_pk_fma_f32 v[206:207],v[206:207],v[78:79],v[78:79] op_sel:[0,0,0] op_sel_hi:[1,0,0]
v_pk_fma_f32 v[220:221],v[220:221],v[78:79],v[78:79] op_sel:[0,0,0] op_sel_hi:[1,0,0]
v_pk_fma_f32 v[222:223],v[222:223],v[78:79],v[78:79] op_sel:[0,0,0] op_sel_hi:[1,0,0]
v_rcp_f32 v204,v204
v_rcp_f32 v205,v205
v_rcp_f32 v206,v206
v_rcp_f32 v207,v207
v_rcp_f32 v220,v220
v_rcp_f32 v221,v221
v_rcp_f32 v222,v222
v_rcp_f32 v223,v223
s_add_u32 s50,s49,443392
v_pk_mul_f32 v[204:205],v[204:205],v[236:237] op_sel:[0,0] op_sel_hi:[1,1]
v_pk_mul_f32 v[206:207],v[206:207],v[238:239] op_sel:[0,0] op_sel_hi:[1,1]
v_pk_mul_f32 v[220:221],v[220:221],v[252:253] op_sel:[0,0] op_sel_hi:[1,1]
v_pk_mul_f32 v[222:223],v[222:223],v[254:255] op_sel:[0,0] op_sel_hi:[1,1]
v_cvt_pk_bf16_f32 v204,v204,v205
v_cvt_pk_bf16_f32 v205,v206,v207
v_cvt_pk_bf16_f32 v206,v220,v221
v_cvt_pk_bf16_f32 v207,v222,v223
buffer_store_dwordx4 v[204:207],v1,s[36:39],s50 offen sc1
s_cmp_eq_u32 s100,-1
s_cbranch_scc1 af_entry
s_branch m_hnext
.p2align 6
g2_sp0:
s_waitcnt lgkmcnt(15)
v_mfma_f32_16x16x32_bf16 v[96:99],v[56:59],v[16:19],v[96:99]
v_mfma_f32_16x16x32_bf16 v[100:103],v[60:63],v[16:19],v[100:103]
v_mfma_f32_16x16x32_bf16 v[104:107],v[64:67],v[16:19],v[104:107]
v_mfma_f32_16x16x32_bf16 v[108:111],v[68:71],v[16:19],v[108:111]
s_waitcnt vmcnt(10) lgkmcnt(0)
s_barrier
s_bitcmp1_b32 s68,0
s_cbranch_scc0 g2_c0_1
v_lshlrev_b32 v12,16,v16
v_and_b32 v13,s69,v16
v_add_f32 v14,v12,v13
v_lshlrev_b32 v12,16,v17
v_and_b32 v13,s69,v17
v_add_f32 v14,v14,v12
v_add_f32 v14,v14,v13
v_lshlrev_b32 v12,16,v18
v_and_b32 v13,s69,v18
v_add_f32 v14,v14,v12
v_add_f32 v14,v14,v13
v_lshlrev_b32 v12,16,v19
v_and_b32 v13,s69,v19
v_add_f32 v14,v14,v12
v_add_f32 v14,v14,v13
g2_c0_1:
ds_read_b64_tr_b16 v[16:17],v1 offset:20480
v_mfma_f32_16x16x32_bf16 v[112:115],v[56:59],v[20:23],v[112:115]
ds_read_b64_tr_b16 v[18:19],v1 offset:20992
v_mfma_f32_16x16x32_bf16 v[116:119],v[60:63],v[20:23],v[116:119]
ds_read_b128 v[72:75],v94 offset:0
v_mfma_f32_16x16x32_bf16 v[120:123],v[64:67],v[20:23],v[120:123]
ds_read_b128 v[76:79],v94 offset:2048
v_mfma_f32_16x16x32_bf16 v[124:127],v[68:71],v[20:23],v[124:127]
s_bitcmp1_b32 s68,1
s_cbranch_scc0 g2_c0_2
v_lshlrev_b32 v12,16,v20
v_and_b32 v13,s69,v20
v_add_f32 v14,v12,v13
v_lshlrev_b32 v12,16,v21
v_and_b32 v13,s69,v21
v_add_f32 v14,v14,v12
v_add_f32 v14,v14,v13
v_lshlrev_b32 v12,16,v22
v_and_b32 v13,s69,v22
v_add_f32 v14,v14,v12
v_add_f32 v14,v14,v13
v_lshlrev_b32 v12,16,v23
v_and_b32 v13,s69,v23
v_add_f32 v14,v14,v12
v_add_f32 v14,v14,v13
g2_c0_2:
ds_read_b64_tr_b16 v[20:21],v2 offset:20480
v_mfma_f32_16x16x32_bf16 v[128:131],v[24:27],v[56:59],v[128:131]
ds_read_b64_tr_b16 v[22:23],v2 offset:20992
v_mfma_f32_16x16x32_bf16 v[132:135],v[24:27],v[60:63],v[132:135]
ds_read_b128 v[80:83],v94 offset:4096
v_mfma_f32_16x16x32_bf16 v[136:139],v[24:27],v[64:67],v[136:139]
ds_read_b128 v[84:87],v94 offset:6144
v_mfma_f32_16x16x32_bf16 v[140:143],v[24:27],v[68:71],v[140:143]
s_bitcmp1_b32 s68,2
s_cbranch_scc0 g2_c0_3
v_lshlrev_b32 v12,16,v24
v_and_b32 v13,s69,v24
v_add_f32 v14,v12,v13
v_lshlrev_b32 v12,16,v25
v_and_b32 v13,s69,v25
v_add_f32 v14,v14,v12
v_add_f32 v14,v14,v13
v_lshlrev_b32 v12,16,v26
v_and_b32 v13,s69,v26
v_add_f32 v14,v14,v12
v_add_f32 v14,v14,v13
v_lshlrev_b32 v12,16,v27
v_and_b32 v13,s69,v27
v_add_f32 v14,v14,v12
v_add_f32 v14,v14,v13
g2_c0_3:
ds_read_b64_tr_b16 v[24:25],v3 offset:20480
v_mfma_f32_16x16x32_bf16 v[144:147],v[28:31],v[56:59],v[144:147]
ds_read_b64_tr_b16 v[26:27],v3 offset:21504
v_mfma_f32_16x16x32_bf16 v[148:151],v[28:31],v[60:63],v[148:151]
s_add_u32 m0,s54,0
s_nop 0
buffer_load_dwordx4 v88,s[20:23],s48 offen lds
v_mfma_f32_16x16x32_bf16 v[152:155],v[28:31],v[64:67],v[152:155]
v_mfma_f32_16x16x32_bf16 v[156:159],v[28:31],v[68:71],v[156:159]
s_bitcmp1_b32 s68,3
s_cbranch_scc0 g2_c0_4
v_lshlrev_b32 v12,16,v28
v_and_b32 v13,s69,v28
v_add_f32 v14,v12,v13
v_lshlrev_b32 v12,16,v29
v_and_b32 v13,s69,v29
v_add_f32 v14,v14,v12
v_add_f32 v14,v14,v13
v_lshlrev_b32 v12,16,v30
v_and_b32 v13,s69,v30
v_add_f32 v14,v14,v12
v_add_f32 v14,v14,v13
v_lshlrev_b32 v12,16,v31
v_and_b32 v13,s69,v31
v_add_f32 v14,v14,v12
v_add_f32 v14,v14,v13
g2_c0_4:
ds_read_b64_tr_b16 v[28:29],v4 offset:20480
v_mfma_f32_16x16x32_bf16 v[160:163],v[32:35],v[56:59],v[160:163]
ds_read_b64_tr_b16 v[30:31],v4 offset:21504
v_mfma_f32_16x16x32_bf16 v[164:167],v[32:35],v[60:63],v[164:167]
s_add_u32 m0,s54,4096
s_nop 0
buffer_load_dwordx4 v89,s[24:27],s49 offen lds
v_mfma_f32_16x16x32_bf16 v[168:171],v[32:35],v[64:67],v[168:171]
v_mfma_f32_16x16x32_bf16 v[172:175],v[32:35],v[68:71],v[172:175]
s_bitcmp1_b32 s68,4
s_cbranch_scc0 g2_c0_5
v_lshlrev_b32 v12,16,v32
v_and_b32 v13,s69,v32
v_add_f32 v15,v12,v13
v_lshlrev_b32 v12,16,v33
v_and_b32 v13,s69,v33
v_add_f32 v15,v15,v12
v_add_f32 v15,v15,v13
v_lshlrev_b32 v12,16,v34
v_and_b32 v13,s69,v34
v_add_f32 v15,v15,v12
v_add_f32 v15,v15,v13
v_lshlrev_b32 v12,16,v35
v_and_b32 v13,s69,v35
v_add_f32 v15,v15,v12
v_add_f32 v15,v15,v13
g2_c0_5:
ds_read_b64_tr_b16 v[32:33],v5 offset:20480
v_mfma_f32_16x16x32_bf16 v[176:179],v[36:39],v[56:59],v[176:179]
ds_read_b64_tr_b16 v[34:35],v5 offset:21504
v_mfma_f32_16x16x32_bf16 v[180:183],v[36:39],v[60:63],v[180:183]
s_add_u32 m0,s54,8192
s_nop 0
buffer_load_dwordx4 v90,s[24:27],s49 offen lds
v_mfma_f32_16x16x32_bf16 v[184:187],v[36:39],v[64:67],v[184:187]
v_mfma_f32_16x16x32_bf16 v[188:191],v[36:39],v[68:71],v[188:191]
s_bitcmp1_b32 s68,5
s_cbranch_scc0 g2_c0_6
v_lshlrev_b32 v12,16,v36
v_and_b32 v13,s69,v36
v_add_f32 v15,v12,v13
v_lshlrev_b32 v12,16,v37
v_and_b32 v13,s69,v37
v_add_f32 v15,v15,v12
v_add_f32 v15,v15,v13
v_lshlrev_b32 v12,16,v38
v_and_b32 v13,s69,v38
v_add_f32 v15,v15,v12
v_add_f32 v15,v15,v13
v_lshlrev_b32 v12,16,v39
v_and_b32 v13,s69,v39
v_add_f32 v15,v15,v12
v_add_f32 v15,v15,v13
g2_c0_6:
ds_read_b64_tr_b16 v[36:37],v6 offset:20480
v_mfma_f32_16x16x32_bf16 v[192:195],v[40:43],v[56:59],v[192:195]
ds_read_b64_tr_b16 v[38:39],v6 offset:21504
v_mfma_f32_16x16x32_bf16 v[196:199],v[40:43],v[60:63],v[196:199]
s_add_u32 m0,s54,12288
s_nop 0
buffer_load_dwordx4 v91,s[28:31],s49 offen lds
v_mfma_f32_16x16x32_bf16 v[200:203],v[40:43],v[64:67],v[200:203]
v_mfma_f32_16x16x32_bf16 v[204:207],v[40:43],v[68:71],v[204:207]
s_bitcmp1_b32 s68,6
s_cbranch_scc0 g2_c0_7
v_lshlrev_b32 v12,16,v40
v_and_b32 v13,s69,v40
v_add_f32 v15,v12,v13
v_lshlrev_b32 v12,16,v41
v_and_b32 v13,s69,v41
v_add_f32 v15,v15,v12
v_add_f32 v15,v15,v13
v_lshlrev_b32 v12,16,v42
v_and_b32 v13,s69,v42
v_add_f32 v15,v15,v12
v_add_f32 v15,v15,v13
v_lshlrev_b32 v12,16,v43
v_and_b32 v13,s69,v43
v_add_f32 v15,v15,v12
v_add_f32 v15,v15,v13
g2_c0_7:
ds_read_b64_tr_b16 v[40:41],v7 offset:20480
v_mfma_f32_16x16x32_bf16 v[208:211],v[44:47],v[56:59],v[208:211]
ds_read_b64_tr_b16 v[42:43],v7 offset:21504
v_mfma_f32_16x16x32_bf16 v[212:215],v[44:47],v[60:63],v[212:215]
s_add_u32 m0,s54,16384
s_nop 0
buffer_load_dwordx4 v92,s[28:31],s49 offen lds
s_add_u32 s48,s48,196608
s_add_u32 s49,s49,229376
v_mfma_f32_16x16x32_bf16 v[216:219],v[44:47],v[64:67],v[216:219]
v_mfma_f32_16x16x32_bf16 v[220:223],v[44:47],v[68:71],v[220:223]
s_bitcmp1_b32 s68,7
s_cbranch_scc0 g2_c0_8
v_lshlrev_b32 v12,16,v44
v_and_b32 v13,s69,v44
v_add_f32 v15,v12,v13
v_lshlrev_b32 v12,16,v45
v_and_b32 v13,s69,v45
v_add_f32 v15,v15,v12
v_add_f32 v15,v15,v13
v_lshlrev_b32 v12,16,v46
v_and_b32 v13,s69,v46
v_add_f32 v15,v15,v12
v_add_f32 v15,v15,v13
v_lshlrev_b32 v12,16,v47
v_and_b32 v13,s69,v47
v_add_f32 v15,v15,v12
v_add_f32 v15,v15,v13
g2_c0_8:
ds_read_b64_tr_b16 v[44:45],v8 offset:20480
v_mfma_f32_16x16x32_bf16 v[224:227],v[48:51],v[56:59],v[224:227]
ds_read_b64_tr_b16 v[46:47],v8 offset:21504
v_mfma_f32_16x16x32_bf16 v[228:231],v[48:51],v[60:63],v[228:231]
v_mfma_f32_16x16x32_bf16 v[232:235],v[48:51],v[64:67],v[232:235]
v_mfma_f32_16x16x32_bf16 v[236:239],v[48:51],v[68:71],v[236:239]
s_bitcmp1_b32 s68,8
s_cbranch_scc0 g2_c0_9
v_lshlrev_b32 v12,16,v48
v_and_b32 v13,s69,v48
v_add_f32 v93,v12,v13
v_lshlrev_b32 v12,16,v49
v_and_b32 v13,s69,v49
v_add_f32 v93,v93,v12
v_add_f32 v93,v93,v13
v_lshlrev_b32 v12,16,v50
v_and_b32 v13,s69,v50
v_add_f32 v93,v93,v12
v_add_f32 v93,v93,v13
v_lshlrev_b32 v12,16,v51
v_and_b32 v13,s69,v51
v_add_f32 v93,v93,v12
v_add_f32 v93,v93,v13
g2_c0_9:
ds_read_b64_tr_b16 v[48:49],v9 offset:20480
v_mfma_f32_16x16x32_bf16 v[240:243],v[52:55],v[56:59],v[240:243]
ds_read_b64_tr_b16 v[50:51],v9 offset:21504
v_mfma_f32_16x16x32_bf16 v[244:247],v[52:55],v[60:63],v[244:247]
v_mfma_f32_16x16x32_bf16 v[248:251],v[52:55],v[64:67],v[248:251]
v_mfma_f32_16x16x32_bf16 v[252:255],v[52:55],v[68:71],v[252:255]
s_bitcmp1_b32 s68,9
s_cbranch_scc0 g2_c0_10
v_lshlrev_b32 v12,16,v52
v_and_b32 v13,s69,v52
v_add_f32 v93,v12,v13
v_lshlrev_b32 v12,16,v53
v_and_b32 v13,s69,v53
v_add_f32 v93,v93,v12
v_add_f32 v93,v93,v13
v_lshlrev_b32 v12,16,v54
v_and_b32 v13,s69,v54
v_add_f32 v93,v93,v12
v_add_f32 v93,v93,v13
v_lshlrev_b32 v12,16,v55
v_and_b32 v13,s69,v55
v_add_f32 v93,v93,v12
v_add_f32 v93,v93,v13
g2_c0_10:
ds_read_b64_tr_b16 v[52:53],v10 offset:20480
ds_read_b64_tr_b16 v[54:55],v10 offset:21504
s_waitcnt lgkmcnt(15)
v_mfma_f32_16x16x32_bf16 v[96:99],v[72:75],v[16:19],v[96:99]
v_mfma_f32_16x16x32_bf16 v[100:103],v[76:79],v[16:19],v[100:103]
v_mfma_f32_16x16x32_bf16 v[104:107],v[80:83],v[16:19],v[104:107]
v_mfma_f32_16x16x32_bf16 v[108:111],v[84:87],v[16:19],v[108:111]
s_waitcnt vmcnt(10) lgkmcnt(0)
s_barrier
s_bitcmp1_b32 s68,0
s_cbranch_scc0 g2_c0_11
v_lshlrev_b32 v12,16,v16
v_and_b32 v13,s69,v16
v_add_f32 v14,v14,v12
v_add_f32 v14,v14,v13
v_lshlrev_b32 v12,16,v17
v_and_b32 v13,s69,v17
v_add_f32 v14,v14,v12
v_add_f32 v14,v14,v13
v_lshlrev_b32 v12,16,v18
v_and_b32 v13,s69,v18
v_add_f32 v14,v14,v12
v_add_f32 v14,v14,v13
v_lshlrev_b32 v12,16,v19
v_and_b32 v13,s69,v19
v_add_f32 v14,v14,v12
v_add_f32 v14,v14,v13
g2_c0_11:
ds_read_b64_tr_b16 v[16:17],v1 offset:40960
v_mfma_f32_16x16x32_bf16 v[112:115],v[72:75],v[20:23],v[112:115]
ds_read_b64_tr_b16 v[18:19],v1 offset:41472
v_mfma_f32_16x16x32_bf16 v[116:119],v[76:79],v[20:23],v[116:119]
ds_read_b128 v[56:59],v11 offset:32768
v_mfma_f32_16x16x32_bf16 v[120:123],v[80:83],v[20:23],v[120:123]
ds_read_b128 v[60:63],v11 offset:34816
v_mfma_f32_16x16x32_bf16 v[124:127],v[84:87],v[20:23],v[124:127]
s_bitcmp1_b32 s68,1
s_cbranch_scc0 g2_c0_12
v_lshlrev_b32 v12,16,v20
v_and_b32 v13,s69,v20
v_add_f32 v14,v14,v12
v_add_f32 v14,v14,v13
v_lshlrev_b32 v12,16,v21
v_and_b32 v13,s69,v21
v_add_f32 v14,v14,v12
v_add_f32 v14,v14,v13
v_lshlrev_b32 v12,16,v22
v_and_b32 v13,s69,v22
v_add_f32 v14,v14,v12
v_add_f32 v14,v14,v13
v_lshlrev_b32 v12,16,v23
v_and_b32 v13,s69,v23
v_add_f32 v14,v14,v12
v_add_f32 v14,v14,v13
g2_c0_12:
ds_read_b64_tr_b16 v[20:21],v2 offset:40960
v_mfma_f32_16x16x32_bf16 v[128:131],v[24:27],v[72:75],v[128:131]
ds_read_b64_tr_b16 v[22:23],v2 offset:41472
v_mfma_f32_16x16x32_bf16 v[132:135],v[24:27],v[76:79],v[132:135]
ds_read_b128 v[64:67],v11 offset:36864
v_mfma_f32_16x16x32_bf16 v[136:139],v[24:27],v[80:83],v[136:139]
ds_read_b128 v[68:71],v11 offset:38912
v_mfma_f32_16x16x32_bf16 v[140:143],v[24:27],v[84:87],v[140:143]
s_bitcmp1_b32 s68,2
s_cbranch_scc0 g2_c0_13
v_lshlrev_b32 v12,16,v24
v_and_b32 v13,s69,v24
v_add_f32 v14,v14,v12
v_add_f32 v14,v14,v13
v_lshlrev_b32 v12,16,v25
v_and_b32 v13,s69,v25
v_add_f32 v14,v14,v12
v_add_f32 v14,v14,v13
v_lshlrev_b32 v12,16,v26
v_and_b32 v13,s69,v26
v_add_f32 v14,v14,v12
v_add_f32 v14,v14,v13
v_lshlrev_b32 v12,16,v27
v_and_b32 v13,s69,v27
v_add_f32 v14,v14,v12
v_add_f32 v14,v14,v13
g2_c0_13:
ds_read_b64_tr_b16 v[24:25],v3 offset:40960
v_mfma_f32_16x16x32_bf16 v[144:147],v[28:31],v[72:75],v[144:147]
ds_read_b64_tr_b16 v[26:27],v3 offset:41984
v_mfma_f32_16x16x32_bf16 v[148:151],v[28:31],v[76:79],v[148:151]
s_add_u32 m0,s54,20480
s_nop 0
buffer_load_dwordx4 v88,s[20:23],s48 offen lds
v_mfma_f32_16x16x32_bf16 v[152:155],v[28:31],v[80:83],v[152:155]
v_mfma_f32_16x16x32_bf16 v[156:159],v[28:31],v[84:87],v[156:159]
s_bitcmp1_b32 s68,3
s_cbranch_scc0 g2_c0_14
v_lshlrev_b32 v12,16,v28
v_and_b32 v13,s69,v28
v_add_f32 v14,v14,v12
v_add_f32 v14,v14,v13
v_lshlrev_b32 v12,16,v29
v_and_b32 v13,s69,v29
v_add_f32 v14,v14,v12
v_add_f32 v14,v14,v13
v_lshlrev_b32 v12,16,v30
v_and_b32 v13,s69,v30
v_add_f32 v14,v14,v12
v_add_f32 v14,v14,v13
v_lshlrev_b32 v12,16,v31
v_and_b32 v13,s69,v31
v_add_f32 v14,v14,v12
v_add_f32 v14,v14,v13
g2_c0_14:
ds_read_b64_tr_b16 v[28:29],v4 offset:40960
v_mfma_f32_16x16x32_bf16 v[160:163],v[32:35],v[72:75],v[160:163]
ds_read_b64_tr_b16 v[30:31],v4 offset:41984
v_mfma_f32_16x16x32_bf16 v[164:167],v[32:35],v[76:79],v[164:167]
s_add_u32 m0,s54,24576
s_nop 0
buffer_load_dwordx4 v89,s[24:27],s49 offen lds
v_mfma_f32_16x16x32_bf16 v[168:171],v[32:35],v[80:83],v[168:171]
v_mfma_f32_16x16x32_bf16 v[172:175],v[32:35],v[84:87],v[172:175]
s_bitcmp1_b32 s68,4
s_cbranch_scc0 g2_c0_15
v_lshlrev_b32 v12,16,v32
v_and_b32 v13,s69,v32
v_add_f32 v15,v15,v12
v_add_f32 v15,v15,v13
v_lshlrev_b32 v12,16,v33
v_and_b32 v13,s69,v33
v_add_f32 v15,v15,v12
v_add_f32 v15,v15,v13
v_lshlrev_b32 v12,16,v34
v_and_b32 v13,s69,v34
v_add_f32 v15,v15,v12
v_add_f32 v15,v15,v13
v_lshlrev_b32 v12,16,v35
v_and_b32 v13,s69,v35
v_add_f32 v15,v15,v12
v_add_f32 v15,v15,v13
g2_c0_15:
ds_read_b64_tr_b16 v[32:33],v5 offset:40960
v_mfma_f32_16x16x32_bf16 v[176:179],v[36:39],v[72:75],v[176:179]
ds_read_b64_tr_b16 v[34:35],v5 offset:41984
v_mfma_f32_16x16x32_bf16 v[180:183],v[36:39],v[76:79],v[180:183]
s_add_u32 m0,s54,28672
s_nop 0
buffer_load_dwordx4 v90,s[24:27],s49 offen lds
v_mfma_f32_16x16x32_bf16 v[184:187],v[36:39],v[80:83],v[184:187]
v_mfma_f32_16x16x32_bf16 v[188:191],v[36:39],v[84:87],v[188:191]
s_bitcmp1_b32 s68,5
s_cbranch_scc0 g2_c0_16
v_lshlrev_b32 v12,16,v36
v_and_b32 v13,s69,v36
v_add_f32 v15,v15,v12
v_add_f32 v15,v15,v13
v_lshlrev_b32 v12,16,v37
v_and_b32 v13,s69,v37
v_add_f32 v15,v15,v12
v_add_f32 v15,v15,v13
v_lshlrev_b32 v12,16,v38
v_and_b32 v13,s69,v38
v_add_f32 v15,v15,v12
v_add_f32 v15,v15,v13
v_lshlrev_b32 v12,16,v39
v_and_b32 v13,s69,v39
v_add_f32 v15,v15,v12
v_add_f32 v15,v15,v13
g2_c0_16:
ds_read_b64_tr_b16 v[36:37],v6 offset:40960
v_mfma_f32_16x16x32_bf16 v[192:195],v[40:43],v[72:75],v[192:195]
ds_read_b64_tr_b16 v[38:39],v6 offset:41984
v_mfma_f32_16x16x32_bf16 v[196:199],v[40:43],v[76:79],v[196:199]
s_add_u32 m0,s54,32768
s_nop 0
buffer_load_dwordx4 v91,s[28:31],s49 offen lds
v_mfma_f32_16x16x32_bf16 v[200:203],v[40:43],v[80:83],v[200:203]
v_mfma_f32_16x16x32_bf16 v[204:207],v[40:43],v[84:87],v[204:207]
s_bitcmp1_b32 s68,6
s_cbranch_scc0 g2_c0_17
v_lshlrev_b32 v12,16,v40
v_and_b32 v13,s69,v40
v_add_f32 v15,v15,v12
v_add_f32 v15,v15,v13
v_lshlrev_b32 v12,16,v41
v_and_b32 v13,s69,v41
v_add_f32 v15,v15,v12
v_add_f32 v15,v15,v13
v_lshlrev_b32 v12,16,v42
v_and_b32 v13,s69,v42
v_add_f32 v15,v15,v12
v_add_f32 v15,v15,v13
v_lshlrev_b32 v12,16,v43
v_and_b32 v13,s69,v43
v_add_f32 v15,v15,v12
v_add_f32 v15,v15,v13
g2_c0_17:
ds_read_b64_tr_b16 v[40:41],v7 offset:40960
v_mfma_f32_16x16x32_bf16 v[208:211],v[44:47],v[72:75],v[208:211]
ds_read_b64_tr_b16 v[42:43],v7 offset:41984
v_mfma_f32_16x16x32_bf16 v[212:215],v[44:47],v[76:79],v[212:215]
s_add_u32 m0,s54,36864
s_nop 0
buffer_load_dwordx4 v92,s[28:31],s49 offen lds
s_add_u32 s48,s48,196608
s_add_u32 s49,s49,229376
v_mfma_f32_16x16x32_bf16 v[216:219],v[44:47],v[80:83],v[216:219]
v_mfma_f32_16x16x32_bf16 v[220:223],v[44:47],v[84:87],v[220:223]
s_bitcmp1_b32 s68,7
s_cbranch_scc0 g2_c0_18
v_lshlrev_b32 v12,16,v44
v_and_b32 v13,s69,v44
v_add_f32 v15,v15,v12
v_add_f32 v15,v15,v13
v_lshlrev_b32 v12,16,v45
v_and_b32 v13,s69,v45
v_add_f32 v15,v15,v12
v_add_f32 v15,v15,v13
v_lshlrev_b32 v12,16,v46
v_and_b32 v13,s69,v46
v_add_f32 v15,v15,v12
v_add_f32 v15,v15,v13
v_lshlrev_b32 v12,16,v47
v_and_b32 v13,s69,v47
v_add_f32 v15,v15,v12
v_add_f32 v15,v15,v13
g2_c0_18:
ds_read_b64_tr_b16 v[44:45],v8 offset:40960
v_mfma_f32_16x16x32_bf16 v[224:227],v[48:51],v[72:75],v[224:227]
ds_read_b64_tr_b16 v[46:47],v8 offset:41984
v_mfma_f32_16x16x32_bf16 v[228:231],v[48:51],v[76:79],v[228:231]
v_mfma_f32_16x16x32_bf16 v[232:235],v[48:51],v[80:83],v[232:235]
v_mfma_f32_16x16x32_bf16 v[236:239],v[48:51],v[84:87],v[236:239]
s_bitcmp1_b32 s68,8
s_cbranch_scc0 g2_c0_19
v_lshlrev_b32 v12,16,v48
v_and_b32 v13,s69,v48
v_add_f32 v93,v93,v12
v_add_f32 v93,v93,v13
v_lshlrev_b32 v12,16,v49
v_and_b32 v13,s69,v49
v_add_f32 v93,v93,v12
v_add_f32 v93,v93,v13
v_lshlrev_b32 v12,16,v50
v_and_b32 v13,s69,v50
v_add_f32 v93,v93,v12
v_add_f32 v93,v93,v13
v_lshlrev_b32 v12,16,v51
v_and_b32 v13,s69,v51
v_add_f32 v93,v93,v12
v_add_f32 v93,v93,v13
g2_c0_19:
ds_read_b64_tr_b16 v[48:49],v9 offset:40960
v_mfma_f32_16x16x32_bf16 v[240:243],v[52:55],v[72:75],v[240:243]
ds_read_b64_tr_b16 v[50:51],v9 offset:41984
v_mfma_f32_16x16x32_bf16 v[244:247],v[52:55],v[76:79],v[244:247]
v_mfma_f32_16x16x32_bf16 v[248:251],v[52:55],v[80:83],v[248:251]
v_mfma_f32_16x16x32_bf16 v[252:255],v[52:55],v[84:87],v[252:255]
s_bitcmp1_b32 s68,9
s_cbranch_scc0 g2_c0_20
v_lshlrev_b32 v12,16,v52
v_and_b32 v13,s69,v52
v_add_f32 v93,v93,v12
v_add_f32 v93,v93,v13
v_lshlrev_b32 v12,16,v53
v_and_b32 v13,s69,v53
v_add_f32 v93,v93,v12
v_add_f32 v93,v93,v13
v_lshlrev_b32 v12,16,v54
v_and_b32 v13,s69,v54
v_add_f32 v93,v93,v12
v_add_f32 v93,v93,v13
v_lshlrev_b32 v12,16,v55
v_and_b32 v13,s69,v55
v_add_f32 v93,v93,v12
v_add_f32 v93,v93,v13
g2_c0_20:
ds_read_b64_tr_b16 v[52:53],v10 offset:40960
ds_read_b64_tr_b16 v[54:55],v10 offset:41984
s_waitcnt lgkmcnt(15)
v_mfma_f32_16x16x32_bf16 v[96:99],v[56:59],v[16:19],v[96:99]
v_mfma_f32_16x16x32_bf16 v[100:103],v[60:63],v[16:19],v[100:103]
v_mfma_f32_16x16x32_bf16 v[104:107],v[64:67],v[16:19],v[104:107]
v_mfma_f32_16x16x32_bf16 v[108:111],v[68:71],v[16:19],v[108:111]
s_waitcnt vmcnt(10) lgkmcnt(0)
s_barrier
s_bitcmp1_b32 s68,0
s_cbranch_scc0 g2_c0_21
v_lshlrev_b32 v12,16,v16
v_and_b32 v13,s69,v16
v_add_f32 v14,v14,v12
v_add_f32 v14,v14,v13
v_lshlrev_b32 v12,16,v17
v_and_b32 v13,s69,v17
v_add_f32 v14,v14,v12
v_add_f32 v14,v14,v13
v_lshlrev_b32 v12,16,v18
v_and_b32 v13,s69,v18
v_add_f32 v14,v14,v12
v_add_f32 v14,v14,v13
v_lshlrev_b32 v12,16,v19
v_and_b32 v13,s69,v19
v_add_f32 v14,v14,v12
v_add_f32 v14,v14,v13
g2_c0_21:
ds_read_b64_tr_b16 v[16:17],v1 offset:61440
v_mfma_f32_16x16x32_bf16 v[112:115],v[56:59],v[20:23],v[112:115]
ds_read_b64_tr_b16 v[18:19],v1 offset:61952
v_mfma_f32_16x16x32_bf16 v[116:119],v[60:63],v[20:23],v[116:119]
ds_read_b128 v[72:75],v94 offset:32768
v_mfma_f32_16x16x32_bf16 v[120:123],v[64:67],v[20:23],v[120:123]
ds_read_b128 v[76:79],v94 offset:34816
v_mfma_f32_16x16x32_bf16 v[124:127],v[68:71],v[20:23],v[124:127]
s_bitcmp1_b32 s68,1
s_cbranch_scc0 g2_c0_22
v_lshlrev_b32 v12,16,v20
v_and_b32 v13,s69,v20
v_add_f32 v14,v14,v12
v_add_f32 v14,v14,v13
v_lshlrev_b32 v12,16,v21
v_and_b32 v13,s69,v21
v_add_f32 v14,v14,v12
v_add_f32 v14,v14,v13
v_lshlrev_b32 v12,16,v22
v_and_b32 v13,s69,v22
v_add_f32 v14,v14,v12
v_add_f32 v14,v14,v13
v_lshlrev_b32 v12,16,v23
v_and_b32 v13,s69,v23
v_add_f32 v14,v14,v12
v_add_f32 v14,v14,v13
g2_c0_22:
ds_read_b64_tr_b16 v[20:21],v2 offset:61440
v_mfma_f32_16x16x32_bf16 v[128:131],v[24:27],v[56:59],v[128:131]
ds_read_b64_tr_b16 v[22:23],v2 offset:61952
v_mfma_f32_16x16x32_bf16 v[132:135],v[24:27],v[60:63],v[132:135]
ds_read_b128 v[80:83],v94 offset:36864
v_mfma_f32_16x16x32_bf16 v[136:139],v[24:27],v[64:67],v[136:139]
ds_read_b128 v[84:87],v94 offset:38912
v_mfma_f32_16x16x32_bf16 v[140:143],v[24:27],v[68:71],v[140:143]
s_bitcmp1_b32 s68,2
s_cbranch_scc0 g2_c0_23
v_lshlrev_b32 v12,16,v24
v_and_b32 v13,s69,v24
v_add_f32 v14,v14,v12
v_add_f32 v14,v14,v13
v_lshlrev_b32 v12,16,v25
v_and_b32 v13,s69,v25
v_add_f32 v14,v14,v12
v_add_f32 v14,v14,v13
v_lshlrev_b32 v12,16,v26
v_and_b32 v13,s69,v26
v_add_f32 v14,v14,v12
v_add_f32 v14,v14,v13
v_lshlrev_b32 v12,16,v27
v_and_b32 v13,s69,v27
v_add_f32 v14,v14,v12
v_add_f32 v14,v14,v13
g2_c0_23:
ds_read_b64_tr_b16 v[24:25],v3 offset:61440
v_mfma_f32_16x16x32_bf16 v[144:147],v[28:31],v[56:59],v[144:147]
ds_read_b64_tr_b16 v[26:27],v3 offset:62464
v_mfma_f32_16x16x32_bf16 v[148:151],v[28:31],v[60:63],v[148:151]
s_add_u32 m0,s54,40960
s_nop 0
buffer_load_dwordx4 v88,s[20:23],s48 offen lds
v_mfma_f32_16x16x32_bf16 v[152:155],v[28:31],v[64:67],v[152:155]
v_mfma_f32_16x16x32_bf16 v[156:159],v[28:31],v[68:71],v[156:159]
s_bitcmp1_b32 s68,3
s_cbranch_scc0 g2_c0_24
v_lshlrev_b32 v12,16,v28
v_and_b32 v13,s69,v28
v_add_f32 v14,v14,v12
v_add_f32 v14,v14,v13
v_lshlrev_b32 v12,16,v29
v_and_b32 v13,s69,v29
v_add_f32 v14,v14,v12
v_add_f32 v14,v14,v13
v_lshlrev_b32 v12,16,v30
v_and_b32 v13,s69,v30
v_add_f32 v14,v14,v12
v_add_f32 v14,v14,v13
v_lshlrev_b32 v12,16,v31
v_and_b32 v13,s69,v31
v_add_f32 v14,v14,v12
v_add_f32 v14,v14,v13
g2_c0_24:
ds_read_b64_tr_b16 v[28:29],v4 offset:61440
v_mfma_f32_16x16x32_bf16 v[160:163],v[32:35],v[56:59],v[160:163]
ds_read_b64_tr_b16 v[30:31],v4 offset:62464
v_mfma_f32_16x16x32_bf16 v[164:167],v[32:35],v[60:63],v[164:167]
s_add_u32 m0,s54,45056
s_nop 0
buffer_load_dwordx4 v89,s[24:27],s49 offen lds
v_mfma_f32_16x16x32_bf16 v[168:171],v[32:35],v[64:67],v[168:171]
v_mfma_f32_16x16x32_bf16 v[172:175],v[32:35],v[68:71],v[172:175]
s_bitcmp1_b32 s68,4
s_cbranch_scc0 g2_c0_25
v_lshlrev_b32 v12,16,v32
v_and_b32 v13,s69,v32
v_add_f32 v15,v15,v12
v_add_f32 v15,v15,v13
v_lshlrev_b32 v12,16,v33
v_and_b32 v13,s69,v33
v_add_f32 v15,v15,v12
v_add_f32 v15,v15,v13
v_lshlrev_b32 v12,16,v34
v_and_b32 v13,s69,v34
v_add_f32 v15,v15,v12
v_add_f32 v15,v15,v13
v_lshlrev_b32 v12,16,v35
v_and_b32 v13,s69,v35
v_add_f32 v15,v15,v12
v_add_f32 v15,v15,v13
g2_c0_25:
ds_read_b64_tr_b16 v[32:33],v5 offset:61440
v_mfma_f32_16x16x32_bf16 v[176:179],v[36:39],v[56:59],v[176:179]
ds_read_b64_tr_b16 v[34:35],v5 offset:62464
v_mfma_f32_16x16x32_bf16 v[180:183],v[36:39],v[60:63],v[180:183]
s_add_u32 m0,s54,49152
s_nop 0
buffer_load_dwordx4 v90,s[24:27],s49 offen lds
v_mfma_f32_16x16x32_bf16 v[184:187],v[36:39],v[64:67],v[184:187]
v_mfma_f32_16x16x32_bf16 v[188:191],v[36:39],v[68:71],v[188:191]
s_bitcmp1_b32 s68,5
s_cbranch_scc0 g2_c0_26
v_lshlrev_b32 v12,16,v36
v_and_b32 v13,s69,v36
v_add_f32 v15,v15,v12
v_add_f32 v15,v15,v13
v_lshlrev_b32 v12,16,v37
v_and_b32 v13,s69,v37
v_add_f32 v15,v15,v12
v_add_f32 v15,v15,v13
v_lshlrev_b32 v12,16,v38
v_and_b32 v13,s69,v38
v_add_f32 v15,v15,v12
v_add_f32 v15,v15,v13
v_lshlrev_b32 v12,16,v39
v_and_b32 v13,s69,v39
v_add_f32 v15,v15,v12
v_add_f32 v15,v15,v13
g2_c0_26:
ds_read_b64_tr_b16 v[36:37],v6 offset:61440
v_mfma_f32_16x16x32_bf16 v[192:195],v[40:43],v[56:59],v[192:195]
ds_read_b64_tr_b16 v[38:39],v6 offset:62464
v_mfma_f32_16x16x32_bf16 v[196:199],v[40:43],v[60:63],v[196:199]
s_add_u32 m0,s54,53248
s_nop 0
buffer_load_dwordx4 v91,s[28:31],s49 offen lds
v_mfma_f32_16x16x32_bf16 v[200:203],v[40:43],v[64:67],v[200:203]
v_mfma_f32_16x16x32_bf16 v[204:207],v[40:43],v[68:71],v[204:207]
s_bitcmp1_b32 s68,6
s_cbranch_scc0 g2_c0_27
v_lshlrev_b32 v12,16,v40
v_and_b32 v13,s69,v40
v_add_f32 v15,v15,v12
v_add_f32 v15,v15,v13
v_lshlrev_b32 v12,16,v41
v_and_b32 v13,s69,v41
v_add_f32 v15,v15,v12
v_add_f32 v15,v15,v13
v_lshlrev_b32 v12,16,v42
v_and_b32 v13,s69,v42
v_add_f32 v15,v15,v12
v_add_f32 v15,v15,v13
v_lshlrev_b32 v12,16,v43
v_and_b32 v13,s69,v43
v_add_f32 v15,v15,v12
v_add_f32 v15,v15,v13
g2_c0_27:
ds_read_b64_tr_b16 v[40:41],v7 offset:61440
v_mfma_f32_16x16x32_bf16 v[208:211],v[44:47],v[56:59],v[208:211]
ds_read_b64_tr_b16 v[42:43],v7 offset:62464
v_mfma_f32_16x16x32_bf16 v[212:215],v[44:47],v[60:63],v[212:215]
s_add_u32 m0,s54,57344
s_nop 0
buffer_load_dwordx4 v92,s[28:31],s49 offen lds
s_add_u32 s48,s48,196608
s_add_u32 s49,s49,229376
v_mfma_f32_16x16x32_bf16 v[216:219],v[44:47],v[64:67],v[216:219]
v_mfma_f32_16x16x32_bf16 v[220:223],v[44:47],v[68:71],v[220:223]
s_bitcmp1_b32 s68,7
s_cbranch_scc0 g2_c0_28
v_lshlrev_b32 v12,16,v44
v_and_b32 v13,s69,v44
v_add_f32 v15,v15,v12
v_add_f32 v15,v15,v13
v_lshlrev_b32 v12,16,v45
v_and_b32 v13,s69,v45
v_add_f32 v15,v15,v12
v_add_f32 v15,v15,v13
v_lshlrev_b32 v12,16,v46
v_and_b32 v13,s69,v46
v_add_f32 v15,v15,v12
v_add_f32 v15,v15,v13
v_lshlrev_b32 v12,16,v47
v_and_b32 v13,s69,v47
v_add_f32 v15,v15,v12
v_add_f32 v15,v15,v13
g2_c0_28:
ds_read_b64_tr_b16 v[44:45],v8 offset:61440
v_mfma_f32_16x16x32_bf16 v[224:227],v[48:51],v[56:59],v[224:227]
ds_read_b64_tr_b16 v[46:47],v8 offset:62464
v_mfma_f32_16x16x32_bf16 v[228:231],v[48:51],v[60:63],v[228:231]
v_mfma_f32_16x16x32_bf16 v[232:235],v[48:51],v[64:67],v[232:235]
v_mfma_f32_16x16x32_bf16 v[236:239],v[48:51],v[68:71],v[236:239]
s_bitcmp1_b32 s68,8
s_cbranch_scc0 g2_c0_29
v_lshlrev_b32 v12,16,v48
v_and_b32 v13,s69,v48
v_add_f32 v93,v93,v12
v_add_f32 v93,v93,v13
v_lshlrev_b32 v12,16,v49
v_and_b32 v13,s69,v49
v_add_f32 v93,v93,v12
v_add_f32 v93,v93,v13
v_lshlrev_b32 v12,16,v50
v_and_b32 v13,s69,v50
v_add_f32 v93,v93,v12
v_add_f32 v93,v93,v13
v_lshlrev_b32 v12,16,v51
v_and_b32 v13,s69,v51
v_add_f32 v93,v93,v12
v_add_f32 v93,v93,v13
g2_c0_29:
ds_read_b64_tr_b16 v[48:49],v9 offset:61440
v_mfma_f32_16x16x32_bf16 v[240:243],v[52:55],v[56:59],v[240:243]
ds_read_b64_tr_b16 v[50:51],v9 offset:62464
v_mfma_f32_16x16x32_bf16 v[244:247],v[52:55],v[60:63],v[244:247]
v_mfma_f32_16x16x32_bf16 v[248:251],v[52:55],v[64:67],v[248:251]
v_mfma_f32_16x16x32_bf16 v[252:255],v[52:55],v[68:71],v[252:255]
s_bitcmp1_b32 s68,9
s_cbranch_scc0 g2_c0_30
v_lshlrev_b32 v12,16,v52
v_and_b32 v13,s69,v52
v_add_f32 v93,v93,v12
v_add_f32 v93,v93,v13
v_lshlrev_b32 v12,16,v53
v_and_b32 v13,s69,v53
v_add_f32 v93,v93,v12
v_add_f32 v93,v93,v13
v_lshlrev_b32 v12,16,v54
v_and_b32 v13,s69,v54
v_add_f32 v93,v93,v12
v_add_f32 v93,v93,v13
v_lshlrev_b32 v12,16,v55
v_and_b32 v13,s69,v55
v_add_f32 v93,v93,v12
v_add_f32 v93,v93,v13
g2_c0_30:
ds_read_b64_tr_b16 v[52:53],v10 offset:61440
ds_read_b64_tr_b16 v[54:55],v10 offset:62464
s_waitcnt lgkmcnt(15)
v_mfma_f32_16x16x32_bf16 v[96:99],v[72:75],v[16:19],v[96:99]
v_mfma_f32_16x16x32_bf16 v[100:103],v[76:79],v[16:19],v[100:103]
v_mfma_f32_16x16x32_bf16 v[104:107],v[80:83],v[16:19],v[104:107]
v_mfma_f32_16x16x32_bf16 v[108:111],v[84:87],v[16:19],v[108:111]
s_waitcnt vmcnt(10) lgkmcnt(0)
s_barrier
s_bitcmp1_b32 s68,0
s_cbranch_scc0 g2_c0_31
v_lshlrev_b32 v12,16,v16
v_and_b32 v13,s69,v16
v_add_f32 v14,v14,v12
v_add_f32 v14,v14,v13
v_lshlrev_b32 v12,16,v17
v_and_b32 v13,s69,v17
v_add_f32 v14,v14,v12
v_add_f32 v14,v14,v13
v_lshlrev_b32 v12,16,v18
v_and_b32 v13,s69,v18
v_add_f32 v14,v14,v12
v_add_f32 v14,v14,v13
v_lshlrev_b32 v12,16,v19
v_and_b32 v13,s69,v19
v_add_f32 v14,v14,v12
v_add_f32 v14,v14,v13
v_and_b32 v12,15,v0
v_lshrrev_b32 v13,4,v0
v_lshlrev_b32 v12,4,v12
v_lshl_add_u32 v12,v13,2,v12
v_add_u32 v12,153600,v12
ds_write_b32 v12,v14 offset:0
g2_c0_31:
ds_read_b64_tr_b16 v[16:17],v1 offset:0
v_mfma_f32_16x16x32_bf16 v[112:115],v[72:75],v[20:23],v[112:115]
ds_read_b64_tr_b16 v[18:19],v1 offset:512
v_mfma_f32_16x16x32_bf16 v[116:119],v[76:79],v[20:23],v[116:119]
ds_read_b128 v[56:59],v11 offset:0
v_mfma_f32_16x16x32_bf16 v[120:123],v[80:83],v[20:23],v[120:123]
ds_read_b128 v[60:63],v11 offset:2048
v_mfma_f32_16x16x32_bf16 v[124:127],v[84:87],v[20:23],v[124:127]
s_bitcmp1_b32 s68,1
s_cbranch_scc0 g2_c0_32
v_lshlrev_b32 v12,16,v20
v_and_b32 v13,s69,v20
v_add_f32 v14,v14,v12
v_add_f32 v14,v14,v13
v_lshlrev_b32 v12,16,v21
v_and_b32 v13,s69,v21
v_add_f32 v14,v14,v12
v_add_f32 v14,v14,v13
v_lshlrev_b32 v12,16,v22
v_and_b32 v13,s69,v22
v_add_f32 v14,v14,v12
v_add_f32 v14,v14,v13
v_lshlrev_b32 v12,16,v23
v_and_b32 v13,s69,v23
v_add_f32 v14,v14,v12
v_add_f32 v14,v14,v13
v_and_b32 v12,15,v0
v_lshrrev_b32 v13,4,v0
v_lshlrev_b32 v12,4,v12
v_lshl_add_u32 v12,v13,2,v12
v_add_u32 v12,153600,v12
ds_write_b32 v12,v14 offset:256
g2_c0_32:
ds_read_b64_tr_b16 v[20:21],v2 offset:0
v_mfma_f32_16x16x32_bf16 v[128:131],v[24:27],v[72:75],v[128:131]
ds_read_b64_tr_b16 v[22:23],v2 offset:512
v_mfma_f32_16x16x32_bf16 v[132:135],v[24:27],v[76:79],v[132:135]
ds_read_b128 v[64:67],v11 offset:4096
v_mfma_f32_16x16x32_bf16 v[136:139],v[24:27],v[80:83],v[136:139]
ds_read_b128 v[68:71],v11 offset:6144
v_mfma_f32_16x16x32_bf16 v[140:143],v[24:27],v[84:87],v[140:143]
s_bitcmp1_b32 s68,2
s_cbranch_scc0 g2_c0_33
v_lshlrev_b32 v12,16,v24
v_and_b32 v13,s69,v24
v_add_f32 v14,v14,v12
v_add_f32 v14,v14,v13
v_lshlrev_b32 v12,16,v25
v_and_b32 v13,s69,v25
v_add_f32 v14,v14,v12
v_add_f32 v14,v14,v13
v_lshlrev_b32 v12,16,v26
v_and_b32 v13,s69,v26
v_add_f32 v14,v14,v12
v_add_f32 v14,v14,v13
v_lshlrev_b32 v12,16,v27
v_and_b32 v13,s69,v27
v_add_f32 v14,v14,v12
v_add_f32 v14,v14,v13
v_and_b32 v12,15,v0
v_lshrrev_b32 v13,4,v0
v_lshlrev_b32 v12,4,v12
v_lshl_add_u32 v12,v13,2,v12
v_add_u32 v12,153600,v12
ds_write_b32 v12,v14 offset:1024
g2_c0_33:
ds_read_b64_tr_b16 v[24:25],v3 offset:0
v_mfma_f32_16x16x32_bf16 v[144:147],v[28:31],v[72:75],v[144:147]
ds_read_b64_tr_b16 v[26:27],v3 offset:1024
v_mfma_f32_16x16x32_bf16 v[148:151],v[28:31],v[76:79],v[148:151]
s_add_u32 m0,s54,61440
s_nop 0
buffer_load_dwordx4 v88,s[20:23],s48 offen lds
v_mfma_f32_16x16x32_bf16 v[152:155],v[28:31],v[80:83],v[152:155]
v_mfma_f32_16x16x32_bf16 v[156:159],v[28:31],v[84:87],v[156:159]
s_bitcmp1_b32 s68,3
s_cbranch_scc0 g2_c0_34
v_lshlrev_b32 v12,16,v28
v_and_b32 v13,s69,v28
v_add_f32 v14,v14,v12
v_add_f32 v14,v14,v13
v_lshlrev_b32 v12,16,v29
v_and_b32 v13,s69,v29
v_add_f32 v14,v14,v12
v_add_f32 v14,v14,v13
v_lshlrev_b32 v12,16,v30
v_and_b32 v13,s69,v30
v_add_f32 v14,v14,v12
v_add_f32 v14,v14,v13
v_lshlrev_b32 v12,16,v31
v_and_b32 v13,s69,v31
v_add_f32 v14,v14,v12
v_add_f32 v14,v14,v13
v_and_b32 v12,15,v0
v_lshrrev_b32 v13,4,v0
v_lshlrev_b32 v12,4,v12
v_lshl_add_u32 v12,v13,2,v12
v_add_u32 v12,153600,v12
ds_write_b32 v12,v14 offset:1280
g2_c0_34:
ds_read_b64_tr_b16 v[28:29],v4 offset:0
v_mfma_f32_16x16x32_bf16 v[160:163],v[32:35],v[72:75],v[160:163]
ds_read_b64_tr_b16 v[30:31],v4 offset:1024
v_mfma_f32_16x16x32_bf16 v[164:167],v[32:35],v[76:79],v[164:167]
s_add_u32 m0,s54,65536
s_nop 0
buffer_load_dwordx4 v89,s[24:27],s49 offen lds
v_mfma_f32_16x16x32_bf16 v[168:171],v[32:35],v[80:83],v[168:171]
v_mfma_f32_16x16x32_bf16 v[172:175],v[32:35],v[84:87],v[172:175]
s_bitcmp1_b32 s68,4
s_cbranch_scc0 g2_c0_35
v_lshlrev_b32 v12,16,v32
v_and_b32 v13,s69,v32
v_add_f32 v15,v15,v12
v_add_f32 v15,v15,v13
v_lshlrev_b32 v12,16,v33
v_and_b32 v13,s69,v33
v_add_f32 v15,v15,v12
v_add_f32 v15,v15,v13
v_lshlrev_b32 v12,16,v34
v_and_b32 v13,s69,v34
v_add_f32 v15,v15,v12
v_add_f32 v15,v15,v13
v_lshlrev_b32 v12,16,v35
v_and_b32 v13,s69,v35
v_add_f32 v15,v15,v12
v_add_f32 v15,v15,v13
v_and_b32 v12,15,v0
v_lshrrev_b32 v13,4,v0
v_lshlrev_b32 v12,4,v12
v_lshl_add_u32 v12,v13,2,v12
v_add_u32 v12,153600,v12
ds_write_b32 v12,v15 offset:3072
g2_c0_35:
ds_read_b64_tr_b16 v[32:33],v5 offset:0
v_mfma_f32_16x16x32_bf16 v[176:179],v[36:39],v[72:75],v[176:179]
ds_read_b64_tr_b16 v[34:35],v5 offset:1024
v_mfma_f32_16x16x32_bf16 v[180:183],v[36:39],v[76:79],v[180:183]
s_add_u32 m0,s54,69632
s_nop 0
buffer_load_dwordx4 v90,s[24:27],s49 offen lds
v_mfma_f32_16x16x32_bf16 v[184:187],v[36:39],v[80:83],v[184:187]
v_mfma_f32_16x16x32_bf16 v[188:191],v[36:39],v[84:87],v[188:191]
s_bitcmp1_b32 s68,5
s_cbranch_scc0 g2_c0_36
v_lshlrev_b32 v12,16,v36
v_and_b32 v13,s69,v36
v_add_f32 v15,v15,v12
v_add_f32 v15,v15,v13
v_lshlrev_b32 v12,16,v37
v_and_b32 v13,s69,v37
v_add_f32 v15,v15,v12
v_add_f32 v15,v15,v13
v_lshlrev_b32 v12,16,v38
v_and_b32 v13,s69,v38
v_add_f32 v15,v15,v12
v_add_f32 v15,v15,v13
v_lshlrev_b32 v12,16,v39
v_and_b32 v13,s69,v39
v_add_f32 v15,v15,v12
v_add_f32 v15,v15,v13
v_and_b32 v12,15,v0
v_lshrrev_b32 v13,4,v0
v_lshlrev_b32 v12,4,v12
v_lshl_add_u32 v12,v13,2,v12
v_add_u32 v12,153600,v12
ds_write_b32 v12,v15 offset:3328
g2_c0_36:
ds_read_b64_tr_b16 v[36:37],v6 offset:0
v_mfma_f32_16x16x32_bf16 v[192:195],v[40:43],v[72:75],v[192:195]
ds_read_b64_tr_b16 v[38:39],v6 offset:1024
v_mfma_f32_16x16x32_bf16 v[196:199],v[40:43],v[76:79],v[196:199]
s_add_u32 m0,s54,73728
s_nop 0
buffer_load_dwordx4 v91,s[28:31],s49 offen lds
v_mfma_f32_16x16x32_bf16 v[200:203],v[40:43],v[80:83],v[200:203]
v_mfma_f32_16x16x32_bf16 v[204:207],v[40:43],v[84:87],v[204:207]
s_bitcmp1_b32 s68,6
s_cbranch_scc0 g2_c0_37
v_lshlrev_b32 v12,16,v40
v_and_b32 v13,s69,v40
v_add_f32 v15,v15,v12
v_add_f32 v15,v15,v13
v_lshlrev_b32 v12,16,v41
v_and_b32 v13,s69,v41
v_add_f32 v15,v15,v12
v_add_f32 v15,v15,v13
v_lshlrev_b32 v12,16,v42
v_and_b32 v13,s69,v42
v_add_f32 v15,v15,v12
v_add_f32 v15,v15,v13
v_lshlrev_b32 v12,16,v43
v_and_b32 v13,s69,v43
v_add_f32 v15,v15,v12
v_add_f32 v15,v15,v13
v_and_b32 v12,15,v0
v_lshrrev_b32 v13,4,v0
v_lshlrev_b32 v12,4,v12
v_lshl_add_u32 v12,v13,2,v12
v_add_u32 v12,153600,v12
ds_write_b32 v12,v15 offset:1536
g2_c0_37:
ds_read_b64_tr_b16 v[40:41],v7 offset:0
v_mfma_f32_16x16x32_bf16 v[208:211],v[44:47],v[72:75],v[208:211]
ds_read_b64_tr_b16 v[42:43],v7 offset:1024
v_mfma_f32_16x16x32_bf16 v[212:215],v[44:47],v[76:79],v[212:215]
s_add_u32 m0,s54,77824
s_nop 0
buffer_load_dwordx4 v92,s[28:31],s49 offen lds
s_and_b32 s50,s64,7
s_lshr_b32 s64,s64,4
s_mul_i32 s48,s50,786432
s_add_u32 s48,s48,s65
s_mul_i32 s49,s50,917504
s_add_u32 s49,s49,s66
v_mfma_f32_16x16x32_bf16 v[216:219],v[44:47],v[80:83],v[216:219]
v_mfma_f32_16x16x32_bf16 v[220:223],v[44:47],v[84:87],v[220:223]
s_bitcmp1_b32 s68,7
s_cbranch_scc0 g2_c0_38
v_lshlrev_b32 v12,16,v44
v_and_b32 v13,s69,v44
v_add_f32 v15,v15,v12
v_add_f32 v15,v15,v13
v_lshlrev_b32 v12,16,v45
v_and_b32 v13,s69,v45
v_add_f32 v15,v15,v12
v_add_f32 v15,v15,v13
v_lshlrev_b32 v12,16,v46
v_and_b32 v13,s69,v46
v_add_f32 v15,v15,v12
v_add_f32 v15,v15,v13
v_lshlrev_b32 v12,16,v47
v_and_b32 v13,s69,v47
v_add_f32 v15,v15,v12
v_add_f32 v15,v15,v13
v_and_b32 v12,15,v0
v_lshrrev_b32 v13,4,v0
v_lshlrev_b32 v12,4,v12
v_lshl_add_u32 v12,v13,2,v12
v_add_u32 v12,153600,v12
ds_write_b32 v12,v15 offset:1792
g2_c0_38:
ds_read_b64_tr_b16 v[44:45],v8 offset:0
v_mfma_f32_16x16x32_bf16 v[224:227],v[48:51],v[72:75],v[224:227]
ds_read_b64_tr_b16 v[46:47],v8 offset:1024
v_mfma_f32_16x16x32_bf16 v[228:231],v[48:51],v[76:79],v[228:231]
v_mfma_f32_16x16x32_bf16 v[232:235],v[48:51],v[80:83],v[232:235]
v_mfma_f32_16x16x32_bf16 v[236:239],v[48:51],v[84:87],v[236:239]
s_bitcmp1_b32 s68,8
s_cbranch_scc0 g2_c0_39
v_lshlrev_b32 v12,16,v48
v_and_b32 v13,s69,v48
v_add_f32 v93,v93,v12
v_add_f32 v93,v93,v13
v_lshlrev_b32 v12,16,v49
v_and_b32 v13,s69,v49
v_add_f32 v93,v93,v12
v_add_f32 v93,v93,v13
v_lshlrev_b32 v12,16,v50
v_and_b32 v13,s69,v50
v_add_f32 v93,v93,v12
v_add_f32 v93,v93,v13
v_lshlrev_b32 v12,16,v51
v_and_b32 v13,s69,v51
v_add_f32 v93,v93,v12
v_add_f32 v93,v93,v13
v_and_b32 v12,15,v0
v_lshrrev_b32 v13,4,v0
v_lshlrev_b32 v12,4,v12
v_lshl_add_u32 v12,v13,2,v12
v_add_u32 v12,153600,v12
ds_write_b32 v12,v93 offset:3584
g2_c0_39:
ds_read_b64_tr_b16 v[48:49],v9 offset:0
v_mfma_f32_16x16x32_bf16 v[240:243],v[52:55],v[72:75],v[240:243]
ds_read_b64_tr_b16 v[50:51],v9 offset:1024
v_mfma_f32_16x16x32_bf16 v[244:247],v[52:55],v[76:79],v[244:247]
v_mfma_f32_16x16x32_bf16 v[248:251],v[52:55],v[80:83],v[248:251]
v_mfma_f32_16x16x32_bf16 v[252:255],v[52:55],v[84:87],v[252:255]
s_bitcmp1_b32 s68,9
s_cbranch_scc0 g2_c0_40
v_lshlrev_b32 v12,16,v52
v_and_b32 v13,s69,v52
v_add_f32 v93,v93,v12
v_add_f32 v93,v93,v13
v_lshlrev_b32 v12,16,v53
v_and_b32 v13,s69,v53
v_add_f32 v93,v93,v12
v_add_f32 v93,v93,v13
v_lshlrev_b32 v12,16,v54
v_and_b32 v13,s69,v54
v_add_f32 v93,v93,v12
v_add_f32 v93,v93,v13
v_lshlrev_b32 v12,16,v55
v_and_b32 v13,s69,v55
v_add_f32 v93,v93,v12
v_add_f32 v93,v93,v13
v_and_b32 v12,15,v0
v_lshrrev_b32 v13,4,v0
v_lshlrev_b32 v12,4,v12
v_lshl_add_u32 v12,v13,2,v12
v_add_u32 v12,153600,v12
ds_write_b32 v12,v93 offset:3840
g2_c0_40:
ds_read_b64_tr_b16 v[52:53],v10 offset:0
ds_read_b64_tr_b16 v[54:55],v10 offset:1024
s_sub_u32 s53,s53,1
s_branch g2_loop0
g2_pub0:
s_lshl_b32 s50,s40,10
s_add_u32 s50,s50,153600
v_add_u32 v93,s50,v95
ds_read_b128 v[12:15],v93
v_lshlrev_b32 v93,5,v0
s_lshl_b32 s50,s43,2
s_add_u32 s50,s50,s98
s_waitcnt lgkmcnt(0)
v_add_f32 v12,v12,v13
v_add_f32 v14,v14,v15
v_add_f32 v12,v12,v14
buffer_store_dword v12,v93,s[36:39],s50 offen sc1
s_branch g2_pubr0
g2_sig0:
v_mov_b32 v12,1
s_mov_b64 exec,1
buffer_atomic_add v12,off,s[60:63],0 sc1
s_mov_b64 exec,-1
s_branch g2_sigr0
g2_bad0:
v_lshlrev_b32 v92,2,v0
v_add_u32 v92,151552,v92
ds_write_b32 v92,v92
s_branch g2_badr0
g2_rd0:
ds_read2_b32 v[56:57],v94 offset0:0 offset1:32
ds_read2_b32 v[58:59],v94 offset0:16 offset1:48
ds_read2_b32 v[60:61],v94 offset0:64 offset1:96
ds_read2_b32 v[62:63],v94 offset0:80 offset1:112
ds_read_b128 v[4:7],v95 offset:128
ds_read_b128 v[8:11],v95 offset:192
ds_read_b128 v[12:15],v95 offset:384
ds_read_b128 v[88:91],v95 offset:448
ds_read_b32 v16,v93 offset:0
ds_read_b32 v20,v93 offset:64
ds_read_b128 v[24:27],v92 offset:256
ds_read_b128 v[28:31],v92 offset:320
ds_read_b128 v[32:35],v92 offset:768
ds_read_b128 v[36:39],v92 offset:832
ds_read_b128 v[40:43],v92 offset:384
ds_read_b128 v[44:47],v92 offset:448
ds_read_b128 v[48:51],v92 offset:896
ds_read_b128 v[52:55],v92 offset:960
s_waitcnt lgkmcnt(0)
s_branch g2_ep0
g2_v1:
v_lshrrev_b32 v12,3,v0
v_lshrrev_b32 v13,4,v0
v_xor_b32 v13,v13,v0
v_and_b32 v13,7,v13
v_lshlrev_b32 v12,11,v12
v_lshl_add_u32 v88,v13,4,v12
v_xor_b32 v12,64,v88
v_add_u32 v89,15360,v12
s_lshl_b32 s65,s43,19
s_lshl_b32 s50,s41,17
s_add_u32 s65,s65,s50
s_and_b32 s50,s64,7
s_lshr_b32 s64,s64,4
s_mul_i32 s55,s50,256
s_add_u32 s55,s55,s65
s_lshl_b32 s54,s41,13
s_add_u32 s54,s54,81920
s_waitcnt lgkmcnt(0)
s_mov_b32 s56,s4
s_and_b32 s57,s5,0xffff
s_mov_b32 s58,4194304
s_mov_b32 s59,0x00020000
buffer_load_dwordx4 v[96:99],v95,s[56:59],s53 offen offset:0
buffer_load_dwordx4 v[100:103],v95,s[56:59],s53 offen offset:1024
s_add_u32 m0,s54,0
s_nop 0
buffer_load_dwordx4 v88,s[56:59],s55 offen lds
buffer_load_dwordx4 v89,s[56:59],s55 offen offset:1024 lds
s_add_u32 m0,s54,2048
s_add_u32 s51,s55,32768
buffer_load_dwordx4 v88,s[56:59],s51 offen lds
buffer_load_dwordx4 v89,s[56:59],s51 offen offset:1024 lds
s_add_u32 m0,s54,4096
s_add_u32 s51,s55,65536
buffer_load_dwordx4 v88,s[56:59],s51 offen lds
buffer_load_dwordx4 v89,s[56:59],s51 offen offset:1024 lds
s_add_u32 m0,s54,6144
s_add_u32 s51,s55,98304
buffer_load_dwordx4 v88,s[56:59],s51 offen lds
buffer_load_dwordx4 v89,s[56:59],s51 offen offset:1024 lds
s_add_u32 s55,s55,128
s_cmp_eq_u32 s43,0
s_cselect_b32 s64,0x17654320,s64
s_cmp_eq_u32 s43,1
s_cselect_b32 s64,0x17654321,s64
s_cmp_eq_u32 s43,2
s_cselect_b32 s64,0x27654321,s64
s_cmp_eq_u32 s43,3
s_cselect_b32 s64,0x37654321,s64
s_cmp_eq_u32 s43,4
s_cselect_b32 s64,0x37653421,s64
s_cmp_eq_u32 s43,5
s_cselect_b32 s64,0x37643521,s64
s_cmp_eq_u32 s43,6
s_cselect_b32 s64,0x37543621,s64
s_cmp_eq_u32 s43,7
s_cselect_b32 s64,0x36543721,s64
s_lshr_b32 s67,s64,28
s_sub_u32 s67,7,s67
s_sub_u32 s96,s67,1
s_mov_b32 s36,s12
s_and_b32 s37,s13,0xffff
s_mov_b32 s38,50331648
s_mov_b32 s39,0x00020000
s_mov_b32 s60,s18
s_and_b32 s61,s19,0xffff
s_mov_b32 s62,256
s_mov_b32 s63,0x00020000
s_lshl_b32 s68,0x11111111,s41
s_mov_b32 s69,0xffff0000
s_cmp_eq_u32 s40,0
s_cselect_b32 s97,s96,99
s_cmp_eq_u32 s100,-1
s_cselect_b32 s97,s97,99
s_lshl_b32 s98,s44,14
s_lshl_b32 s50,s40,11
s_add_u32 s98,s98,s50
s_add_u32 s98,s98,44040192
s_lshl_b32 s50,s40,8
s_add_u32 s50,s50,147456
v_lshl_add_u32 v12,v0,2,s50
v_mov_b32 v13,0
ds_write_b32 v12,v13 offset:4096
v_lshlrev_b32 v12,2,v0
v_add_u32 v12,161792,v12
ds_write_b32 v12,v13
s_lshl_b32 s50,s2,2
s_add_u32 s50,s50,s41
s_lshl_b32 s50,s50,11
v_lshlrev_b32 v90,5,v0
s_mov_b32 s28,s6
s_and_b32 s29,s7,0xffff
s_mov_b32 s30,6291456
s_mov_b32 s31,0x00020000
s_mov_b32 s48,3145728
s_mov_b32 s49,622592
s_mov_b32 s24,s8
s_and_b32 s25,s9,0xffff
s_mov_b32 s26,7340032
s_mov_b32 s27,0x00020000
s_cmp_ge_u32 s2,76
s_cselect_b32 s28,s24,s28
s_cselect_b32 s29,s25,s29
s_cselect_b32 s30,s26,s30
s_cselect_b32 s48,3047424,s48
s_cselect_b32 s49,737280,s49
s_mov_b32 s24,s10
s_and_b32 s25,s11,0xffff
s_mov_b32 s26,7340032
s_mov_b32 s27,0x00020000
s_cmp_ge_u32 s2,166
s_cselect_b32 s28,s24,s28
s_cselect_b32 s29,s25,s29
s_cselect_b32 s30,s26,s30
s_cselect_b32 s48,2310144,s48
s_cselect_b32 s49,737280,s49
s_add_u32 s48,s48,s50
s_mov_b32 s32,s16
s_and_b32 s33,s17,0xffff
s_mov_b32 s34,7340032
s_mov_b32 s35,0x00020000
s_mov_b32 s94,0
s_mov_b32 s95,1630208
s_mov_b32 s24,s14
s_and_b32 s25,s15,0xffff
s_mov_b32 s26,2097152
s_mov_b32 s27,0x00020000
s_cmp_ge_u32 s2,199
s_cselect_b32 s32,s24,s32
s_cselect_b32 s33,s25,s33
s_cselect_b32 s34,s26,s34
s_cselect_b32 s94,4293337088,s94
s_cselect_b32 s95,466944,s95
s_add_u32 s94,s94,s50
v_bfe_u32 v12,v0,2,2
v_lshrrev_b32 v13,4,v0
v_lshl_add_u32 v14,v13,3,v12
v_and_b32 v15,3,v0
v_lshlrev_b32 v15,3,v15
v_and_b32 v13,1,v13
v_lshrrev_b32 v93,1,v12
v_lshl_add_u32 v93,v13,1,v93
v_lshlrev_b32 v93,5,v93
v_mul_u32_u24 v94,128,v14
v_add_u32 v94,v94,v15
v_xor_b32 v11,64,v93
v_add_u32 v11,0,v11
v_add_u32 v1,v94,v11
v_xor_b32 v11,96,v93
v_add_u32 v11,0,v11
v_add_u32 v2,v94,v11
v_lshl_add_u32 v93,v13,2,v12
v_lshlrev_b32 v93,5,v93
v_mul_u32_u24 v94,256,v14
v_add_u32 v94,v94,v15
v_xor_b32 v11,128,v93
v_add_u32 v11,4096,v11
v_add_u32 v3,v94,v11
v_xor_b32 v11,160,v93
v_add_u32 v11,4096,v11
v_add_u32 v4,v94,v11
v_xor_b32 v11,128,v93
v_add_u32 v11,12288,v11
v_add_u32 v5,v94,v11
v_xor_b32 v11,160,v93
v_add_u32 v11,12288,v11
v_add_u32 v6,v94,v11
v_xor_b32 v11,192,v93
v_add_u32 v11,4096,v11
v_add_u32 v7,v94,v11
v_xor_b32 v11,224,v93
v_add_u32 v11,4096,v11
v_add_u32 v8,v94,v11
v_xor_b32 v11,192,v93
v_add_u32 v11,12288,v11
v_add_u32 v9,v94,v11
v_xor_b32 v11,224,v93
v_add_u32 v11,12288,v11
v_add_u32 v10,v94,v11
s_lshl_b32 s50,s41,13
s_add_u32 s50,s50,81920
v_and_b32 v12,15,v0
v_lshrrev_b32 v13,1,v12
v_lshrrev_b32 v14,4,v0
v_xor_b32 v13,v13,v14
v_lshl_add_u32 v14,v12,7,s50
v_lshl_add_u32 v11,v13,4,v14
v_xor_b32 v94,64,v11
s_waitcnt vmcnt(8)
v_lshlrev_b32 v108,16,v96
v_and_b32 v109,0xffff0000,v96
v_mov_b32 v104,v108
v_mov_b32 v106,v109
v_mul_f32 v105,v108,v108
v_mul_f32 v107,v109,v109
v_lshlrev_b32 v108,16,v97
v_and_b32 v109,0xffff0000,v97
v_add_f32 v104,v104,v108
v_add_f32 v106,v106,v109
v_fmac_f32 v105,v108,v108
v_fmac_f32 v107,v109,v109
v_lshlrev_b32 v108,16,v98
v_and_b32 v109,0xffff0000,v98
v_add_f32 v104,v104,v108
v_add_f32 v106,v106,v109
v_fmac_f32 v105,v108,v108
v_fmac_f32 v107,v109,v109
v_lshlrev_b32 v108,16,v99
v_and_b32 v109,0xffff0000,v99
v_add_f32 v104,v104,v108
v_add_f32 v106,v106,v109
v_fmac_f32 v105,v108,v108
v_fmac_f32 v107,v109,v109
v_lshlrev_b32 v108,16,v100
v_and_b32 v109,0xffff0000,v100
v_add_f32 v104,v104,v108
v_add_f32 v106,v106,v109
v_fmac_f32 v105,v108,v108
v_fmac_f32 v107,v109,v109
v_lshlrev_b32 v108,16,v101
v_and_b32 v109,0xffff0000,v101
v_add_f32 v104,v104,v108
v_add_f32 v106,v106,v109
v_fmac_f32 v105,v108,v108
v_fmac_f32 v107,v109,v109
v_lshlrev_b32 v108,16,v102
v_and_b32 v109,0xffff0000,v102
v_add_f32 v104,v104,v108
v_add_f32 v106,v106,v109
v_fmac_f32 v105,v108,v108
v_fmac_f32 v107,v109,v109
v_lshlrev_b32 v108,16,v103
v_and_b32 v109,0xffff0000,v103
v_add_f32 v104,v104,v108
v_add_f32 v106,v106,v109
v_fmac_f32 v105,v108,v108
v_fmac_f32 v107,v109,v109
v_add_f32 v104,v104,v106
v_add_f32 v105,v105,v107
s_nop 0
s_nop 0
v_add_f32_dpp v104,v104,v104 row_ror:8 row_mask:0xf bank_mask:0xf
v_add_f32_dpp v105,v105,v105 row_ror:8 row_mask:0xf bank_mask:0xf
s_nop 0
v_add_f32_dpp v104,v104,v104 row_ror:4 row_mask:0xf bank_mask:0xf
v_add_f32_dpp v105,v105,v105 row_ror:4 row_mask:0xf bank_mask:0xf
s_nop 0
v_add_f32_dpp v104,v104,v104 row_ror:2 row_mask:0xf bank_mask:0xf
v_add_f32_dpp v105,v105,v105 row_ror:2 row_mask:0xf bank_mask:0xf
s_nop 0
v_add_f32_dpp v104,v104,v104 row_ror:1 row_mask:0xf bank_mask:0xf
v_add_f32_dpp v105,v105,v105 row_ror:1 row_mask:0xf bank_mask:0xf
v_mov_b32 v106,v104
v_mov_b32 v107,v105
s_nop 0
v_permlane16_swap_b32 v104,v106
v_permlane16_swap_b32 v105,v107
v_add_f32 v104,v104,v106
v_add_f32 v105,v105,v107
v_mov_b32 v106,v104
v_mov_b32 v107,v105
s_nop 0
v_permlane32_swap_b32 v104,v106
v_permlane32_swap_b32 v105,v107
v_add_f32 v104,v104,v106
v_add_f32 v105,v105,v107
v_mul_f32 v104,0xba800000,v104
v_mul_f32 v105,0x3a800000,v105
v_fma_f32 v105,-v104,v104,v105
v_max_f32 v105,0,v105
v_cvt_pk_bf16_f32 v104,v104,v105
v_and_b32 v105,0xffff0000,v104
v_lshlrev_b32 v104,16,v104
v_add_f32 v105,0x3727c5ac,v105
v_cvt_pk_bf16_f32 v105,v105,v105
v_and_b32 v105,0xffff0000,v105
v_sqrt_f32 v105,v105
s_nop 0
v_cvt_pk_bf16_f32 v105,v105,v105
v_and_b32 v105,0xffff0000,v105
v_cmp_eq_u32 vcc,0,v0
v_lshlrev_b32 v106,13,v0
s_lshl_b32 s50,s52,2
s_add_u32 s50,s50,42991616
v_cndmask_b32 v104,v105,v104,vcc
s_mov_b64 exec,3
buffer_store_dword v104,v106,s[36:39],s50 offen sc1
s_mov_b64 exec,-1
s_waitcnt vmcnt(1) lgkmcnt(0)
s_barrier
ds_read_b128 v[56:59],v11 offset:0
ds_read_b128 v[60:63],v11 offset:2048
ds_read_b128 v[64:67],v11 offset:4096
ds_read_b128 v[68:71],v11 offset:6144
ds_read_b64_tr_b16 v[16:17],v1 offset:0
ds_read_b64_tr_b16 v[18:19],v1 offset:512
ds_read_b64_tr_b16 v[20:21],v2 offset:0
ds_read_b64_tr_b16 v[22:23],v2 offset:512
ds_read_b64_tr_b16 v[24:25],v3 offset:0
ds_read_b64_tr_b16 v[26:27],v3 offset:1024
ds_read_b64_tr_b16 v[28:29],v4 offset:0
ds_read_b64_tr_b16 v[30:31],v4 offset:1024
ds_read_b64_tr_b16 v[32:33],v5 offset:0
ds_read_b64_tr_b16 v[34:35],v5 offset:1024
ds_read_b64_tr_b16 v[36:37],v6 offset:0
ds_read_b64_tr_b16 v[38:39],v6 offset:1024
ds_read_b64_tr_b16 v[40:41],v7 offset:0
ds_read_b64_tr_b16 v[42:43],v7 offset:1024
ds_read_b64_tr_b16 v[44:45],v8 offset:0
ds_read_b64_tr_b16 v[46:47],v8 offset:1024
ds_read_b64_tr_b16 v[48:49],v9 offset:0
ds_read_b64_tr_b16 v[50:51],v9 offset:1024
ds_read_b64_tr_b16 v[52:53],v10 offset:0
ds_read_b64_tr_b16 v[54:55],v10 offset:1024
s_add_u32 m0,s54,32768
s_nop 0
buffer_load_dwordx4 v88,s[56:59],s55 offen lds
buffer_load_dwordx4 v89,s[56:59],s55 offen offset:1024 lds
s_add_u32 m0,s54,34816
s_add_u32 s51,s55,32768
buffer_load_dwordx4 v88,s[56:59],s51 offen lds
buffer_load_dwordx4 v89,s[56:59],s51 offen offset:1024 lds
s_add_u32 m0,s54,36864
s_add_u32 s51,s55,65536
buffer_load_dwordx4 v88,s[56:59],s51 offen lds
buffer_load_dwordx4 v89,s[56:59],s51 offen offset:1024 lds
s_add_u32 m0,s54,38912
s_add_u32 s51,s55,98304
buffer_load_dwordx4 v88,s[56:59],s51 offen lds
buffer_load_dwordx4 v89,s[56:59],s51 offen offset:1024 lds
s_and_b32 s50,s64,7
s_lshr_b32 s64,s64,4
s_mul_i32 s55,s50,256
s_add_u32 s55,s55,s65
s_waitcnt lgkmcnt(15)
v_mfma_f32_16x16x32_bf16 v[96:99],v[56:59],v[16:19],0
v_mfma_f32_16x16x32_bf16 v[100:103],v[60:63],v[16:19],0
v_mfma_f32_16x16x32_bf16 v[104:107],v[64:67],v[16:19],0
v_mfma_f32_16x16x32_bf16 v[108:111],v[68:71],v[16:19],0
s_waitcnt vmcnt(9) lgkmcnt(0)
s_barrier
ds_read_b64_tr_b16 v[16:17],v1 offset:20480
v_mfma_f32_16x16x32_bf16 v[112:115],v[56:59],v[20:23],0
ds_read_b64_tr_b16 v[18:19],v1 offset:20992
v_mfma_f32_16x16x32_bf16 v[116:119],v[60:63],v[20:23],0
ds_read_b128 v[72:75],v94 offset:0
v_mfma_f32_16x16x32_bf16 v[120:123],v[64:67],v[20:23],0
ds_read_b128 v[76:79],v94 offset:2048
v_mfma_f32_16x16x32_bf16 v[124:127],v[68:71],v[20:23],0
ds_read_b64_tr_b16 v[20:21],v2 offset:20480
v_mfma_f32_16x16x32_bf16 v[128:131],v[24:27],v[56:59],0
ds_read_b64_tr_b16 v[22:23],v2 offset:20992
v_mfma_f32_16x16x32_bf16 v[132:135],v[24:27],v[60:63],0
ds_read_b128 v[80:83],v94 offset:4096
v_mfma_f32_16x16x32_bf16 v[136:139],v[24:27],v[64:67],0
ds_read_b128 v[84:87],v94 offset:6144
v_mfma_f32_16x16x32_bf16 v[140:143],v[24:27],v[68:71],0
ds_read_b64_tr_b16 v[24:25],v3 offset:20480
v_mfma_f32_16x16x32_bf16 v[144:147],v[28:31],v[56:59],0
ds_read_b64_tr_b16 v[26:27],v3 offset:21504
v_mfma_f32_16x16x32_bf16 v[148:151],v[28:31],v[60:63],0
buffer_load_dword v91,v90,s[28:31],s48 offen
s_add_u32 s48,s48,s49
v_mfma_f32_16x16x32_bf16 v[152:155],v[28:31],v[64:67],0
v_mfma_f32_16x16x32_bf16 v[156:159],v[28:31],v[68:71],0
ds_read_b64_tr_b16 v[28:29],v4 offset:20480
v_mfma_f32_16x16x32_bf16 v[160:163],v[32:35],v[56:59],0
ds_read_b64_tr_b16 v[30:31],v4 offset:21504
v_mfma_f32_16x16x32_bf16 v[164:167],v[32:35],v[60:63],0
v_mfma_f32_16x16x32_bf16 v[168:171],v[32:35],v[64:67],0
v_mfma_f32_16x16x32_bf16 v[172:175],v[32:35],v[68:71],0
ds_read_b64_tr_b16 v[32:33],v5 offset:20480
v_mfma_f32_16x16x32_bf16 v[176:179],v[36:39],v[56:59],0
ds_read_b64_tr_b16 v[34:35],v5 offset:21504
v_mfma_f32_16x16x32_bf16 v[180:183],v[36:39],v[60:63],0
v_mfma_f32_16x16x32_bf16 v[184:187],v[36:39],v[64:67],0
v_mfma_f32_16x16x32_bf16 v[188:191],v[36:39],v[68:71],0
ds_read_b64_tr_b16 v[36:37],v6 offset:20480
v_mfma_f32_16x16x32_bf16 v[192:195],v[40:43],v[56:59],0
ds_read_b64_tr_b16 v[38:39],v6 offset:21504
v_mfma_f32_16x16x32_bf16 v[196:199],v[40:43],v[60:63],0
v_mfma_f32_16x16x32_bf16 v[200:203],v[40:43],v[64:67],0
v_mfma_f32_16x16x32_bf16 v[204:207],v[40:43],v[68:71],0
ds_read_b64_tr_b16 v[40:41],v7 offset:20480
v_mfma_f32_16x16x32_bf16 v[208:211],v[44:47],v[56:59],0
ds_read_b64_tr_b16 v[42:43],v7 offset:21504
v_mfma_f32_16x16x32_bf16 v[212:215],v[44:47],v[60:63],0
v_mfma_f32_16x16x32_bf16 v[216:219],v[44:47],v[64:67],0
v_mfma_f32_16x16x32_bf16 v[220:223],v[44:47],v[68:71],0
ds_read_b64_tr_b16 v[44:45],v8 offset:20480
v_mfma_f32_16x16x32_bf16 v[224:227],v[48:51],v[56:59],0
ds_read_b64_tr_b16 v[46:47],v8 offset:21504
v_mfma_f32_16x16x32_bf16 v[228:231],v[48:51],v[60:63],0
v_mfma_f32_16x16x32_bf16 v[232:235],v[48:51],v[64:67],0
v_mfma_f32_16x16x32_bf16 v[236:239],v[48:51],v[68:71],0
ds_read_b64_tr_b16 v[48:49],v9 offset:20480
v_mfma_f32_16x16x32_bf16 v[240:243],v[52:55],v[56:59],0
ds_read_b64_tr_b16 v[50:51],v9 offset:21504
v_mfma_f32_16x16x32_bf16 v[244:247],v[52:55],v[60:63],0
v_mfma_f32_16x16x32_bf16 v[248:251],v[52:55],v[64:67],0
v_mfma_f32_16x16x32_bf16 v[252:255],v[52:55],v[68:71],0
ds_read_b64_tr_b16 v[52:53],v10 offset:20480
ds_read_b64_tr_b16 v[54:55],v10 offset:21504
s_waitcnt lgkmcnt(15)
v_mfma_f32_16x16x32_bf16 v[96:99],v[72:75],v[16:19],v[96:99]
v_mfma_f32_16x16x32_bf16 v[100:103],v[76:79],v[16:19],v[100:103]
v_mfma_f32_16x16x32_bf16 v[104:107],v[80:83],v[16:19],v[104:107]
v_mfma_f32_16x16x32_bf16 v[108:111],v[84:87],v[16:19],v[108:111]
s_waitcnt vmcnt(1) lgkmcnt(0)
s_barrier
ds_read_b64_tr_b16 v[16:17],v1 offset:40960
v_mfma_f32_16x16x32_bf16 v[112:115],v[72:75],v[20:23],v[112:115]
ds_read_b64_tr_b16 v[18:19],v1 offset:41472
v_mfma_f32_16x16x32_bf16 v[116:119],v[76:79],v[20:23],v[116:119]
ds_read_b128 v[56:59],v11 offset:32768
v_mfma_f32_16x16x32_bf16 v[120:123],v[80:83],v[20:23],v[120:123]
ds_read_b128 v[60:63],v11 offset:34816
v_mfma_f32_16x16x32_bf16 v[124:127],v[84:87],v[20:23],v[124:127]
ds_read_b64_tr_b16 v[20:21],v2 offset:40960
v_mfma_f32_16x16x32_bf16 v[128:131],v[24:27],v[72:75],v[128:131]
ds_read_b64_tr_b16 v[22:23],v2 offset:41472
v_mfma_f32_16x16x32_bf16 v[132:135],v[24:27],v[76:79],v[132:135]
ds_read_b128 v[64:67],v11 offset:36864
v_mfma_f32_16x16x32_bf16 v[136:139],v[24:27],v[80:83],v[136:139]
ds_read_b128 v[68:71],v11 offset:38912
v_mfma_f32_16x16x32_bf16 v[140:143],v[24:27],v[84:87],v[140:143]
ds_read_b64_tr_b16 v[24:25],v3 offset:40960
v_mfma_f32_16x16x32_bf16 v[144:147],v[28:31],v[72:75],v[144:147]
ds_read_b64_tr_b16 v[26:27],v3 offset:41984
v_mfma_f32_16x16x32_bf16 v[148:151],v[28:31],v[76:79],v[148:151]
s_add_u32 m0,s54,0
s_nop 0
buffer_load_dwordx4 v88,s[56:59],s55 offen lds
v_mfma_f32_16x16x32_bf16 v[152:155],v[28:31],v[80:83],v[152:155]
v_mfma_f32_16x16x32_bf16 v[156:159],v[28:31],v[84:87],v[156:159]
ds_read_b64_tr_b16 v[28:29],v4 offset:40960
v_mfma_f32_16x16x32_bf16 v[160:163],v[32:35],v[72:75],v[160:163]
ds_read_b64_tr_b16 v[30:31],v4 offset:41984
v_mfma_f32_16x16x32_bf16 v[164:167],v[32:35],v[76:79],v[164:167]
buffer_load_dwordx4 v89,s[56:59],s55 offen offset:1024 lds
v_mfma_f32_16x16x32_bf16 v[168:171],v[32:35],v[80:83],v[168:171]
v_mfma_f32_16x16x32_bf16 v[172:175],v[32:35],v[84:87],v[172:175]
ds_read_b64_tr_b16 v[32:33],v5 offset:40960
v_mfma_f32_16x16x32_bf16 v[176:179],v[36:39],v[72:75],v[176:179]
ds_read_b64_tr_b16 v[34:35],v5 offset:41984
v_mfma_f32_16x16x32_bf16 v[180:183],v[36:39],v[76:79],v[180:183]
s_add_u32 m0,s54,2048
s_add_u32 s51,s55,32768
buffer_load_dwordx4 v88,s[56:59],s51 offen lds
v_mfma_f32_16x16x32_bf16 v[184:187],v[36:39],v[80:83],v[184:187]
v_mfma_f32_16x16x32_bf16 v[188:191],v[36:39],v[84:87],v[188:191]
ds_read_b64_tr_b16 v[36:37],v6 offset:40960
v_mfma_f32_16x16x32_bf16 v[192:195],v[40:43],v[72:75],v[192:195]
ds_read_b64_tr_b16 v[38:39],v6 offset:41984
v_mfma_f32_16x16x32_bf16 v[196:199],v[40:43],v[76:79],v[196:199]
buffer_load_dwordx4 v89,s[56:59],s51 offen offset:1024 lds
v_mfma_f32_16x16x32_bf16 v[200:203],v[40:43],v[80:83],v[200:203]
v_mfma_f32_16x16x32_bf16 v[204:207],v[40:43],v[84:87],v[204:207]
ds_read_b64_tr_b16 v[40:41],v7 offset:40960
v_mfma_f32_16x16x32_bf16 v[208:211],v[44:47],v[72:75],v[208:211]
ds_read_b64_tr_b16 v[42:43],v7 offset:41984
v_mfma_f32_16x16x32_bf16 v[212:215],v[44:47],v[76:79],v[212:215]
s_add_u32 m0,s54,4096
s_add_u32 s51,s55,65536
buffer_load_dwordx4 v88,s[56:59],s51 offen lds
v_mfma_f32_16x16x32_bf16 v[216:219],v[44:47],v[80:83],v[216:219]
v_mfma_f32_16x16x32_bf16 v[220:223],v[44:47],v[84:87],v[220:223]
ds_read_b64_tr_b16 v[44:45],v8 offset:40960
v_mfma_f32_16x16x32_bf16 v[224:227],v[48:51],v[72:75],v[224:227]
ds_read_b64_tr_b16 v[46:47],v8 offset:41984
v_mfma_f32_16x16x32_bf16 v[228:231],v[48:51],v[76:79],v[228:231]
buffer_load_dwordx4 v89,s[56:59],s51 offen offset:1024 lds
v_mfma_f32_16x16x32_bf16 v[232:235],v[48:51],v[80:83],v[232:235]
v_mfma_f32_16x16x32_bf16 v[236:239],v[48:51],v[84:87],v[236:239]
ds_read_b64_tr_b16 v[48:49],v9 offset:40960
v_mfma_f32_16x16x32_bf16 v[240:243],v[52:55],v[72:75],v[240:243]
ds_read_b64_tr_b16 v[50:51],v9 offset:41984
v_mfma_f32_16x16x32_bf16 v[244:247],v[52:55],v[76:79],v[244:247]
s_add_u32 m0,s54,6144
s_add_u32 s51,s55,98304
buffer_load_dwordx4 v88,s[56:59],s51 offen lds
v_mfma_f32_16x16x32_bf16 v[248:251],v[52:55],v[80:83],v[248:251]
buffer_load_dwordx4 v89,s[56:59],s51 offen offset:1024 lds
s_add_u32 s55,s55,128
v_mfma_f32_16x16x32_bf16 v[252:255],v[52:55],v[84:87],v[252:255]
ds_read_b64_tr_b16 v[52:53],v10 offset:40960
ds_read_b64_tr_b16 v[54:55],v10 offset:41984
s_waitcnt lgkmcnt(15)
v_mfma_f32_16x16x32_bf16 v[96:99],v[56:59],v[16:19],v[96:99]
v_mfma_f32_16x16x32_bf16 v[100:103],v[60:63],v[16:19],v[100:103]
v_mfma_f32_16x16x32_bf16 v[104:107],v[64:67],v[16:19],v[104:107]
v_mfma_f32_16x16x32_bf16 v[108:111],v[68:71],v[16:19],v[108:111]
s_waitcnt vmcnt(9) lgkmcnt(0)
s_barrier
ds_read_b64_tr_b16 v[16:17],v1 offset:61440
v_mfma_f32_16x16x32_bf16 v[112:115],v[56:59],v[20:23],v[112:115]
ds_read_b64_tr_b16 v[18:19],v1 offset:61952
v_mfma_f32_16x16x32_bf16 v[116:119],v[60:63],v[20:23],v[116:119]
ds_read_b128 v[72:75],v94 offset:32768
v_mfma_f32_16x16x32_bf16 v[120:123],v[64:67],v[20:23],v[120:123]
ds_read_b128 v[76:79],v94 offset:34816
v_mfma_f32_16x16x32_bf16 v[124:127],v[68:71],v[20:23],v[124:127]
ds_read_b64_tr_b16 v[20:21],v2 offset:61440
v_mfma_f32_16x16x32_bf16 v[128:131],v[24:27],v[56:59],v[128:131]
ds_read_b64_tr_b16 v[22:23],v2 offset:61952
v_mfma_f32_16x16x32_bf16 v[132:135],v[24:27],v[60:63],v[132:135]
ds_read_b128 v[80:83],v94 offset:36864
v_mfma_f32_16x16x32_bf16 v[136:139],v[24:27],v[64:67],v[136:139]
ds_read_b128 v[84:87],v94 offset:38912
v_mfma_f32_16x16x32_bf16 v[140:143],v[24:27],v[68:71],v[140:143]
ds_read_b64_tr_b16 v[24:25],v3 offset:61440
v_mfma_f32_16x16x32_bf16 v[144:147],v[28:31],v[56:59],v[144:147]
ds_read_b64_tr_b16 v[26:27],v3 offset:62464
v_mfma_f32_16x16x32_bf16 v[148:151],v[28:31],v[60:63],v[148:151]
buffer_load_dword v91,v90,s[28:31],s48 offen
s_add_u32 s48,s48,s49
v_mfma_f32_16x16x32_bf16 v[152:155],v[28:31],v[64:67],v[152:155]
v_mfma_f32_16x16x32_bf16 v[156:159],v[28:31],v[68:71],v[156:159]
ds_read_b64_tr_b16 v[28:29],v4 offset:61440
v_mfma_f32_16x16x32_bf16 v[160:163],v[32:35],v[56:59],v[160:163]
ds_read_b64_tr_b16 v[30:31],v4 offset:62464
v_mfma_f32_16x16x32_bf16 v[164:167],v[32:35],v[60:63],v[164:167]
v_mfma_f32_16x16x32_bf16 v[168:171],v[32:35],v[64:67],v[168:171]
v_mfma_f32_16x16x32_bf16 v[172:175],v[32:35],v[68:71],v[172:175]
ds_read_b64_tr_b16 v[32:33],v5 offset:61440
v_mfma_f32_16x16x32_bf16 v[176:179],v[36:39],v[56:59],v[176:179]
ds_read_b64_tr_b16 v[34:35],v5 offset:62464
v_mfma_f32_16x16x32_bf16 v[180:183],v[36:39],v[60:63],v[180:183]
v_mfma_f32_16x16x32_bf16 v[184:187],v[36:39],v[64:67],v[184:187]
v_mfma_f32_16x16x32_bf16 v[188:191],v[36:39],v[68:71],v[188:191]
ds_read_b64_tr_b16 v[36:37],v6 offset:61440
v_mfma_f32_16x16x32_bf16 v[192:195],v[40:43],v[56:59],v[192:195]
ds_read_b64_tr_b16 v[38:39],v6 offset:62464
v_mfma_f32_16x16x32_bf16 v[196:199],v[40:43],v[60:63],v[196:199]
v_mfma_f32_16x16x32_bf16 v[200:203],v[40:43],v[64:67],v[200:203]
v_mfma_f32_16x16x32_bf16 v[204:207],v[40:43],v[68:71],v[204:207]
ds_read_b64_tr_b16 v[40:41],v7 offset:61440
v_mfma_f32_16x16x32_bf16 v[208:211],v[44:47],v[56:59],v[208:211]
ds_read_b64_tr_b16 v[42:43],v7 offset:62464
v_mfma_f32_16x16x32_bf16 v[212:215],v[44:47],v[60:63],v[212:215]
v_mfma_f32_16x16x32_bf16 v[216:219],v[44:47],v[64:67],v[216:219]
v_mfma_f32_16x16x32_bf16 v[220:223],v[44:47],v[68:71],v[220:223]
ds_read_b64_tr_b16 v[44:45],v8 offset:61440
v_mfma_f32_16x16x32_bf16 v[224:227],v[48:51],v[56:59],v[224:227]
ds_read_b64_tr_b16 v[46:47],v8 offset:62464
v_mfma_f32_16x16x32_bf16 v[228:231],v[48:51],v[60:63],v[228:231]
v_mfma_f32_16x16x32_bf16 v[232:235],v[48:51],v[64:67],v[232:235]
v_mfma_f32_16x16x32_bf16 v[236:239],v[48:51],v[68:71],v[236:239]
ds_read_b64_tr_b16 v[48:49],v9 offset:61440
v_mfma_f32_16x16x32_bf16 v[240:243],v[52:55],v[56:59],v[240:243]
ds_read_b64_tr_b16 v[50:51],v9 offset:62464
v_mfma_f32_16x16x32_bf16 v[244:247],v[52:55],v[60:63],v[244:247]
v_mfma_f32_16x16x32_bf16 v[248:251],v[52:55],v[64:67],v[248:251]
v_mfma_f32_16x16x32_bf16 v[252:255],v[52:55],v[68:71],v[252:255]
ds_read_b64_tr_b16 v[52:53],v10 offset:61440
ds_read_b64_tr_b16 v[54:55],v10 offset:62464
s_waitcnt lgkmcnt(15)
v_mfma_f32_16x16x32_bf16 v[96:99],v[72:75],v[16:19],v[96:99]
v_mfma_f32_16x16x32_bf16 v[100:103],v[76:79],v[16:19],v[100:103]
v_mfma_f32_16x16x32_bf16 v[104:107],v[80:83],v[16:19],v[104:107]
v_mfma_f32_16x16x32_bf16 v[108:111],v[84:87],v[16:19],v[108:111]
s_waitcnt vmcnt(1) lgkmcnt(0)
s_barrier
ds_read_b64_tr_b16 v[16:17],v1 offset:0
v_mfma_f32_16x16x32_bf16 v[112:115],v[72:75],v[20:23],v[112:115]
ds_read_b64_tr_b16 v[18:19],v1 offset:512
v_mfma_f32_16x16x32_bf16 v[116:119],v[76:79],v[20:23],v[116:119]
ds_read_b128 v[56:59],v11 offset:0
v_mfma_f32_16x16x32_bf16 v[120:123],v[80:83],v[20:23],v[120:123]
ds_read_b128 v[60:63],v11 offset:2048
v_mfma_f32_16x16x32_bf16 v[124:127],v[84:87],v[20:23],v[124:127]
ds_read_b64_tr_b16 v[20:21],v2 offset:0
v_mfma_f32_16x16x32_bf16 v[128:131],v[24:27],v[72:75],v[128:131]
ds_read_b64_tr_b16 v[22:23],v2 offset:512
v_mfma_f32_16x16x32_bf16 v[132:135],v[24:27],v[76:79],v[132:135]
ds_read_b128 v[64:67],v11 offset:4096
v_mfma_f32_16x16x32_bf16 v[136:139],v[24:27],v[80:83],v[136:139]
ds_read_b128 v[68:71],v11 offset:6144
v_mfma_f32_16x16x32_bf16 v[140:143],v[24:27],v[84:87],v[140:143]
ds_read_b64_tr_b16 v[24:25],v3 offset:0
v_mfma_f32_16x16x32_bf16 v[144:147],v[28:31],v[72:75],v[144:147]
ds_read_b64_tr_b16 v[26:27],v3 offset:1024
v_mfma_f32_16x16x32_bf16 v[148:151],v[28:31],v[76:79],v[148:151]
s_add_u32 m0,s54,32768
s_nop 0
buffer_load_dwordx4 v88,s[56:59],s55 offen lds
v_mfma_f32_16x16x32_bf16 v[152:155],v[28:31],v[80:83],v[152:155]
v_mfma_f32_16x16x32_bf16 v[156:159],v[28:31],v[84:87],v[156:159]
ds_read_b64_tr_b16 v[28:29],v4 offset:0
v_mfma_f32_16x16x32_bf16 v[160:163],v[32:35],v[72:75],v[160:163]
ds_read_b64_tr_b16 v[30:31],v4 offset:1024
v_mfma_f32_16x16x32_bf16 v[164:167],v[32:35],v[76:79],v[164:167]
buffer_load_dwordx4 v89,s[56:59],s55 offen offset:1024 lds
v_mfma_f32_16x16x32_bf16 v[168:171],v[32:35],v[80:83],v[168:171]
v_mfma_f32_16x16x32_bf16 v[172:175],v[32:35],v[84:87],v[172:175]
ds_read_b64_tr_b16 v[32:33],v5 offset:0
v_mfma_f32_16x16x32_bf16 v[176:179],v[36:39],v[72:75],v[176:179]
ds_read_b64_tr_b16 v[34:35],v5 offset:1024
v_mfma_f32_16x16x32_bf16 v[180:183],v[36:39],v[76:79],v[180:183]
s_add_u32 m0,s54,34816
s_add_u32 s51,s55,32768
buffer_load_dwordx4 v88,s[56:59],s51 offen lds
v_mfma_f32_16x16x32_bf16 v[184:187],v[36:39],v[80:83],v[184:187]
v_mfma_f32_16x16x32_bf16 v[188:191],v[36:39],v[84:87],v[188:191]
ds_read_b64_tr_b16 v[36:37],v6 offset:0
v_mfma_f32_16x16x32_bf16 v[192:195],v[40:43],v[72:75],v[192:195]
ds_read_b64_tr_b16 v[38:39],v6 offset:1024
v_mfma_f32_16x16x32_bf16 v[196:199],v[40:43],v[76:79],v[196:199]
buffer_load_dwordx4 v89,s[56:59],s51 offen offset:1024 lds
v_mfma_f32_16x16x32_bf16 v[200:203],v[40:43],v[80:83],v[200:203]
v_mfma_f32_16x16x32_bf16 v[204:207],v[40:43],v[84:87],v[204:207]
ds_read_b64_tr_b16 v[40:41],v7 offset:0
v_mfma_f32_16x16x32_bf16 v[208:211],v[44:47],v[72:75],v[208:211]
ds_read_b64_tr_b16 v[42:43],v7 offset:1024
v_mfma_f32_16x16x32_bf16 v[212:215],v[44:47],v[76:79],v[212:215]
s_add_u32 m0,s54,36864
s_add_u32 s51,s55,65536
buffer_load_dwordx4 v88,s[56:59],s51 offen lds
v_mfma_f32_16x16x32_bf16 v[216:219],v[44:47],v[80:83],v[216:219]
v_mfma_f32_16x16x32_bf16 v[220:223],v[44:47],v[84:87],v[220:223]
ds_read_b64_tr_b16 v[44:45],v8 offset:0
v_mfma_f32_16x16x32_bf16 v[224:227],v[48:51],v[72:75],v[224:227]
ds_read_b64_tr_b16 v[46:47],v8 offset:1024
v_mfma_f32_16x16x32_bf16 v[228:231],v[48:51],v[76:79],v[228:231]
buffer_load_dwordx4 v89,s[56:59],s51 offen offset:1024 lds
v_mfma_f32_16x16x32_bf16 v[232:235],v[48:51],v[80:83],v[232:235]
v_mfma_f32_16x16x32_bf16 v[236:239],v[48:51],v[84:87],v[236:239]
ds_read_b64_tr_b16 v[48:49],v9 offset:0
v_mfma_f32_16x16x32_bf16 v[240:243],v[52:55],v[72:75],v[240:243]
ds_read_b64_tr_b16 v[50:51],v9 offset:1024
v_mfma_f32_16x16x32_bf16 v[244:247],v[52:55],v[76:79],v[244:247]
s_add_u32 m0,s54,38912
s_add_u32 s51,s55,98304
buffer_load_dwordx4 v88,s[56:59],s51 offen lds
v_mfma_f32_16x16x32_bf16 v[248:251],v[52:55],v[80:83],v[248:251]
buffer_load_dwordx4 v89,s[56:59],s51 offen offset:1024 lds
s_and_b32 s50,s64,7
s_lshr_b32 s64,s64,4
s_mul_i32 s55,s50,256
s_add_u32 s55,s55,s65
v_mfma_f32_16x16x32_bf16 v[252:255],v[52:55],v[84:87],v[252:255]
ds_read_b64_tr_b16 v[52:53],v10 offset:0
ds_read_b64_tr_b16 v[54:55],v10 offset:1024
s_mov_b32 s53,6
.p2align 6
g2_loop1:
s_cmp_eq_u32 s53,4
s_cselect_b32 s28,s32,s28
s_cselect_b32 s29,s33,s29
s_cselect_b32 s30,s34,s30
s_cselect_b32 s48,s94,s48
s_cselect_b32 s49,s95,s49
s_cmp_eq_u32 s53,s67
s_cbranch_scc1 g2_sp1
s_waitcnt lgkmcnt(15)
v_mfma_f32_16x16x32_bf16 v[96:99],v[56:59],v[16:19],v[96:99]
v_mfma_f32_16x16x32_bf16 v[100:103],v[60:63],v[16:19],v[100:103]
v_mfma_f32_16x16x32_bf16 v[104:107],v[64:67],v[16:19],v[104:107]
v_mfma_f32_16x16x32_bf16 v[108:111],v[68:71],v[16:19],v[108:111]
s_waitcnt vmcnt(9) lgkmcnt(0)
s_barrier
s_cmp_eq_u32 s53,s96
s_cbranch_scc1 g2_pub1
g2_pubr1:
ds_read_b64_tr_b16 v[16:17],v1 offset:20480
v_mfma_f32_16x16x32_bf16 v[112:115],v[56:59],v[20:23],v[112:115]
ds_read_b64_tr_b16 v[18:19],v1 offset:20992
v_mfma_f32_16x16x32_bf16 v[116:119],v[60:63],v[20:23],v[116:119]
ds_read_b128 v[72:75],v94 offset:0
v_mfma_f32_16x16x32_bf16 v[120:123],v[64:67],v[20:23],v[120:123]
ds_read_b128 v[76:79],v94 offset:2048
v_mfma_f32_16x16x32_bf16 v[124:127],v[68:71],v[20:23],v[124:127]
ds_read_b64_tr_b16 v[20:21],v2 offset:20480
v_mfma_f32_16x16x32_bf16 v[128:131],v[24:27],v[56:59],v[128:131]
ds_read_b64_tr_b16 v[22:23],v2 offset:20992
v_mfma_f32_16x16x32_bf16 v[132:135],v[24:27],v[60:63],v[132:135]
ds_read_b128 v[80:83],v94 offset:4096
v_mfma_f32_16x16x32_bf16 v[136:139],v[24:27],v[64:67],v[136:139]
ds_read_b128 v[84:87],v94 offset:6144
v_mfma_f32_16x16x32_bf16 v[140:143],v[24:27],v[68:71],v[140:143]
ds_read_b64_tr_b16 v[24:25],v3 offset:20480
v_mfma_f32_16x16x32_bf16 v[144:147],v[28:31],v[56:59],v[144:147]
ds_read_b64_tr_b16 v[26:27],v3 offset:21504
v_mfma_f32_16x16x32_bf16 v[148:151],v[28:31],v[60:63],v[148:151]
buffer_load_dword v91,v90,s[28:31],s48 offen
s_add_u32 s48,s48,s49
v_mfma_f32_16x16x32_bf16 v[152:155],v[28:31],v[64:67],v[152:155]
v_mfma_f32_16x16x32_bf16 v[156:159],v[28:31],v[68:71],v[156:159]
ds_read_b64_tr_b16 v[28:29],v4 offset:20480
v_mfma_f32_16x16x32_bf16 v[160:163],v[32:35],v[56:59],v[160:163]
ds_read_b64_tr_b16 v[30:31],v4 offset:21504
v_mfma_f32_16x16x32_bf16 v[164:167],v[32:35],v[60:63],v[164:167]
v_mfma_f32_16x16x32_bf16 v[168:171],v[32:35],v[64:67],v[168:171]
v_mfma_f32_16x16x32_bf16 v[172:175],v[32:35],v[68:71],v[172:175]
ds_read_b64_tr_b16 v[32:33],v5 offset:20480
v_mfma_f32_16x16x32_bf16 v[176:179],v[36:39],v[56:59],v[176:179]
ds_read_b64_tr_b16 v[34:35],v5 offset:21504
v_mfma_f32_16x16x32_bf16 v[180:183],v[36:39],v[60:63],v[180:183]
v_mfma_f32_16x16x32_bf16 v[184:187],v[36:39],v[64:67],v[184:187]
v_mfma_f32_16x16x32_bf16 v[188:191],v[36:39],v[68:71],v[188:191]
ds_read_b64_tr_b16 v[36:37],v6 offset:20480
v_mfma_f32_16x16x32_bf16 v[192:195],v[40:43],v[56:59],v[192:195]
ds_read_b64_tr_b16 v[38:39],v6 offset:21504
v_mfma_f32_16x16x32_bf16 v[196:199],v[40:43],v[60:63],v[196:199]
v_mfma_f32_16x16x32_bf16 v[200:203],v[40:43],v[64:67],v[200:203]
v_mfma_f32_16x16x32_bf16 v[204:207],v[40:43],v[68:71],v[204:207]
ds_read_b64_tr_b16 v[40:41],v7 offset:20480
v_mfma_f32_16x16x32_bf16 v[208:211],v[44:47],v[56:59],v[208:211]
ds_read_b64_tr_b16 v[42:43],v7 offset:21504
v_mfma_f32_16x16x32_bf16 v[212:215],v[44:47],v[60:63],v[212:215]
v_mfma_f32_16x16x32_bf16 v[216:219],v[44:47],v[64:67],v[216:219]
v_mfma_f32_16x16x32_bf16 v[220:223],v[44:47],v[68:71],v[220:223]
ds_read_b64_tr_b16 v[44:45],v8 offset:20480
v_mfma_f32_16x16x32_bf16 v[224:227],v[48:51],v[56:59],v[224:227]
ds_read_b64_tr_b16 v[46:47],v8 offset:21504
v_mfma_f32_16x16x32_bf16 v[228:231],v[48:51],v[60:63],v[228:231]
v_mfma_f32_16x16x32_bf16 v[232:235],v[48:51],v[64:67],v[232:235]
v_mfma_f32_16x16x32_bf16 v[236:239],v[48:51],v[68:71],v[236:239]
ds_read_b64_tr_b16 v[48:49],v9 offset:20480
v_mfma_f32_16x16x32_bf16 v[240:243],v[52:55],v[56:59],v[240:243]
ds_read_b64_tr_b16 v[50:51],v9 offset:21504
v_mfma_f32_16x16x32_bf16 v[244:247],v[52:55],v[60:63],v[244:247]
v_mfma_f32_16x16x32_bf16 v[248:251],v[52:55],v[64:67],v[248:251]
v_mfma_f32_16x16x32_bf16 v[252:255],v[52:55],v[68:71],v[252:255]
ds_read_b64_tr_b16 v[52:53],v10 offset:20480
ds_read_b64_tr_b16 v[54:55],v10 offset:21504
s_waitcnt lgkmcnt(15)
v_mfma_f32_16x16x32_bf16 v[96:99],v[72:75],v[16:19],v[96:99]
v_mfma_f32_16x16x32_bf16 v[100:103],v[76:79],v[16:19],v[100:103]
v_mfma_f32_16x16x32_bf16 v[104:107],v[80:83],v[16:19],v[104:107]
v_mfma_f32_16x16x32_bf16 v[108:111],v[84:87],v[16:19],v[108:111]
s_waitcnt vmcnt(1) lgkmcnt(0)
s_barrier
ds_read_b64_tr_b16 v[16:17],v1 offset:40960
v_mfma_f32_16x16x32_bf16 v[112:115],v[72:75],v[20:23],v[112:115]
ds_read_b64_tr_b16 v[18:19],v1 offset:41472
v_mfma_f32_16x16x32_bf16 v[116:119],v[76:79],v[20:23],v[116:119]
ds_read_b128 v[56:59],v11 offset:32768
v_mfma_f32_16x16x32_bf16 v[120:123],v[80:83],v[20:23],v[120:123]
ds_read_b128 v[60:63],v11 offset:34816
v_mfma_f32_16x16x32_bf16 v[124:127],v[84:87],v[20:23],v[124:127]
ds_read_b64_tr_b16 v[20:21],v2 offset:40960
v_mfma_f32_16x16x32_bf16 v[128:131],v[24:27],v[72:75],v[128:131]
ds_read_b64_tr_b16 v[22:23],v2 offset:41472
v_mfma_f32_16x16x32_bf16 v[132:135],v[24:27],v[76:79],v[132:135]
ds_read_b128 v[64:67],v11 offset:36864
v_mfma_f32_16x16x32_bf16 v[136:139],v[24:27],v[80:83],v[136:139]
ds_read_b128 v[68:71],v11 offset:38912
v_mfma_f32_16x16x32_bf16 v[140:143],v[24:27],v[84:87],v[140:143]
ds_read_b64_tr_b16 v[24:25],v3 offset:40960
v_mfma_f32_16x16x32_bf16 v[144:147],v[28:31],v[72:75],v[144:147]
ds_read_b64_tr_b16 v[26:27],v3 offset:41984
v_mfma_f32_16x16x32_bf16 v[148:151],v[28:31],v[76:79],v[148:151]
s_add_u32 m0,s54,0
s_nop 0
buffer_load_dwordx4 v88,s[56:59],s55 offen lds
v_mfma_f32_16x16x32_bf16 v[152:155],v[28:31],v[80:83],v[152:155]
v_mfma_f32_16x16x32_bf16 v[156:159],v[28:31],v[84:87],v[156:159]
ds_read_b64_tr_b16 v[28:29],v4 offset:40960
v_mfma_f32_16x16x32_bf16 v[160:163],v[32:35],v[72:75],v[160:163]
ds_read_b64_tr_b16 v[30:31],v4 offset:41984
v_mfma_f32_16x16x32_bf16 v[164:167],v[32:35],v[76:79],v[164:167]
buffer_load_dwordx4 v89,s[56:59],s55 offen offset:1024 lds
v_mfma_f32_16x16x32_bf16 v[168:171],v[32:35],v[80:83],v[168:171]
v_mfma_f32_16x16x32_bf16 v[172:175],v[32:35],v[84:87],v[172:175]
ds_read_b64_tr_b16 v[32:33],v5 offset:40960
v_mfma_f32_16x16x32_bf16 v[176:179],v[36:39],v[72:75],v[176:179]
ds_read_b64_tr_b16 v[34:35],v5 offset:41984
v_mfma_f32_16x16x32_bf16 v[180:183],v[36:39],v[76:79],v[180:183]
s_add_u32 m0,s54,2048
s_add_u32 s51,s55,32768
buffer_load_dwordx4 v88,s[56:59],s51 offen lds
v_mfma_f32_16x16x32_bf16 v[184:187],v[36:39],v[80:83],v[184:187]
v_mfma_f32_16x16x32_bf16 v[188:191],v[36:39],v[84:87],v[188:191]
ds_read_b64_tr_b16 v[36:37],v6 offset:40960
v_mfma_f32_16x16x32_bf16 v[192:195],v[40:43],v[72:75],v[192:195]
ds_read_b64_tr_b16 v[38:39],v6 offset:41984
v_mfma_f32_16x16x32_bf16 v[196:199],v[40:43],v[76:79],v[196:199]
buffer_load_dwordx4 v89,s[56:59],s51 offen offset:1024 lds
v_mfma_f32_16x16x32_bf16 v[200:203],v[40:43],v[80:83],v[200:203]
v_mfma_f32_16x16x32_bf16 v[204:207],v[40:43],v[84:87],v[204:207]
ds_read_b64_tr_b16 v[40:41],v7 offset:40960
v_mfma_f32_16x16x32_bf16 v[208:211],v[44:47],v[72:75],v[208:211]
ds_read_b64_tr_b16 v[42:43],v7 offset:41984
v_mfma_f32_16x16x32_bf16 v[212:215],v[44:47],v[76:79],v[212:215]
s_add_u32 m0,s54,4096
s_add_u32 s51,s55,65536
buffer_load_dwordx4 v88,s[56:59],s51 offen lds
v_mfma_f32_16x16x32_bf16 v[216:219],v[44:47],v[80:83],v[216:219]
v_mfma_f32_16x16x32_bf16 v[220:223],v[44:47],v[84:87],v[220:223]
ds_read_b64_tr_b16 v[44:45],v8 offset:40960
v_mfma_f32_16x16x32_bf16 v[224:227],v[48:51],v[72:75],v[224:227]
ds_read_b64_tr_b16 v[46:47],v8 offset:41984
v_mfma_f32_16x16x32_bf16 v[228:231],v[48:51],v[76:79],v[228:231]
buffer_load_dwordx4 v89,s[56:59],s51 offen offset:1024 lds
v_mfma_f32_16x16x32_bf16 v[232:235],v[48:51],v[80:83],v[232:235]
v_mfma_f32_16x16x32_bf16 v[236:239],v[48:51],v[84:87],v[236:239]
ds_read_b64_tr_b16 v[48:49],v9 offset:40960
v_mfma_f32_16x16x32_bf16 v[240:243],v[52:55],v[72:75],v[240:243]
ds_read_b64_tr_b16 v[50:51],v9 offset:41984
v_mfma_f32_16x16x32_bf16 v[244:247],v[52:55],v[76:79],v[244:247]
s_add_u32 m0,s54,6144
s_add_u32 s51,s55,98304
buffer_load_dwordx4 v88,s[56:59],s51 offen lds
v_mfma_f32_16x16x32_bf16 v[248:251],v[52:55],v[80:83],v[248:251]
buffer_load_dwordx4 v89,s[56:59],s51 offen offset:1024 lds
s_add_u32 s55,s55,128
v_mfma_f32_16x16x32_bf16 v[252:255],v[52:55],v[84:87],v[252:255]
ds_read_b64_tr_b16 v[52:53],v10 offset:40960
ds_read_b64_tr_b16 v[54:55],v10 offset:41984
s_waitcnt lgkmcnt(15)
v_mfma_f32_16x16x32_bf16 v[96:99],v[56:59],v[16:19],v[96:99]
v_mfma_f32_16x16x32_bf16 v[100:103],v[60:63],v[16:19],v[100:103]
v_mfma_f32_16x16x32_bf16 v[104:107],v[64:67],v[16:19],v[104:107]
v_mfma_f32_16x16x32_bf16 v[108:111],v[68:71],v[16:19],v[108:111]
s_waitcnt vmcnt(9) lgkmcnt(0)
s_barrier
ds_read_b64_tr_b16 v[16:17],v1 offset:61440
v_mfma_f32_16x16x32_bf16 v[112:115],v[56:59],v[20:23],v[112:115]
ds_read_b64_tr_b16 v[18:19],v1 offset:61952
v_mfma_f32_16x16x32_bf16 v[116:119],v[60:63],v[20:23],v[116:119]
ds_read_b128 v[72:75],v94 offset:32768
v_mfma_f32_16x16x32_bf16 v[120:123],v[64:67],v[20:23],v[120:123]
ds_read_b128 v[76:79],v94 offset:34816
v_mfma_f32_16x16x32_bf16 v[124:127],v[68:71],v[20:23],v[124:127]
ds_read_b64_tr_b16 v[20:21],v2 offset:61440
v_mfma_f32_16x16x32_bf16 v[128:131],v[24:27],v[56:59],v[128:131]
ds_read_b64_tr_b16 v[22:23],v2 offset:61952
v_mfma_f32_16x16x32_bf16 v[132:135],v[24:27],v[60:63],v[132:135]
ds_read_b128 v[80:83],v94 offset:36864
v_mfma_f32_16x16x32_bf16 v[136:139],v[24:27],v[64:67],v[136:139]
ds_read_b128 v[84:87],v94 offset:38912
v_mfma_f32_16x16x32_bf16 v[140:143],v[24:27],v[68:71],v[140:143]
ds_read_b64_tr_b16 v[24:25],v3 offset:61440
v_mfma_f32_16x16x32_bf16 v[144:147],v[28:31],v[56:59],v[144:147]
ds_read_b64_tr_b16 v[26:27],v3 offset:62464
v_mfma_f32_16x16x32_bf16 v[148:151],v[28:31],v[60:63],v[148:151]
buffer_load_dword v91,v90,s[28:31],s48 offen
s_add_u32 s48,s48,s49
v_mfma_f32_16x16x32_bf16 v[152:155],v[28:31],v[64:67],v[152:155]
v_mfma_f32_16x16x32_bf16 v[156:159],v[28:31],v[68:71],v[156:159]
ds_read_b64_tr_b16 v[28:29],v4 offset:61440
v_mfma_f32_16x16x32_bf16 v[160:163],v[32:35],v[56:59],v[160:163]
ds_read_b64_tr_b16 v[30:31],v4 offset:62464
v_mfma_f32_16x16x32_bf16 v[164:167],v[32:35],v[60:63],v[164:167]
v_mfma_f32_16x16x32_bf16 v[168:171],v[32:35],v[64:67],v[168:171]
v_mfma_f32_16x16x32_bf16 v[172:175],v[32:35],v[68:71],v[172:175]
ds_read_b64_tr_b16 v[32:33],v5 offset:61440
v_mfma_f32_16x16x32_bf16 v[176:179],v[36:39],v[56:59],v[176:179]
ds_read_b64_tr_b16 v[34:35],v5 offset:62464
v_mfma_f32_16x16x32_bf16 v[180:183],v[36:39],v[60:63],v[180:183]
v_mfma_f32_16x16x32_bf16 v[184:187],v[36:39],v[64:67],v[184:187]
v_mfma_f32_16x16x32_bf16 v[188:191],v[36:39],v[68:71],v[188:191]
ds_read_b64_tr_b16 v[36:37],v6 offset:61440
v_mfma_f32_16x16x32_bf16 v[192:195],v[40:43],v[56:59],v[192:195]
ds_read_b64_tr_b16 v[38:39],v6 offset:62464
v_mfma_f32_16x16x32_bf16 v[196:199],v[40:43],v[60:63],v[196:199]
v_mfma_f32_16x16x32_bf16 v[200:203],v[40:43],v[64:67],v[200:203]
v_mfma_f32_16x16x32_bf16 v[204:207],v[40:43],v[68:71],v[204:207]
ds_read_b64_tr_b16 v[40:41],v7 offset:61440
v_mfma_f32_16x16x32_bf16 v[208:211],v[44:47],v[56:59],v[208:211]
ds_read_b64_tr_b16 v[42:43],v7 offset:62464
v_mfma_f32_16x16x32_bf16 v[212:215],v[44:47],v[60:63],v[212:215]
v_mfma_f32_16x16x32_bf16 v[216:219],v[44:47],v[64:67],v[216:219]
v_mfma_f32_16x16x32_bf16 v[220:223],v[44:47],v[68:71],v[220:223]
ds_read_b64_tr_b16 v[44:45],v8 offset:61440
v_mfma_f32_16x16x32_bf16 v[224:227],v[48:51],v[56:59],v[224:227]
ds_read_b64_tr_b16 v[46:47],v8 offset:62464
v_mfma_f32_16x16x32_bf16 v[228:231],v[48:51],v[60:63],v[228:231]
v_mfma_f32_16x16x32_bf16 v[232:235],v[48:51],v[64:67],v[232:235]
v_mfma_f32_16x16x32_bf16 v[236:239],v[48:51],v[68:71],v[236:239]
ds_read_b64_tr_b16 v[48:49],v9 offset:61440
v_mfma_f32_16x16x32_bf16 v[240:243],v[52:55],v[56:59],v[240:243]
ds_read_b64_tr_b16 v[50:51],v9 offset:62464
v_mfma_f32_16x16x32_bf16 v[244:247],v[52:55],v[60:63],v[244:247]
v_mfma_f32_16x16x32_bf16 v[248:251],v[52:55],v[64:67],v[248:251]
v_mfma_f32_16x16x32_bf16 v[252:255],v[52:55],v[68:71],v[252:255]
ds_read_b64_tr_b16 v[52:53],v10 offset:61440
ds_read_b64_tr_b16 v[54:55],v10 offset:62464
s_waitcnt lgkmcnt(15)
v_mfma_f32_16x16x32_bf16 v[96:99],v[72:75],v[16:19],v[96:99]
v_mfma_f32_16x16x32_bf16 v[100:103],v[76:79],v[16:19],v[100:103]
v_mfma_f32_16x16x32_bf16 v[104:107],v[80:83],v[16:19],v[104:107]
v_mfma_f32_16x16x32_bf16 v[108:111],v[84:87],v[16:19],v[108:111]
s_waitcnt vmcnt(1) lgkmcnt(0)
s_barrier
ds_read_b64_tr_b16 v[16:17],v1 offset:0
v_mfma_f32_16x16x32_bf16 v[112:115],v[72:75],v[20:23],v[112:115]
ds_read_b64_tr_b16 v[18:19],v1 offset:512
v_mfma_f32_16x16x32_bf16 v[116:119],v[76:79],v[20:23],v[116:119]
ds_read_b128 v[56:59],v11 offset:0
v_mfma_f32_16x16x32_bf16 v[120:123],v[80:83],v[20:23],v[120:123]
ds_read_b128 v[60:63],v11 offset:2048
v_mfma_f32_16x16x32_bf16 v[124:127],v[84:87],v[20:23],v[124:127]
ds_read_b64_tr_b16 v[20:21],v2 offset:0
v_mfma_f32_16x16x32_bf16 v[128:131],v[24:27],v[72:75],v[128:131]
ds_read_b64_tr_b16 v[22:23],v2 offset:512
v_mfma_f32_16x16x32_bf16 v[132:135],v[24:27],v[76:79],v[132:135]
ds_read_b128 v[64:67],v11 offset:4096
v_mfma_f32_16x16x32_bf16 v[136:139],v[24:27],v[80:83],v[136:139]
ds_read_b128 v[68:71],v11 offset:6144
v_mfma_f32_16x16x32_bf16 v[140:143],v[24:27],v[84:87],v[140:143]
ds_read_b64_tr_b16 v[24:25],v3 offset:0
v_mfma_f32_16x16x32_bf16 v[144:147],v[28:31],v[72:75],v[144:147]
ds_read_b64_tr_b16 v[26:27],v3 offset:1024
v_mfma_f32_16x16x32_bf16 v[148:151],v[28:31],v[76:79],v[148:151]
s_add_u32 m0,s54,32768
s_nop 0
buffer_load_dwordx4 v88,s[56:59],s55 offen lds
v_mfma_f32_16x16x32_bf16 v[152:155],v[28:31],v[80:83],v[152:155]
v_mfma_f32_16x16x32_bf16 v[156:159],v[28:31],v[84:87],v[156:159]
ds_read_b64_tr_b16 v[28:29],v4 offset:0
v_mfma_f32_16x16x32_bf16 v[160:163],v[32:35],v[72:75],v[160:163]
ds_read_b64_tr_b16 v[30:31],v4 offset:1024
v_mfma_f32_16x16x32_bf16 v[164:167],v[32:35],v[76:79],v[164:167]
buffer_load_dwordx4 v89,s[56:59],s55 offen offset:1024 lds
v_mfma_f32_16x16x32_bf16 v[168:171],v[32:35],v[80:83],v[168:171]
v_mfma_f32_16x16x32_bf16 v[172:175],v[32:35],v[84:87],v[172:175]
ds_read_b64_tr_b16 v[32:33],v5 offset:0
v_mfma_f32_16x16x32_bf16 v[176:179],v[36:39],v[72:75],v[176:179]
ds_read_b64_tr_b16 v[34:35],v5 offset:1024
v_mfma_f32_16x16x32_bf16 v[180:183],v[36:39],v[76:79],v[180:183]
s_add_u32 m0,s54,34816
s_add_u32 s51,s55,32768
buffer_load_dwordx4 v88,s[56:59],s51 offen lds
v_mfma_f32_16x16x32_bf16 v[184:187],v[36:39],v[80:83],v[184:187]
v_mfma_f32_16x16x32_bf16 v[188:191],v[36:39],v[84:87],v[188:191]
ds_read_b64_tr_b16 v[36:37],v6 offset:0
v_mfma_f32_16x16x32_bf16 v[192:195],v[40:43],v[72:75],v[192:195]
ds_read_b64_tr_b16 v[38:39],v6 offset:1024
v_mfma_f32_16x16x32_bf16 v[196:199],v[40:43],v[76:79],v[196:199]
buffer_load_dwordx4 v89,s[56:59],s51 offen offset:1024 lds
v_mfma_f32_16x16x32_bf16 v[200:203],v[40:43],v[80:83],v[200:203]
v_mfma_f32_16x16x32_bf16 v[204:207],v[40:43],v[84:87],v[204:207]
ds_read_b64_tr_b16 v[40:41],v7 offset:0
v_mfma_f32_16x16x32_bf16 v[208:211],v[44:47],v[72:75],v[208:211]
ds_read_b64_tr_b16 v[42:43],v7 offset:1024
v_mfma_f32_16x16x32_bf16 v[212:215],v[44:47],v[76:79],v[212:215]
s_add_u32 m0,s54,36864
s_add_u32 s51,s55,65536
buffer_load_dwordx4 v88,s[56:59],s51 offen lds
v_mfma_f32_16x16x32_bf16 v[216:219],v[44:47],v[80:83],v[216:219]
v_mfma_f32_16x16x32_bf16 v[220:223],v[44:47],v[84:87],v[220:223]
ds_read_b64_tr_b16 v[44:45],v8 offset:0
v_mfma_f32_16x16x32_bf16 v[224:227],v[48:51],v[72:75],v[224:227]
ds_read_b64_tr_b16 v[46:47],v8 offset:1024
v_mfma_f32_16x16x32_bf16 v[228:231],v[48:51],v[76:79],v[228:231]
buffer_load_dwordx4 v89,s[56:59],s51 offen offset:1024 lds
v_mfma_f32_16x16x32_bf16 v[232:235],v[48:51],v[80:83],v[232:235]
v_mfma_f32_16x16x32_bf16 v[236:239],v[48:51],v[84:87],v[236:239]
ds_read_b64_tr_b16 v[48:49],v9 offset:0
v_mfma_f32_16x16x32_bf16 v[240:243],v[52:55],v[72:75],v[240:243]
ds_read_b64_tr_b16 v[50:51],v9 offset:1024
v_mfma_f32_16x16x32_bf16 v[244:247],v[52:55],v[76:79],v[244:247]
s_add_u32 m0,s54,38912
s_add_u32 s51,s55,98304
buffer_load_dwordx4 v88,s[56:59],s51 offen lds
v_mfma_f32_16x16x32_bf16 v[248:251],v[52:55],v[80:83],v[248:251]
buffer_load_dwordx4 v89,s[56:59],s51 offen offset:1024 lds
s_and_b32 s50,s64,7
s_lshr_b32 s64,s64,4
s_mul_i32 s55,s50,256
s_add_u32 s55,s55,s65
v_mfma_f32_16x16x32_bf16 v[252:255],v[52:55],v[84:87],v[252:255]
ds_read_b64_tr_b16 v[52:53],v10 offset:0
ds_read_b64_tr_b16 v[54:55],v10 offset:1024
s_sub_u32 s53,s53,1
s_cmp_lg_u32 s53,0
s_cbranch_scc1 g2_loop1
s_waitcnt lgkmcnt(15)
v_mfma_f32_16x16x32_bf16 v[96:99],v[56:59],v[16:19],v[96:99]
v_mfma_f32_16x16x32_bf16 v[100:103],v[60:63],v[16:19],v[100:103]
v_mfma_f32_16x16x32_bf16 v[104:107],v[64:67],v[16:19],v[104:107]
v_mfma_f32_16x16x32_bf16 v[108:111],v[68:71],v[16:19],v[108:111]
s_waitcnt vmcnt(9) lgkmcnt(0)
s_barrier
ds_read_b64_tr_b16 v[16:17],v1 offset:20480
v_mfma_f32_16x16x32_bf16 v[112:115],v[56:59],v[20:23],v[112:115]
ds_read_b64_tr_b16 v[18:19],v1 offset:20992
v_mfma_f32_16x16x32_bf16 v[116:119],v[60:63],v[20:23],v[116:119]
ds_read_b128 v[72:75],v94 offset:0
v_mfma_f32_16x16x32_bf16 v[120:123],v[64:67],v[20:23],v[120:123]
ds_read_b128 v[76:79],v94 offset:2048
v_mfma_f32_16x16x32_bf16 v[124:127],v[68:71],v[20:23],v[124:127]
ds_read_b64_tr_b16 v[20:21],v2 offset:20480
v_mfma_f32_16x16x32_bf16 v[128:131],v[24:27],v[56:59],v[128:131]
ds_read_b64_tr_b16 v[22:23],v2 offset:20992
v_mfma_f32_16x16x32_bf16 v[132:135],v[24:27],v[60:63],v[132:135]
ds_read_b128 v[80:83],v94 offset:4096
v_mfma_f32_16x16x32_bf16 v[136:139],v[24:27],v[64:67],v[136:139]
ds_read_b128 v[84:87],v94 offset:6144
v_mfma_f32_16x16x32_bf16 v[140:143],v[24:27],v[68:71],v[140:143]
ds_read_b64_tr_b16 v[24:25],v3 offset:20480
v_mfma_f32_16x16x32_bf16 v[144:147],v[28:31],v[56:59],v[144:147]
ds_read_b64_tr_b16 v[26:27],v3 offset:21504
v_mfma_f32_16x16x32_bf16 v[148:151],v[28:31],v[60:63],v[148:151]
buffer_load_dword v93,off,s[60:63],0 sc1
v_mfma_f32_16x16x32_bf16 v[152:155],v[28:31],v[64:67],v[152:155]
v_mfma_f32_16x16x32_bf16 v[156:159],v[28:31],v[68:71],v[156:159]
ds_read_b64_tr_b16 v[28:29],v4 offset:20480
v_mfma_f32_16x16x32_bf16 v[160:163],v[32:35],v[56:59],v[160:163]
ds_read_b64_tr_b16 v[30:31],v4 offset:21504
v_mfma_f32_16x16x32_bf16 v[164:167],v[32:35],v[60:63],v[164:167]
s_getpc_b64 s[28:29]
g2_cx1:
s_and_b32 s29,s29,0xffff
s_mov_b32 s30,text_end-g2_cx1
s_mov_b32 s31,0x00020000
s_bfe_u32 s48,s2,0x30003
s_lshl_b32 s48,s48,2
s_add_u32 s48,s48,s41
s_lshl_b32 s48,s48,11
s_add_u32 s48,s48,af_entry-g2_cx1
buffer_load_dword v91,v90,s[28:31],s48 offen
v_mfma_f32_16x16x32_bf16 v[168:171],v[32:35],v[64:67],v[168:171]
v_mfma_f32_16x16x32_bf16 v[172:175],v[32:35],v[68:71],v[172:175]
ds_read_b64_tr_b16 v[32:33],v5 offset:20480
v_mfma_f32_16x16x32_bf16 v[176:179],v[36:39],v[56:59],v[176:179]
ds_read_b64_tr_b16 v[34:35],v5 offset:21504
v_mfma_f32_16x16x32_bf16 v[180:183],v[36:39],v[60:63],v[180:183]
v_mfma_f32_16x16x32_bf16 v[184:187],v[36:39],v[64:67],v[184:187]
v_mfma_f32_16x16x32_bf16 v[188:191],v[36:39],v[68:71],v[188:191]
ds_read_b64_tr_b16 v[36:37],v6 offset:20480
v_mfma_f32_16x16x32_bf16 v[192:195],v[40:43],v[56:59],v[192:195]
ds_read_b64_tr_b16 v[38:39],v6 offset:21504
v_mfma_f32_16x16x32_bf16 v[196:199],v[40:43],v[60:63],v[196:199]
v_mfma_f32_16x16x32_bf16 v[200:203],v[40:43],v[64:67],v[200:203]
v_mfma_f32_16x16x32_bf16 v[204:207],v[40:43],v[68:71],v[204:207]
ds_read_b64_tr_b16 v[40:41],v7 offset:20480
v_mfma_f32_16x16x32_bf16 v[208:211],v[44:47],v[56:59],v[208:211]
ds_read_b64_tr_b16 v[42:43],v7 offset:21504
v_mfma_f32_16x16x32_bf16 v[212:215],v[44:47],v[60:63],v[212:215]
v_mfma_f32_16x16x32_bf16 v[216:219],v[44:47],v[64:67],v[216:219]
v_mfma_f32_16x16x32_bf16 v[220:223],v[44:47],v[68:71],v[220:223]
ds_read_b64_tr_b16 v[44:45],v8 offset:20480
v_mfma_f32_16x16x32_bf16 v[224:227],v[48:51],v[56:59],v[224:227]
ds_read_b64_tr_b16 v[46:47],v8 offset:21504
v_mfma_f32_16x16x32_bf16 v[228:231],v[48:51],v[60:63],v[228:231]
v_mfma_f32_16x16x32_bf16 v[232:235],v[48:51],v[64:67],v[232:235]
v_mfma_f32_16x16x32_bf16 v[236:239],v[48:51],v[68:71],v[236:239]
ds_read_b64_tr_b16 v[48:49],v9 offset:20480
v_mfma_f32_16x16x32_bf16 v[240:243],v[52:55],v[56:59],v[240:243]
ds_read_b64_tr_b16 v[50:51],v9 offset:21504
v_mfma_f32_16x16x32_bf16 v[244:247],v[52:55],v[60:63],v[244:247]
v_mfma_f32_16x16x32_bf16 v[248:251],v[52:55],v[64:67],v[248:251]
v_mfma_f32_16x16x32_bf16 v[252:255],v[52:55],v[68:71],v[252:255]
ds_read_b64_tr_b16 v[52:53],v10 offset:20480
ds_read_b64_tr_b16 v[54:55],v10 offset:21504
s_waitcnt lgkmcnt(15)
v_mfma_f32_16x16x32_bf16 v[96:99],v[72:75],v[16:19],v[96:99]
v_mfma_f32_16x16x32_bf16 v[100:103],v[76:79],v[16:19],v[100:103]
v_mfma_f32_16x16x32_bf16 v[104:107],v[80:83],v[16:19],v[104:107]
v_mfma_f32_16x16x32_bf16 v[108:111],v[84:87],v[16:19],v[108:111]
s_waitcnt vmcnt(1) lgkmcnt(0)
s_barrier
v_readfirstlane_b32 s50,v93
s_nop 0
s_cmp_lg_u32 s50,256
s_cbranch_scc1 g2_bad1
g2_badr1:
ds_read_b64_tr_b16 v[16:17],v1 offset:40960
v_mfma_f32_16x16x32_bf16 v[112:115],v[72:75],v[20:23],v[112:115]
ds_read_b64_tr_b16 v[18:19],v1 offset:41472
v_mfma_f32_16x16x32_bf16 v[116:119],v[76:79],v[20:23],v[116:119]
ds_read_b128 v[56:59],v11 offset:32768
v_mfma_f32_16x16x32_bf16 v[120:123],v[80:83],v[20:23],v[120:123]
ds_read_b128 v[60:63],v11 offset:34816
v_mfma_f32_16x16x32_bf16 v[124:127],v[84:87],v[20:23],v[124:127]
ds_read_b64_tr_b16 v[20:21],v2 offset:40960
v_mfma_f32_16x16x32_bf16 v[128:131],v[24:27],v[72:75],v[128:131]
ds_read_b64_tr_b16 v[22:23],v2 offset:41472
v_mfma_f32_16x16x32_bf16 v[132:135],v[24:27],v[76:79],v[132:135]
ds_read_b128 v[64:67],v11 offset:36864
v_mfma_f32_16x16x32_bf16 v[136:139],v[24:27],v[80:83],v[136:139]
ds_read_b128 v[68:71],v11 offset:38912
v_mfma_f32_16x16x32_bf16 v[140:143],v[24:27],v[84:87],v[140:143]
ds_read_b64_tr_b16 v[24:25],v3 offset:40960
v_mfma_f32_16x16x32_bf16 v[144:147],v[28:31],v[72:75],v[144:147]
ds_read_b64_tr_b16 v[26:27],v3 offset:41984
v_mfma_f32_16x16x32_bf16 v[148:151],v[28:31],v[76:79],v[148:151]
v_lshlrev_b32 v92,5,v0
buffer_load_dwordx4 v[12:15],v92,s[36:39],s98 offen sc1
v_mfma_f32_16x16x32_bf16 v[152:155],v[28:31],v[80:83],v[152:155]
v_mfma_f32_16x16x32_bf16 v[156:159],v[28:31],v[84:87],v[156:159]
ds_read_b64_tr_b16 v[28:29],v4 offset:40960
v_mfma_f32_16x16x32_bf16 v[160:163],v[32:35],v[72:75],v[160:163]
ds_read_b64_tr_b16 v[30:31],v4 offset:41984
v_mfma_f32_16x16x32_bf16 v[164:167],v[32:35],v[76:79],v[164:167]
buffer_load_dwordx4 v[88:91],v92,s[36:39],s98 offen offset:16 sc1
v_mfma_f32_16x16x32_bf16 v[168:171],v[32:35],v[80:83],v[168:171]
v_mfma_f32_16x16x32_bf16 v[172:175],v[32:35],v[84:87],v[172:175]
ds_read_b64_tr_b16 v[32:33],v5 offset:40960
v_mfma_f32_16x16x32_bf16 v[176:179],v[36:39],v[72:75],v[176:179]
ds_read_b64_tr_b16 v[34:35],v5 offset:41984
v_mfma_f32_16x16x32_bf16 v[180:183],v[36:39],v[76:79],v[180:183]
v_lshrrev_b32 v93,5,v0
v_mul_u32_u24 v93,8064,v93
v_lshl_add_u32 v93,v0,2,v93
s_lshl_b32 s50,s40,8
s_add_u32 m0,s50,149504
s_lshr_b32 s50,s50,1
s_lshl_b32 s51,s43,10
s_add_u32 s50,s50,s51
s_add_u32 s50,s50,42991616
buffer_load_dword v93,s[36:39],s50 offen sc1 lds
v_mfma_f32_16x16x32_bf16 v[184:187],v[36:39],v[80:83],v[184:187]
v_mfma_f32_16x16x32_bf16 v[188:191],v[36:39],v[84:87],v[188:191]
ds_read_b64_tr_b16 v[36:37],v6 offset:40960
v_mfma_f32_16x16x32_bf16 v[192:195],v[40:43],v[72:75],v[192:195]
ds_read_b64_tr_b16 v[38:39],v6 offset:41984
v_mfma_f32_16x16x32_bf16 v[196:199],v[40:43],v[76:79],v[196:199]
v_mfma_f32_16x16x32_bf16 v[200:203],v[40:43],v[80:83],v[200:203]
v_mfma_f32_16x16x32_bf16 v[204:207],v[40:43],v[84:87],v[204:207]
ds_read_b64_tr_b16 v[40:41],v7 offset:40960
v_mfma_f32_16x16x32_bf16 v[208:211],v[44:47],v[72:75],v[208:211]
ds_read_b64_tr_b16 v[42:43],v7 offset:41984
v_mfma_f32_16x16x32_bf16 v[212:215],v[44:47],v[76:79],v[212:215]
v_mfma_f32_16x16x32_bf16 v[216:219],v[44:47],v[80:83],v[216:219]
v_mfma_f32_16x16x32_bf16 v[220:223],v[44:47],v[84:87],v[220:223]
ds_read_b64_tr_b16 v[44:45],v8 offset:40960
v_mfma_f32_16x16x32_bf16 v[224:227],v[48:51],v[72:75],v[224:227]
ds_read_b64_tr_b16 v[46:47],v8 offset:41984
v_mfma_f32_16x16x32_bf16 v[228:231],v[48:51],v[76:79],v[228:231]
v_mfma_f32_16x16x32_bf16 v[232:235],v[48:51],v[80:83],v[232:235]
v_mfma_f32_16x16x32_bf16 v[236:239],v[48:51],v[84:87],v[236:239]
ds_read_b64_tr_b16 v[48:49],v9 offset:40960
v_mfma_f32_16x16x32_bf16 v[240:243],v[52:55],v[72:75],v[240:243]
ds_read_b64_tr_b16 v[50:51],v9 offset:41984
v_mfma_f32_16x16x32_bf16 v[244:247],v[52:55],v[76:79],v[244:247]
v_mfma_f32_16x16x32_bf16 v[248:251],v[52:55],v[80:83],v[248:251]
v_mfma_f32_16x16x32_bf16 v[252:255],v[52:55],v[84:87],v[252:255]
ds_read_b64_tr_b16 v[52:53],v10 offset:40960
ds_read_b64_tr_b16 v[54:55],v10 offset:41984
s_waitcnt lgkmcnt(15)
v_mfma_f32_16x16x32_bf16 v[96:99],v[56:59],v[16:19],v[96:99]
v_mfma_f32_16x16x32_bf16 v[100:103],v[60:63],v[16:19],v[100:103]
v_mfma_f32_16x16x32_bf16 v[104:107],v[64:67],v[16:19],v[104:107]
v_mfma_f32_16x16x32_bf16 v[108:111],v[68:71],v[16:19],v[108:111]
s_waitcnt vmcnt(0) lgkmcnt(0)
s_barrier
ds_read_b64_tr_b16 v[16:17],v1 offset:61440
v_mfma_f32_16x16x32_bf16 v[112:115],v[56:59],v[20:23],v[112:115]
ds_read_b64_tr_b16 v[18:19],v1 offset:61952
v_mfma_f32_16x16x32_bf16 v[116:119],v[60:63],v[20:23],v[116:119]
ds_read_b128 v[72:75],v94 offset:32768
v_mfma_f32_16x16x32_bf16 v[120:123],v[64:67],v[20:23],v[120:123]
ds_read_b128 v[76:79],v94 offset:34816
v_mfma_f32_16x16x32_bf16 v[124:127],v[68:71],v[20:23],v[124:127]
ds_read_b64_tr_b16 v[20:21],v2 offset:61440
v_mfma_f32_16x16x32_bf16 v[128:131],v[24:27],v[56:59],v[128:131]
ds_read_b64_tr_b16 v[22:23],v2 offset:61952
v_mfma_f32_16x16x32_bf16 v[132:135],v[24:27],v[60:63],v[132:135]
ds_read_b128 v[80:83],v94 offset:36864
v_mfma_f32_16x16x32_bf16 v[136:139],v[24:27],v[64:67],v[136:139]
ds_read_b128 v[84:87],v94 offset:38912
v_mfma_f32_16x16x32_bf16 v[140:143],v[24:27],v[68:71],v[140:143]
ds_read_b64_tr_b16 v[24:25],v3 offset:61440
v_mfma_f32_16x16x32_bf16 v[144:147],v[28:31],v[56:59],v[144:147]
ds_read_b64_tr_b16 v[26:27],v3 offset:62464
v_mfma_f32_16x16x32_bf16 v[148:151],v[28:31],v[60:63],v[148:151]
v_add_f32 v12,v12,v88
v_add_f32 v13,v13,v89
v_add_f32 v14,v14,v90
v_add_f32 v15,v15,v91
v_add_f32 v12,v12,v13
v_add_f32 v14,v14,v15
v_add_f32 v12,v12,v14
s_lshl_b32 s50,s40,8
s_add_u32 s50,s50,147456
v_lshl_add_u32 v92,v0,2,s50
ds_write_b32 v92,v12
v_mfma_f32_16x16x32_bf16 v[152:155],v[28:31],v[64:67],v[152:155]
v_mfma_f32_16x16x32_bf16 v[156:159],v[28:31],v[68:71],v[156:159]
ds_read_b64_tr_b16 v[28:29],v4 offset:61440
v_mfma_f32_16x16x32_bf16 v[160:163],v[32:35],v[56:59],v[160:163]
ds_read_b64_tr_b16 v[30:31],v4 offset:62464
v_mfma_f32_16x16x32_bf16 v[164:167],v[32:35],v[60:63],v[164:167]
v_mfma_f32_16x16x32_bf16 v[168:171],v[32:35],v[64:67],v[168:171]
v_mfma_f32_16x16x32_bf16 v[172:175],v[32:35],v[68:71],v[172:175]
ds_read_b64_tr_b16 v[32:33],v5 offset:61440
v_mfma_f32_16x16x32_bf16 v[176:179],v[36:39],v[56:59],v[176:179]
ds_read_b64_tr_b16 v[34:35],v5 offset:62464
v_mfma_f32_16x16x32_bf16 v[180:183],v[36:39],v[60:63],v[180:183]
v_mfma_f32_16x16x32_bf16 v[184:187],v[36:39],v[64:67],v[184:187]
v_mfma_f32_16x16x32_bf16 v[188:191],v[36:39],v[68:71],v[188:191]
ds_read_b64_tr_b16 v[36:37],v6 offset:61440
v_mfma_f32_16x16x32_bf16 v[192:195],v[40:43],v[56:59],v[192:195]
ds_read_b64_tr_b16 v[38:39],v6 offset:62464
v_mfma_f32_16x16x32_bf16 v[196:199],v[40:43],v[60:63],v[196:199]
v_mfma_f32_16x16x32_bf16 v[200:203],v[40:43],v[64:67],v[200:203]
v_mfma_f32_16x16x32_bf16 v[204:207],v[40:43],v[68:71],v[204:207]
ds_read_b64_tr_b16 v[40:41],v7 offset:61440
v_mfma_f32_16x16x32_bf16 v[208:211],v[44:47],v[56:59],v[208:211]
ds_read_b64_tr_b16 v[42:43],v7 offset:62464
v_mfma_f32_16x16x32_bf16 v[212:215],v[44:47],v[60:63],v[212:215]
v_mfma_f32_16x16x32_bf16 v[216:219],v[44:47],v[64:67],v[216:219]
v_mfma_f32_16x16x32_bf16 v[220:223],v[44:47],v[68:71],v[220:223]
ds_read_b64_tr_b16 v[44:45],v8 offset:61440
v_mfma_f32_16x16x32_bf16 v[224:227],v[48:51],v[56:59],v[224:227]
ds_read_b64_tr_b16 v[46:47],v8 offset:62464
v_mfma_f32_16x16x32_bf16 v[228:231],v[48:51],v[60:63],v[228:231]
v_mfma_f32_16x16x32_bf16 v[232:235],v[48:51],v[64:67],v[232:235]
v_mfma_f32_16x16x32_bf16 v[236:239],v[48:51],v[68:71],v[236:239]
ds_read_b64_tr_b16 v[48:49],v9 offset:61440
v_mfma_f32_16x16x32_bf16 v[240:243],v[52:55],v[56:59],v[240:243]
ds_read_b64_tr_b16 v[50:51],v9 offset:62464
v_mfma_f32_16x16x32_bf16 v[244:247],v[52:55],v[60:63],v[244:247]
v_mfma_f32_16x16x32_bf16 v[248:251],v[52:55],v[64:67],v[248:251]
v_mfma_f32_16x16x32_bf16 v[252:255],v[52:55],v[68:71],v[252:255]
ds_read_b64_tr_b16 v[52:53],v10 offset:61440
ds_read_b64_tr_b16 v[54:55],v10 offset:62464
s_waitcnt lgkmcnt(15)
v_mfma_f32_16x16x32_bf16 v[96:99],v[72:75],v[16:19],v[96:99]
v_lshrrev_b32 v92,4,v0
v_lshlrev_b32 v92,4,v92
v_and_b32 v93,15,v0
v_lshlrev_b32 v93,2,v93
s_lshl_b32 s50,s41,9
v_mfma_f32_16x16x32_bf16 v[100:103],v[76:79],v[16:19],v[100:103]
s_add_u32 s50,s50,149504
v_add_u32 v94,s50,v93
v_add_u32 v95,s50,v92
v_add_u32 v92,147456,v92
v_add_u32 v93,147456,v93
v_mfma_f32_16x16x32_bf16 v[104:107],v[80:83],v[16:19],v[104:107]
v_mfma_f32_16x16x32_bf16 v[108:111],v[84:87],v[16:19],v[108:111]
s_waitcnt lgkmcnt(0)
s_barrier
ds_read_b32 v16,v93 offset:128
v_mfma_f32_16x16x32_bf16 v[112:115],v[72:75],v[20:23],v[112:115]
v_mfma_f32_16x16x32_bf16 v[116:119],v[76:79],v[20:23],v[116:119]
ds_read_b32 v2,v93 offset:4096
v_mfma_f32_16x16x32_bf16 v[120:123],v[80:83],v[20:23],v[120:123]
ds_read2_b32 v[56:57],v94 offset0:0 offset1:32
v_mfma_f32_16x16x32_bf16 v[124:127],v[84:87],v[20:23],v[124:127]
ds_read_b32 v20,v93 offset:192
v_mfma_f32_16x16x32_bf16 v[128:131],v[24:27],v[72:75],v[128:131]
v_mfma_f32_16x16x32_bf16 v[132:135],v[24:27],v[76:79],v[132:135]
ds_read2_b32 v[58:59],v94 offset0:16 offset1:48
v_mfma_f32_16x16x32_bf16 v[136:139],v[24:27],v[80:83],v[136:139]
ds_read2_b32 v[60:61],v94 offset0:64 offset1:96
v_mfma_f32_16x16x32_bf16 v[140:143],v[24:27],v[84:87],v[140:143]
ds_read_b128 v[24:27],v92 offset:512
v_mfma_f32_16x16x32_bf16 v[144:147],v[28:31],v[72:75],v[144:147]
v_mfma_f32_16x16x32_bf16 v[148:151],v[28:31],v[76:79],v[148:151]
ds_read2_b32 v[62:63],v94 offset0:80 offset1:112
v_mfma_f32_16x16x32_bf16 v[152:155],v[28:31],v[80:83],v[152:155]
ds_read_b128 v[4:7],v95 offset:128
v_mfma_f32_16x16x32_bf16 v[156:159],v[28:31],v[84:87],v[156:159]
ds_read_b128 v[28:31],v92 offset:576
v_mfma_f32_16x16x32_bf16 v[160:163],v[32:35],v[72:75],v[160:163]
v_mfma_f32_16x16x32_bf16 v[164:167],v[32:35],v[76:79],v[164:167]
ds_read_b128 v[8:11],v95 offset:192
v_mfma_f32_16x16x32_bf16 v[168:171],v[32:35],v[80:83],v[168:171]
ds_read_b128 v[12:15],v95 offset:384
v_mfma_f32_16x16x32_bf16 v[172:175],v[32:35],v[84:87],v[172:175]
ds_read_b128 v[32:35],v92 offset:1024
v_mfma_f32_16x16x32_bf16 v[176:179],v[36:39],v[72:75],v[176:179]
v_mfma_f32_16x16x32_bf16 v[180:183],v[36:39],v[76:79],v[180:183]
ds_read_b128 v[88:91],v95 offset:448
v_mfma_f32_16x16x32_bf16 v[184:187],v[36:39],v[80:83],v[184:187]
v_mfma_f32_16x16x32_bf16 v[188:191],v[36:39],v[84:87],v[188:191]
ds_read_b128 v[36:39],v92 offset:1088
v_mfma_f32_16x16x32_bf16 v[192:195],v[40:43],v[72:75],v[192:195]
v_mfma_f32_16x16x32_bf16 v[196:199],v[40:43],v[76:79],v[196:199]
v_mfma_f32_16x16x32_bf16 v[200:203],v[40:43],v[80:83],v[200:203]
v_mfma_f32_16x16x32_bf16 v[204:207],v[40:43],v[84:87],v[204:207]
ds_read_b128 v[40:43],v92 offset:640
v_mfma_f32_16x16x32_bf16 v[208:211],v[44:47],v[72:75],v[208:211]
v_mfma_f32_16x16x32_bf16 v[212:215],v[44:47],v[76:79],v[212:215]
v_mfma_f32_16x16x32_bf16 v[216:219],v[44:47],v[80:83],v[216:219]
v_mfma_f32_16x16x32_bf16 v[220:223],v[44:47],v[84:87],v[220:223]
ds_read_b128 v[44:47],v92 offset:704
v_mfma_f32_16x16x32_bf16 v[224:227],v[48:51],v[72:75],v[224:227]
v_mfma_f32_16x16x32_bf16 v[228:231],v[48:51],v[76:79],v[228:231]
v_mfma_f32_16x16x32_bf16 v[232:235],v[48:51],v[80:83],v[232:235]
v_mfma_f32_16x16x32_bf16 v[236:239],v[48:51],v[84:87],v[236:239]
ds_read_b128 v[48:51],v92 offset:1152
v_mfma_f32_16x16x32_bf16 v[240:243],v[52:55],v[72:75],v[240:243]
v_mfma_f32_16x16x32_bf16 v[244:247],v[52:55],v[76:79],v[244:247]
v_mfma_f32_16x16x32_bf16 v[248:251],v[52:55],v[80:83],v[248:251]
v_mfma_f32_16x16x32_bf16 v[252:255],v[52:55],v[84:87],v[252:255]
ds_read_b128 v[52:55],v92 offset:1216
s_waitcnt lgkmcnt(4)
v_readfirstlane_b32 s50,v2
v_lshlrev_b32 v1,4,v0
s_cmp_lg_u32 s50,0
s_cbranch_scc1 g2_rec
g2_ep1:
s_load_dwordx2 s[10:11],s[0:1],56
s_mov_b64 s[6:7],s[14:15]
s_mov_b64 s[8:9],s[16:17]
s_setprio 3
ds_read_b128 v[72:75],v95 offset:0
ds_read_b128 v[76:79],v95 offset:64
ds_read_b128 v[80:83],v95 offset:256
ds_read_b128 v[84:87],v95 offset:320
v_rcp_f32 v65,v57
v_rcp_f32 v67,v59
v_rcp_f32 v69,v61
v_rcp_f32 v71,v63
v_rcp_f32 v4,v4
v_rcp_f32 v5,v5
v_rcp_f32 v6,v6
v_rcp_f32 v7,v7
v_rcp_f32 v8,v8
v_rcp_f32 v9,v9
v_rcp_f32 v10,v10
v_rcp_f32 v11,v11
v_rcp_f32 v12,v12
v_rcp_f32 v13,v13
v_rcp_f32 v14,v14
v_rcp_f32 v15,v15
v_rcp_f32 v88,v88
v_rcp_f32 v89,v89
v_rcp_f32 v90,v90
v_rcp_f32 v91,v91
s_lshl_b32 s50,s43,3
s_lshl_b32 s51,s41,1
s_add_u32 s50,s50,s51
s_lshl_b32 s48,s50,11
s_lshl_b32 s51,s45,18
s_add_u32 s48,s48,s51
s_mul_i32 s49,s50,294912
s_lshl_b32 s51,s47,5
s_add_u32 s49,s49,s51
s_add_u32 s49,s49,12582912
v_mul_f32 v64,0xbfb8aa3b,v65
v_mul_f32 v66,0xbfb8aa3b,v67
v_mul_f32 v68,0xbfb8aa3b,v69
v_mul_f32 v70,0xbfb8aa3b,v71
s_waitcnt lgkmcnt(0)
s_add_u32 s50,s48,8519680
v_pk_fma_f32 v[96:97],v[72:73],v[16:17],v[96:97] op_sel:[0,0,0] op_sel_hi:[1,0,1]
v_pk_fma_f32 v[98:99],v[74:75],v[16:17],v[98:99] op_sel:[0,0,0] op_sel_hi:[1,0,1]
v_pk_fma_f32 v[100:101],v[76:77],v[16:17],v[100:101] op_sel:[0,0,0] op_sel_hi:[1,0,1]
v_pk_fma_f32 v[102:103],v[78:79],v[16:17],v[102:103] op_sel:[0,0,0] op_sel_hi:[1,0,1]
v_pk_mul_f32 v[96:97],v[96:97],v[4:5] op_sel:[0,0] op_sel_hi:[1,1]
v_pk_mul_f32 v[98:99],v[98:99],v[6:7] op_sel:[0,0] op_sel_hi:[1,1]
v_pk_mul_f32 v[100:101],v[100:101],v[8:9] op_sel:[0,0] op_sel_hi:[1,1]
v_pk_mul_f32 v[102:103],v[102:103],v[10:11] op_sel:[0,0] op_sel_hi:[1,1]
v_cvt_pk_bf16_f32 v96,v96,v97
v_cvt_pk_bf16_f32 v97,v98,v99
v_cvt_pk_bf16_f32 v98,v100,v101
v_cvt_pk_bf16_f32 v99,v102,v103
buffer_store_dwordx4 v[96:99],v1,s[36:39],s50 offen offset:0 sc1
v_pk_fma_f32 v[104:105],v[80:81],v[16:17],v[104:105] op_sel:[0,0,0] op_sel_hi:[1,0,1]
v_pk_fma_f32 v[106:107],v[82:83],v[16:17],v[106:107] op_sel:[0,0,0] op_sel_hi:[1,0,1]
v_pk_fma_f32 v[108:109],v[84:85],v[16:17],v[108:109] op_sel:[0,0,0] op_sel_hi:[1,0,1]
v_pk_fma_f32 v[110:111],v[86:87],v[16:17],v[110:111] op_sel:[0,0,0] op_sel_hi:[1,0,1]
v_pk_mul_f32 v[104:105],v[104:105],v[12:13] op_sel:[0,0] op_sel_hi:[1,1]
v_pk_mul_f32 v[106:107],v[106:107],v[14:15] op_sel:[0,0] op_sel_hi:[1,1]
v_pk_mul_f32 v[108:109],v[108:109],v[88:89] op_sel:[0,0] op_sel_hi:[1,1]
v_pk_mul_f32 v[110:111],v[110:111],v[90:91] op_sel:[0,0] op_sel_hi:[1,1]
v_cvt_pk_bf16_f32 v104,v104,v105
v_cvt_pk_bf16_f32 v105,v106,v107
v_cvt_pk_bf16_f32 v106,v108,v109
v_cvt_pk_bf16_f32 v107,v110,v111
buffer_store_dwordx4 v[104:107],v1,s[36:39],s50 offen offset:2048 sc1
v_pk_fma_f32 v[112:113],v[72:73],v[20:21],v[112:113] op_sel:[0,0,0] op_sel_hi:[1,0,1]
v_pk_fma_f32 v[114:115],v[74:75],v[20:21],v[114:115] op_sel:[0,0,0] op_sel_hi:[1,0,1]
v_pk_fma_f32 v[116:117],v[76:77],v[20:21],v[116:117] op_sel:[0,0,0] op_sel_hi:[1,0,1]
v_pk_fma_f32 v[118:119],v[78:79],v[20:21],v[118:119] op_sel:[0,0,0] op_sel_hi:[1,0,1]
v_pk_mul_f32 v[112:113],v[112:113],v[4:5] op_sel:[0,0] op_sel_hi:[1,1]
v_pk_mul_f32 v[114:115],v[114:115],v[6:7] op_sel:[0,0] op_sel_hi:[1,1]
v_pk_mul_f32 v[116:117],v[116:117],v[8:9] op_sel:[0,0] op_sel_hi:[1,1]
v_pk_mul_f32 v[118:119],v[118:119],v[10:11] op_sel:[0,0] op_sel_hi:[1,1]
v_cvt_pk_bf16_f32 v112,v112,v113
v_cvt_pk_bf16_f32 v113,v114,v115
v_cvt_pk_bf16_f32 v114,v116,v117
v_cvt_pk_bf16_f32 v115,v118,v119
buffer_store_dwordx4 v[112:115],v1,s[36:39],s50 offen offset:1024 sc1
v_pk_fma_f32 v[120:121],v[80:81],v[20:21],v[120:121] op_sel:[0,0,0] op_sel_hi:[1,0,1]
v_pk_fma_f32 v[122:123],v[82:83],v[20:21],v[122:123] op_sel:[0,0,0] op_sel_hi:[1,0,1]
v_pk_fma_f32 v[124:125],v[84:85],v[20:21],v[124:125] op_sel:[0,0,0] op_sel_hi:[1,0,1]
v_pk_fma_f32 v[126:127],v[86:87],v[20:21],v[126:127] op_sel:[0,0,0] op_sel_hi:[1,0,1]
v_pk_mul_f32 v[120:121],v[120:121],v[12:13] op_sel:[0,0] op_sel_hi:[1,1]
v_pk_mul_f32 v[122:123],v[122:123],v[14:15] op_sel:[0,0] op_sel_hi:[1,1]
v_pk_mul_f32 v[124:125],v[124:125],v[88:89] op_sel:[0,0] op_sel_hi:[1,1]
v_pk_mul_f32 v[126:127],v[126:127],v[90:91] op_sel:[0,0] op_sel_hi:[1,1]
v_cvt_pk_bf16_f32 v120,v120,v121
v_cvt_pk_bf16_f32 v121,v122,v123
v_cvt_pk_bf16_f32 v122,v124,v125
v_cvt_pk_bf16_f32 v123,v126,v127
buffer_store_dwordx4 v[120:123],v1,s[36:39],s50 offen offset:3072 sc1
s_setprio 1
v_mov_b32 v72,v57
v_mov_b32 v74,v59
v_mov_b32 v76,v61
v_mov_b32 v78,v63
v_mov_b32 v2,161792
v_mov_b32 v3,1
s_waitcnt vmcnt(0)
s_mov_b64 exec,1
ds_add_rtn_u32 v3,v2,v3 offset:48
s_mov_b64 exec,-1
s_lshl_b32 s51,s43,1
s_and_b32 s52,s44,1
s_add_u32 s51,s51,s52
s_lshl_b32 s51,s51,2
s_lshl_b32 s52,s45,13
s_add_u32 s51,s51,s52
s_add_u32 s51,s51,42074112
s_waitcnt lgkmcnt(0)
v_readfirstlane_b32 s52,v3
v_lshlrev_b32 v3,9,v0
s_cmp_lg_u32 s52,7
s_cbranch_scc1 g2_nq1
s_mov_b64 exec,0xffff
buffer_store_dword v2,v3,s[36:39],s51 offen sc1
s_mov_b64 exec,-1
g2_nq1:
v_pk_fma_f32 v[128:129],v[24:25],v[56:57],v[128:129] op_sel:[0,0,0] op_sel_hi:[1,0,1]
v_pk_fma_f32 v[130:131],v[26:27],v[56:57],v[130:131] op_sel:[0,0,0] op_sel_hi:[1,0,1]
v_pk_fma_f32 v[144:145],v[28:29],v[56:57],v[144:145] op_sel:[0,0,0] op_sel_hi:[1,0,1]
v_pk_fma_f32 v[146:147],v[30:31],v[56:57],v[146:147] op_sel:[0,0,0] op_sel_hi:[1,0,1]
v_pk_mul_f32 v[128:129],v[128:129],v[64:65] op_sel:[0,0] op_sel_hi:[1,0]
v_pk_mul_f32 v[130:131],v[130:131],v[64:65] op_sel:[0,0] op_sel_hi:[1,0]
v_pk_mul_f32 v[144:145],v[144:145],v[64:65] op_sel:[0,0] op_sel_hi:[1,0]
v_pk_mul_f32 v[146:147],v[146:147],v[64:65] op_sel:[0,0] op_sel_hi:[1,0]
v_exp_f32 v128,v128
v_exp_f32 v129,v129
v_exp_f32 v130,v130
v_exp_f32 v131,v131
v_exp_f32 v144,v144
v_exp_f32 v145,v145
v_exp_f32 v146,v146
v_exp_f32 v147,v147
v_pk_fma_f32 v[160:161],v[32:33],v[56:57],v[160:161] op_sel:[0,0,0] op_sel_hi:[1,0,1]
v_pk_fma_f32 v[162:163],v[34:35],v[56:57],v[162:163] op_sel:[0,0,0] op_sel_hi:[1,0,1]
v_pk_fma_f32 v[176:177],v[36:37],v[56:57],v[176:177] op_sel:[0,0,0] op_sel_hi:[1,0,1]
v_pk_fma_f32 v[178:179],v[38:39],v[56:57],v[178:179] op_sel:[0,0,0] op_sel_hi:[1,0,1]
v_pk_fma_f32 v[128:129],v[128:129],v[72:73],v[72:73] op_sel:[0,0,0] op_sel_hi:[1,0,0]
v_pk_fma_f32 v[130:131],v[130:131],v[72:73],v[72:73] op_sel:[0,0,0] op_sel_hi:[1,0,0]
v_pk_fma_f32 v[144:145],v[144:145],v[72:73],v[72:73] op_sel:[0,0,0] op_sel_hi:[1,0,0]
v_pk_fma_f32 v[146:147],v[146:147],v[72:73],v[72:73] op_sel:[0,0,0] op_sel_hi:[1,0,0]
v_rcp_f32 v128,v128
v_rcp_f32 v129,v129
v_rcp_f32 v130,v130
v_rcp_f32 v131,v131
v_rcp_f32 v144,v144
v_rcp_f32 v145,v145
v_rcp_f32 v146,v146
v_rcp_f32 v147,v147
s_nop 0
v_pk_mul_f32 v[128:129],v[128:129],v[160:161] op_sel:[0,0] op_sel_hi:[1,1]
v_pk_mul_f32 v[130:131],v[130:131],v[162:163] op_sel:[0,0] op_sel_hi:[1,1]
v_pk_mul_f32 v[144:145],v[144:145],v[176:177] op_sel:[0,0] op_sel_hi:[1,1]
v_pk_mul_f32 v[146:147],v[146:147],v[178:179] op_sel:[0,0] op_sel_hi:[1,1]
v_cvt_pk_bf16_f32 v128,v128,v129
v_cvt_pk_bf16_f32 v129,v130,v131
v_cvt_pk_bf16_f32 v130,v144,v145
v_cvt_pk_bf16_f32 v131,v146,v147
v_pk_fma_f32 v[132:133],v[24:25],v[58:59],v[132:133] op_sel:[0,0,0] op_sel_hi:[1,0,1]
v_pk_fma_f32 v[134:135],v[26:27],v[58:59],v[134:135] op_sel:[0,0,0] op_sel_hi:[1,0,1]
v_pk_fma_f32 v[148:149],v[28:29],v[58:59],v[148:149] op_sel:[0,0,0] op_sel_hi:[1,0,1]
v_pk_fma_f32 v[150:151],v[30:31],v[58:59],v[150:151] op_sel:[0,0,0] op_sel_hi:[1,0,1]
v_pk_mul_f32 v[132:133],v[132:133],v[66:67] op_sel:[0,0] op_sel_hi:[1,0]
v_pk_mul_f32 v[134:135],v[134:135],v[66:67] op_sel:[0,0] op_sel_hi:[1,0]
v_pk_mul_f32 v[148:149],v[148:149],v[66:67] op_sel:[0,0] op_sel_hi:[1,0]
v_pk_mul_f32 v[150:151],v[150:151],v[66:67] op_sel:[0,0] op_sel_hi:[1,0]
v_exp_f32 v132,v132
v_exp_f32 v133,v133
v_exp_f32 v134,v134
v_exp_f32 v135,v135
v_exp_f32 v148,v148
v_exp_f32 v149,v149
v_exp_f32 v150,v150
v_exp_f32 v151,v151
v_pk_fma_f32 v[164:165],v[32:33],v[58:59],v[164:165] op_sel:[0,0,0] op_sel_hi:[1,0,1]
v_pk_fma_f32 v[166:167],v[34:35],v[58:59],v[166:167] op_sel:[0,0,0] op_sel_hi:[1,0,1]
v_pk_fma_f32 v[180:181],v[36:37],v[58:59],v[180:181] op_sel:[0,0,0] op_sel_hi:[1,0,1]
v_pk_fma_f32 v[182:183],v[38:39],v[58:59],v[182:183] op_sel:[0,0,0] op_sel_hi:[1,0,1]
v_pk_fma_f32 v[132:133],v[132:133],v[74:75],v[74:75] op_sel:[0,0,0] op_sel_hi:[1,0,0]
v_pk_fma_f32 v[134:135],v[134:135],v[74:75],v[74:75] op_sel:[0,0,0] op_sel_hi:[1,0,0]
v_pk_fma_f32 v[148:149],v[148:149],v[74:75],v[74:75] op_sel:[0,0,0] op_sel_hi:[1,0,0]
v_pk_fma_f32 v[150:151],v[150:151],v[74:75],v[74:75] op_sel:[0,0,0] op_sel_hi:[1,0,0]
v_rcp_f32 v132,v132
v_rcp_f32 v133,v133
v_rcp_f32 v134,v134
v_rcp_f32 v135,v135
v_rcp_f32 v148,v148
v_rcp_f32 v149,v149
v_rcp_f32 v150,v150
v_rcp_f32 v151,v151
s_nop 0
v_pk_mul_f32 v[132:133],v[132:133],v[164:165] op_sel:[0,0] op_sel_hi:[1,1]
v_pk_mul_f32 v[134:135],v[134:135],v[166:167] op_sel:[0,0] op_sel_hi:[1,1]
v_pk_mul_f32 v[148:149],v[148:149],v[180:181] op_sel:[0,0] op_sel_hi:[1,1]
v_pk_mul_f32 v[150:151],v[150:151],v[182:183] op_sel:[0,0] op_sel_hi:[1,1]
v_cvt_pk_bf16_f32 v132,v132,v133
v_cvt_pk_bf16_f32 v133,v134,v135
v_cvt_pk_bf16_f32 v134,v148,v149
v_cvt_pk_bf16_f32 v135,v150,v151
v_pk_fma_f32 v[136:137],v[24:25],v[60:61],v[136:137] op_sel:[0,0,0] op_sel_hi:[1,0,1]
v_pk_fma_f32 v[138:139],v[26:27],v[60:61],v[138:139] op_sel:[0,0,0] op_sel_hi:[1,0,1]
v_pk_fma_f32 v[152:153],v[28:29],v[60:61],v[152:153] op_sel:[0,0,0] op_sel_hi:[1,0,1]
v_pk_fma_f32 v[154:155],v[30:31],v[60:61],v[154:155] op_sel:[0,0,0] op_sel_hi:[1,0,1]
v_pk_mul_f32 v[136:137],v[136:137],v[68:69] op_sel:[0,0] op_sel_hi:[1,0]
v_pk_mul_f32 v[138:139],v[138:139],v[68:69] op_sel:[0,0] op_sel_hi:[1,0]
v_pk_mul_f32 v[152:153],v[152:153],v[68:69] op_sel:[0,0] op_sel_hi:[1,0]
v_pk_mul_f32 v[154:155],v[154:155],v[68:69] op_sel:[0,0] op_sel_hi:[1,0]
v_exp_f32 v136,v136
v_exp_f32 v137,v137
v_exp_f32 v138,v138
v_exp_f32 v139,v139
v_exp_f32 v152,v152
v_exp_f32 v153,v153
v_exp_f32 v154,v154
v_exp_f32 v155,v155
v_pk_fma_f32 v[168:169],v[32:33],v[60:61],v[168:169] op_sel:[0,0,0] op_sel_hi:[1,0,1]
v_pk_fma_f32 v[170:171],v[34:35],v[60:61],v[170:171] op_sel:[0,0,0] op_sel_hi:[1,0,1]
v_pk_fma_f32 v[184:185],v[36:37],v[60:61],v[184:185] op_sel:[0,0,0] op_sel_hi:[1,0,1]
v_pk_fma_f32 v[186:187],v[38:39],v[60:61],v[186:187] op_sel:[0,0,0] op_sel_hi:[1,0,1]
v_pk_fma_f32 v[136:137],v[136:137],v[76:77],v[76:77] op_sel:[0,0,0] op_sel_hi:[1,0,0]
v_pk_fma_f32 v[138:139],v[138:139],v[76:77],v[76:77] op_sel:[0,0,0] op_sel_hi:[1,0,0]
v_pk_fma_f32 v[152:153],v[152:153],v[76:77],v[76:77] op_sel:[0,0,0] op_sel_hi:[1,0,0]
v_pk_fma_f32 v[154:155],v[154:155],v[76:77],v[76:77] op_sel:[0,0,0] op_sel_hi:[1,0,0]
v_rcp_f32 v136,v136
v_rcp_f32 v137,v137
v_rcp_f32 v138,v138
v_rcp_f32 v139,v139
v_rcp_f32 v152,v152
v_rcp_f32 v153,v153
v_rcp_f32 v154,v154
v_rcp_f32 v155,v155
s_nop 0
v_pk_mul_f32 v[136:137],v[136:137],v[168:169] op_sel:[0,0] op_sel_hi:[1,1]
v_pk_mul_f32 v[138:139],v[138:139],v[170:171] op_sel:[0,0] op_sel_hi:[1,1]
v_pk_mul_f32 v[152:153],v[152:153],v[184:185] op_sel:[0,0] op_sel_hi:[1,1]
v_pk_mul_f32 v[154:155],v[154:155],v[186:187] op_sel:[0,0] op_sel_hi:[1,1]
v_cvt_pk_bf16_f32 v136,v136,v137
v_cvt_pk_bf16_f32 v137,v138,v139
v_cvt_pk_bf16_f32 v138,v152,v153
v_cvt_pk_bf16_f32 v139,v154,v155
v_pk_fma_f32 v[140:141],v[24:25],v[62:63],v[140:141] op_sel:[0,0,0] op_sel_hi:[1,0,1]
v_pk_fma_f32 v[142:143],v[26:27],v[62:63],v[142:143] op_sel:[0,0,0] op_sel_hi:[1,0,1]
v_pk_fma_f32 v[156:157],v[28:29],v[62:63],v[156:157] op_sel:[0,0,0] op_sel_hi:[1,0,1]
v_pk_fma_f32 v[158:159],v[30:31],v[62:63],v[158:159] op_sel:[0,0,0] op_sel_hi:[1,0,1]
v_pk_mul_f32 v[140:141],v[140:141],v[70:71] op_sel:[0,0] op_sel_hi:[1,0]
v_pk_mul_f32 v[142:143],v[142:143],v[70:71] op_sel:[0,0] op_sel_hi:[1,0]
v_pk_mul_f32 v[156:157],v[156:157],v[70:71] op_sel:[0,0] op_sel_hi:[1,0]
v_pk_mul_f32 v[158:159],v[158:159],v[70:71] op_sel:[0,0] op_sel_hi:[1,0]
v_exp_f32 v140,v140
v_exp_f32 v141,v141
v_exp_f32 v142,v142
v_exp_f32 v143,v143
v_exp_f32 v156,v156
v_exp_f32 v157,v157
v_exp_f32 v158,v158
v_exp_f32 v159,v159
v_pk_fma_f32 v[172:173],v[32:33],v[62:63],v[172:173] op_sel:[0,0,0] op_sel_hi:[1,0,1]
v_pk_fma_f32 v[174:175],v[34:35],v[62:63],v[174:175] op_sel:[0,0,0] op_sel_hi:[1,0,1]
v_pk_fma_f32 v[188:189],v[36:37],v[62:63],v[188:189] op_sel:[0,0,0] op_sel_hi:[1,0,1]
v_pk_fma_f32 v[190:191],v[38:39],v[62:63],v[190:191] op_sel:[0,0,0] op_sel_hi:[1,0,1]
v_pk_fma_f32 v[140:141],v[140:141],v[78:79],v[78:79] op_sel:[0,0,0] op_sel_hi:[1,0,0]
v_pk_fma_f32 v[142:143],v[142:143],v[78:79],v[78:79] op_sel:[0,0,0] op_sel_hi:[1,0,0]
v_pk_fma_f32 v[156:157],v[156:157],v[78:79],v[78:79] op_sel:[0,0,0] op_sel_hi:[1,0,0]
v_pk_fma_f32 v[158:159],v[158:159],v[78:79],v[78:79] op_sel:[0,0,0] op_sel_hi:[1,0,0]
v_rcp_f32 v140,v140
v_rcp_f32 v141,v141
v_rcp_f32 v142,v142
v_rcp_f32 v143,v143
v_rcp_f32 v156,v156
v_rcp_f32 v157,v157
v_rcp_f32 v158,v158
v_rcp_f32 v159,v159
s_nop 0
v_pk_mul_f32 v[140:141],v[140:141],v[172:173] op_sel:[0,0] op_sel_hi:[1,1]
v_pk_mul_f32 v[142:143],v[142:143],v[174:175] op_sel:[0,0] op_sel_hi:[1,1]
v_pk_mul_f32 v[156:157],v[156:157],v[188:189] op_sel:[0,0] op_sel_hi:[1,1]
v_pk_mul_f32 v[158:159],v[158:159],v[190:191] op_sel:[0,0] op_sel_hi:[1,1]
v_cvt_pk_bf16_f32 v140,v140,v141
v_cvt_pk_bf16_f32 v141,v142,v143
v_cvt_pk_bf16_f32 v142,v156,v157
v_cvt_pk_bf16_f32 v143,v158,v159
v_pk_fma_f32 v[192:193],v[40:41],v[56:57],v[192:193] op_sel:[0,0,0] op_sel_hi:[1,0,1]
v_pk_fma_f32 v[194:195],v[42:43],v[56:57],v[194:195] op_sel:[0,0,0] op_sel_hi:[1,0,1]
v_pk_fma_f32 v[208:209],v[44:45],v[56:57],v[208:209] op_sel:[0,0,0] op_sel_hi:[1,0,1]
v_pk_fma_f32 v[210:211],v[46:47],v[56:57],v[210:211] op_sel:[0,0,0] op_sel_hi:[1,0,1]
v_pk_mul_f32 v[192:193],v[192:193],v[64:65] op_sel:[0,0] op_sel_hi:[1,0]
v_pk_mul_f32 v[194:195],v[194:195],v[64:65] op_sel:[0,0] op_sel_hi:[1,0]
v_pk_mul_f32 v[208:209],v[208:209],v[64:65] op_sel:[0,0] op_sel_hi:[1,0]
v_pk_mul_f32 v[210:211],v[210:211],v[64:65] op_sel:[0,0] op_sel_hi:[1,0]
v_exp_f32 v192,v192
v_exp_f32 v193,v193
v_exp_f32 v194,v194
v_exp_f32 v195,v195
v_exp_f32 v208,v208
v_exp_f32 v209,v209
v_exp_f32 v210,v210
v_exp_f32 v211,v211
v_pk_fma_f32 v[224:225],v[48:49],v[56:57],v[224:225] op_sel:[0,0,0] op_sel_hi:[1,0,1]
v_pk_fma_f32 v[226:227],v[50:51],v[56:57],v[226:227] op_sel:[0,0,0] op_sel_hi:[1,0,1]
v_pk_fma_f32 v[240:241],v[52:53],v[56:57],v[240:241] op_sel:[0,0,0] op_sel_hi:[1,0,1]
v_pk_fma_f32 v[242:243],v[54:55],v[56:57],v[242:243] op_sel:[0,0,0] op_sel_hi:[1,0,1]
v_pk_fma_f32 v[192:193],v[192:193],v[72:73],v[72:73] op_sel:[0,0,0] op_sel_hi:[1,0,0]
v_pk_fma_f32 v[194:195],v[194:195],v[72:73],v[72:73] op_sel:[0,0,0] op_sel_hi:[1,0,0]
v_pk_fma_f32 v[208:209],v[208:209],v[72:73],v[72:73] op_sel:[0,0,0] op_sel_hi:[1,0,0]
v_pk_fma_f32 v[210:211],v[210:211],v[72:73],v[72:73] op_sel:[0,0,0] op_sel_hi:[1,0,0]
v_rcp_f32 v192,v192
v_rcp_f32 v193,v193
v_rcp_f32 v194,v194
v_rcp_f32 v195,v195
v_rcp_f32 v208,v208
v_rcp_f32 v209,v209
v_rcp_f32 v210,v210
v_rcp_f32 v211,v211
s_nop 0
v_pk_mul_f32 v[192:193],v[192:193],v[224:225] op_sel:[0,0] op_sel_hi:[1,1]
v_pk_mul_f32 v[194:195],v[194:195],v[226:227] op_sel:[0,0] op_sel_hi:[1,1]
v_pk_mul_f32 v[208:209],v[208:209],v[240:241] op_sel:[0,0] op_sel_hi:[1,1]
v_pk_mul_f32 v[210:211],v[210:211],v[242:243] op_sel:[0,0] op_sel_hi:[1,1]
v_cvt_pk_bf16_f32 v144,v192,v193
v_cvt_pk_bf16_f32 v145,v194,v195
v_cvt_pk_bf16_f32 v146,v208,v209
v_cvt_pk_bf16_f32 v147,v210,v211
v_pk_fma_f32 v[196:197],v[40:41],v[58:59],v[196:197] op_sel:[0,0,0] op_sel_hi:[1,0,1]
v_pk_fma_f32 v[198:199],v[42:43],v[58:59],v[198:199] op_sel:[0,0,0] op_sel_hi:[1,0,1]
v_pk_fma_f32 v[212:213],v[44:45],v[58:59],v[212:213] op_sel:[0,0,0] op_sel_hi:[1,0,1]
v_pk_fma_f32 v[214:215],v[46:47],v[58:59],v[214:215] op_sel:[0,0,0] op_sel_hi:[1,0,1]
v_pk_mul_f32 v[196:197],v[196:197],v[66:67] op_sel:[0,0] op_sel_hi:[1,0]
v_pk_mul_f32 v[198:199],v[198:199],v[66:67] op_sel:[0,0] op_sel_hi:[1,0]
v_pk_mul_f32 v[212:213],v[212:213],v[66:67] op_sel:[0,0] op_sel_hi:[1,0]
v_pk_mul_f32 v[214:215],v[214:215],v[66:67] op_sel:[0,0] op_sel_hi:[1,0]
v_exp_f32 v196,v196
v_exp_f32 v197,v197
v_exp_f32 v198,v198
v_exp_f32 v199,v199
v_exp_f32 v212,v212
v_exp_f32 v213,v213
v_exp_f32 v214,v214
v_exp_f32 v215,v215
v_pk_fma_f32 v[228:229],v[48:49],v[58:59],v[228:229] op_sel:[0,0,0] op_sel_hi:[1,0,1]
v_pk_fma_f32 v[230:231],v[50:51],v[58:59],v[230:231] op_sel:[0,0,0] op_sel_hi:[1,0,1]
v_pk_fma_f32 v[244:245],v[52:53],v[58:59],v[244:245] op_sel:[0,0,0] op_sel_hi:[1,0,1]
v_pk_fma_f32 v[246:247],v[54:55],v[58:59],v[246:247] op_sel:[0,0,0] op_sel_hi:[1,0,1]
v_pk_fma_f32 v[196:197],v[196:197],v[74:75],v[74:75] op_sel:[0,0,0] op_sel_hi:[1,0,0]
v_pk_fma_f32 v[198:199],v[198:199],v[74:75],v[74:75] op_sel:[0,0,0] op_sel_hi:[1,0,0]
v_pk_fma_f32 v[212:213],v[212:213],v[74:75],v[74:75] op_sel:[0,0,0] op_sel_hi:[1,0,0]
v_pk_fma_f32 v[214:215],v[214:215],v[74:75],v[74:75] op_sel:[0,0,0] op_sel_hi:[1,0,0]
v_rcp_f32 v196,v196
v_rcp_f32 v197,v197
v_rcp_f32 v198,v198
v_rcp_f32 v199,v199
v_rcp_f32 v212,v212
v_rcp_f32 v213,v213
v_rcp_f32 v214,v214
v_rcp_f32 v215,v215
s_nop 0
v_pk_mul_f32 v[196:197],v[196:197],v[228:229] op_sel:[0,0] op_sel_hi:[1,1]
v_pk_mul_f32 v[198:199],v[198:199],v[230:231] op_sel:[0,0] op_sel_hi:[1,1]
v_pk_mul_f32 v[212:213],v[212:213],v[244:245] op_sel:[0,0] op_sel_hi:[1,1]
v_pk_mul_f32 v[214:215],v[214:215],v[246:247] op_sel:[0,0] op_sel_hi:[1,1]
v_cvt_pk_bf16_f32 v148,v196,v197
v_cvt_pk_bf16_f32 v149,v198,v199
v_cvt_pk_bf16_f32 v150,v212,v213
v_cvt_pk_bf16_f32 v151,v214,v215
v_pk_fma_f32 v[200:201],v[40:41],v[60:61],v[200:201] op_sel:[0,0,0] op_sel_hi:[1,0,1]
v_pk_fma_f32 v[202:203],v[42:43],v[60:61],v[202:203] op_sel:[0,0,0] op_sel_hi:[1,0,1]
v_pk_fma_f32 v[216:217],v[44:45],v[60:61],v[216:217] op_sel:[0,0,0] op_sel_hi:[1,0,1]
v_pk_fma_f32 v[218:219],v[46:47],v[60:61],v[218:219] op_sel:[0,0,0] op_sel_hi:[1,0,1]
v_pk_mul_f32 v[200:201],v[200:201],v[68:69] op_sel:[0,0] op_sel_hi:[1,0]
v_pk_mul_f32 v[202:203],v[202:203],v[68:69] op_sel:[0,0] op_sel_hi:[1,0]
v_pk_mul_f32 v[216:217],v[216:217],v[68:69] op_sel:[0,0] op_sel_hi:[1,0]
v_pk_mul_f32 v[218:219],v[218:219],v[68:69] op_sel:[0,0] op_sel_hi:[1,0]
v_exp_f32 v200,v200
v_exp_f32 v201,v201
v_exp_f32 v202,v202
v_exp_f32 v203,v203
v_exp_f32 v216,v216
v_exp_f32 v217,v217
v_exp_f32 v218,v218
v_exp_f32 v219,v219
v_pk_fma_f32 v[232:233],v[48:49],v[60:61],v[232:233] op_sel:[0,0,0] op_sel_hi:[1,0,1]
v_pk_fma_f32 v[234:235],v[50:51],v[60:61],v[234:235] op_sel:[0,0,0] op_sel_hi:[1,0,1]
v_pk_fma_f32 v[248:249],v[52:53],v[60:61],v[248:249] op_sel:[0,0,0] op_sel_hi:[1,0,1]
v_pk_fma_f32 v[250:251],v[54:55],v[60:61],v[250:251] op_sel:[0,0,0] op_sel_hi:[1,0,1]
v_pk_fma_f32 v[200:201],v[200:201],v[76:77],v[76:77] op_sel:[0,0,0] op_sel_hi:[1,0,0]
v_pk_fma_f32 v[202:203],v[202:203],v[76:77],v[76:77] op_sel:[0,0,0] op_sel_hi:[1,0,0]
v_pk_fma_f32 v[216:217],v[216:217],v[76:77],v[76:77] op_sel:[0,0,0] op_sel_hi:[1,0,0]
v_pk_fma_f32 v[218:219],v[218:219],v[76:77],v[76:77] op_sel:[0,0,0] op_sel_hi:[1,0,0]
v_rcp_f32 v200,v200
v_rcp_f32 v201,v201
v_rcp_f32 v202,v202
v_rcp_f32 v203,v203
v_rcp_f32 v216,v216
v_rcp_f32 v217,v217
v_rcp_f32 v218,v218
v_rcp_f32 v219,v219
s_nop 0
v_pk_mul_f32 v[200:201],v[200:201],v[232:233] op_sel:[0,0] op_sel_hi:[1,1]
v_pk_mul_f32 v[202:203],v[202:203],v[234:235] op_sel:[0,0] op_sel_hi:[1,1]
v_pk_mul_f32 v[216:217],v[216:217],v[248:249] op_sel:[0,0] op_sel_hi:[1,1]
v_pk_mul_f32 v[218:219],v[218:219],v[250:251] op_sel:[0,0] op_sel_hi:[1,1]
v_cvt_pk_bf16_f32 v152,v200,v201
v_cvt_pk_bf16_f32 v153,v202,v203
v_cvt_pk_bf16_f32 v154,v216,v217
v_cvt_pk_bf16_f32 v155,v218,v219
v_pk_fma_f32 v[204:205],v[40:41],v[62:63],v[204:205] op_sel:[0,0,0] op_sel_hi:[1,0,1]
v_pk_fma_f32 v[206:207],v[42:43],v[62:63],v[206:207] op_sel:[0,0,0] op_sel_hi:[1,0,1]
v_pk_fma_f32 v[220:221],v[44:45],v[62:63],v[220:221] op_sel:[0,0,0] op_sel_hi:[1,0,1]
v_pk_fma_f32 v[222:223],v[46:47],v[62:63],v[222:223] op_sel:[0,0,0] op_sel_hi:[1,0,1]
v_pk_mul_f32 v[204:205],v[204:205],v[70:71] op_sel:[0,0] op_sel_hi:[1,0]
v_pk_mul_f32 v[206:207],v[206:207],v[70:71] op_sel:[0,0] op_sel_hi:[1,0]
v_pk_mul_f32 v[220:221],v[220:221],v[70:71] op_sel:[0,0] op_sel_hi:[1,0]
v_pk_mul_f32 v[222:223],v[222:223],v[70:71] op_sel:[0,0] op_sel_hi:[1,0]
v_exp_f32 v204,v204
v_exp_f32 v205,v205
v_exp_f32 v206,v206
v_exp_f32 v207,v207
v_exp_f32 v220,v220
v_exp_f32 v221,v221
v_exp_f32 v222,v222
v_exp_f32 v223,v223
v_pk_fma_f32 v[236:237],v[48:49],v[62:63],v[236:237] op_sel:[0,0,0] op_sel_hi:[1,0,1]
v_pk_fma_f32 v[238:239],v[50:51],v[62:63],v[238:239] op_sel:[0,0,0] op_sel_hi:[1,0,1]
v_pk_fma_f32 v[252:253],v[52:53],v[62:63],v[252:253] op_sel:[0,0,0] op_sel_hi:[1,0,1]
v_pk_fma_f32 v[254:255],v[54:55],v[62:63],v[254:255] op_sel:[0,0,0] op_sel_hi:[1,0,1]
v_pk_fma_f32 v[204:205],v[204:205],v[78:79],v[78:79] op_sel:[0,0,0] op_sel_hi:[1,0,0]
v_pk_fma_f32 v[206:207],v[206:207],v[78:79],v[78:79] op_sel:[0,0,0] op_sel_hi:[1,0,0]
v_pk_fma_f32 v[220:221],v[220:221],v[78:79],v[78:79] op_sel:[0,0,0] op_sel_hi:[1,0,0]
v_pk_fma_f32 v[222:223],v[222:223],v[78:79],v[78:79] op_sel:[0,0,0] op_sel_hi:[1,0,0]
v_rcp_f32 v204,v204
v_rcp_f32 v205,v205
v_rcp_f32 v206,v206
v_rcp_f32 v207,v207
v_rcp_f32 v220,v220
v_rcp_f32 v221,v221
v_rcp_f32 v222,v222
v_rcp_f32 v223,v223
s_nop 0
v_pk_mul_f32 v[204:205],v[204:205],v[236:237] op_sel:[0,0] op_sel_hi:[1,1]
v_pk_mul_f32 v[206:207],v[206:207],v[238:239] op_sel:[0,0] op_sel_hi:[1,1]
v_pk_mul_f32 v[220:221],v[220:221],v[252:253] op_sel:[0,0] op_sel_hi:[1,1]
v_pk_mul_f32 v[222:223],v[222:223],v[254:255] op_sel:[0,0] op_sel_hi:[1,1]
v_cvt_pk_bf16_f32 v156,v204,v205
v_cvt_pk_bf16_f32 v157,v206,v207
v_cvt_pk_bf16_f32 v158,v220,v221
v_cvt_pk_bf16_f32 v159,v222,v223
s_add_u32 s61,s49,2048
s_mov_b32 s62,0
s_cmp_eq_u32 s100,-1
s_cbranch_scc1 af_entry
s_add_u32 s50,s61,0
buffer_store_dwordx4 v[128:131],v1,s[36:39],s50 offen sc1
s_add_u32 s50,s61,147456
buffer_store_dwordx4 v[132:135],v1,s[36:39],s50 offen sc1
s_add_u32 s50,s61,294912
buffer_store_dwordx4 v[136:139],v1,s[36:39],s50 offen sc1
s_add_u32 s50,s61,442368
buffer_store_dwordx4 v[140:143],v1,s[36:39],s50 offen sc1
s_add_u32 s50,s61,1024
buffer_store_dwordx4 v[144:147],v1,s[36:39],s50 offen sc1
s_add_u32 s50,s61,148480
buffer_store_dwordx4 v[148:151],v1,s[36:39],s50 offen sc1
s_add_u32 s50,s61,295936
buffer_store_dwordx4 v[152:155],v1,s[36:39],s50 offen sc1
s_add_u32 s50,s61,443392
buffer_store_dwordx4 v[156:159],v1,s[36:39],s50 offen sc1
s_branch m_hnext
.p2align 6
g2_sp1:
s_waitcnt lgkmcnt(15)
v_mfma_f32_16x16x32_bf16 v[96:99],v[56:59],v[16:19],v[96:99]
v_mfma_f32_16x16x32_bf16 v[100:103],v[60:63],v[16:19],v[100:103]
v_mfma_f32_16x16x32_bf16 v[104:107],v[64:67],v[16:19],v[104:107]
v_mfma_f32_16x16x32_bf16 v[108:111],v[68:71],v[16:19],v[108:111]
s_waitcnt vmcnt(9) lgkmcnt(0)
s_barrier
s_bitcmp1_b32 s68,2
s_cbranch_scc0 g2_c1_1
v_lshlrev_b32 v12,16,v16
v_and_b32 v13,s69,v16
v_add_f32 v14,v12,v13
v_lshlrev_b32 v12,16,v17
v_and_b32 v13,s69,v17
v_add_f32 v14,v14,v12
v_add_f32 v14,v14,v13
v_lshlrev_b32 v12,16,v18
v_and_b32 v13,s69,v18
v_add_f32 v14,v14,v12
v_add_f32 v14,v14,v13
v_lshlrev_b32 v12,16,v19
v_and_b32 v13,s69,v19
v_add_f32 v14,v14,v12
v_add_f32 v14,v14,v13
g2_c1_1:
ds_read_b64_tr_b16 v[16:17],v1 offset:20480
v_mfma_f32_16x16x32_bf16 v[112:115],v[56:59],v[20:23],v[112:115]
ds_read_b64_tr_b16 v[18:19],v1 offset:20992
v_mfma_f32_16x16x32_bf16 v[116:119],v[60:63],v[20:23],v[116:119]
ds_read_b128 v[72:75],v94 offset:0
v_mfma_f32_16x16x32_bf16 v[120:123],v[64:67],v[20:23],v[120:123]
ds_read_b128 v[76:79],v94 offset:2048
v_mfma_f32_16x16x32_bf16 v[124:127],v[68:71],v[20:23],v[124:127]
s_bitcmp1_b32 s68,3
s_cbranch_scc0 g2_c1_2
v_lshlrev_b32 v12,16,v20
v_and_b32 v13,s69,v20
v_add_f32 v14,v12,v13
v_lshlrev_b32 v12,16,v21
v_and_b32 v13,s69,v21
v_add_f32 v14,v14,v12
v_add_f32 v14,v14,v13
v_lshlrev_b32 v12,16,v22
v_and_b32 v13,s69,v22
v_add_f32 v14,v14,v12
v_add_f32 v14,v14,v13
v_lshlrev_b32 v12,16,v23
v_and_b32 v13,s69,v23
v_add_f32 v14,v14,v12
v_add_f32 v14,v14,v13
g2_c1_2:
ds_read_b64_tr_b16 v[20:21],v2 offset:20480
v_mfma_f32_16x16x32_bf16 v[128:131],v[24:27],v[56:59],v[128:131]
ds_read_b64_tr_b16 v[22:23],v2 offset:20992
v_mfma_f32_16x16x32_bf16 v[132:135],v[24:27],v[60:63],v[132:135]
ds_read_b128 v[80:83],v94 offset:4096
v_mfma_f32_16x16x32_bf16 v[136:139],v[24:27],v[64:67],v[136:139]
ds_read_b128 v[84:87],v94 offset:6144
v_mfma_f32_16x16x32_bf16 v[140:143],v[24:27],v[68:71],v[140:143]
s_bitcmp1_b32 s68,4
s_cbranch_scc0 g2_c1_3
v_lshlrev_b32 v12,16,v24
v_and_b32 v13,s69,v24
v_add_f32 v14,v12,v13
v_lshlrev_b32 v12,16,v25
v_and_b32 v13,s69,v25
v_add_f32 v14,v14,v12
v_add_f32 v14,v14,v13
v_lshlrev_b32 v12,16,v26
v_and_b32 v13,s69,v26
v_add_f32 v14,v14,v12
v_add_f32 v14,v14,v13
v_lshlrev_b32 v12,16,v27
v_and_b32 v13,s69,v27
v_add_f32 v14,v14,v12
v_add_f32 v14,v14,v13
g2_c1_3:
ds_read_b64_tr_b16 v[24:25],v3 offset:20480
v_mfma_f32_16x16x32_bf16 v[144:147],v[28:31],v[56:59],v[144:147]
ds_read_b64_tr_b16 v[26:27],v3 offset:21504
v_mfma_f32_16x16x32_bf16 v[148:151],v[28:31],v[60:63],v[148:151]
buffer_load_dword v91,v90,s[28:31],s48 offen
s_add_u32 s48,s48,s49
v_mfma_f32_16x16x32_bf16 v[152:155],v[28:31],v[64:67],v[152:155]
v_mfma_f32_16x16x32_bf16 v[156:159],v[28:31],v[68:71],v[156:159]
s_bitcmp1_b32 s68,5
s_cbranch_scc0 g2_c1_4
v_lshlrev_b32 v12,16,v28
v_and_b32 v13,s69,v28
v_add_f32 v14,v12,v13
v_lshlrev_b32 v12,16,v29
v_and_b32 v13,s69,v29
v_add_f32 v14,v14,v12
v_add_f32 v14,v14,v13
v_lshlrev_b32 v12,16,v30
v_and_b32 v13,s69,v30
v_add_f32 v14,v14,v12
v_add_f32 v14,v14,v13
v_lshlrev_b32 v12,16,v31
v_and_b32 v13,s69,v31
v_add_f32 v14,v14,v12
v_add_f32 v14,v14,v13
g2_c1_4:
ds_read_b64_tr_b16 v[28:29],v4 offset:20480
v_mfma_f32_16x16x32_bf16 v[160:163],v[32:35],v[56:59],v[160:163]
ds_read_b64_tr_b16 v[30:31],v4 offset:21504
v_mfma_f32_16x16x32_bf16 v[164:167],v[32:35],v[60:63],v[164:167]
v_mfma_f32_16x16x32_bf16 v[168:171],v[32:35],v[64:67],v[168:171]
v_mfma_f32_16x16x32_bf16 v[172:175],v[32:35],v[68:71],v[172:175]
s_bitcmp1_b32 s68,6
s_cbranch_scc0 g2_c1_5
v_lshlrev_b32 v12,16,v32
v_and_b32 v13,s69,v32
v_add_f32 v15,v12,v13
v_lshlrev_b32 v12,16,v33
v_and_b32 v13,s69,v33
v_add_f32 v15,v15,v12
v_add_f32 v15,v15,v13
v_lshlrev_b32 v12,16,v34
v_and_b32 v13,s69,v34
v_add_f32 v15,v15,v12
v_add_f32 v15,v15,v13
v_lshlrev_b32 v12,16,v35
v_and_b32 v13,s69,v35
v_add_f32 v15,v15,v12
v_add_f32 v15,v15,v13
g2_c1_5:
ds_read_b64_tr_b16 v[32:33],v5 offset:20480
v_mfma_f32_16x16x32_bf16 v[176:179],v[36:39],v[56:59],v[176:179]
ds_read_b64_tr_b16 v[34:35],v5 offset:21504
v_mfma_f32_16x16x32_bf16 v[180:183],v[36:39],v[60:63],v[180:183]
v_mfma_f32_16x16x32_bf16 v[184:187],v[36:39],v[64:67],v[184:187]
v_mfma_f32_16x16x32_bf16 v[188:191],v[36:39],v[68:71],v[188:191]
s_bitcmp1_b32 s68,7
s_cbranch_scc0 g2_c1_6
v_lshlrev_b32 v12,16,v36
v_and_b32 v13,s69,v36
v_add_f32 v15,v12,v13
v_lshlrev_b32 v12,16,v37
v_and_b32 v13,s69,v37
v_add_f32 v15,v15,v12
v_add_f32 v15,v15,v13
v_lshlrev_b32 v12,16,v38
v_and_b32 v13,s69,v38
v_add_f32 v15,v15,v12
v_add_f32 v15,v15,v13
v_lshlrev_b32 v12,16,v39
v_and_b32 v13,s69,v39
v_add_f32 v15,v15,v12
v_add_f32 v15,v15,v13
g2_c1_6:
ds_read_b64_tr_b16 v[36:37],v6 offset:20480
v_mfma_f32_16x16x32_bf16 v[192:195],v[40:43],v[56:59],v[192:195]
ds_read_b64_tr_b16 v[38:39],v6 offset:21504
v_mfma_f32_16x16x32_bf16 v[196:199],v[40:43],v[60:63],v[196:199]
v_mfma_f32_16x16x32_bf16 v[200:203],v[40:43],v[64:67],v[200:203]
v_mfma_f32_16x16x32_bf16 v[204:207],v[40:43],v[68:71],v[204:207]
s_bitcmp1_b32 s68,8
s_cbranch_scc0 g2_c1_7
v_lshlrev_b32 v12,16,v40
v_and_b32 v13,s69,v40
v_add_f32 v15,v12,v13
v_lshlrev_b32 v12,16,v41
v_and_b32 v13,s69,v41
v_add_f32 v15,v15,v12
v_add_f32 v15,v15,v13
v_lshlrev_b32 v12,16,v42
v_and_b32 v13,s69,v42
v_add_f32 v15,v15,v12
v_add_f32 v15,v15,v13
v_lshlrev_b32 v12,16,v43
v_and_b32 v13,s69,v43
v_add_f32 v15,v15,v12
v_add_f32 v15,v15,v13
g2_c1_7:
ds_read_b64_tr_b16 v[40:41],v7 offset:20480
v_mfma_f32_16x16x32_bf16 v[208:211],v[44:47],v[56:59],v[208:211]
ds_read_b64_tr_b16 v[42:43],v7 offset:21504
v_mfma_f32_16x16x32_bf16 v[212:215],v[44:47],v[60:63],v[212:215]
v_mfma_f32_16x16x32_bf16 v[216:219],v[44:47],v[64:67],v[216:219]
v_mfma_f32_16x16x32_bf16 v[220:223],v[44:47],v[68:71],v[220:223]
s_bitcmp1_b32 s68,9
s_cbranch_scc0 g2_c1_8
v_lshlrev_b32 v12,16,v44
v_and_b32 v13,s69,v44
v_add_f32 v15,v12,v13
v_lshlrev_b32 v12,16,v45
v_and_b32 v13,s69,v45
v_add_f32 v15,v15,v12
v_add_f32 v15,v15,v13
v_lshlrev_b32 v12,16,v46
v_and_b32 v13,s69,v46
v_add_f32 v15,v15,v12
v_add_f32 v15,v15,v13
v_lshlrev_b32 v12,16,v47
v_and_b32 v13,s69,v47
v_add_f32 v15,v15,v12
v_add_f32 v15,v15,v13
g2_c1_8:
ds_read_b64_tr_b16 v[44:45],v8 offset:20480
v_mfma_f32_16x16x32_bf16 v[224:227],v[48:51],v[56:59],v[224:227]
ds_read_b64_tr_b16 v[46:47],v8 offset:21504
v_mfma_f32_16x16x32_bf16 v[228:231],v[48:51],v[60:63],v[228:231]
v_mfma_f32_16x16x32_bf16 v[232:235],v[48:51],v[64:67],v[232:235]
v_mfma_f32_16x16x32_bf16 v[236:239],v[48:51],v[68:71],v[236:239]
s_bitcmp1_b32 s68,10
s_cbranch_scc0 g2_c1_9
v_lshlrev_b32 v12,16,v48
v_and_b32 v13,s69,v48
v_add_f32 v93,v12,v13
v_lshlrev_b32 v12,16,v49
v_and_b32 v13,s69,v49
v_add_f32 v93,v93,v12
v_add_f32 v93,v93,v13
v_lshlrev_b32 v12,16,v50
v_and_b32 v13,s69,v50
v_add_f32 v93,v93,v12
v_add_f32 v93,v93,v13
v_lshlrev_b32 v12,16,v51
v_and_b32 v13,s69,v51
v_add_f32 v93,v93,v12
v_add_f32 v93,v93,v13
g2_c1_9:
ds_read_b64_tr_b16 v[48:49],v9 offset:20480
v_mfma_f32_16x16x32_bf16 v[240:243],v[52:55],v[56:59],v[240:243]
ds_read_b64_tr_b16 v[50:51],v9 offset:21504
v_mfma_f32_16x16x32_bf16 v[244:247],v[52:55],v[60:63],v[244:247]
v_mfma_f32_16x16x32_bf16 v[248:251],v[52:55],v[64:67],v[248:251]
v_mfma_f32_16x16x32_bf16 v[252:255],v[52:55],v[68:71],v[252:255]
s_bitcmp1_b32 s68,11
s_cbranch_scc0 g2_c1_10
v_lshlrev_b32 v12,16,v52
v_and_b32 v13,s69,v52
v_add_f32 v93,v12,v13
v_lshlrev_b32 v12,16,v53
v_and_b32 v13,s69,v53
v_add_f32 v93,v93,v12
v_add_f32 v93,v93,v13
v_lshlrev_b32 v12,16,v54
v_and_b32 v13,s69,v54
v_add_f32 v93,v93,v12
v_add_f32 v93,v93,v13
v_lshlrev_b32 v12,16,v55
v_and_b32 v13,s69,v55
v_add_f32 v93,v93,v12
v_add_f32 v93,v93,v13
g2_c1_10:
ds_read_b64_tr_b16 v[52:53],v10 offset:20480
ds_read_b64_tr_b16 v[54:55],v10 offset:21504
s_waitcnt lgkmcnt(15)
v_mfma_f32_16x16x32_bf16 v[96:99],v[72:75],v[16:19],v[96:99]
v_mfma_f32_16x16x32_bf16 v[100:103],v[76:79],v[16:19],v[100:103]
v_mfma_f32_16x16x32_bf16 v[104:107],v[80:83],v[16:19],v[104:107]
v_mfma_f32_16x16x32_bf16 v[108:111],v[84:87],v[16:19],v[108:111]
s_waitcnt vmcnt(1) lgkmcnt(0)
s_barrier
s_bitcmp1_b32 s68,2
s_cbranch_scc0 g2_c1_11
v_lshlrev_b32 v12,16,v16
v_and_b32 v13,s69,v16
v_add_f32 v14,v14,v12
v_add_f32 v14,v14,v13
v_lshlrev_b32 v12,16,v17
v_and_b32 v13,s69,v17
v_add_f32 v14,v14,v12
v_add_f32 v14,v14,v13
v_lshlrev_b32 v12,16,v18
v_and_b32 v13,s69,v18
v_add_f32 v14,v14,v12
v_add_f32 v14,v14,v13
v_lshlrev_b32 v12,16,v19
v_and_b32 v13,s69,v19
v_add_f32 v14,v14,v12
v_add_f32 v14,v14,v13
g2_c1_11:
ds_read_b64_tr_b16 v[16:17],v1 offset:40960
v_mfma_f32_16x16x32_bf16 v[112:115],v[72:75],v[20:23],v[112:115]
ds_read_b64_tr_b16 v[18:19],v1 offset:41472
v_mfma_f32_16x16x32_bf16 v[116:119],v[76:79],v[20:23],v[116:119]
ds_read_b128 v[56:59],v11 offset:32768
v_mfma_f32_16x16x32_bf16 v[120:123],v[80:83],v[20:23],v[120:123]
ds_read_b128 v[60:63],v11 offset:34816
v_mfma_f32_16x16x32_bf16 v[124:127],v[84:87],v[20:23],v[124:127]
s_bitcmp1_b32 s68,3
s_cbranch_scc0 g2_c1_12
v_lshlrev_b32 v12,16,v20
v_and_b32 v13,s69,v20
v_add_f32 v14,v14,v12
v_add_f32 v14,v14,v13
v_lshlrev_b32 v12,16,v21
v_and_b32 v13,s69,v21
v_add_f32 v14,v14,v12
v_add_f32 v14,v14,v13
v_lshlrev_b32 v12,16,v22
v_and_b32 v13,s69,v22
v_add_f32 v14,v14,v12
v_add_f32 v14,v14,v13
v_lshlrev_b32 v12,16,v23
v_and_b32 v13,s69,v23
v_add_f32 v14,v14,v12
v_add_f32 v14,v14,v13
g2_c1_12:
ds_read_b64_tr_b16 v[20:21],v2 offset:40960
v_mfma_f32_16x16x32_bf16 v[128:131],v[24:27],v[72:75],v[128:131]
ds_read_b64_tr_b16 v[22:23],v2 offset:41472
v_mfma_f32_16x16x32_bf16 v[132:135],v[24:27],v[76:79],v[132:135]
ds_read_b128 v[64:67],v11 offset:36864
v_mfma_f32_16x16x32_bf16 v[136:139],v[24:27],v[80:83],v[136:139]
ds_read_b128 v[68:71],v11 offset:38912
v_mfma_f32_16x16x32_bf16 v[140:143],v[24:27],v[84:87],v[140:143]
s_bitcmp1_b32 s68,4
s_cbranch_scc0 g2_c1_13
v_lshlrev_b32 v12,16,v24
v_and_b32 v13,s69,v24
v_add_f32 v14,v14,v12
v_add_f32 v14,v14,v13
v_lshlrev_b32 v12,16,v25
v_and_b32 v13,s69,v25
v_add_f32 v14,v14,v12
v_add_f32 v14,v14,v13
v_lshlrev_b32 v12,16,v26
v_and_b32 v13,s69,v26
v_add_f32 v14,v14,v12
v_add_f32 v14,v14,v13
v_lshlrev_b32 v12,16,v27
v_and_b32 v13,s69,v27
v_add_f32 v14,v14,v12
v_add_f32 v14,v14,v13
g2_c1_13:
ds_read_b64_tr_b16 v[24:25],v3 offset:40960
v_mfma_f32_16x16x32_bf16 v[144:147],v[28:31],v[72:75],v[144:147]
ds_read_b64_tr_b16 v[26:27],v3 offset:41984
v_mfma_f32_16x16x32_bf16 v[148:151],v[28:31],v[76:79],v[148:151]
s_add_u32 m0,s54,0
s_nop 0
buffer_load_dwordx4 v88,s[56:59],s55 offen lds
v_mfma_f32_16x16x32_bf16 v[152:155],v[28:31],v[80:83],v[152:155]
v_mfma_f32_16x16x32_bf16 v[156:159],v[28:31],v[84:87],v[156:159]
s_bitcmp1_b32 s68,5
s_cbranch_scc0 g2_c1_14
v_lshlrev_b32 v12,16,v28
v_and_b32 v13,s69,v28
v_add_f32 v14,v14,v12
v_add_f32 v14,v14,v13
v_lshlrev_b32 v12,16,v29
v_and_b32 v13,s69,v29
v_add_f32 v14,v14,v12
v_add_f32 v14,v14,v13
v_lshlrev_b32 v12,16,v30
v_and_b32 v13,s69,v30
v_add_f32 v14,v14,v12
v_add_f32 v14,v14,v13
v_lshlrev_b32 v12,16,v31
v_and_b32 v13,s69,v31
v_add_f32 v14,v14,v12
v_add_f32 v14,v14,v13
g2_c1_14:
ds_read_b64_tr_b16 v[28:29],v4 offset:40960
v_mfma_f32_16x16x32_bf16 v[160:163],v[32:35],v[72:75],v[160:163]
ds_read_b64_tr_b16 v[30:31],v4 offset:41984
v_mfma_f32_16x16x32_bf16 v[164:167],v[32:35],v[76:79],v[164:167]
buffer_load_dwordx4 v89,s[56:59],s55 offen offset:1024 lds
v_mfma_f32_16x16x32_bf16 v[168:171],v[32:35],v[80:83],v[168:171]
v_mfma_f32_16x16x32_bf16 v[172:175],v[32:35],v[84:87],v[172:175]
s_bitcmp1_b32 s68,6
s_cbranch_scc0 g2_c1_15
v_lshlrev_b32 v12,16,v32
v_and_b32 v13,s69,v32
v_add_f32 v15,v15,v12
v_add_f32 v15,v15,v13
v_lshlrev_b32 v12,16,v33
v_and_b32 v13,s69,v33
v_add_f32 v15,v15,v12
v_add_f32 v15,v15,v13
v_lshlrev_b32 v12,16,v34
v_and_b32 v13,s69,v34
v_add_f32 v15,v15,v12
v_add_f32 v15,v15,v13
v_lshlrev_b32 v12,16,v35
v_and_b32 v13,s69,v35
v_add_f32 v15,v15,v12
v_add_f32 v15,v15,v13
g2_c1_15:
ds_read_b64_tr_b16 v[32:33],v5 offset:40960
v_mfma_f32_16x16x32_bf16 v[176:179],v[36:39],v[72:75],v[176:179]
ds_read_b64_tr_b16 v[34:35],v5 offset:41984
v_mfma_f32_16x16x32_bf16 v[180:183],v[36:39],v[76:79],v[180:183]
s_add_u32 m0,s54,2048
s_add_u32 s51,s55,32768
buffer_load_dwordx4 v88,s[56:59],s51 offen lds
v_mfma_f32_16x16x32_bf16 v[184:187],v[36:39],v[80:83],v[184:187]
v_mfma_f32_16x16x32_bf16 v[188:191],v[36:39],v[84:87],v[188:191]
s_bitcmp1_b32 s68,7
s_cbranch_scc0 g2_c1_16
v_lshlrev_b32 v12,16,v36
v_and_b32 v13,s69,v36
v_add_f32 v15,v15,v12
v_add_f32 v15,v15,v13
v_lshlrev_b32 v12,16,v37
v_and_b32 v13,s69,v37
v_add_f32 v15,v15,v12
v_add_f32 v15,v15,v13
v_lshlrev_b32 v12,16,v38
v_and_b32 v13,s69,v38
v_add_f32 v15,v15,v12
v_add_f32 v15,v15,v13
v_lshlrev_b32 v12,16,v39
v_and_b32 v13,s69,v39
v_add_f32 v15,v15,v12
v_add_f32 v15,v15,v13
g2_c1_16:
ds_read_b64_tr_b16 v[36:37],v6 offset:40960
v_mfma_f32_16x16x32_bf16 v[192:195],v[40:43],v[72:75],v[192:195]
ds_read_b64_tr_b16 v[38:39],v6 offset:41984
v_mfma_f32_16x16x32_bf16 v[196:199],v[40:43],v[76:79],v[196:199]
buffer_load_dwordx4 v89,s[56:59],s51 offen offset:1024 lds
v_mfma_f32_16x16x32_bf16 v[200:203],v[40:43],v[80:83],v[200:203]
v_mfma_f32_16x16x32_bf16 v[204:207],v[40:43],v[84:87],v[204:207]
s_bitcmp1_b32 s68,8
s_cbranch_scc0 g2_c1_17
v_lshlrev_b32 v12,16,v40
v_and_b32 v13,s69,v40
v_add_f32 v15,v15,v12
v_add_f32 v15,v15,v13
v_lshlrev_b32 v12,16,v41
v_and_b32 v13,s69,v41
v_add_f32 v15,v15,v12
v_add_f32 v15,v15,v13
v_lshlrev_b32 v12,16,v42
v_and_b32 v13,s69,v42
v_add_f32 v15,v15,v12
v_add_f32 v15,v15,v13
v_lshlrev_b32 v12,16,v43
v_and_b32 v13,s69,v43
v_add_f32 v15,v15,v12
v_add_f32 v15,v15,v13
g2_c1_17:
ds_read_b64_tr_b16 v[40:41],v7 offset:40960
v_mfma_f32_16x16x32_bf16 v[208:211],v[44:47],v[72:75],v[208:211]
ds_read_b64_tr_b16 v[42:43],v7 offset:41984
v_mfma_f32_16x16x32_bf16 v[212:215],v[44:47],v[76:79],v[212:215]
s_add_u32 m0,s54,4096
s_add_u32 s51,s55,65536
buffer_load_dwordx4 v88,s[56:59],s51 offen lds
v_mfma_f32_16x16x32_bf16 v[216:219],v[44:47],v[80:83],v[216:219]
v_mfma_f32_16x16x32_bf16 v[220:223],v[44:47],v[84:87],v[220:223]
s_bitcmp1_b32 s68,9
s_cbranch_scc0 g2_c1_18
v_lshlrev_b32 v12,16,v44
v_and_b32 v13,s69,v44
v_add_f32 v15,v15,v12
v_add_f32 v15,v15,v13
v_lshlrev_b32 v12,16,v45
v_and_b32 v13,s69,v45
v_add_f32 v15,v15,v12
v_add_f32 v15,v15,v13
v_lshlrev_b32 v12,16,v46
v_and_b32 v13,s69,v46
v_add_f32 v15,v15,v12
v_add_f32 v15,v15,v13
v_lshlrev_b32 v12,16,v47
v_and_b32 v13,s69,v47
v_add_f32 v15,v15,v12
v_add_f32 v15,v15,v13
g2_c1_18:
ds_read_b64_tr_b16 v[44:45],v8 offset:40960
v_mfma_f32_16x16x32_bf16 v[224:227],v[48:51],v[72:75],v[224:227]
ds_read_b64_tr_b16 v[46:47],v8 offset:41984
v_mfma_f32_16x16x32_bf16 v[228:231],v[48:51],v[76:79],v[228:231]
buffer_load_dwordx4 v89,s[56:59],s51 offen offset:1024 lds
v_mfma_f32_16x16x32_bf16 v[232:235],v[48:51],v[80:83],v[232:235]
v_mfma_f32_16x16x32_bf16 v[236:239],v[48:51],v[84:87],v[236:239]
s_bitcmp1_b32 s68,10
s_cbranch_scc0 g2_c1_19
v_lshlrev_b32 v12,16,v48
v_and_b32 v13,s69,v48
v_add_f32 v93,v93,v12
v_add_f32 v93,v93,v13
v_lshlrev_b32 v12,16,v49
v_and_b32 v13,s69,v49
v_add_f32 v93,v93,v12
v_add_f32 v93,v93,v13
v_lshlrev_b32 v12,16,v50
v_and_b32 v13,s69,v50
v_add_f32 v93,v93,v12
v_add_f32 v93,v93,v13
v_lshlrev_b32 v12,16,v51
v_and_b32 v13,s69,v51
v_add_f32 v93,v93,v12
v_add_f32 v93,v93,v13
g2_c1_19:
ds_read_b64_tr_b16 v[48:49],v9 offset:40960
v_mfma_f32_16x16x32_bf16 v[240:243],v[52:55],v[72:75],v[240:243]
ds_read_b64_tr_b16 v[50:51],v9 offset:41984
v_mfma_f32_16x16x32_bf16 v[244:247],v[52:55],v[76:79],v[244:247]
s_add_u32 m0,s54,6144
s_add_u32 s51,s55,98304
buffer_load_dwordx4 v88,s[56:59],s51 offen lds
v_mfma_f32_16x16x32_bf16 v[248:251],v[52:55],v[80:83],v[248:251]
buffer_load_dwordx4 v89,s[56:59],s51 offen offset:1024 lds
s_add_u32 s55,s55,128
v_mfma_f32_16x16x32_bf16 v[252:255],v[52:55],v[84:87],v[252:255]
s_bitcmp1_b32 s68,11
s_cbranch_scc0 g2_c1_20
v_lshlrev_b32 v12,16,v52
v_and_b32 v13,s69,v52
v_add_f32 v93,v93,v12
v_add_f32 v93,v93,v13
v_lshlrev_b32 v12,16,v53
v_and_b32 v13,s69,v53
v_add_f32 v93,v93,v12
v_add_f32 v93,v93,v13
v_lshlrev_b32 v12,16,v54
v_and_b32 v13,s69,v54
v_add_f32 v93,v93,v12
v_add_f32 v93,v93,v13
v_lshlrev_b32 v12,16,v55
v_and_b32 v13,s69,v55
v_add_f32 v93,v93,v12
v_add_f32 v93,v93,v13
g2_c1_20:
ds_read_b64_tr_b16 v[52:53],v10 offset:40960
ds_read_b64_tr_b16 v[54:55],v10 offset:41984
s_waitcnt lgkmcnt(15)
v_mfma_f32_16x16x32_bf16 v[96:99],v[56:59],v[16:19],v[96:99]
v_mfma_f32_16x16x32_bf16 v[100:103],v[60:63],v[16:19],v[100:103]
v_mfma_f32_16x16x32_bf16 v[104:107],v[64:67],v[16:19],v[104:107]
v_mfma_f32_16x16x32_bf16 v[108:111],v[68:71],v[16:19],v[108:111]
s_waitcnt vmcnt(9) lgkmcnt(0)
s_barrier
s_bitcmp1_b32 s68,2
s_cbranch_scc0 g2_c1_21
v_lshlrev_b32 v12,16,v16
v_and_b32 v13,s69,v16
v_add_f32 v14,v14,v12
v_add_f32 v14,v14,v13
v_lshlrev_b32 v12,16,v17
v_and_b32 v13,s69,v17
v_add_f32 v14,v14,v12
v_add_f32 v14,v14,v13
v_lshlrev_b32 v12,16,v18
v_and_b32 v13,s69,v18
v_add_f32 v14,v14,v12
v_add_f32 v14,v14,v13
v_lshlrev_b32 v12,16,v19
v_and_b32 v13,s69,v19
v_add_f32 v14,v14,v12
v_add_f32 v14,v14,v13
g2_c1_21:
ds_read_b64_tr_b16 v[16:17],v1 offset:61440
v_mfma_f32_16x16x32_bf16 v[112:115],v[56:59],v[20:23],v[112:115]
ds_read_b64_tr_b16 v[18:19],v1 offset:61952
v_mfma_f32_16x16x32_bf16 v[116:119],v[60:63],v[20:23],v[116:119]
ds_read_b128 v[72:75],v94 offset:32768
v_mfma_f32_16x16x32_bf16 v[120:123],v[64:67],v[20:23],v[120:123]
ds_read_b128 v[76:79],v94 offset:34816
v_mfma_f32_16x16x32_bf16 v[124:127],v[68:71],v[20:23],v[124:127]
s_bitcmp1_b32 s68,3
s_cbranch_scc0 g2_c1_22
v_lshlrev_b32 v12,16,v20
v_and_b32 v13,s69,v20
v_add_f32 v14,v14,v12
v_add_f32 v14,v14,v13
v_lshlrev_b32 v12,16,v21
v_and_b32 v13,s69,v21
v_add_f32 v14,v14,v12
v_add_f32 v14,v14,v13
v_lshlrev_b32 v12,16,v22
v_and_b32 v13,s69,v22
v_add_f32 v14,v14,v12
v_add_f32 v14,v14,v13
v_lshlrev_b32 v12,16,v23
v_and_b32 v13,s69,v23
v_add_f32 v14,v14,v12
v_add_f32 v14,v14,v13
g2_c1_22:
ds_read_b64_tr_b16 v[20:21],v2 offset:61440
v_mfma_f32_16x16x32_bf16 v[128:131],v[24:27],v[56:59],v[128:131]
ds_read_b64_tr_b16 v[22:23],v2 offset:61952
v_mfma_f32_16x16x32_bf16 v[132:135],v[24:27],v[60:63],v[132:135]
ds_read_b128 v[80:83],v94 offset:36864
v_mfma_f32_16x16x32_bf16 v[136:139],v[24:27],v[64:67],v[136:139]
ds_read_b128 v[84:87],v94 offset:38912
v_mfma_f32_16x16x32_bf16 v[140:143],v[24:27],v[68:71],v[140:143]
s_bitcmp1_b32 s68,4
s_cbranch_scc0 g2_c1_23
v_lshlrev_b32 v12,16,v24
v_and_b32 v13,s69,v24
v_add_f32 v14,v14,v12
v_add_f32 v14,v14,v13
v_lshlrev_b32 v12,16,v25
v_and_b32 v13,s69,v25
v_add_f32 v14,v14,v12
v_add_f32 v14,v14,v13
v_lshlrev_b32 v12,16,v26
v_and_b32 v13,s69,v26
v_add_f32 v14,v14,v12
v_add_f32 v14,v14,v13
v_lshlrev_b32 v12,16,v27
v_and_b32 v13,s69,v27
v_add_f32 v14,v14,v12
v_add_f32 v14,v14,v13
g2_c1_23:
ds_read_b64_tr_b16 v[24:25],v3 offset:61440
v_mfma_f32_16x16x32_bf16 v[144:147],v[28:31],v[56:59],v[144:147]
ds_read_b64_tr_b16 v[26:27],v3 offset:62464
v_mfma_f32_16x16x32_bf16 v[148:151],v[28:31],v[60:63],v[148:151]
buffer_load_dword v91,v90,s[28:31],s48 offen
s_add_u32 s48,s48,s49
v_mfma_f32_16x16x32_bf16 v[152:155],v[28:31],v[64:67],v[152:155]
v_mfma_f32_16x16x32_bf16 v[156:159],v[28:31],v[68:71],v[156:159]
s_bitcmp1_b32 s68,5
s_cbranch_scc0 g2_c1_24
v_lshlrev_b32 v12,16,v28
v_and_b32 v13,s69,v28
v_add_f32 v14,v14,v12
v_add_f32 v14,v14,v13
v_lshlrev_b32 v12,16,v29
v_and_b32 v13,s69,v29
v_add_f32 v14,v14,v12
v_add_f32 v14,v14,v13
v_lshlrev_b32 v12,16,v30
v_and_b32 v13,s69,v30
v_add_f32 v14,v14,v12
v_add_f32 v14,v14,v13
v_lshlrev_b32 v12,16,v31
v_and_b32 v13,s69,v31
v_add_f32 v14,v14,v12
v_add_f32 v14,v14,v13
g2_c1_24:
ds_read_b64_tr_b16 v[28:29],v4 offset:61440
v_mfma_f32_16x16x32_bf16 v[160:163],v[32:35],v[56:59],v[160:163]
ds_read_b64_tr_b16 v[30:31],v4 offset:62464
v_mfma_f32_16x16x32_bf16 v[164:167],v[32:35],v[60:63],v[164:167]
v_mfma_f32_16x16x32_bf16 v[168:171],v[32:35],v[64:67],v[168:171]
v_mfma_f32_16x16x32_bf16 v[172:175],v[32:35],v[68:71],v[172:175]
s_bitcmp1_b32 s68,6
s_cbranch_scc0 g2_c1_25
v_lshlrev_b32 v12,16,v32
v_and_b32 v13,s69,v32
v_add_f32 v15,v15,v12
v_add_f32 v15,v15,v13
v_lshlrev_b32 v12,16,v33
v_and_b32 v13,s69,v33
v_add_f32 v15,v15,v12
v_add_f32 v15,v15,v13
v_lshlrev_b32 v12,16,v34
v_and_b32 v13,s69,v34
v_add_f32 v15,v15,v12
v_add_f32 v15,v15,v13
v_lshlrev_b32 v12,16,v35
v_and_b32 v13,s69,v35
v_add_f32 v15,v15,v12
v_add_f32 v15,v15,v13
g2_c1_25:
ds_read_b64_tr_b16 v[32:33],v5 offset:61440
v_mfma_f32_16x16x32_bf16 v[176:179],v[36:39],v[56:59],v[176:179]
ds_read_b64_tr_b16 v[34:35],v5 offset:62464
v_mfma_f32_16x16x32_bf16 v[180:183],v[36:39],v[60:63],v[180:183]
v_mfma_f32_16x16x32_bf16 v[184:187],v[36:39],v[64:67],v[184:187]
v_mfma_f32_16x16x32_bf16 v[188:191],v[36:39],v[68:71],v[188:191]
s_bitcmp1_b32 s68,7
s_cbranch_scc0 g2_c1_26
v_lshlrev_b32 v12,16,v36
v_and_b32 v13,s69,v36
v_add_f32 v15,v15,v12
v_add_f32 v15,v15,v13
v_lshlrev_b32 v12,16,v37
v_and_b32 v13,s69,v37
v_add_f32 v15,v15,v12
v_add_f32 v15,v15,v13
v_lshlrev_b32 v12,16,v38
v_and_b32 v13,s69,v38
v_add_f32 v15,v15,v12
v_add_f32 v15,v15,v13
v_lshlrev_b32 v12,16,v39
v_and_b32 v13,s69,v39
v_add_f32 v15,v15,v12
v_add_f32 v15,v15,v13
g2_c1_26:
ds_read_b64_tr_b16 v[36:37],v6 offset:61440
v_mfma_f32_16x16x32_bf16 v[192:195],v[40:43],v[56:59],v[192:195]
ds_read_b64_tr_b16 v[38:39],v6 offset:62464
v_mfma_f32_16x16x32_bf16 v[196:199],v[40:43],v[60:63],v[196:199]
v_mfma_f32_16x16x32_bf16 v[200:203],v[40:43],v[64:67],v[200:203]
v_mfma_f32_16x16x32_bf16 v[204:207],v[40:43],v[68:71],v[204:207]
s_bitcmp1_b32 s68,8
s_cbranch_scc0 g2_c1_27
v_lshlrev_b32 v12,16,v40
v_and_b32 v13,s69,v40
v_add_f32 v15,v15,v12
v_add_f32 v15,v15,v13
v_lshlrev_b32 v12,16,v41
v_and_b32 v13,s69,v41
v_add_f32 v15,v15,v12
v_add_f32 v15,v15,v13
v_lshlrev_b32 v12,16,v42
v_and_b32 v13,s69,v42
v_add_f32 v15,v15,v12
v_add_f32 v15,v15,v13
v_lshlrev_b32 v12,16,v43
v_and_b32 v13,s69,v43
v_add_f32 v15,v15,v12
v_add_f32 v15,v15,v13
g2_c1_27:
ds_read_b64_tr_b16 v[40:41],v7 offset:61440
v_mfma_f32_16x16x32_bf16 v[208:211],v[44:47],v[56:59],v[208:211]
ds_read_b64_tr_b16 v[42:43],v7 offset:62464
v_mfma_f32_16x16x32_bf16 v[212:215],v[44:47],v[60:63],v[212:215]
v_mfma_f32_16x16x32_bf16 v[216:219],v[44:47],v[64:67],v[216:219]
v_mfma_f32_16x16x32_bf16 v[220:223],v[44:47],v[68:71],v[220:223]
s_bitcmp1_b32 s68,9
s_cbranch_scc0 g2_c1_28
v_lshlrev_b32 v12,16,v44
v_and_b32 v13,s69,v44
v_add_f32 v15,v15,v12
v_add_f32 v15,v15,v13
v_lshlrev_b32 v12,16,v45
v_and_b32 v13,s69,v45
v_add_f32 v15,v15,v12
v_add_f32 v15,v15,v13
v_lshlrev_b32 v12,16,v46
v_and_b32 v13,s69,v46
v_add_f32 v15,v15,v12
v_add_f32 v15,v15,v13
v_lshlrev_b32 v12,16,v47
v_and_b32 v13,s69,v47
v_add_f32 v15,v15,v12
v_add_f32 v15,v15,v13
g2_c1_28:
ds_read_b64_tr_b16 v[44:45],v8 offset:61440
v_mfma_f32_16x16x32_bf16 v[224:227],v[48:51],v[56:59],v[224:227]
ds_read_b64_tr_b16 v[46:47],v8 offset:62464
v_mfma_f32_16x16x32_bf16 v[228:231],v[48:51],v[60:63],v[228:231]
v_mfma_f32_16x16x32_bf16 v[232:235],v[48:51],v[64:67],v[232:235]
v_mfma_f32_16x16x32_bf16 v[236:239],v[48:51],v[68:71],v[236:239]
s_bitcmp1_b32 s68,10
s_cbranch_scc0 g2_c1_29
v_lshlrev_b32 v12,16,v48
v_and_b32 v13,s69,v48
v_add_f32 v93,v93,v12
v_add_f32 v93,v93,v13
v_lshlrev_b32 v12,16,v49
v_and_b32 v13,s69,v49
v_add_f32 v93,v93,v12
v_add_f32 v93,v93,v13
v_lshlrev_b32 v12,16,v50
v_and_b32 v13,s69,v50
v_add_f32 v93,v93,v12
v_add_f32 v93,v93,v13
v_lshlrev_b32 v12,16,v51
v_and_b32 v13,s69,v51
v_add_f32 v93,v93,v12
v_add_f32 v93,v93,v13
g2_c1_29:
ds_read_b64_tr_b16 v[48:49],v9 offset:61440
v_mfma_f32_16x16x32_bf16 v[240:243],v[52:55],v[56:59],v[240:243]
ds_read_b64_tr_b16 v[50:51],v9 offset:62464
v_mfma_f32_16x16x32_bf16 v[244:247],v[52:55],v[60:63],v[244:247]
v_mfma_f32_16x16x32_bf16 v[248:251],v[52:55],v[64:67],v[248:251]
v_mfma_f32_16x16x32_bf16 v[252:255],v[52:55],v[68:71],v[252:255]
s_bitcmp1_b32 s68,11
s_cbranch_scc0 g2_c1_30
v_lshlrev_b32 v12,16,v52
v_and_b32 v13,s69,v52
v_add_f32 v93,v93,v12
v_add_f32 v93,v93,v13
v_lshlrev_b32 v12,16,v53
v_and_b32 v13,s69,v53
v_add_f32 v93,v93,v12
v_add_f32 v93,v93,v13
v_lshlrev_b32 v12,16,v54
v_and_b32 v13,s69,v54
v_add_f32 v93,v93,v12
v_add_f32 v93,v93,v13
v_lshlrev_b32 v12,16,v55
v_and_b32 v13,s69,v55
v_add_f32 v93,v93,v12
v_add_f32 v93,v93,v13
g2_c1_30:
ds_read_b64_tr_b16 v[52:53],v10 offset:61440
ds_read_b64_tr_b16 v[54:55],v10 offset:62464
s_waitcnt lgkmcnt(15)
v_mfma_f32_16x16x32_bf16 v[96:99],v[72:75],v[16:19],v[96:99]
v_mfma_f32_16x16x32_bf16 v[100:103],v[76:79],v[16:19],v[100:103]
v_mfma_f32_16x16x32_bf16 v[104:107],v[80:83],v[16:19],v[104:107]
v_mfma_f32_16x16x32_bf16 v[108:111],v[84:87],v[16:19],v[108:111]
s_waitcnt vmcnt(1) lgkmcnt(0)
s_barrier
s_bitcmp1_b32 s68,2
s_cbranch_scc0 g2_c1_31
v_lshlrev_b32 v12,16,v16
v_and_b32 v13,s69,v16
v_add_f32 v14,v14,v12
v_add_f32 v14,v14,v13
v_lshlrev_b32 v12,16,v17
v_and_b32 v13,s69,v17
v_add_f32 v14,v14,v12
v_add_f32 v14,v14,v13
v_lshlrev_b32 v12,16,v18
v_and_b32 v13,s69,v18
v_add_f32 v14,v14,v12
v_add_f32 v14,v14,v13
v_lshlrev_b32 v12,16,v19
v_and_b32 v13,s69,v19
v_add_f32 v14,v14,v12
v_add_f32 v14,v14,v13
v_and_b32 v12,15,v0
v_lshrrev_b32 v13,4,v0
v_lshlrev_b32 v12,4,v12
v_lshl_add_u32 v12,v13,2,v12
v_add_u32 v12,153600,v12
ds_write_b32 v12,v14 offset:512
g2_c1_31:
ds_read_b64_tr_b16 v[16:17],v1 offset:0
v_mfma_f32_16x16x32_bf16 v[112:115],v[72:75],v[20:23],v[112:115]
ds_read_b64_tr_b16 v[18:19],v1 offset:512
v_mfma_f32_16x16x32_bf16 v[116:119],v[76:79],v[20:23],v[116:119]
ds_read_b128 v[56:59],v11 offset:0
v_mfma_f32_16x16x32_bf16 v[120:123],v[80:83],v[20:23],v[120:123]
ds_read_b128 v[60:63],v11 offset:2048
v_mfma_f32_16x16x32_bf16 v[124:127],v[84:87],v[20:23],v[124:127]
s_bitcmp1_b32 s68,3
s_cbranch_scc0 g2_c1_32
v_lshlrev_b32 v12,16,v20
v_and_b32 v13,s69,v20
v_add_f32 v14,v14,v12
v_add_f32 v14,v14,v13
v_lshlrev_b32 v12,16,v21
v_and_b32 v13,s69,v21
v_add_f32 v14,v14,v12
v_add_f32 v14,v14,v13
v_lshlrev_b32 v12,16,v22
v_and_b32 v13,s69,v22
v_add_f32 v14,v14,v12
v_add_f32 v14,v14,v13
v_lshlrev_b32 v12,16,v23
v_and_b32 v13,s69,v23
v_add_f32 v14,v14,v12
v_add_f32 v14,v14,v13
v_and_b32 v12,15,v0
v_lshrrev_b32 v13,4,v0
v_lshlrev_b32 v12,4,v12
v_lshl_add_u32 v12,v13,2,v12
v_add_u32 v12,153600,v12
ds_write_b32 v12,v14 offset:768
g2_c1_32:
ds_read_b64_tr_b16 v[20:21],v2 offset:0
v_mfma_f32_16x16x32_bf16 v[128:131],v[24:27],v[72:75],v[128:131]
ds_read_b64_tr_b16 v[22:23],v2 offset:512
v_mfma_f32_16x16x32_bf16 v[132:135],v[24:27],v[76:79],v[132:135]
ds_read_b128 v[64:67],v11 offset:4096
v_mfma_f32_16x16x32_bf16 v[136:139],v[24:27],v[80:83],v[136:139]
ds_read_b128 v[68:71],v11 offset:6144
v_mfma_f32_16x16x32_bf16 v[140:143],v[24:27],v[84:87],v[140:143]
s_bitcmp1_b32 s68,4
s_cbranch_scc0 g2_c1_33
v_lshlrev_b32 v12,16,v24
v_and_b32 v13,s69,v24
v_add_f32 v14,v14,v12
v_add_f32 v14,v14,v13
v_lshlrev_b32 v12,16,v25
v_and_b32 v13,s69,v25
v_add_f32 v14,v14,v12
v_add_f32 v14,v14,v13
v_lshlrev_b32 v12,16,v26
v_and_b32 v13,s69,v26
v_add_f32 v14,v14,v12
v_add_f32 v14,v14,v13
v_lshlrev_b32 v12,16,v27
v_and_b32 v13,s69,v27
v_add_f32 v14,v14,v12
v_add_f32 v14,v14,v13
v_and_b32 v12,15,v0
v_lshrrev_b32 v13,4,v0
v_lshlrev_b32 v12,4,v12
v_lshl_add_u32 v12,v13,2,v12
v_add_u32 v12,153600,v12
ds_write_b32 v12,v14 offset:2048
g2_c1_33:
ds_read_b64_tr_b16 v[24:25],v3 offset:0
v_mfma_f32_16x16x32_bf16 v[144:147],v[28:31],v[72:75],v[144:147]
ds_read_b64_tr_b16 v[26:27],v3 offset:1024
v_mfma_f32_16x16x32_bf16 v[148:151],v[28:31],v[76:79],v[148:151]
s_add_u32 m0,s54,32768
s_nop 0
buffer_load_dwordx4 v88,s[56:59],s55 offen lds
v_mfma_f32_16x16x32_bf16 v[152:155],v[28:31],v[80:83],v[152:155]
v_mfma_f32_16x16x32_bf16 v[156:159],v[28:31],v[84:87],v[156:159]
s_bitcmp1_b32 s68,5
s_cbranch_scc0 g2_c1_34
v_lshlrev_b32 v12,16,v28
v_and_b32 v13,s69,v28
v_add_f32 v14,v14,v12
v_add_f32 v14,v14,v13
v_lshlrev_b32 v12,16,v29
v_and_b32 v13,s69,v29
v_add_f32 v14,v14,v12
v_add_f32 v14,v14,v13
v_lshlrev_b32 v12,16,v30
v_and_b32 v13,s69,v30
v_add_f32 v14,v14,v12
v_add_f32 v14,v14,v13
v_lshlrev_b32 v12,16,v31
v_and_b32 v13,s69,v31
v_add_f32 v14,v14,v12
v_add_f32 v14,v14,v13
v_and_b32 v12,15,v0
v_lshrrev_b32 v13,4,v0
v_lshlrev_b32 v12,4,v12
v_lshl_add_u32 v12,v13,2,v12
v_add_u32 v12,153600,v12
ds_write_b32 v12,v14 offset:2304
g2_c1_34:
ds_read_b64_tr_b16 v[28:29],v4 offset:0
v_mfma_f32_16x16x32_bf16 v[160:163],v[32:35],v[72:75],v[160:163]
ds_read_b64_tr_b16 v[30:31],v4 offset:1024
v_mfma_f32_16x16x32_bf16 v[164:167],v[32:35],v[76:79],v[164:167]
buffer_load_dwordx4 v89,s[56:59],s55 offen offset:1024 lds
v_mfma_f32_16x16x32_bf16 v[168:171],v[32:35],v[80:83],v[168:171]
v_mfma_f32_16x16x32_bf16 v[172:175],v[32:35],v[84:87],v[172:175]
s_bitcmp1_b32 s68,6
s_cbranch_scc0 g2_c1_35
v_lshlrev_b32 v12,16,v32
v_and_b32 v13,s69,v32
v_add_f32 v15,v15,v12
v_add_f32 v15,v15,v13
v_lshlrev_b32 v12,16,v33
v_and_b32 v13,s69,v33
v_add_f32 v15,v15,v12
v_add_f32 v15,v15,v13
v_lshlrev_b32 v12,16,v34
v_and_b32 v13,s69,v34
v_add_f32 v15,v15,v12
v_add_f32 v15,v15,v13
v_lshlrev_b32 v12,16,v35
v_and_b32 v13,s69,v35
v_add_f32 v15,v15,v12
v_add_f32 v15,v15,v13
v_and_b32 v12,15,v0
v_lshrrev_b32 v13,4,v0
v_lshlrev_b32 v12,4,v12
v_lshl_add_u32 v12,v13,2,v12
v_add_u32 v12,153600,v12
ds_write_b32 v12,v15 offset:4096
g2_c1_35:
ds_read_b64_tr_b16 v[32:33],v5 offset:0
v_mfma_f32_16x16x32_bf16 v[176:179],v[36:39],v[72:75],v[176:179]
ds_read_b64_tr_b16 v[34:35],v5 offset:1024
v_mfma_f32_16x16x32_bf16 v[180:183],v[36:39],v[76:79],v[180:183]
s_add_u32 m0,s54,34816
s_add_u32 s51,s55,32768
buffer_load_dwordx4 v88,s[56:59],s51 offen lds
v_mfma_f32_16x16x32_bf16 v[184:187],v[36:39],v[80:83],v[184:187]
v_mfma_f32_16x16x32_bf16 v[188:191],v[36:39],v[84:87],v[188:191]
s_bitcmp1_b32 s68,7
s_cbranch_scc0 g2_c1_36
v_lshlrev_b32 v12,16,v36
v_and_b32 v13,s69,v36
v_add_f32 v15,v15,v12
v_add_f32 v15,v15,v13
v_lshlrev_b32 v12,16,v37
v_and_b32 v13,s69,v37
v_add_f32 v15,v15,v12
v_add_f32 v15,v15,v13
v_lshlrev_b32 v12,16,v38
v_and_b32 v13,s69,v38
v_add_f32 v15,v15,v12
v_add_f32 v15,v15,v13
v_lshlrev_b32 v12,16,v39
v_and_b32 v13,s69,v39
v_add_f32 v15,v15,v12
v_add_f32 v15,v15,v13
v_and_b32 v12,15,v0
v_lshrrev_b32 v13,4,v0
v_lshlrev_b32 v12,4,v12
v_lshl_add_u32 v12,v13,2,v12
v_add_u32 v12,153600,v12
ds_write_b32 v12,v15 offset:4352
g2_c1_36:
ds_read_b64_tr_b16 v[36:37],v6 offset:0
v_mfma_f32_16x16x32_bf16 v[192:195],v[40:43],v[72:75],v[192:195]
ds_read_b64_tr_b16 v[38:39],v6 offset:1024
v_mfma_f32_16x16x32_bf16 v[196:199],v[40:43],v[76:79],v[196:199]
buffer_load_dwordx4 v89,s[56:59],s51 offen offset:1024 lds
v_mfma_f32_16x16x32_bf16 v[200:203],v[40:43],v[80:83],v[200:203]
v_mfma_f32_16x16x32_bf16 v[204:207],v[40:43],v[84:87],v[204:207]
s_bitcmp1_b32 s68,8
s_cbranch_scc0 g2_c1_37
v_lshlrev_b32 v12,16,v40
v_and_b32 v13,s69,v40
v_add_f32 v15,v15,v12
v_add_f32 v15,v15,v13
v_lshlrev_b32 v12,16,v41
v_and_b32 v13,s69,v41
v_add_f32 v15,v15,v12
v_add_f32 v15,v15,v13
v_lshlrev_b32 v12,16,v42
v_and_b32 v13,s69,v42
v_add_f32 v15,v15,v12
v_add_f32 v15,v15,v13
v_lshlrev_b32 v12,16,v43
v_and_b32 v13,s69,v43
v_add_f32 v15,v15,v12
v_add_f32 v15,v15,v13
v_and_b32 v12,15,v0
v_lshrrev_b32 v13,4,v0
v_lshlrev_b32 v12,4,v12
v_lshl_add_u32 v12,v13,2,v12
v_add_u32 v12,153600,v12
ds_write_b32 v12,v15 offset:2560
g2_c1_37:
ds_read_b64_tr_b16 v[40:41],v7 offset:0
v_mfma_f32_16x16x32_bf16 v[208:211],v[44:47],v[72:75],v[208:211]
ds_read_b64_tr_b16 v[42:43],v7 offset:1024
v_mfma_f32_16x16x32_bf16 v[212:215],v[44:47],v[76:79],v[212:215]
s_add_u32 m0,s54,36864
s_add_u32 s51,s55,65536
buffer_load_dwordx4 v88,s[56:59],s51 offen lds
v_mfma_f32_16x16x32_bf16 v[216:219],v[44:47],v[80:83],v[216:219]
v_mfma_f32_16x16x32_bf16 v[220:223],v[44:47],v[84:87],v[220:223]
s_bitcmp1_b32 s68,9
s_cbranch_scc0 g2_c1_38
v_lshlrev_b32 v12,16,v44
v_and_b32 v13,s69,v44
v_add_f32 v15,v15,v12
v_add_f32 v15,v15,v13
v_lshlrev_b32 v12,16,v45
v_and_b32 v13,s69,v45
v_add_f32 v15,v15,v12
v_add_f32 v15,v15,v13
v_lshlrev_b32 v12,16,v46
v_and_b32 v13,s69,v46
v_add_f32 v15,v15,v12
v_add_f32 v15,v15,v13
v_lshlrev_b32 v12,16,v47
v_and_b32 v13,s69,v47
v_add_f32 v15,v15,v12
v_add_f32 v15,v15,v13
v_and_b32 v12,15,v0
v_lshrrev_b32 v13,4,v0
v_lshlrev_b32 v12,4,v12
v_lshl_add_u32 v12,v13,2,v12
v_add_u32 v12,153600,v12
ds_write_b32 v12,v15 offset:2816
g2_c1_38:
ds_read_b64_tr_b16 v[44:45],v8 offset:0
v_mfma_f32_16x16x32_bf16 v[224:227],v[48:51],v[72:75],v[224:227]
ds_read_b64_tr_b16 v[46:47],v8 offset:1024
v_mfma_f32_16x16x32_bf16 v[228:231],v[48:51],v[76:79],v[228:231]
buffer_load_dwordx4 v89,s[56:59],s51 offen offset:1024 lds
v_mfma_f32_16x16x32_bf16 v[232:235],v[48:51],v[80:83],v[232:235]
v_mfma_f32_16x16x32_bf16 v[236:239],v[48:51],v[84:87],v[236:239]
s_bitcmp1_b32 s68,10
s_cbranch_scc0 g2_c1_39
v_lshlrev_b32 v12,16,v48
v_and_b32 v13,s69,v48
v_add_f32 v93,v93,v12
v_add_f32 v93,v93,v13
v_lshlrev_b32 v12,16,v49
v_and_b32 v13,s69,v49
v_add_f32 v93,v93,v12
v_add_f32 v93,v93,v13
v_lshlrev_b32 v12,16,v50
v_and_b32 v13,s69,v50
v_add_f32 v93,v93,v12
v_add_f32 v93,v93,v13
v_lshlrev_b32 v12,16,v51
v_and_b32 v13,s69,v51
v_add_f32 v93,v93,v12
v_add_f32 v93,v93,v13
v_and_b32 v12,15,v0
v_lshrrev_b32 v13,4,v0
v_lshlrev_b32 v12,4,v12
v_lshl_add_u32 v12,v13,2,v12
v_add_u32 v12,153600,v12
ds_write_b32 v12,v93 offset:4608
g2_c1_39:
ds_read_b64_tr_b16 v[48:49],v9 offset:0
v_mfma_f32_16x16x32_bf16 v[240:243],v[52:55],v[72:75],v[240:243]
ds_read_b64_tr_b16 v[50:51],v9 offset:1024
v_mfma_f32_16x16x32_bf16 v[244:247],v[52:55],v[76:79],v[244:247]
s_add_u32 m0,s54,38912
s_add_u32 s51,s55,98304
buffer_load_dwordx4 v88,s[56:59],s51 offen lds
v_mfma_f32_16x16x32_bf16 v[248:251],v[52:55],v[80:83],v[248:251]
buffer_load_dwordx4 v89,s[56:59],s51 offen offset:1024 lds
s_and_b32 s50,s64,7
s_lshr_b32 s64,s64,4
s_mul_i32 s55,s50,256
s_add_u32 s55,s55,s65
v_mfma_f32_16x16x32_bf16 v[252:255],v[52:55],v[84:87],v[252:255]
s_bitcmp1_b32 s68,11
s_cbranch_scc0 g2_c1_40
v_lshlrev_b32 v12,16,v52
v_and_b32 v13,s69,v52
v_add_f32 v93,v93,v12
v_add_f32 v93,v93,v13
v_lshlrev_b32 v12,16,v53
v_and_b32 v13,s69,v53
v_add_f32 v93,v93,v12
v_add_f32 v93,v93,v13
v_lshlrev_b32 v12,16,v54
v_and_b32 v13,s69,v54
v_add_f32 v93,v93,v12
v_add_f32 v93,v93,v13
v_lshlrev_b32 v12,16,v55
v_and_b32 v13,s69,v55
v_add_f32 v93,v93,v12
v_add_f32 v93,v93,v13
v_and_b32 v12,15,v0
v_lshrrev_b32 v13,4,v0
v_lshlrev_b32 v12,4,v12
v_lshl_add_u32 v12,v13,2,v12
v_add_u32 v12,153600,v12
ds_write_b32 v12,v93 offset:4864
g2_c1_40:
ds_read_b64_tr_b16 v[52:53],v10 offset:0
ds_read_b64_tr_b16 v[54:55],v10 offset:1024
s_sub_u32 s53,s53,1
s_branch g2_loop1
g2_pub1:
s_lshl_b32 s50,s40,10
s_add_u32 s50,s50,153600
v_add_u32 v93,s50,v95
ds_read_b128 v[12:15],v93
v_lshlrev_b32 v93,5,v0
s_lshl_b32 s50,s43,2
s_add_u32 s50,s50,s98
s_waitcnt lgkmcnt(0)
v_add_f32 v12,v12,v13
v_add_f32 v14,v14,v15
v_add_f32 v12,v12,v14
buffer_store_dword v12,v93,s[36:39],s50 offen sc1
s_branch g2_pubr1
g2_bad1:
v_lshlrev_b32 v92,2,v0
v_add_u32 v92,151552,v92
ds_write_b32 v92,v92
s_branch g2_badr1
g2_rd1:
ds_read2_b32 v[56:57],v94 offset0:0 offset1:32
ds_read2_b32 v[58:59],v94 offset0:16 offset1:48
ds_read2_b32 v[60:61],v94 offset0:64 offset1:96
ds_read2_b32 v[62:63],v94 offset0:80 offset1:112
ds_read_b128 v[4:7],v95 offset:128
ds_read_b128 v[8:11],v95 offset:192
ds_read_b128 v[12:15],v95 offset:384
ds_read_b128 v[88:91],v95 offset:448
ds_read_b32 v16,v93 offset:128
ds_read_b32 v20,v93 offset:192
ds_read_b128 v[24:27],v92 offset:512
ds_read_b128 v[28:31],v92 offset:576
ds_read_b128 v[32:35],v92 offset:1024
ds_read_b128 v[36:39],v92 offset:1088
ds_read_b128 v[40:43],v92 offset:640
ds_read_b128 v[44:47],v92 offset:704
ds_read_b128 v[48:51],v92 offset:1152
ds_read_b128 v[52:55],v92 offset:1216
s_waitcnt lgkmcnt(0)
s_branch g2_ep1
g2_v2:
s_lshl_b32 s50,s41,6
s_lshl_b32 s54,s41,10
s_add_u32 s51,s50,0
v_add_u32 v12,s51,v0
v_lshrrev_b32 v13,4,v12
v_and_b32 v14,15,v12
v_and_b32 v15,3,v13
v_lshlrev_b32 v15,1,v15
v_xor_b32 v14,v14,v15
v_and_b32 v15,8,v13
v_xor_b32 v14,v14,v15
v_mul_u32_u24 v13,6144,v13
v_lshrrev_b32 v15,3,v14
v_lshl_add_u32 v13,v15,11,v13
v_and_b32 v14,7,v14
v_lshl_add_u32 v88,v14,4,v13
s_add_u32 s51,s50,256
v_add_u32 v12,s51,v0
v_lshrrev_b32 v13,4,v12
v_and_b32 v14,15,v12
v_and_b32 v15,3,v13
v_lshlrev_b32 v15,1,v15
v_xor_b32 v14,v14,v15
v_and_b32 v15,8,v13
v_xor_b32 v14,v14,v15
v_mul_u32_u24 v13,6144,v13
v_lshrrev_b32 v15,3,v14
v_lshl_add_u32 v13,v15,11,v13
v_and_b32 v14,7,v14
v_lshl_add_u32 v89,v14,4,v13
s_add_u32 s51,s50,0
v_add_u32 v12,s51,v0
v_mul_u32_u24 v13,43691,v12
v_lshrrev_b32 v13,19,v13
v_mul_u32_u24 v14,12,v13
v_sub_u32 v14,v12,v14
v_bfe_u32 v15,v13,3,1
v_lshlrev_b32 v15,1,v15
v_xor_b32 v14,v14,v15
v_mul_u32_u24 v13,7168,v13
v_lshl_add_u32 v90,v14,4,v13
s_cmp_lt_u32 s41,2
s_cselect_b32 s51,384,0
s_add_u32 s51,s51,s50
s_sub_u32 s51,s51,128
v_add_u32 v12,s51,v0
v_mul_u32_u24 v13,43691,v12
v_lshrrev_b32 v13,19,v13
v_mul_u32_u24 v14,12,v13
v_sub_u32 v14,v12,v14
v_bfe_u32 v15,v13,3,1
v_lshlrev_b32 v15,1,v15
v_xor_b32 v14,v14,v15
v_mul_u32_u24 v13,7168,v13
v_lshl_add_u32 v91,v14,4,v13
s_add_u32 s51,s50,128
v_add_u32 v12,s51,v0
v_mul_u32_u24 v13,43691,v12
v_lshrrev_b32 v13,19,v13
v_mul_u32_u24 v14,12,v13
v_sub_u32 v14,v12,v14
v_bfe_u32 v15,v13,3,1
v_lshlrev_b32 v15,1,v15
v_xor_b32 v14,v14,v15
v_mul_u32_u24 v13,7168,v13
v_lshl_add_u32 v92,v14,4,v13
s_lshl_b32 s65,s45,7
s_lshl_b32 s66,s47,1
s_and_b32 s50,s64,7
s_lshr_b32 s64,s64,4
s_mul_i32 s48,s50,786432
s_add_u32 s48,s48,s65
s_mul_i32 s49,s50,917504
s_add_u32 s49,s49,s66
s_waitcnt lgkmcnt(0)
s_mov_b32 s56,s4
s_and_b32 s57,s5,0xffff
s_mov_b32 s58,4194304
s_mov_b32 s59,0x00020000
buffer_load_dwordx4 v[96:99],v95,s[56:59],s53 offen offset:0
buffer_load_dwordx4 v[100:103],v95,s[56:59],s53 offen offset:1024
s_mov_b32 s20,s6
s_and_b32 s21,s7,0xffff
s_mov_b32 s22,6291456
s_mov_b32 s23,0x00020000
s_mov_b32 s24,s8
s_and_b32 s25,s9,0xffff
s_mov_b32 s26,7340032
s_mov_b32 s27,0x00020000
s_mov_b32 s28,s10
s_and_b32 s29,s11,0xffff
s_mov_b32 s30,7340032
s_mov_b32 s31,0x00020000
s_cmp_lt_u32 s41,2
s_cselect_b32 s32,s24,s28
s_cselect_b32 s33,s25,s29
s_mov_b32 s34,7340032
s_mov_b32 s35,0x00020000
s_add_u32 m0,s54,0
s_nop 0
buffer_load_dwordx4 v88,s[20:23],s48 offen lds
s_add_u32 m0,s54,4096
s_nop 0
buffer_load_dwordx4 v89,s[20:23],s48 offen lds
s_add_u32 m0,s54,8192
s_nop 0
buffer_load_dwordx4 v90,s[24:27],s49 offen lds
s_add_u32 m0,s54,12288
s_nop 0
buffer_load_dwordx4 v91,s[32:35],s49 offen lds
s_add_u32 m0,s54,16384
s_nop 0
buffer_load_dwordx4 v92,s[28:31],s49 offen lds
s_add_u32 s48,s48,196608
s_add_u32 s49,s49,229376
s_cmp_eq_u32 s43,0
s_cselect_b32 s64,0x17654320,s64
s_cmp_eq_u32 s43,1
s_cselect_b32 s64,0x17654321,s64
s_cmp_eq_u32 s43,2
s_cselect_b32 s64,0x27654321,s64
s_cmp_eq_u32 s43,3
s_cselect_b32 s64,0x37654321,s64
s_cmp_eq_u32 s43,4
s_cselect_b32 s64,0x37653421,s64
s_cmp_eq_u32 s43,5
s_cselect_b32 s64,0x37643521,s64
s_cmp_eq_u32 s43,6
s_cselect_b32 s64,0x37543621,s64
s_cmp_eq_u32 s43,7
s_cselect_b32 s64,0x36543721,s64
s_lshr_b32 s67,s64,28
s_sub_u32 s67,7,s67
s_sub_u32 s96,s67,1
s_add_u32 m0,s54,20480
s_nop 0
buffer_load_dwordx4 v88,s[20:23],s48 offen lds
s_add_u32 m0,s54,24576
s_nop 0
buffer_load_dwordx4 v89,s[20:23],s48 offen lds
s_add_u32 m0,s54,28672
s_nop 0
buffer_load_dwordx4 v90,s[24:27],s49 offen lds
s_add_u32 m0,s54,32768
s_nop 0
buffer_load_dwordx4 v91,s[32:35],s49 offen lds
s_add_u32 m0,s54,36864
s_nop 0
buffer_load_dwordx4 v92,s[28:31],s49 offen lds
s_add_u32 s48,s48,196608
s_add_u32 s49,s49,229376
s_mov_b32 s36,s12
s_and_b32 s37,s13,0xffff
s_mov_b32 s38,50331648
s_mov_b32 s39,0x00020000
s_mov_b32 s60,s18
s_and_b32 s61,s19,0xffff
s_mov_b32 s62,256
s_mov_b32 s63,0x00020000
s_lshl_b32 s68,0x11111111,s41
s_mov_b32 s69,0xffff0000
s_cmp_eq_u32 s40,0
s_cselect_b32 s97,s96,99
s_cmp_eq_u32 s100,-1
s_cselect_b32 s97,s97,99
s_lshl_b32 s98,s44,14
s_lshl_b32 s50,s40,11
s_add_u32 s98,s98,s50
s_add_u32 s98,s98,44040192
s_lshl_b32 s50,s40,8
s_add_u32 s50,s50,147456
v_lshl_add_u32 v12,v0,2,s50
v_mov_b32 v13,0
ds_write_b32 v12,v13 offset:4096
v_lshlrev_b32 v12,2,v0
v_add_u32 v12,161792,v12
ds_write_b32 v12,v13
v_bfe_u32 v12,v0,2,2
v_lshrrev_b32 v13,4,v0
v_lshl_add_u32 v14,v13,3,v12
v_and_b32 v15,3,v0
v_lshlrev_b32 v15,3,v15
v_and_b32 v13,1,v13
v_mov_b32 v93,v13
v_lshlrev_b32 v93,5,v93
v_mul_u32_u24 v94,192,v14
v_add_u32 v94,v94,v15
v_xor_b32 v11,0,v93
v_add_u32 v11,8192,v11
v_add_u32 v7,v94,v11
v_xor_b32 v11,32,v93
v_add_u32 v11,8192,v11
v_add_u32 v8,v94,v11
v_xor_b32 v11,0,v93
v_add_u32 v11,14336,v11
v_add_u32 v9,v94,v11
v_xor_b32 v11,32,v93
v_add_u32 v11,14336,v11
v_add_u32 v10,v94,v11
v_lshl_add_u32 v93,v13,2,v12
v_lshlrev_b32 v93,5,v93
v_mul_u32_u24 v94,256,v14
v_add_u32 v94,v94,v15
v_xor_b32 v11,0,v93
v_add_u32 v11,0,v11
v_add_u32 v1,v94,v11
v_xor_b32 v11,32,v93
v_add_u32 v11,0,v11
v_add_u32 v2,v94,v11
v_xor_b32 v11,64,v93
v_add_u32 v11,0,v11
v_add_u32 v3,v94,v11
v_xor_b32 v11,96,v93
v_add_u32 v11,0,v11
v_add_u32 v4,v94,v11
v_xor_b32 v11,128,v93
v_add_u32 v11,0,v11
v_add_u32 v5,v94,v11
v_xor_b32 v11,160,v93
v_add_u32 v11,0,v11
v_add_u32 v6,v94,v11
s_lshl_b32 s50,s41,13
s_add_u32 s50,s50,81920
v_and_b32 v12,15,v0
v_lshrrev_b32 v13,1,v12
v_lshrrev_b32 v14,4,v0
v_xor_b32 v13,v13,v14
v_lshl_add_u32 v14,v12,7,s50
v_lshl_add_u32 v11,v13,4,v14
v_xor_b32 v94,64,v11
s_waitcnt vmcnt(10)
v_lshlrev_b32 v108,16,v96
v_and_b32 v109,0xffff0000,v96
v_mov_b32 v104,v108
v_mov_b32 v106,v109
v_mul_f32 v105,v108,v108
v_mul_f32 v107,v109,v109
v_lshlrev_b32 v108,16,v97
v_and_b32 v109,0xffff0000,v97
v_add_f32 v104,v104,v108
v_add_f32 v106,v106,v109
v_fmac_f32 v105,v108,v108
v_fmac_f32 v107,v109,v109
v_lshlrev_b32 v108,16,v98
v_and_b32 v109,0xffff0000,v98
v_add_f32 v104,v104,v108
v_add_f32 v106,v106,v109
v_fmac_f32 v105,v108,v108
v_fmac_f32 v107,v109,v109
v_lshlrev_b32 v108,16,v99
v_and_b32 v109,0xffff0000,v99
v_add_f32 v104,v104,v108
v_add_f32 v106,v106,v109
v_fmac_f32 v105,v108,v108
v_fmac_f32 v107,v109,v109
v_lshlrev_b32 v108,16,v100
v_and_b32 v109,0xffff0000,v100
v_add_f32 v104,v104,v108
v_add_f32 v106,v106,v109
v_fmac_f32 v105,v108,v108
v_fmac_f32 v107,v109,v109
v_lshlrev_b32 v108,16,v101
v_and_b32 v109,0xffff0000,v101
v_add_f32 v104,v104,v108
v_add_f32 v106,v106,v109
v_fmac_f32 v105,v108,v108
v_fmac_f32 v107,v109,v109
v_lshlrev_b32 v108,16,v102
v_and_b32 v109,0xffff0000,v102
v_add_f32 v104,v104,v108
v_add_f32 v106,v106,v109
v_fmac_f32 v105,v108,v108
v_fmac_f32 v107,v109,v109
v_lshlrev_b32 v108,16,v103
v_and_b32 v109,0xffff0000,v103
v_add_f32 v104,v104,v108
v_add_f32 v106,v106,v109
v_fmac_f32 v105,v108,v108
v_fmac_f32 v107,v109,v109
v_add_f32 v104,v104,v106
v_add_f32 v105,v105,v107
s_nop 0
s_nop 0
v_add_f32_dpp v104,v104,v104 row_ror:8 row_mask:0xf bank_mask:0xf
v_add_f32_dpp v105,v105,v105 row_ror:8 row_mask:0xf bank_mask:0xf
s_nop 0
v_add_f32_dpp v104,v104,v104 row_ror:4 row_mask:0xf bank_mask:0xf
v_add_f32_dpp v105,v105,v105 row_ror:4 row_mask:0xf bank_mask:0xf
s_nop 0
v_add_f32_dpp v104,v104,v104 row_ror:2 row_mask:0xf bank_mask:0xf
v_add_f32_dpp v105,v105,v105 row_ror:2 row_mask:0xf bank_mask:0xf
s_nop 0
v_add_f32_dpp v104,v104,v104 row_ror:1 row_mask:0xf bank_mask:0xf
v_add_f32_dpp v105,v105,v105 row_ror:1 row_mask:0xf bank_mask:0xf
v_mov_b32 v106,v104
v_mov_b32 v107,v105
s_nop 0
v_permlane16_swap_b32 v104,v106
v_permlane16_swap_b32 v105,v107
v_add_f32 v104,v104,v106
v_add_f32 v105,v105,v107
v_mov_b32 v106,v104
v_mov_b32 v107,v105
s_nop 0
v_permlane32_swap_b32 v104,v106
v_permlane32_swap_b32 v105,v107
v_add_f32 v104,v104,v106
v_add_f32 v105,v105,v107
v_mul_f32 v104,0xba800000,v104
v_mul_f32 v105,0x3a800000,v105
v_fma_f32 v105,-v104,v104,v105
v_max_f32 v105,0,v105
v_cvt_pk_bf16_f32 v104,v104,v105
v_and_b32 v105,0xffff0000,v104
v_lshlrev_b32 v104,16,v104
v_add_f32 v105,0x3727c5ac,v105
v_cvt_pk_bf16_f32 v105,v105,v105
v_and_b32 v105,0xffff0000,v105
v_sqrt_f32 v105,v105
s_nop 0
v_cvt_pk_bf16_f32 v105,v105,v105
v_and_b32 v105,0xffff0000,v105
v_cmp_eq_u32 vcc,0,v0
v_lshlrev_b32 v106,13,v0
s_lshl_b32 s50,s52,2
s_add_u32 s50,s50,42991616
v_cndmask_b32 v104,v105,v104,vcc
s_mov_b64 exec,3
buffer_store_dword v104,v106,s[36:39],s50 offen sc1
s_mov_b64 exec,-1
s_cmp_eq_u32 s97,99
s_cbranch_scc1 g2_nr2
v_mov_b32 v105,0
v_lshlrev_b32 v106,2,v0
s_bfe_u32 s50,s2,0x20001
s_lshl_b32 s50,s50,2
s_and_b32 s51,s44,3
s_add_u32 s50,s50,s51
s_lshl_b32 s50,s50,1
s_and_b32 s51,s2,1
s_add_u32 s50,s50,s51
s_lshl_b32 s50,s50,3
s_add_u32 s50,s50,s43
s_lshl_b32 s50,s50,9
s_add_u32 s50,s50,41943040
buffer_store_dword v105,v106,s[36:39],s50 offen sc1
s_lshl_b32 s50,s43,1
s_and_b32 s51,s44,1
s_add_u32 s50,s50,s51
s_lshl_b32 s51,s45,4
s_add_u32 s50,s50,s51
s_lshl_b32 s50,s50,9
s_add_u32 s50,s50,42074112
buffer_store_dword v105,v106,s[36:39],s50 offen sc1
g2_nr2:
s_waitcnt vmcnt(6) lgkmcnt(0)
s_barrier
ds_read_b128 v[56:59],v11 offset:0
ds_read_b128 v[60:63],v11 offset:2048
ds_read_b128 v[64:67],v11 offset:4096
ds_read_b128 v[68:71],v11 offset:6144
ds_read_b64_tr_b16 v[16:17],v1 offset:0
ds_read_b64_tr_b16 v[18:19],v1 offset:1024
ds_read_b64_tr_b16 v[20:21],v2 offset:0
ds_read_b64_tr_b16 v[22:23],v2 offset:1024
ds_read_b64_tr_b16 v[24:25],v3 offset:0
ds_read_b64_tr_b16 v[26:27],v3 offset:1024
ds_read_b64_tr_b16 v[28:29],v4 offset:0
ds_read_b64_tr_b16 v[30:31],v4 offset:1024
ds_read_b64_tr_b16 v[32:33],v5 offset:0
ds_read_b64_tr_b16 v[34:35],v5 offset:1024
ds_read_b64_tr_b16 v[36:37],v6 offset:0
ds_read_b64_tr_b16 v[38:39],v6 offset:1024
ds_read_b64_tr_b16 v[40:41],v7 offset:0
ds_read_b64_tr_b16 v[42:43],v7 offset:768
ds_read_b64_tr_b16 v[44:45],v8 offset:0
ds_read_b64_tr_b16 v[46:47],v8 offset:768
ds_read_b64_tr_b16 v[48:49],v9 offset:0
ds_read_b64_tr_b16 v[50:51],v9 offset:768
ds_read_b64_tr_b16 v[52:53],v10 offset:0
ds_read_b64_tr_b16 v[54:55],v10 offset:768
s_add_u32 m0,s54,40960
s_nop 0
buffer_load_dwordx4 v88,s[20:23],s48 offen lds
s_add_u32 m0,s54,45056
s_nop 0
buffer_load_dwordx4 v89,s[20:23],s48 offen lds
s_add_u32 m0,s54,49152
s_nop 0
buffer_load_dwordx4 v90,s[24:27],s49 offen lds
s_add_u32 m0,s54,53248
s_nop 0
buffer_load_dwordx4 v91,s[32:35],s49 offen lds
s_add_u32 m0,s54,57344
s_nop 0
buffer_load_dwordx4 v92,s[28:31],s49 offen lds
s_add_u32 s48,s48,196608
s_add_u32 s49,s49,229376
s_waitcnt lgkmcnt(15)
v_mfma_f32_16x16x32_bf16 v[96:99],v[16:19],v[56:59],0
v_mfma_f32_16x16x32_bf16 v[100:103],v[16:19],v[60:63],0
v_mfma_f32_16x16x32_bf16 v[104:107],v[16:19],v[64:67],0
v_mfma_f32_16x16x32_bf16 v[108:111],v[16:19],v[68:71],0
s_waitcnt vmcnt(6) lgkmcnt(0)
s_barrier
ds_read_b64_tr_b16 v[16:17],v1 offset:20480
v_mfma_f32_16x16x32_bf16 v[112:115],v[20:23],v[56:59],0
ds_read_b64_tr_b16 v[18:19],v1 offset:21504
v_mfma_f32_16x16x32_bf16 v[116:119],v[20:23],v[60:63],0
ds_read_b128 v[72:75],v94 offset:0
v_mfma_f32_16x16x32_bf16 v[120:123],v[20:23],v[64:67],0
ds_read_b128 v[76:79],v94 offset:2048
v_mfma_f32_16x16x32_bf16 v[124:127],v[20:23],v[68:71],0
ds_read_b64_tr_b16 v[20:21],v2 offset:20480
v_mfma_f32_16x16x32_bf16 v[128:131],v[24:27],v[56:59],0
ds_read_b64_tr_b16 v[22:23],v2 offset:21504
v_mfma_f32_16x16x32_bf16 v[132:135],v[24:27],v[60:63],0
ds_read_b128 v[80:83],v94 offset:4096
v_mfma_f32_16x16x32_bf16 v[136:139],v[24:27],v[64:67],0
ds_read_b128 v[84:87],v94 offset:6144
v_mfma_f32_16x16x32_bf16 v[140:143],v[24:27],v[68:71],0
ds_read_b64_tr_b16 v[24:25],v3 offset:20480
v_mfma_f32_16x16x32_bf16 v[144:147],v[28:31],v[56:59],0
ds_read_b64_tr_b16 v[26:27],v3 offset:21504
v_mfma_f32_16x16x32_bf16 v[148:151],v[28:31],v[60:63],0
s_add_u32 m0,s54,61440
s_nop 0
buffer_load_dwordx4 v88,s[20:23],s48 offen lds
v_mfma_f32_16x16x32_bf16 v[152:155],v[28:31],v[64:67],0
s_add_u32 m0,s54,65536
s_nop 0
buffer_load_dwordx4 v89,s[20:23],s48 offen lds
v_mfma_f32_16x16x32_bf16 v[156:159],v[28:31],v[68:71],0
ds_read_b64_tr_b16 v[28:29],v4 offset:20480
v_mfma_f32_16x16x32_bf16 v[160:163],v[32:35],v[56:59],0
ds_read_b64_tr_b16 v[30:31],v4 offset:21504
v_mfma_f32_16x16x32_bf16 v[164:167],v[32:35],v[60:63],0
s_add_u32 m0,s54,69632
s_nop 0
buffer_load_dwordx4 v90,s[24:27],s49 offen lds
v_mfma_f32_16x16x32_bf16 v[168:171],v[32:35],v[64:67],0
s_add_u32 m0,s54,73728
s_nop 0
buffer_load_dwordx4 v91,s[32:35],s49 offen lds
v_mfma_f32_16x16x32_bf16 v[172:175],v[32:35],v[68:71],0
ds_read_b64_tr_b16 v[32:33],v5 offset:20480
v_mfma_f32_16x16x32_bf16 v[176:179],v[36:39],v[56:59],0
ds_read_b64_tr_b16 v[34:35],v5 offset:21504
v_mfma_f32_16x16x32_bf16 v[180:183],v[36:39],v[60:63],0
s_add_u32 m0,s54,77824
s_nop 0
buffer_load_dwordx4 v92,s[28:31],s49 offen lds
s_and_b32 s50,s64,7
s_lshr_b32 s64,s64,4
s_mul_i32 s48,s50,786432
s_add_u32 s48,s48,s65
s_mul_i32 s49,s50,917504
s_add_u32 s49,s49,s66
v_mfma_f32_16x16x32_bf16 v[184:187],v[36:39],v[64:67],0
s_add_u32 m0,s54,0
s_nop 0
buffer_load_dwordx4 v88,s[20:23],s48 offen lds
v_mfma_f32_16x16x32_bf16 v[188:191],v[36:39],v[68:71],0
ds_read_b64_tr_b16 v[36:37],v6 offset:20480
v_mfma_f32_16x16x32_bf16 v[192:195],v[40:43],v[56:59],0
ds_read_b64_tr_b16 v[38:39],v6 offset:21504
v_mfma_f32_16x16x32_bf16 v[196:199],v[40:43],v[60:63],0
s_add_u32 m0,s54,4096
s_nop 0
buffer_load_dwordx4 v89,s[20:23],s48 offen lds
v_mfma_f32_16x16x32_bf16 v[200:203],v[40:43],v[64:67],0
s_add_u32 m0,s54,8192
s_nop 0
buffer_load_dwordx4 v90,s[24:27],s49 offen lds
v_mfma_f32_16x16x32_bf16 v[204:207],v[40:43],v[68:71],0
ds_read_b64_tr_b16 v[40:41],v7 offset:20480
v_mfma_f32_16x16x32_bf16 v[208:211],v[44:47],v[56:59],0
ds_read_b64_tr_b16 v[42:43],v7 offset:21248
v_mfma_f32_16x16x32_bf16 v[212:215],v[44:47],v[60:63],0
s_add_u32 m0,s54,12288
s_nop 0
buffer_load_dwordx4 v91,s[32:35],s49 offen lds
v_mfma_f32_16x16x32_bf16 v[216:219],v[44:47],v[64:67],0
s_add_u32 m0,s54,16384
s_nop 0
buffer_load_dwordx4 v92,s[28:31],s49 offen lds
s_add_u32 s48,s48,196608
s_add_u32 s49,s49,229376
v_mfma_f32_16x16x32_bf16 v[220:223],v[44:47],v[68:71],0
ds_read_b64_tr_b16 v[44:45],v8 offset:20480
v_mfma_f32_16x16x32_bf16 v[224:227],v[48:51],v[56:59],0
ds_read_b64_tr_b16 v[46:47],v8 offset:21248
v_mfma_f32_16x16x32_bf16 v[228:231],v[48:51],v[60:63],0
v_mfma_f32_16x16x32_bf16 v[232:235],v[48:51],v[64:67],0
v_mfma_f32_16x16x32_bf16 v[236:239],v[48:51],v[68:71],0
ds_read_b64_tr_b16 v[48:49],v9 offset:20480
v_mfma_f32_16x16x32_bf16 v[240:243],v[52:55],v[56:59],0
ds_read_b64_tr_b16 v[50:51],v9 offset:21248
v_mfma_f32_16x16x32_bf16 v[244:247],v[52:55],v[60:63],0
v_mfma_f32_16x16x32_bf16 v[248:251],v[52:55],v[64:67],0
v_mfma_f32_16x16x32_bf16 v[252:255],v[52:55],v[68:71],0
ds_read_b64_tr_b16 v[52:53],v10 offset:20480
ds_read_b64_tr_b16 v[54:55],v10 offset:21248
s_waitcnt lgkmcnt(15)
v_mfma_f32_16x16x32_bf16 v[96:99],v[16:19],v[72:75],v[96:99]
v_mfma_f32_16x16x32_bf16 v[100:103],v[16:19],v[76:79],v[100:103]
v_mfma_f32_16x16x32_bf16 v[104:107],v[16:19],v[80:83],v[104:107]
v_mfma_f32_16x16x32_bf16 v[108:111],v[16:19],v[84:87],v[108:111]
s_waitcnt vmcnt(10) lgkmcnt(0)
s_barrier
ds_read_b64_tr_b16 v[16:17],v1 offset:40960
v_mfma_f32_16x16x32_bf16 v[112:115],v[20:23],v[72:75],v[112:115]
ds_read_b64_tr_b16 v[18:19],v1 offset:41984
v_mfma_f32_16x16x32_bf16 v[116:119],v[20:23],v[76:79],v[116:119]
ds_read_b128 v[56:59],v11 offset:32768
v_mfma_f32_16x16x32_bf16 v[120:123],v[20:23],v[80:83],v[120:123]
ds_read_b128 v[60:63],v11 offset:34816
v_mfma_f32_16x16x32_bf16 v[124:127],v[20:23],v[84:87],v[124:127]
ds_read_b64_tr_b16 v[20:21],v2 offset:40960
v_mfma_f32_16x16x32_bf16 v[128:131],v[24:27],v[72:75],v[128:131]
ds_read_b64_tr_b16 v[22:23],v2 offset:41984
v_mfma_f32_16x16x32_bf16 v[132:135],v[24:27],v[76:79],v[132:135]
ds_read_b128 v[64:67],v11 offset:36864
v_mfma_f32_16x16x32_bf16 v[136:139],v[24:27],v[80:83],v[136:139]
ds_read_b128 v[68:71],v11 offset:38912
v_mfma_f32_16x16x32_bf16 v[140:143],v[24:27],v[84:87],v[140:143]
ds_read_b64_tr_b16 v[24:25],v3 offset:40960
v_mfma_f32_16x16x32_bf16 v[144:147],v[28:31],v[72:75],v[144:147]
ds_read_b64_tr_b16 v[26:27],v3 offset:41984
v_mfma_f32_16x16x32_bf16 v[148:151],v[28:31],v[76:79],v[148:151]
s_add_u32 m0,s54,20480
s_nop 0
buffer_load_dwordx4 v88,s[20:23],s48 offen lds
v_mfma_f32_16x16x32_bf16 v[152:155],v[28:31],v[80:83],v[152:155]
v_mfma_f32_16x16x32_bf16 v[156:159],v[28:31],v[84:87],v[156:159]
ds_read_b64_tr_b16 v[28:29],v4 offset:40960
v_mfma_f32_16x16x32_bf16 v[160:163],v[32:35],v[72:75],v[160:163]
ds_read_b64_tr_b16 v[30:31],v4 offset:41984
v_mfma_f32_16x16x32_bf16 v[164:167],v[32:35],v[76:79],v[164:167]
s_add_u32 m0,s54,24576
s_nop 0
buffer_load_dwordx4 v89,s[20:23],s48 offen lds
v_mfma_f32_16x16x32_bf16 v[168:171],v[32:35],v[80:83],v[168:171]
v_mfma_f32_16x16x32_bf16 v[172:175],v[32:35],v[84:87],v[172:175]
ds_read_b64_tr_b16 v[32:33],v5 offset:40960
v_mfma_f32_16x16x32_bf16 v[176:179],v[36:39],v[72:75],v[176:179]
ds_read_b64_tr_b16 v[34:35],v5 offset:41984
v_mfma_f32_16x16x32_bf16 v[180:183],v[36:39],v[76:79],v[180:183]
s_add_u32 m0,s54,28672
s_nop 0
buffer_load_dwordx4 v90,s[24:27],s49 offen lds
v_mfma_f32_16x16x32_bf16 v[184:187],v[36:39],v[80:83],v[184:187]
v_mfma_f32_16x16x32_bf16 v[188:191],v[36:39],v[84:87],v[188:191]
ds_read_b64_tr_b16 v[36:37],v6 offset:40960
v_mfma_f32_16x16x32_bf16 v[192:195],v[40:43],v[72:75],v[192:195]
ds_read_b64_tr_b16 v[38:39],v6 offset:41984
v_mfma_f32_16x16x32_bf16 v[196:199],v[40:43],v[76:79],v[196:199]
s_add_u32 m0,s54,32768
s_nop 0
buffer_load_dwordx4 v91,s[32:35],s49 offen lds
v_mfma_f32_16x16x32_bf16 v[200:203],v[40:43],v[80:83],v[200:203]
v_mfma_f32_16x16x32_bf16 v[204:207],v[40:43],v[84:87],v[204:207]
ds_read_b64_tr_b16 v[40:41],v7 offset:40960
v_mfma_f32_16x16x32_bf16 v[208:211],v[44:47],v[72:75],v[208:211]
ds_read_b64_tr_b16 v[42:43],v7 offset:41728
v_mfma_f32_16x16x32_bf16 v[212:215],v[44:47],v[76:79],v[212:215]
s_add_u32 m0,s54,36864
s_nop 0
buffer_load_dwordx4 v92,s[28:31],s49 offen lds
s_add_u32 s48,s48,196608
s_add_u32 s49,s49,229376
v_mfma_f32_16x16x32_bf16 v[216:219],v[44:47],v[80:83],v[216:219]
v_mfma_f32_16x16x32_bf16 v[220:223],v[44:47],v[84:87],v[220:223]
ds_read_b64_tr_b16 v[44:45],v8 offset:40960
v_mfma_f32_16x16x32_bf16 v[224:227],v[48:51],v[72:75],v[224:227]
ds_read_b64_tr_b16 v[46:47],v8 offset:41728
v_mfma_f32_16x16x32_bf16 v[228:231],v[48:51],v[76:79],v[228:231]
v_mfma_f32_16x16x32_bf16 v[232:235],v[48:51],v[80:83],v[232:235]
v_mfma_f32_16x16x32_bf16 v[236:239],v[48:51],v[84:87],v[236:239]
ds_read_b64_tr_b16 v[48:49],v9 offset:40960
v_mfma_f32_16x16x32_bf16 v[240:243],v[52:55],v[72:75],v[240:243]
ds_read_b64_tr_b16 v[50:51],v9 offset:41728
v_mfma_f32_16x16x32_bf16 v[244:247],v[52:55],v[76:79],v[244:247]
v_mfma_f32_16x16x32_bf16 v[248:251],v[52:55],v[80:83],v[248:251]
v_mfma_f32_16x16x32_bf16 v[252:255],v[52:55],v[84:87],v[252:255]
ds_read_b64_tr_b16 v[52:53],v10 offset:40960
ds_read_b64_tr_b16 v[54:55],v10 offset:41728
s_waitcnt lgkmcnt(15)
v_mfma_f32_16x16x32_bf16 v[96:99],v[16:19],v[56:59],v[96:99]
v_mfma_f32_16x16x32_bf16 v[100:103],v[16:19],v[60:63],v[100:103]
v_mfma_f32_16x16x32_bf16 v[104:107],v[16:19],v[64:67],v[104:107]
v_mfma_f32_16x16x32_bf16 v[108:111],v[16:19],v[68:71],v[108:111]
s_waitcnt vmcnt(10) lgkmcnt(0)
s_barrier
ds_read_b64_tr_b16 v[16:17],v1 offset:61440
v_mfma_f32_16x16x32_bf16 v[112:115],v[20:23],v[56:59],v[112:115]
ds_read_b64_tr_b16 v[18:19],v1 offset:62464
v_mfma_f32_16x16x32_bf16 v[116:119],v[20:23],v[60:63],v[116:119]
ds_read_b128 v[72:75],v94 offset:32768
v_mfma_f32_16x16x32_bf16 v[120:123],v[20:23],v[64:67],v[120:123]
ds_read_b128 v[76:79],v94 offset:34816
v_mfma_f32_16x16x32_bf16 v[124:127],v[20:23],v[68:71],v[124:127]
ds_read_b64_tr_b16 v[20:21],v2 offset:61440
v_mfma_f32_16x16x32_bf16 v[128:131],v[24:27],v[56:59],v[128:131]
ds_read_b64_tr_b16 v[22:23],v2 offset:62464
v_mfma_f32_16x16x32_bf16 v[132:135],v[24:27],v[60:63],v[132:135]
ds_read_b128 v[80:83],v94 offset:36864
v_mfma_f32_16x16x32_bf16 v[136:139],v[24:27],v[64:67],v[136:139]
ds_read_b128 v[84:87],v94 offset:38912
v_mfma_f32_16x16x32_bf16 v[140:143],v[24:27],v[68:71],v[140:143]
ds_read_b64_tr_b16 v[24:25],v3 offset:61440
v_mfma_f32_16x16x32_bf16 v[144:147],v[28:31],v[56:59],v[144:147]
ds_read_b64_tr_b16 v[26:27],v3 offset:62464
v_mfma_f32_16x16x32_bf16 v[148:151],v[28:31],v[60:63],v[148:151]
s_add_u32 m0,s54,40960
s_nop 0
buffer_load_dwordx4 v88,s[20:23],s48 offen lds
v_mfma_f32_16x16x32_bf16 v[152:155],v[28:31],v[64:67],v[152:155]
v_mfma_f32_16x16x32_bf16 v[156:159],v[28:31],v[68:71],v[156:159]
ds_read_b64_tr_b16 v[28:29],v4 offset:61440
v_mfma_f32_16x16x32_bf16 v[160:163],v[32:35],v[56:59],v[160:163]
ds_read_b64_tr_b16 v[30:31],v4 offset:62464
v_mfma_f32_16x16x32_bf16 v[164:167],v[32:35],v[60:63],v[164:167]
s_add_u32 m0,s54,45056
s_nop 0
buffer_load_dwordx4 v89,s[20:23],s48 offen lds
v_mfma_f32_16x16x32_bf16 v[168:171],v[32:35],v[64:67],v[168:171]
v_mfma_f32_16x16x32_bf16 v[172:175],v[32:35],v[68:71],v[172:175]
ds_read_b64_tr_b16 v[32:33],v5 offset:61440
v_mfma_f32_16x16x32_bf16 v[176:179],v[36:39],v[56:59],v[176:179]
ds_read_b64_tr_b16 v[34:35],v5 offset:62464
v_mfma_f32_16x16x32_bf16 v[180:183],v[36:39],v[60:63],v[180:183]
s_add_u32 m0,s54,49152
s_nop 0
buffer_load_dwordx4 v90,s[24:27],s49 offen lds
v_mfma_f32_16x16x32_bf16 v[184:187],v[36:39],v[64:67],v[184:187]
v_mfma_f32_16x16x32_bf16 v[188:191],v[36:39],v[68:71],v[188:191]
ds_read_b64_tr_b16 v[36:37],v6 offset:61440
v_mfma_f32_16x16x32_bf16 v[192:195],v[40:43],v[56:59],v[192:195]
ds_read_b64_tr_b16 v[38:39],v6 offset:62464
v_mfma_f32_16x16x32_bf16 v[196:199],v[40:43],v[60:63],v[196:199]
s_add_u32 m0,s54,53248
s_nop 0
buffer_load_dwordx4 v91,s[32:35],s49 offen lds
v_mfma_f32_16x16x32_bf16 v[200:203],v[40:43],v[64:67],v[200:203]
v_mfma_f32_16x16x32_bf16 v[204:207],v[40:43],v[68:71],v[204:207]
ds_read_b64_tr_b16 v[40:41],v7 offset:61440
v_mfma_f32_16x16x32_bf16 v[208:211],v[44:47],v[56:59],v[208:211]
ds_read_b64_tr_b16 v[42:43],v7 offset:62208
v_mfma_f32_16x16x32_bf16 v[212:215],v[44:47],v[60:63],v[212:215]
s_add_u32 m0,s54,57344
s_nop 0
buffer_load_dwordx4 v92,s[28:31],s49 offen lds
s_add_u32 s48,s48,196608
s_add_u32 s49,s49,229376
v_mfma_f32_16x16x32_bf16 v[216:219],v[44:47],v[64:67],v[216:219]
v_mfma_f32_16x16x32_bf16 v[220:223],v[44:47],v[68:71],v[220:223]
ds_read_b64_tr_b16 v[44:45],v8 offset:61440
v_mfma_f32_16x16x32_bf16 v[224:227],v[48:51],v[56:59],v[224:227]
ds_read_b64_tr_b16 v[46:47],v8 offset:62208
v_mfma_f32_16x16x32_bf16 v[228:231],v[48:51],v[60:63],v[228:231]
v_mfma_f32_16x16x32_bf16 v[232:235],v[48:51],v[64:67],v[232:235]
v_mfma_f32_16x16x32_bf16 v[236:239],v[48:51],v[68:71],v[236:239]
ds_read_b64_tr_b16 v[48:49],v9 offset:61440
v_mfma_f32_16x16x32_bf16 v[240:243],v[52:55],v[56:59],v[240:243]
ds_read_b64_tr_b16 v[50:51],v9 offset:62208
v_mfma_f32_16x16x32_bf16 v[244:247],v[52:55],v[60:63],v[244:247]
v_mfma_f32_16x16x32_bf16 v[248:251],v[52:55],v[64:67],v[248:251]
v_mfma_f32_16x16x32_bf16 v[252:255],v[52:55],v[68:71],v[252:255]
ds_read_b64_tr_b16 v[52:53],v10 offset:61440
ds_read_b64_tr_b16 v[54:55],v10 offset:62208
s_waitcnt lgkmcnt(15)
v_mfma_f32_16x16x32_bf16 v[96:99],v[16:19],v[72:75],v[96:99]
v_mfma_f32_16x16x32_bf16 v[100:103],v[16:19],v[76:79],v[100:103]
v_mfma_f32_16x16x32_bf16 v[104:107],v[16:19],v[80:83],v[104:107]
v_mfma_f32_16x16x32_bf16 v[108:111],v[16:19],v[84:87],v[108:111]
s_waitcnt vmcnt(10) lgkmcnt(0)
s_barrier
ds_read_b64_tr_b16 v[16:17],v1 offset:0
v_mfma_f32_16x16x32_bf16 v[112:115],v[20:23],v[72:75],v[112:115]
ds_read_b64_tr_b16 v[18:19],v1 offset:1024
v_mfma_f32_16x16x32_bf16 v[116:119],v[20:23],v[76:79],v[116:119]
ds_read_b128 v[56:59],v11 offset:0
v_mfma_f32_16x16x32_bf16 v[120:123],v[20:23],v[80:83],v[120:123]
ds_read_b128 v[60:63],v11 offset:2048
v_mfma_f32_16x16x32_bf16 v[124:127],v[20:23],v[84:87],v[124:127]
ds_read_b64_tr_b16 v[20:21],v2 offset:0
v_mfma_f32_16x16x32_bf16 v[128:131],v[24:27],v[72:75],v[128:131]
ds_read_b64_tr_b16 v[22:23],v2 offset:1024
v_mfma_f32_16x16x32_bf16 v[132:135],v[24:27],v[76:79],v[132:135]
ds_read_b128 v[64:67],v11 offset:4096
v_mfma_f32_16x16x32_bf16 v[136:139],v[24:27],v[80:83],v[136:139]
ds_read_b128 v[68:71],v11 offset:6144
v_mfma_f32_16x16x32_bf16 v[140:143],v[24:27],v[84:87],v[140:143]
ds_read_b64_tr_b16 v[24:25],v3 offset:0
v_mfma_f32_16x16x32_bf16 v[144:147],v[28:31],v[72:75],v[144:147]
ds_read_b64_tr_b16 v[26:27],v3 offset:1024
v_mfma_f32_16x16x32_bf16 v[148:151],v[28:31],v[76:79],v[148:151]
s_add_u32 m0,s54,61440
s_nop 0
buffer_load_dwordx4 v88,s[20:23],s48 offen lds
v_mfma_f32_16x16x32_bf16 v[152:155],v[28:31],v[80:83],v[152:155]
v_mfma_f32_16x16x32_bf16 v[156:159],v[28:31],v[84:87],v[156:159]
ds_read_b64_tr_b16 v[28:29],v4 offset:0
v_mfma_f32_16x16x32_bf16 v[160:163],v[32:35],v[72:75],v[160:163]
ds_read_b64_tr_b16 v[30:31],v4 offset:1024
v_mfma_f32_16x16x32_bf16 v[164:167],v[32:35],v[76:79],v[164:167]
s_add_u32 m0,s54,65536
s_nop 0
buffer_load_dwordx4 v89,s[20:23],s48 offen lds
v_mfma_f32_16x16x32_bf16 v[168:171],v[32:35],v[80:83],v[168:171]
v_mfma_f32_16x16x32_bf16 v[172:175],v[32:35],v[84:87],v[172:175]
ds_read_b64_tr_b16 v[32:33],v5 offset:0
v_mfma_f32_16x16x32_bf16 v[176:179],v[36:39],v[72:75],v[176:179]
ds_read_b64_tr_b16 v[34:35],v5 offset:1024
v_mfma_f32_16x16x32_bf16 v[180:183],v[36:39],v[76:79],v[180:183]
s_add_u32 m0,s54,69632
s_nop 0
buffer_load_dwordx4 v90,s[24:27],s49 offen lds
v_mfma_f32_16x16x32_bf16 v[184:187],v[36:39],v[80:83],v[184:187]
v_mfma_f32_16x16x32_bf16 v[188:191],v[36:39],v[84:87],v[188:191]
ds_read_b64_tr_b16 v[36:37],v6 offset:0
v_mfma_f32_16x16x32_bf16 v[192:195],v[40:43],v[72:75],v[192:195]
ds_read_b64_tr_b16 v[38:39],v6 offset:1024
v_mfma_f32_16x16x32_bf16 v[196:199],v[40:43],v[76:79],v[196:199]
s_add_u32 m0,s54,73728
s_nop 0
buffer_load_dwordx4 v91,s[32:35],s49 offen lds
v_mfma_f32_16x16x32_bf16 v[200:203],v[40:43],v[80:83],v[200:203]
v_mfma_f32_16x16x32_bf16 v[204:207],v[40:43],v[84:87],v[204:207]
ds_read_b64_tr_b16 v[40:41],v7 offset:0
v_mfma_f32_16x16x32_bf16 v[208:211],v[44:47],v[72:75],v[208:211]
ds_read_b64_tr_b16 v[42:43],v7 offset:768
v_mfma_f32_16x16x32_bf16 v[212:215],v[44:47],v[76:79],v[212:215]
s_add_u32 m0,s54,77824
s_nop 0
buffer_load_dwordx4 v92,s[28:31],s49 offen lds
s_and_b32 s50,s64,7
s_lshr_b32 s64,s64,4
s_mul_i32 s48,s50,786432
s_add_u32 s48,s48,s65
s_mul_i32 s49,s50,917504
s_add_u32 s49,s49,s66
v_mfma_f32_16x16x32_bf16 v[216:219],v[44:47],v[80:83],v[216:219]
v_mfma_f32_16x16x32_bf16 v[220:223],v[44:47],v[84:87],v[220:223]
ds_read_b64_tr_b16 v[44:45],v8 offset:0
v_mfma_f32_16x16x32_bf16 v[224:227],v[48:51],v[72:75],v[224:227]
ds_read_b64_tr_b16 v[46:47],v8 offset:768
v_mfma_f32_16x16x32_bf16 v[228:231],v[48:51],v[76:79],v[228:231]
v_mfma_f32_16x16x32_bf16 v[232:235],v[48:51],v[80:83],v[232:235]
v_mfma_f32_16x16x32_bf16 v[236:239],v[48:51],v[84:87],v[236:239]
ds_read_b64_tr_b16 v[48:49],v9 offset:0
v_mfma_f32_16x16x32_bf16 v[240:243],v[52:55],v[72:75],v[240:243]
ds_read_b64_tr_b16 v[50:51],v9 offset:768
v_mfma_f32_16x16x32_bf16 v[244:247],v[52:55],v[76:79],v[244:247]
v_mfma_f32_16x16x32_bf16 v[248:251],v[52:55],v[80:83],v[248:251]
v_mfma_f32_16x16x32_bf16 v[252:255],v[52:55],v[84:87],v[252:255]
ds_read_b64_tr_b16 v[52:53],v10 offset:0
ds_read_b64_tr_b16 v[54:55],v10 offset:768
s_mov_b32 s53,6
.p2align 6
g2_loop2:
s_cmp_eq_u32 s53,s67
s_cbranch_scc1 g2_sp2
s_waitcnt lgkmcnt(15)
v_mfma_f32_16x16x32_bf16 v[96:99],v[16:19],v[56:59],v[96:99]
v_mfma_f32_16x16x32_bf16 v[100:103],v[16:19],v[60:63],v[100:103]
v_mfma_f32_16x16x32_bf16 v[104:107],v[16:19],v[64:67],v[104:107]
v_mfma_f32_16x16x32_bf16 v[108:111],v[16:19],v[68:71],v[108:111]
s_waitcnt vmcnt(10) lgkmcnt(0)
s_barrier
s_cmp_eq_u32 s53,s96
s_cbranch_scc1 g2_pub2
g2_pubr2:
ds_read_b64_tr_b16 v[16:17],v1 offset:20480
v_mfma_f32_16x16x32_bf16 v[112:115],v[20:23],v[56:59],v[112:115]
ds_read_b64_tr_b16 v[18:19],v1 offset:21504
v_mfma_f32_16x16x32_bf16 v[116:119],v[20:23],v[60:63],v[116:119]
ds_read_b128 v[72:75],v94 offset:0
v_mfma_f32_16x16x32_bf16 v[120:123],v[20:23],v[64:67],v[120:123]
ds_read_b128 v[76:79],v94 offset:2048
v_mfma_f32_16x16x32_bf16 v[124:127],v[20:23],v[68:71],v[124:127]
ds_read_b64_tr_b16 v[20:21],v2 offset:20480
v_mfma_f32_16x16x32_bf16 v[128:131],v[24:27],v[56:59],v[128:131]
ds_read_b64_tr_b16 v[22:23],v2 offset:21504
v_mfma_f32_16x16x32_bf16 v[132:135],v[24:27],v[60:63],v[132:135]
ds_read_b128 v[80:83],v94 offset:4096
v_mfma_f32_16x16x32_bf16 v[136:139],v[24:27],v[64:67],v[136:139]
ds_read_b128 v[84:87],v94 offset:6144
v_mfma_f32_16x16x32_bf16 v[140:143],v[24:27],v[68:71],v[140:143]
ds_read_b64_tr_b16 v[24:25],v3 offset:20480
v_mfma_f32_16x16x32_bf16 v[144:147],v[28:31],v[56:59],v[144:147]
ds_read_b64_tr_b16 v[26:27],v3 offset:21504
v_mfma_f32_16x16x32_bf16 v[148:151],v[28:31],v[60:63],v[148:151]
s_add_u32 m0,s54,0
s_nop 0
buffer_load_dwordx4 v88,s[20:23],s48 offen lds
v_mfma_f32_16x16x32_bf16 v[152:155],v[28:31],v[64:67],v[152:155]
v_mfma_f32_16x16x32_bf16 v[156:159],v[28:31],v[68:71],v[156:159]
ds_read_b64_tr_b16 v[28:29],v4 offset:20480
v_mfma_f32_16x16x32_bf16 v[160:163],v[32:35],v[56:59],v[160:163]
ds_read_b64_tr_b16 v[30:31],v4 offset:21504
v_mfma_f32_16x16x32_bf16 v[164:167],v[32:35],v[60:63],v[164:167]
s_add_u32 m0,s54,4096
s_nop 0
buffer_load_dwordx4 v89,s[20:23],s48 offen lds
v_mfma_f32_16x16x32_bf16 v[168:171],v[32:35],v[64:67],v[168:171]
v_mfma_f32_16x16x32_bf16 v[172:175],v[32:35],v[68:71],v[172:175]
ds_read_b64_tr_b16 v[32:33],v5 offset:20480
v_mfma_f32_16x16x32_bf16 v[176:179],v[36:39],v[56:59],v[176:179]
ds_read_b64_tr_b16 v[34:35],v5 offset:21504
v_mfma_f32_16x16x32_bf16 v[180:183],v[36:39],v[60:63],v[180:183]
s_add_u32 m0,s54,8192
s_nop 0
buffer_load_dwordx4 v90,s[24:27],s49 offen lds
v_mfma_f32_16x16x32_bf16 v[184:187],v[36:39],v[64:67],v[184:187]
v_mfma_f32_16x16x32_bf16 v[188:191],v[36:39],v[68:71],v[188:191]
ds_read_b64_tr_b16 v[36:37],v6 offset:20480
v_mfma_f32_16x16x32_bf16 v[192:195],v[40:43],v[56:59],v[192:195]
ds_read_b64_tr_b16 v[38:39],v6 offset:21504
v_mfma_f32_16x16x32_bf16 v[196:199],v[40:43],v[60:63],v[196:199]
s_add_u32 m0,s54,12288
s_nop 0
buffer_load_dwordx4 v91,s[32:35],s49 offen lds
v_mfma_f32_16x16x32_bf16 v[200:203],v[40:43],v[64:67],v[200:203]
v_mfma_f32_16x16x32_bf16 v[204:207],v[40:43],v[68:71],v[204:207]
ds_read_b64_tr_b16 v[40:41],v7 offset:20480
v_mfma_f32_16x16x32_bf16 v[208:211],v[44:47],v[56:59],v[208:211]
ds_read_b64_tr_b16 v[42:43],v7 offset:21248
v_mfma_f32_16x16x32_bf16 v[212:215],v[44:47],v[60:63],v[212:215]
s_add_u32 m0,s54,16384
s_nop 0
buffer_load_dwordx4 v92,s[28:31],s49 offen lds
s_add_u32 s48,s48,196608
s_add_u32 s49,s49,229376
v_mfma_f32_16x16x32_bf16 v[216:219],v[44:47],v[64:67],v[216:219]
v_mfma_f32_16x16x32_bf16 v[220:223],v[44:47],v[68:71],v[220:223]
ds_read_b64_tr_b16 v[44:45],v8 offset:20480
v_mfma_f32_16x16x32_bf16 v[224:227],v[48:51],v[56:59],v[224:227]
ds_read_b64_tr_b16 v[46:47],v8 offset:21248
v_mfma_f32_16x16x32_bf16 v[228:231],v[48:51],v[60:63],v[228:231]
v_mfma_f32_16x16x32_bf16 v[232:235],v[48:51],v[64:67],v[232:235]
v_mfma_f32_16x16x32_bf16 v[236:239],v[48:51],v[68:71],v[236:239]
ds_read_b64_tr_b16 v[48:49],v9 offset:20480
v_mfma_f32_16x16x32_bf16 v[240:243],v[52:55],v[56:59],v[240:243]
ds_read_b64_tr_b16 v[50:51],v9 offset:21248
v_mfma_f32_16x16x32_bf16 v[244:247],v[52:55],v[60:63],v[244:247]
v_mfma_f32_16x16x32_bf16 v[248:251],v[52:55],v[64:67],v[248:251]
v_mfma_f32_16x16x32_bf16 v[252:255],v[52:55],v[68:71],v[252:255]
ds_read_b64_tr_b16 v[52:53],v10 offset:20480
ds_read_b64_tr_b16 v[54:55],v10 offset:21248
s_waitcnt lgkmcnt(15)
v_mfma_f32_16x16x32_bf16 v[96:99],v[16:19],v[72:75],v[96:99]
v_mfma_f32_16x16x32_bf16 v[100:103],v[16:19],v[76:79],v[100:103]
v_mfma_f32_16x16x32_bf16 v[104:107],v[16:19],v[80:83],v[104:107]
v_mfma_f32_16x16x32_bf16 v[108:111],v[16:19],v[84:87],v[108:111]
s_waitcnt vmcnt(10) lgkmcnt(0)
s_barrier
ds_read_b64_tr_b16 v[16:17],v1 offset:40960
v_mfma_f32_16x16x32_bf16 v[112:115],v[20:23],v[72:75],v[112:115]
ds_read_b64_tr_b16 v[18:19],v1 offset:41984
v_mfma_f32_16x16x32_bf16 v[116:119],v[20:23],v[76:79],v[116:119]
ds_read_b128 v[56:59],v11 offset:32768
v_mfma_f32_16x16x32_bf16 v[120:123],v[20:23],v[80:83],v[120:123]
ds_read_b128 v[60:63],v11 offset:34816
v_mfma_f32_16x16x32_bf16 v[124:127],v[20:23],v[84:87],v[124:127]
ds_read_b64_tr_b16 v[20:21],v2 offset:40960
v_mfma_f32_16x16x32_bf16 v[128:131],v[24:27],v[72:75],v[128:131]
ds_read_b64_tr_b16 v[22:23],v2 offset:41984
v_mfma_f32_16x16x32_bf16 v[132:135],v[24:27],v[76:79],v[132:135]
ds_read_b128 v[64:67],v11 offset:36864
v_mfma_f32_16x16x32_bf16 v[136:139],v[24:27],v[80:83],v[136:139]
ds_read_b128 v[68:71],v11 offset:38912
v_mfma_f32_16x16x32_bf16 v[140:143],v[24:27],v[84:87],v[140:143]
ds_read_b64_tr_b16 v[24:25],v3 offset:40960
v_mfma_f32_16x16x32_bf16 v[144:147],v[28:31],v[72:75],v[144:147]
ds_read_b64_tr_b16 v[26:27],v3 offset:41984
v_mfma_f32_16x16x32_bf16 v[148:151],v[28:31],v[76:79],v[148:151]
s_add_u32 m0,s54,20480
s_nop 0
buffer_load_dwordx4 v88,s[20:23],s48 offen lds
v_mfma_f32_16x16x32_bf16 v[152:155],v[28:31],v[80:83],v[152:155]
v_mfma_f32_16x16x32_bf16 v[156:159],v[28:31],v[84:87],v[156:159]
ds_read_b64_tr_b16 v[28:29],v4 offset:40960
v_mfma_f32_16x16x32_bf16 v[160:163],v[32:35],v[72:75],v[160:163]
ds_read_b64_tr_b16 v[30:31],v4 offset:41984
v_mfma_f32_16x16x32_bf16 v[164:167],v[32:35],v[76:79],v[164:167]
s_add_u32 m0,s54,24576
s_nop 0
buffer_load_dwordx4 v89,s[20:23],s48 offen lds
v_mfma_f32_16x16x32_bf16 v[168:171],v[32:35],v[80:83],v[168:171]
v_mfma_f32_16x16x32_bf16 v[172:175],v[32:35],v[84:87],v[172:175]
ds_read_b64_tr_b16 v[32:33],v5 offset:40960
v_mfma_f32_16x16x32_bf16 v[176:179],v[36:39],v[72:75],v[176:179]
ds_read_b64_tr_b16 v[34:35],v5 offset:41984
v_mfma_f32_16x16x32_bf16 v[180:183],v[36:39],v[76:79],v[180:183]
s_add_u32 m0,s54,28672
s_nop 0
buffer_load_dwordx4 v90,s[24:27],s49 offen lds
v_mfma_f32_16x16x32_bf16 v[184:187],v[36:39],v[80:83],v[184:187]
v_mfma_f32_16x16x32_bf16 v[188:191],v[36:39],v[84:87],v[188:191]
ds_read_b64_tr_b16 v[36:37],v6 offset:40960
v_mfma_f32_16x16x32_bf16 v[192:195],v[40:43],v[72:75],v[192:195]
ds_read_b64_tr_b16 v[38:39],v6 offset:41984
v_mfma_f32_16x16x32_bf16 v[196:199],v[40:43],v[76:79],v[196:199]
s_add_u32 m0,s54,32768
s_nop 0
buffer_load_dwordx4 v91,s[32:35],s49 offen lds
v_mfma_f32_16x16x32_bf16 v[200:203],v[40:43],v[80:83],v[200:203]
v_mfma_f32_16x16x32_bf16 v[204:207],v[40:43],v[84:87],v[204:207]
ds_read_b64_tr_b16 v[40:41],v7 offset:40960
v_mfma_f32_16x16x32_bf16 v[208:211],v[44:47],v[72:75],v[208:211]
ds_read_b64_tr_b16 v[42:43],v7 offset:41728
v_mfma_f32_16x16x32_bf16 v[212:215],v[44:47],v[76:79],v[212:215]
s_add_u32 m0,s54,36864
s_nop 0
buffer_load_dwordx4 v92,s[28:31],s49 offen lds
s_add_u32 s48,s48,196608
s_add_u32 s49,s49,229376
v_mfma_f32_16x16x32_bf16 v[216:219],v[44:47],v[80:83],v[216:219]
v_mfma_f32_16x16x32_bf16 v[220:223],v[44:47],v[84:87],v[220:223]
ds_read_b64_tr_b16 v[44:45],v8 offset:40960
v_mfma_f32_16x16x32_bf16 v[224:227],v[48:51],v[72:75],v[224:227]
ds_read_b64_tr_b16 v[46:47],v8 offset:41728
v_mfma_f32_16x16x32_bf16 v[228:231],v[48:51],v[76:79],v[228:231]
v_mfma_f32_16x16x32_bf16 v[232:235],v[48:51],v[80:83],v[232:235]
v_mfma_f32_16x16x32_bf16 v[236:239],v[48:51],v[84:87],v[236:239]
ds_read_b64_tr_b16 v[48:49],v9 offset:40960
v_mfma_f32_16x16x32_bf16 v[240:243],v[52:55],v[72:75],v[240:243]
ds_read_b64_tr_b16 v[50:51],v9 offset:41728
v_mfma_f32_16x16x32_bf16 v[244:247],v[52:55],v[76:79],v[244:247]
v_mfma_f32_16x16x32_bf16 v[248:251],v[52:55],v[80:83],v[248:251]
v_mfma_f32_16x16x32_bf16 v[252:255],v[52:55],v[84:87],v[252:255]
ds_read_b64_tr_b16 v[52:53],v10 offset:40960
ds_read_b64_tr_b16 v[54:55],v10 offset:41728
s_waitcnt lgkmcnt(15)
v_mfma_f32_16x16x32_bf16 v[96:99],v[16:19],v[56:59],v[96:99]
v_mfma_f32_16x16x32_bf16 v[100:103],v[16:19],v[60:63],v[100:103]
v_mfma_f32_16x16x32_bf16 v[104:107],v[16:19],v[64:67],v[104:107]
v_mfma_f32_16x16x32_bf16 v[108:111],v[16:19],v[68:71],v[108:111]
s_waitcnt vmcnt(10) lgkmcnt(0)
s_barrier
ds_read_b64_tr_b16 v[16:17],v1 offset:61440
v_mfma_f32_16x16x32_bf16 v[112:115],v[20:23],v[56:59],v[112:115]
ds_read_b64_tr_b16 v[18:19],v1 offset:62464
v_mfma_f32_16x16x32_bf16 v[116:119],v[20:23],v[60:63],v[116:119]
ds_read_b128 v[72:75],v94 offset:32768
v_mfma_f32_16x16x32_bf16 v[120:123],v[20:23],v[64:67],v[120:123]
ds_read_b128 v[76:79],v94 offset:34816
v_mfma_f32_16x16x32_bf16 v[124:127],v[20:23],v[68:71],v[124:127]
ds_read_b64_tr_b16 v[20:21],v2 offset:61440
v_mfma_f32_16x16x32_bf16 v[128:131],v[24:27],v[56:59],v[128:131]
ds_read_b64_tr_b16 v[22:23],v2 offset:62464
v_mfma_f32_16x16x32_bf16 v[132:135],v[24:27],v[60:63],v[132:135]
ds_read_b128 v[80:83],v94 offset:36864
v_mfma_f32_16x16x32_bf16 v[136:139],v[24:27],v[64:67],v[136:139]
ds_read_b128 v[84:87],v94 offset:38912
v_mfma_f32_16x16x32_bf16 v[140:143],v[24:27],v[68:71],v[140:143]
ds_read_b64_tr_b16 v[24:25],v3 offset:61440
v_mfma_f32_16x16x32_bf16 v[144:147],v[28:31],v[56:59],v[144:147]
ds_read_b64_tr_b16 v[26:27],v3 offset:62464
v_mfma_f32_16x16x32_bf16 v[148:151],v[28:31],v[60:63],v[148:151]
s_add_u32 m0,s54,40960
s_nop 0
buffer_load_dwordx4 v88,s[20:23],s48 offen lds
v_mfma_f32_16x16x32_bf16 v[152:155],v[28:31],v[64:67],v[152:155]
v_mfma_f32_16x16x32_bf16 v[156:159],v[28:31],v[68:71],v[156:159]
ds_read_b64_tr_b16 v[28:29],v4 offset:61440
v_mfma_f32_16x16x32_bf16 v[160:163],v[32:35],v[56:59],v[160:163]
ds_read_b64_tr_b16 v[30:31],v4 offset:62464
v_mfma_f32_16x16x32_bf16 v[164:167],v[32:35],v[60:63],v[164:167]
s_add_u32 m0,s54,45056
s_nop 0
buffer_load_dwordx4 v89,s[20:23],s48 offen lds
v_mfma_f32_16x16x32_bf16 v[168:171],v[32:35],v[64:67],v[168:171]
v_mfma_f32_16x16x32_bf16 v[172:175],v[32:35],v[68:71],v[172:175]
ds_read_b64_tr_b16 v[32:33],v5 offset:61440
v_mfma_f32_16x16x32_bf16 v[176:179],v[36:39],v[56:59],v[176:179]
ds_read_b64_tr_b16 v[34:35],v5 offset:62464
v_mfma_f32_16x16x32_bf16 v[180:183],v[36:39],v[60:63],v[180:183]
s_add_u32 m0,s54,49152
s_nop 0
buffer_load_dwordx4 v90,s[24:27],s49 offen lds
v_mfma_f32_16x16x32_bf16 v[184:187],v[36:39],v[64:67],v[184:187]
v_mfma_f32_16x16x32_bf16 v[188:191],v[36:39],v[68:71],v[188:191]
ds_read_b64_tr_b16 v[36:37],v6 offset:61440
v_mfma_f32_16x16x32_bf16 v[192:195],v[40:43],v[56:59],v[192:195]
ds_read_b64_tr_b16 v[38:39],v6 offset:62464
v_mfma_f32_16x16x32_bf16 v[196:199],v[40:43],v[60:63],v[196:199]
s_add_u32 m0,s54,53248
s_nop 0
buffer_load_dwordx4 v91,s[32:35],s49 offen lds
v_mfma_f32_16x16x32_bf16 v[200:203],v[40:43],v[64:67],v[200:203]
v_mfma_f32_16x16x32_bf16 v[204:207],v[40:43],v[68:71],v[204:207]
ds_read_b64_tr_b16 v[40:41],v7 offset:61440
v_mfma_f32_16x16x32_bf16 v[208:211],v[44:47],v[56:59],v[208:211]
ds_read_b64_tr_b16 v[42:43],v7 offset:62208
v_mfma_f32_16x16x32_bf16 v[212:215],v[44:47],v[60:63],v[212:215]
s_add_u32 m0,s54,57344
s_nop 0
buffer_load_dwordx4 v92,s[28:31],s49 offen lds
s_add_u32 s48,s48,196608
s_add_u32 s49,s49,229376
v_mfma_f32_16x16x32_bf16 v[216:219],v[44:47],v[64:67],v[216:219]
v_mfma_f32_16x16x32_bf16 v[220:223],v[44:47],v[68:71],v[220:223]
ds_read_b64_tr_b16 v[44:45],v8 offset:61440
v_mfma_f32_16x16x32_bf16 v[224:227],v[48:51],v[56:59],v[224:227]
ds_read_b64_tr_b16 v[46:47],v8 offset:62208
v_mfma_f32_16x16x32_bf16 v[228:231],v[48:51],v[60:63],v[228:231]
v_mfma_f32_16x16x32_bf16 v[232:235],v[48:51],v[64:67],v[232:235]
v_mfma_f32_16x16x32_bf16 v[236:239],v[48:51],v[68:71],v[236:239]
ds_read_b64_tr_b16 v[48:49],v9 offset:61440
v_mfma_f32_16x16x32_bf16 v[240:243],v[52:55],v[56:59],v[240:243]
ds_read_b64_tr_b16 v[50:51],v9 offset:62208
v_mfma_f32_16x16x32_bf16 v[244:247],v[52:55],v[60:63],v[244:247]
v_mfma_f32_16x16x32_bf16 v[248:251],v[52:55],v[64:67],v[248:251]
v_mfma_f32_16x16x32_bf16 v[252:255],v[52:55],v[68:71],v[252:255]
ds_read_b64_tr_b16 v[52:53],v10 offset:61440
ds_read_b64_tr_b16 v[54:55],v10 offset:62208
s_waitcnt lgkmcnt(15)
v_mfma_f32_16x16x32_bf16 v[96:99],v[16:19],v[72:75],v[96:99]
v_mfma_f32_16x16x32_bf16 v[100:103],v[16:19],v[76:79],v[100:103]
v_mfma_f32_16x16x32_bf16 v[104:107],v[16:19],v[80:83],v[104:107]
v_mfma_f32_16x16x32_bf16 v[108:111],v[16:19],v[84:87],v[108:111]
s_waitcnt vmcnt(10) lgkmcnt(0)
s_barrier
s_cmp_eq_u32 s53,s97
s_cbranch_scc1 g2_sig2
g2_sigr2:
ds_read_b64_tr_b16 v[16:17],v1 offset:0
v_mfma_f32_16x16x32_bf16 v[112:115],v[20:23],v[72:75],v[112:115]
ds_read_b64_tr_b16 v[18:19],v1 offset:1024
v_mfma_f32_16x16x32_bf16 v[116:119],v[20:23],v[76:79],v[116:119]
ds_read_b128 v[56:59],v11 offset:0
v_mfma_f32_16x16x32_bf16 v[120:123],v[20:23],v[80:83],v[120:123]
ds_read_b128 v[60:63],v11 offset:2048
v_mfma_f32_16x16x32_bf16 v[124:127],v[20:23],v[84:87],v[124:127]
ds_read_b64_tr_b16 v[20:21],v2 offset:0
v_mfma_f32_16x16x32_bf16 v[128:131],v[24:27],v[72:75],v[128:131]
ds_read_b64_tr_b16 v[22:23],v2 offset:1024
v_mfma_f32_16x16x32_bf16 v[132:135],v[24:27],v[76:79],v[132:135]
ds_read_b128 v[64:67],v11 offset:4096
v_mfma_f32_16x16x32_bf16 v[136:139],v[24:27],v[80:83],v[136:139]
ds_read_b128 v[68:71],v11 offset:6144
v_mfma_f32_16x16x32_bf16 v[140:143],v[24:27],v[84:87],v[140:143]
ds_read_b64_tr_b16 v[24:25],v3 offset:0
v_mfma_f32_16x16x32_bf16 v[144:147],v[28:31],v[72:75],v[144:147]
ds_read_b64_tr_b16 v[26:27],v3 offset:1024
v_mfma_f32_16x16x32_bf16 v[148:151],v[28:31],v[76:79],v[148:151]
s_add_u32 m0,s54,61440
s_nop 0
buffer_load_dwordx4 v88,s[20:23],s48 offen lds
v_mfma_f32_16x16x32_bf16 v[152:155],v[28:31],v[80:83],v[152:155]
v_mfma_f32_16x16x32_bf16 v[156:159],v[28:31],v[84:87],v[156:159]
ds_read_b64_tr_b16 v[28:29],v4 offset:0
v_mfma_f32_16x16x32_bf16 v[160:163],v[32:35],v[72:75],v[160:163]
ds_read_b64_tr_b16 v[30:31],v4 offset:1024
v_mfma_f32_16x16x32_bf16 v[164:167],v[32:35],v[76:79],v[164:167]
s_add_u32 m0,s54,65536
s_nop 0
buffer_load_dwordx4 v89,s[20:23],s48 offen lds
v_mfma_f32_16x16x32_bf16 v[168:171],v[32:35],v[80:83],v[168:171]
v_mfma_f32_16x16x32_bf16 v[172:175],v[32:35],v[84:87],v[172:175]
ds_read_b64_tr_b16 v[32:33],v5 offset:0
v_mfma_f32_16x16x32_bf16 v[176:179],v[36:39],v[72:75],v[176:179]
ds_read_b64_tr_b16 v[34:35],v5 offset:1024
v_mfma_f32_16x16x32_bf16 v[180:183],v[36:39],v[76:79],v[180:183]
s_add_u32 m0,s54,69632
s_nop 0
buffer_load_dwordx4 v90,s[24:27],s49 offen lds
v_mfma_f32_16x16x32_bf16 v[184:187],v[36:39],v[80:83],v[184:187]
v_mfma_f32_16x16x32_bf16 v[188:191],v[36:39],v[84:87],v[188:191]
ds_read_b64_tr_b16 v[36:37],v6 offset:0
v_mfma_f32_16x16x32_bf16 v[192:195],v[40:43],v[72:75],v[192:195]
ds_read_b64_tr_b16 v[38:39],v6 offset:1024
v_mfma_f32_16x16x32_bf16 v[196:199],v[40:43],v[76:79],v[196:199]
s_add_u32 m0,s54,73728
s_nop 0
buffer_load_dwordx4 v91,s[32:35],s49 offen lds
v_mfma_f32_16x16x32_bf16 v[200:203],v[40:43],v[80:83],v[200:203]
v_mfma_f32_16x16x32_bf16 v[204:207],v[40:43],v[84:87],v[204:207]
ds_read_b64_tr_b16 v[40:41],v7 offset:0
v_mfma_f32_16x16x32_bf16 v[208:211],v[44:47],v[72:75],v[208:211]
ds_read_b64_tr_b16 v[42:43],v7 offset:768
v_mfma_f32_16x16x32_bf16 v[212:215],v[44:47],v[76:79],v[212:215]
s_add_u32 m0,s54,77824
s_nop 0
buffer_load_dwordx4 v92,s[28:31],s49 offen lds
s_and_b32 s50,s64,7
s_lshr_b32 s64,s64,4
s_mul_i32 s48,s50,786432
s_add_u32 s48,s48,s65
s_mul_i32 s49,s50,917504
s_add_u32 s49,s49,s66
v_mfma_f32_16x16x32_bf16 v[216:219],v[44:47],v[80:83],v[216:219]
v_mfma_f32_16x16x32_bf16 v[220:223],v[44:47],v[84:87],v[220:223]
ds_read_b64_tr_b16 v[44:45],v8 offset:0
v_mfma_f32_16x16x32_bf16 v[224:227],v[48:51],v[72:75],v[224:227]
ds_read_b64_tr_b16 v[46:47],v8 offset:768
v_mfma_f32_16x16x32_bf16 v[228:231],v[48:51],v[76:79],v[228:231]
v_mfma_f32_16x16x32_bf16 v[232:235],v[48:51],v[80:83],v[232:235]
v_mfma_f32_16x16x32_bf16 v[236:239],v[48:51],v[84:87],v[236:239]
ds_read_b64_tr_b16 v[48:49],v9 offset:0
v_mfma_f32_16x16x32_bf16 v[240:243],v[52:55],v[72:75],v[240:243]
ds_read_b64_tr_b16 v[50:51],v9 offset:768
v_mfma_f32_16x16x32_bf16 v[244:247],v[52:55],v[76:79],v[244:247]
v_mfma_f32_16x16x32_bf16 v[248:251],v[52:55],v[80:83],v[248:251]
v_mfma_f32_16x16x32_bf16 v[252:255],v[52:55],v[84:87],v[252:255]
ds_read_b64_tr_b16 v[52:53],v10 offset:0
ds_read_b64_tr_b16 v[54:55],v10 offset:768
s_sub_u32 s53,s53,1
s_cmp_lg_u32 s53,0
s_cbranch_scc1 g2_loop2
s_waitcnt lgkmcnt(15)
v_mfma_f32_16x16x32_bf16 v[96:99],v[16:19],v[56:59],v[96:99]
v_mfma_f32_16x16x32_bf16 v[100:103],v[16:19],v[60:63],v[100:103]
v_mfma_f32_16x16x32_bf16 v[104:107],v[16:19],v[64:67],v[104:107]
v_mfma_f32_16x16x32_bf16 v[108:111],v[16:19],v[68:71],v[108:111]
s_waitcnt vmcnt(10) lgkmcnt(0)
s_barrier
ds_read_b64_tr_b16 v[16:17],v1 offset:20480
v_mfma_f32_16x16x32_bf16 v[112:115],v[20:23],v[56:59],v[112:115]
ds_read_b64_tr_b16 v[18:19],v1 offset:21504
v_mfma_f32_16x16x32_bf16 v[116:119],v[20:23],v[60:63],v[116:119]
ds_read_b128 v[72:75],v94 offset:0
v_mfma_f32_16x16x32_bf16 v[120:123],v[20:23],v[64:67],v[120:123]
ds_read_b128 v[76:79],v94 offset:2048
v_mfma_f32_16x16x32_bf16 v[124:127],v[20:23],v[68:71],v[124:127]
ds_read_b64_tr_b16 v[20:21],v2 offset:20480
v_mfma_f32_16x16x32_bf16 v[128:131],v[24:27],v[56:59],v[128:131]
ds_read_b64_tr_b16 v[22:23],v2 offset:21504
v_mfma_f32_16x16x32_bf16 v[132:135],v[24:27],v[60:63],v[132:135]
ds_read_b128 v[80:83],v94 offset:4096
v_mfma_f32_16x16x32_bf16 v[136:139],v[24:27],v[64:67],v[136:139]
ds_read_b128 v[84:87],v94 offset:6144
v_mfma_f32_16x16x32_bf16 v[140:143],v[24:27],v[68:71],v[140:143]
ds_read_b64_tr_b16 v[24:25],v3 offset:20480
v_mfma_f32_16x16x32_bf16 v[144:147],v[28:31],v[56:59],v[144:147]
ds_read_b64_tr_b16 v[26:27],v3 offset:21504
v_mfma_f32_16x16x32_bf16 v[148:151],v[28:31],v[60:63],v[148:151]
buffer_load_dword v93,off,s[60:63],0 sc1
v_mfma_f32_16x16x32_bf16 v[152:155],v[28:31],v[64:67],v[152:155]
v_mfma_f32_16x16x32_bf16 v[156:159],v[28:31],v[68:71],v[156:159]
ds_read_b64_tr_b16 v[28:29],v4 offset:20480
v_mfma_f32_16x16x32_bf16 v[160:163],v[32:35],v[56:59],v[160:163]
ds_read_b64_tr_b16 v[30:31],v4 offset:21504
v_mfma_f32_16x16x32_bf16 v[164:167],v[32:35],v[60:63],v[164:167]
v_mfma_f32_16x16x32_bf16 v[168:171],v[32:35],v[64:67],v[168:171]
v_mfma_f32_16x16x32_bf16 v[172:175],v[32:35],v[68:71],v[172:175]
ds_read_b64_tr_b16 v[32:33],v5 offset:20480
v_mfma_f32_16x16x32_bf16 v[176:179],v[36:39],v[56:59],v[176:179]
ds_read_b64_tr_b16 v[34:35],v5 offset:21504
v_mfma_f32_16x16x32_bf16 v[180:183],v[36:39],v[60:63],v[180:183]
v_mfma_f32_16x16x32_bf16 v[184:187],v[36:39],v[64:67],v[184:187]
v_mfma_f32_16x16x32_bf16 v[188:191],v[36:39],v[68:71],v[188:191]
ds_read_b64_tr_b16 v[36:37],v6 offset:20480
v_mfma_f32_16x16x32_bf16 v[192:195],v[40:43],v[56:59],v[192:195]
ds_read_b64_tr_b16 v[38:39],v6 offset:21504
v_mfma_f32_16x16x32_bf16 v[196:199],v[40:43],v[60:63],v[196:199]
v_mfma_f32_16x16x32_bf16 v[200:203],v[40:43],v[64:67],v[200:203]
v_mfma_f32_16x16x32_bf16 v[204:207],v[40:43],v[68:71],v[204:207]
ds_read_b64_tr_b16 v[40:41],v7 offset:20480
v_mfma_f32_16x16x32_bf16 v[208:211],v[44:47],v[56:59],v[208:211]
ds_read_b64_tr_b16 v[42:43],v7 offset:21248
v_mfma_f32_16x16x32_bf16 v[212:215],v[44:47],v[60:63],v[212:215]
v_mfma_f32_16x16x32_bf16 v[216:219],v[44:47],v[64:67],v[216:219]
v_mfma_f32_16x16x32_bf16 v[220:223],v[44:47],v[68:71],v[220:223]
ds_read_b64_tr_b16 v[44:45],v8 offset:20480
v_mfma_f32_16x16x32_bf16 v[224:227],v[48:51],v[56:59],v[224:227]
ds_read_b64_tr_b16 v[46:47],v8 offset:21248
v_mfma_f32_16x16x32_bf16 v[228:231],v[48:51],v[60:63],v[228:231]
v_mfma_f32_16x16x32_bf16 v[232:235],v[48:51],v[64:67],v[232:235]
v_mfma_f32_16x16x32_bf16 v[236:239],v[48:51],v[68:71],v[236:239]
ds_read_b64_tr_b16 v[48:49],v9 offset:20480
v_mfma_f32_16x16x32_bf16 v[240:243],v[52:55],v[56:59],v[240:243]
ds_read_b64_tr_b16 v[50:51],v9 offset:21248
v_mfma_f32_16x16x32_bf16 v[244:247],v[52:55],v[60:63],v[244:247]
v_mfma_f32_16x16x32_bf16 v[248:251],v[52:55],v[64:67],v[248:251]
v_mfma_f32_16x16x32_bf16 v[252:255],v[52:55],v[68:71],v[252:255]
ds_read_b64_tr_b16 v[52:53],v10 offset:20480
ds_read_b64_tr_b16 v[54:55],v10 offset:21248
s_waitcnt lgkmcnt(15)
v_mfma_f32_16x16x32_bf16 v[96:99],v[16:19],v[72:75],v[96:99]
v_mfma_f32_16x16x32_bf16 v[100:103],v[16:19],v[76:79],v[100:103]
v_mfma_f32_16x16x32_bf16 v[104:107],v[16:19],v[80:83],v[104:107]
v_mfma_f32_16x16x32_bf16 v[108:111],v[16:19],v[84:87],v[108:111]
s_waitcnt vmcnt(0) lgkmcnt(0)
s_barrier
v_readfirstlane_b32 s50,v93
s_nop 0
s_cmp_lg_u32 s50,256
s_cbranch_scc1 g2_bad2
g2_badr2:
ds_read_b64_tr_b16 v[16:17],v1 offset:40960
v_mfma_f32_16x16x32_bf16 v[112:115],v[20:23],v[72:75],v[112:115]
ds_read_b64_tr_b16 v[18:19],v1 offset:41984
v_mfma_f32_16x16x32_bf16 v[116:119],v[20:23],v[76:79],v[116:119]
ds_read_b128 v[56:59],v11 offset:32768
v_mfma_f32_16x16x32_bf16 v[120:123],v[20:23],v[80:83],v[120:123]
ds_read_b128 v[60:63],v11 offset:34816
v_mfma_f32_16x16x32_bf16 v[124:127],v[20:23],v[84:87],v[124:127]
ds_read_b64_tr_b16 v[20:21],v2 offset:40960
v_mfma_f32_16x16x32_bf16 v[128:131],v[24:27],v[72:75],v[128:131]
ds_read_b64_tr_b16 v[22:23],v2 offset:41984
v_mfma_f32_16x16x32_bf16 v[132:135],v[24:27],v[76:79],v[132:135]
ds_read_b128 v[64:67],v11 offset:36864
v_mfma_f32_16x16x32_bf16 v[136:139],v[24:27],v[80:83],v[136:139]
ds_read_b128 v[68:71],v11 offset:38912
v_mfma_f32_16x16x32_bf16 v[140:143],v[24:27],v[84:87],v[140:143]
ds_read_b64_tr_b16 v[24:25],v3 offset:40960
v_mfma_f32_16x16x32_bf16 v[144:147],v[28:31],v[72:75],v[144:147]
ds_read_b64_tr_b16 v[26:27],v3 offset:41984
v_mfma_f32_16x16x32_bf16 v[148:151],v[28:31],v[76:79],v[148:151]
v_lshlrev_b32 v92,5,v0
buffer_load_dwordx4 v[12:15],v92,s[36:39],s98 offen sc1
v_mfma_f32_16x16x32_bf16 v[152:155],v[28:31],v[80:83],v[152:155]
v_mfma_f32_16x16x32_bf16 v[156:159],v[28:31],v[84:87],v[156:159]
ds_read_b64_tr_b16 v[28:29],v4 offset:40960
v_mfma_f32_16x16x32_bf16 v[160:163],v[32:35],v[72:75],v[160:163]
ds_read_b64_tr_b16 v[30:31],v4 offset:41984
v_mfma_f32_16x16x32_bf16 v[164:167],v[32:35],v[76:79],v[164:167]
buffer_load_dwordx4 v[88:91],v92,s[36:39],s98 offen offset:16 sc1
v_mfma_f32_16x16x32_bf16 v[168:171],v[32:35],v[80:83],v[168:171]
v_mfma_f32_16x16x32_bf16 v[172:175],v[32:35],v[84:87],v[172:175]
ds_read_b64_tr_b16 v[32:33],v5 offset:40960
v_mfma_f32_16x16x32_bf16 v[176:179],v[36:39],v[72:75],v[176:179]
ds_read_b64_tr_b16 v[34:35],v5 offset:41984
v_mfma_f32_16x16x32_bf16 v[180:183],v[36:39],v[76:79],v[180:183]
v_lshrrev_b32 v93,5,v0
v_mul_u32_u24 v93,8064,v93
v_lshl_add_u32 v93,v0,2,v93
s_lshl_b32 s50,s40,8
s_add_u32 m0,s50,149504
s_lshr_b32 s50,s50,1
s_lshl_b32 s51,s43,10
s_add_u32 s50,s50,s51
s_add_u32 s50,s50,42991616
buffer_load_dword v93,s[36:39],s50 offen sc1 lds
v_mfma_f32_16x16x32_bf16 v[184:187],v[36:39],v[80:83],v[184:187]
v_mfma_f32_16x16x32_bf16 v[188:191],v[36:39],v[84:87],v[188:191]
ds_read_b64_tr_b16 v[36:37],v6 offset:40960
v_mfma_f32_16x16x32_bf16 v[192:195],v[40:43],v[72:75],v[192:195]
ds_read_b64_tr_b16 v[38:39],v6 offset:41984
v_mfma_f32_16x16x32_bf16 v[196:199],v[40:43],v[76:79],v[196:199]
v_mfma_f32_16x16x32_bf16 v[200:203],v[40:43],v[80:83],v[200:203]
v_mfma_f32_16x16x32_bf16 v[204:207],v[40:43],v[84:87],v[204:207]
ds_read_b64_tr_b16 v[40:41],v7 offset:40960
v_mfma_f32_16x16x32_bf16 v[208:211],v[44:47],v[72:75],v[208:211]
ds_read_b64_tr_b16 v[42:43],v7 offset:41728
v_mfma_f32_16x16x32_bf16 v[212:215],v[44:47],v[76:79],v[212:215]
v_mfma_f32_16x16x32_bf16 v[216:219],v[44:47],v[80:83],v[216:219]
v_mfma_f32_16x16x32_bf16 v[220:223],v[44:47],v[84:87],v[220:223]
ds_read_b64_tr_b16 v[44:45],v8 offset:40960
v_mfma_f32_16x16x32_bf16 v[224:227],v[48:51],v[72:75],v[224:227]
ds_read_b64_tr_b16 v[46:47],v8 offset:41728
v_mfma_f32_16x16x32_bf16 v[228:231],v[48:51],v[76:79],v[228:231]
v_mfma_f32_16x16x32_bf16 v[232:235],v[48:51],v[80:83],v[232:235]
v_mfma_f32_16x16x32_bf16 v[236:239],v[48:51],v[84:87],v[236:239]
ds_read_b64_tr_b16 v[48:49],v9 offset:40960
v_mfma_f32_16x16x32_bf16 v[240:243],v[52:55],v[72:75],v[240:243]
ds_read_b64_tr_b16 v[50:51],v9 offset:41728
v_mfma_f32_16x16x32_bf16 v[244:247],v[52:55],v[76:79],v[244:247]
v_mfma_f32_16x16x32_bf16 v[248:251],v[52:55],v[80:83],v[248:251]
v_mfma_f32_16x16x32_bf16 v[252:255],v[52:55],v[84:87],v[252:255]
ds_read_b64_tr_b16 v[52:53],v10 offset:40960
ds_read_b64_tr_b16 v[54:55],v10 offset:41728
s_waitcnt lgkmcnt(15)
v_mfma_f32_16x16x32_bf16 v[96:99],v[16:19],v[56:59],v[96:99]
v_mfma_f32_16x16x32_bf16 v[100:103],v[16:19],v[60:63],v[100:103]
v_mfma_f32_16x16x32_bf16 v[104:107],v[16:19],v[64:67],v[104:107]
v_mfma_f32_16x16x32_bf16 v[108:111],v[16:19],v[68:71],v[108:111]
s_waitcnt vmcnt(0) lgkmcnt(0)
s_barrier
ds_read_b64_tr_b16 v[16:17],v1 offset:61440
v_mfma_f32_16x16x32_bf16 v[112:115],v[20:23],v[56:59],v[112:115]
ds_read_b64_tr_b16 v[18:19],v1 offset:62464
v_mfma_f32_16x16x32_bf16 v[116:119],v[20:23],v[60:63],v[116:119]
ds_read_b128 v[72:75],v94 offset:32768
v_mfma_f32_16x16x32_bf16 v[120:123],v[20:23],v[64:67],v[120:123]
ds_read_b128 v[76:79],v94 offset:34816
v_mfma_f32_16x16x32_bf16 v[124:127],v[20:23],v[68:71],v[124:127]
ds_read_b64_tr_b16 v[20:21],v2 offset:61440
v_mfma_f32_16x16x32_bf16 v[128:131],v[24:27],v[56:59],v[128:131]
ds_read_b64_tr_b16 v[22:23],v2 offset:62464
v_mfma_f32_16x16x32_bf16 v[132:135],v[24:27],v[60:63],v[132:135]
ds_read_b128 v[80:83],v94 offset:36864
v_mfma_f32_16x16x32_bf16 v[136:139],v[24:27],v[64:67],v[136:139]
ds_read_b128 v[84:87],v94 offset:38912
v_mfma_f32_16x16x32_bf16 v[140:143],v[24:27],v[68:71],v[140:143]
ds_read_b64_tr_b16 v[24:25],v3 offset:61440
v_mfma_f32_16x16x32_bf16 v[144:147],v[28:31],v[56:59],v[144:147]
ds_read_b64_tr_b16 v[26:27],v3 offset:62464
v_mfma_f32_16x16x32_bf16 v[148:151],v[28:31],v[60:63],v[148:151]
v_add_f32 v12,v12,v88
v_add_f32 v13,v13,v89
v_add_f32 v14,v14,v90
v_add_f32 v15,v15,v91
v_add_f32 v12,v12,v13
v_add_f32 v14,v14,v15
v_add_f32 v12,v12,v14
s_lshl_b32 s50,s40,8
s_add_u32 s50,s50,147456
v_lshl_add_u32 v92,v0,2,s50
ds_write_b32 v92,v12
v_mfma_f32_16x16x32_bf16 v[152:155],v[28:31],v[64:67],v[152:155]
v_mfma_f32_16x16x32_bf16 v[156:159],v[28:31],v[68:71],v[156:159]
ds_read_b64_tr_b16 v[28:29],v4 offset:61440
v_mfma_f32_16x16x32_bf16 v[160:163],v[32:35],v[56:59],v[160:163]
ds_read_b64_tr_b16 v[30:31],v4 offset:62464
v_mfma_f32_16x16x32_bf16 v[164:167],v[32:35],v[60:63],v[164:167]
v_mfma_f32_16x16x32_bf16 v[168:171],v[32:35],v[64:67],v[168:171]
v_mfma_f32_16x16x32_bf16 v[172:175],v[32:35],v[68:71],v[172:175]
ds_read_b64_tr_b16 v[32:33],v5 offset:61440
v_mfma_f32_16x16x32_bf16 v[176:179],v[36:39],v[56:59],v[176:179]
ds_read_b64_tr_b16 v[34:35],v5 offset:62464
v_mfma_f32_16x16x32_bf16 v[180:183],v[36:39],v[60:63],v[180:183]
v_mfma_f32_16x16x32_bf16 v[184:187],v[36:39],v[64:67],v[184:187]
v_mfma_f32_16x16x32_bf16 v[188:191],v[36:39],v[68:71],v[188:191]
ds_read_b64_tr_b16 v[36:37],v6 offset:61440
v_mfma_f32_16x16x32_bf16 v[192:195],v[40:43],v[56:59],v[192:195]
ds_read_b64_tr_b16 v[38:39],v6 offset:62464
v_mfma_f32_16x16x32_bf16 v[196:199],v[40:43],v[60:63],v[196:199]
v_mfma_f32_16x16x32_bf16 v[200:203],v[40:43],v[64:67],v[200:203]
v_mfma_f32_16x16x32_bf16 v[204:207],v[40:43],v[68:71],v[204:207]
ds_read_b64_tr_b16 v[40:41],v7 offset:61440
v_mfma_f32_16x16x32_bf16 v[208:211],v[44:47],v[56:59],v[208:211]
ds_read_b64_tr_b16 v[42:43],v7 offset:62208
v_mfma_f32_16x16x32_bf16 v[212:215],v[44:47],v[60:63],v[212:215]
v_mfma_f32_16x16x32_bf16 v[216:219],v[44:47],v[64:67],v[216:219]
v_mfma_f32_16x16x32_bf16 v[220:223],v[44:47],v[68:71],v[220:223]
ds_read_b64_tr_b16 v[44:45],v8 offset:61440
v_mfma_f32_16x16x32_bf16 v[224:227],v[48:51],v[56:59],v[224:227]
ds_read_b64_tr_b16 v[46:47],v8 offset:62208
v_mfma_f32_16x16x32_bf16 v[228:231],v[48:51],v[60:63],v[228:231]
v_mfma_f32_16x16x32_bf16 v[232:235],v[48:51],v[64:67],v[232:235]
v_mfma_f32_16x16x32_bf16 v[236:239],v[48:51],v[68:71],v[236:239]
ds_read_b64_tr_b16 v[48:49],v9 offset:61440
v_mfma_f32_16x16x32_bf16 v[240:243],v[52:55],v[56:59],v[240:243]
ds_read_b64_tr_b16 v[50:51],v9 offset:62208
v_mfma_f32_16x16x32_bf16 v[244:247],v[52:55],v[60:63],v[244:247]
v_mfma_f32_16x16x32_bf16 v[248:251],v[52:55],v[64:67],v[248:251]
v_mfma_f32_16x16x32_bf16 v[252:255],v[52:55],v[68:71],v[252:255]
ds_read_b64_tr_b16 v[52:53],v10 offset:61440
ds_read_b64_tr_b16 v[54:55],v10 offset:62208
s_waitcnt lgkmcnt(15)
v_mfma_f32_16x16x32_bf16 v[96:99],v[16:19],v[72:75],v[96:99]
v_lshrrev_b32 v92,4,v0
v_lshlrev_b32 v92,4,v92
v_and_b32 v93,15,v0
v_lshlrev_b32 v93,2,v93
s_lshl_b32 s50,s41,9
v_mfma_f32_16x16x32_bf16 v[100:103],v[16:19],v[76:79],v[100:103]
s_add_u32 s50,s50,149504
v_add_u32 v94,s50,v93
v_add_u32 v95,s50,v92
v_add_u32 v92,147456,v92
v_add_u32 v93,147456,v93
v_mfma_f32_16x16x32_bf16 v[104:107],v[16:19],v[80:83],v[104:107]
v_mfma_f32_16x16x32_bf16 v[108:111],v[16:19],v[84:87],v[108:111]
s_waitcnt lgkmcnt(0)
s_barrier
ds_read_b128 v[16:19],v92 offset:0
v_mfma_f32_16x16x32_bf16 v[112:115],v[20:23],v[72:75],v[112:115]
v_mfma_f32_16x16x32_bf16 v[116:119],v[20:23],v[76:79],v[116:119]
ds_read_b32 v2,v93 offset:4096
v_mfma_f32_16x16x32_bf16 v[120:123],v[20:23],v[80:83],v[120:123]
ds_read2_b32 v[56:57],v94 offset0:0 offset1:32
v_mfma_f32_16x16x32_bf16 v[124:127],v[20:23],v[84:87],v[124:127]
ds_read_b128 v[20:23],v92 offset:64
v_mfma_f32_16x16x32_bf16 v[128:131],v[24:27],v[72:75],v[128:131]
v_mfma_f32_16x16x32_bf16 v[132:135],v[24:27],v[76:79],v[132:135]
ds_read2_b32 v[58:59],v94 offset0:16 offset1:48
v_mfma_f32_16x16x32_bf16 v[136:139],v[24:27],v[80:83],v[136:139]
ds_read2_b32 v[60:61],v94 offset0:64 offset1:96
v_mfma_f32_16x16x32_bf16 v[140:143],v[24:27],v[84:87],v[140:143]
ds_read_b128 v[24:27],v92 offset:128
v_mfma_f32_16x16x32_bf16 v[144:147],v[28:31],v[72:75],v[144:147]
v_mfma_f32_16x16x32_bf16 v[148:151],v[28:31],v[76:79],v[148:151]
ds_read2_b32 v[62:63],v94 offset0:80 offset1:112
v_mfma_f32_16x16x32_bf16 v[152:155],v[28:31],v[80:83],v[152:155]
v_mfma_f32_16x16x32_bf16 v[156:159],v[28:31],v[84:87],v[156:159]
ds_read_b128 v[28:31],v92 offset:192
v_mfma_f32_16x16x32_bf16 v[160:163],v[32:35],v[72:75],v[160:163]
v_mfma_f32_16x16x32_bf16 v[164:167],v[32:35],v[76:79],v[164:167]
v_mfma_f32_16x16x32_bf16 v[168:171],v[32:35],v[80:83],v[168:171]
v_mfma_f32_16x16x32_bf16 v[172:175],v[32:35],v[84:87],v[172:175]
ds_read_b128 v[32:35],v92 offset:256
v_mfma_f32_16x16x32_bf16 v[176:179],v[36:39],v[72:75],v[176:179]
v_mfma_f32_16x16x32_bf16 v[180:183],v[36:39],v[76:79],v[180:183]
v_mfma_f32_16x16x32_bf16 v[184:187],v[36:39],v[80:83],v[184:187]
v_mfma_f32_16x16x32_bf16 v[188:191],v[36:39],v[84:87],v[188:191]
ds_read_b128 v[36:39],v92 offset:320
v_mfma_f32_16x16x32_bf16 v[192:195],v[40:43],v[72:75],v[192:195]
v_mfma_f32_16x16x32_bf16 v[196:199],v[40:43],v[76:79],v[196:199]
v_mfma_f32_16x16x32_bf16 v[200:203],v[40:43],v[80:83],v[200:203]
v_mfma_f32_16x16x32_bf16 v[204:207],v[40:43],v[84:87],v[204:207]
ds_read_b128 v[40:43],v92 offset:512
v_mfma_f32_16x16x32_bf16 v[208:211],v[44:47],v[72:75],v[208:211]
v_mfma_f32_16x16x32_bf16 v[212:215],v[44:47],v[76:79],v[212:215]
v_mfma_f32_16x16x32_bf16 v[216:219],v[44:47],v[80:83],v[216:219]
v_mfma_f32_16x16x32_bf16 v[220:223],v[44:47],v[84:87],v[220:223]
ds_read_b128 v[44:47],v92 offset:576
v_mfma_f32_16x16x32_bf16 v[224:227],v[48:51],v[72:75],v[224:227]
v_mfma_f32_16x16x32_bf16 v[228:231],v[48:51],v[76:79],v[228:231]
v_mfma_f32_16x16x32_bf16 v[232:235],v[48:51],v[80:83],v[232:235]
v_mfma_f32_16x16x32_bf16 v[236:239],v[48:51],v[84:87],v[236:239]
ds_read_b128 v[48:51],v92 offset:896
v_mfma_f32_16x16x32_bf16 v[240:243],v[52:55],v[72:75],v[240:243]
v_mfma_f32_16x16x32_bf16 v[244:247],v[52:55],v[76:79],v[244:247]
v_mfma_f32_16x16x32_bf16 v[248:251],v[52:55],v[80:83],v[248:251]
v_mfma_f32_16x16x32_bf16 v[252:255],v[52:55],v[84:87],v[252:255]
ds_read_b128 v[52:55],v92 offset:960
s_waitcnt lgkmcnt(4)
v_readfirstlane_b32 s50,v2
v_lshlrev_b32 v1,4,v0
s_cmp_lg_u32 s50,0
s_cbranch_scc1 g2_rec
g2_ep2:
s_load_dwordx2 s[10:11],s[0:1],56
s_mov_b64 s[6:7],s[14:15]
s_mov_b64 s[8:9],s[16:17]
s_setprio 3
v_and_b32 v12,0x33,v0
v_lshlrev_b32 v12,4,v12
v_bfe_u32 v13,v0,2,1
v_lshl_add_u32 v12,v13,7,v12
v_bfe_u32 v13,v0,3,1
v_lshl_add_u32 v3,v13,10,v12
v_rcp_f32 v80,v57
v_rcp_f32 v82,v59
v_rcp_f32 v84,v61
v_rcp_f32 v86,v63
s_lshl_b32 s50,s43,3
s_lshl_b32 s51,s41,1
s_add_u32 s50,s50,s51
s_lshl_b32 s48,s50,11
s_lshl_b32 s51,s45,18
s_add_u32 s48,s48,s51
s_mul_i32 s49,s50,294912
s_lshl_b32 s51,s47,5
s_add_u32 s49,s49,s51
s_add_u32 s49,s49,12582912
v_mul_f32 v64,0xbfb8aa3b,v80
v_mul_f32 v66,0xbfb8aa3b,v82
v_mul_f32 v68,0xbfb8aa3b,v84
v_mul_f32 v70,0xbfb8aa3b,v86
v_mul_f32 v72,0x3e8293ee,v80
v_mul_f32 v74,0x3e8293ee,v82
v_mul_f32 v76,0x3e8293ee,v84
v_mul_f32 v78,0x3e8293ee,v86
s_waitcnt lgkmcnt(0)
s_add_u32 s50,s48,0
v_pk_fma_f32 v[96:97],v[16:17],v[56:57],v[96:97] op_sel:[0,0,0] op_sel_hi:[1,0,1]
v_pk_fma_f32 v[98:99],v[18:19],v[56:57],v[98:99] op_sel:[0,0,0] op_sel_hi:[1,0,1]
v_pk_fma_f32 v[112:113],v[20:21],v[56:57],v[112:113] op_sel:[0,0,0] op_sel_hi:[1,0,1]
v_pk_fma_f32 v[114:115],v[22:23],v[56:57],v[114:115] op_sel:[0,0,0] op_sel_hi:[1,0,1]
v_pk_mul_f32 v[96:97],v[96:97],v[72:73] op_sel:[0,0] op_sel_hi:[1,0]
v_pk_mul_f32 v[98:99],v[98:99],v[72:73] op_sel:[0,0] op_sel_hi:[1,0]
v_pk_mul_f32 v[112:113],v[112:113],v[72:73] op_sel:[0,0] op_sel_hi:[1,0]
v_pk_mul_f32 v[114:115],v[114:115],v[72:73] op_sel:[0,0] op_sel_hi:[1,0]
v_cvt_pk_bf16_f32 v96,v96,v97
v_cvt_pk_bf16_f32 v97,v98,v99
v_cvt_pk_bf16_f32 v98,v112,v113
v_cvt_pk_bf16_f32 v99,v114,v115
buffer_store_dwordx4 v[96:99],v1,s[36:39],s50 offen offset:0 sc1
v_pk_fma_f32 v[100:101],v[16:17],v[58:59],v[100:101] op_sel:[0,0,0] op_sel_hi:[1,0,1]
v_pk_fma_f32 v[102:103],v[18:19],v[58:59],v[102:103] op_sel:[0,0,0] op_sel_hi:[1,0,1]
v_pk_fma_f32 v[116:117],v[20:21],v[58:59],v[116:117] op_sel:[0,0,0] op_sel_hi:[1,0,1]
v_pk_fma_f32 v[118:119],v[22:23],v[58:59],v[118:119] op_sel:[0,0,0] op_sel_hi:[1,0,1]
v_pk_mul_f32 v[100:101],v[100:101],v[74:75] op_sel:[0,0] op_sel_hi:[1,0]
v_pk_mul_f32 v[102:103],v[102:103],v[74:75] op_sel:[0,0] op_sel_hi:[1,0]
v_pk_mul_f32 v[116:117],v[116:117],v[74:75] op_sel:[0,0] op_sel_hi:[1,0]
v_pk_mul_f32 v[118:119],v[118:119],v[74:75] op_sel:[0,0] op_sel_hi:[1,0]
v_cvt_pk_bf16_f32 v100,v100,v101
v_cvt_pk_bf16_f32 v101,v102,v103
v_cvt_pk_bf16_f32 v102,v116,v117
v_cvt_pk_bf16_f32 v103,v118,v119
buffer_store_dwordx4 v[100:103],v1,s[36:39],s50 offen offset:1024 sc1
v_pk_fma_f32 v[104:105],v[16:17],v[60:61],v[104:105] op_sel:[0,0,0] op_sel_hi:[1,0,1]
v_pk_fma_f32 v[106:107],v[18:19],v[60:61],v[106:107] op_sel:[0,0,0] op_sel_hi:[1,0,1]
v_pk_fma_f32 v[120:121],v[20:21],v[60:61],v[120:121] op_sel:[0,0,0] op_sel_hi:[1,0,1]
v_pk_fma_f32 v[122:123],v[22:23],v[60:61],v[122:123] op_sel:[0,0,0] op_sel_hi:[1,0,1]
v_pk_mul_f32 v[104:105],v[104:105],v[76:77] op_sel:[0,0] op_sel_hi:[1,0]
v_pk_mul_f32 v[106:107],v[106:107],v[76:77] op_sel:[0,0] op_sel_hi:[1,0]
v_pk_mul_f32 v[120:121],v[120:121],v[76:77] op_sel:[0,0] op_sel_hi:[1,0]
v_pk_mul_f32 v[122:123],v[122:123],v[76:77] op_sel:[0,0] op_sel_hi:[1,0]
v_cvt_pk_bf16_f32 v104,v104,v105
v_cvt_pk_bf16_f32 v105,v106,v107
v_cvt_pk_bf16_f32 v106,v120,v121
v_cvt_pk_bf16_f32 v107,v122,v123
buffer_store_dwordx4 v[104:107],v1,s[36:39],s50 offen offset:2048 sc1
v_pk_fma_f32 v[108:109],v[16:17],v[62:63],v[108:109] op_sel:[0,0,0] op_sel_hi:[1,0,1]
v_pk_fma_f32 v[110:111],v[18:19],v[62:63],v[110:111] op_sel:[0,0,0] op_sel_hi:[1,0,1]
v_pk_fma_f32 v[124:125],v[20:21],v[62:63],v[124:125] op_sel:[0,0,0] op_sel_hi:[1,0,1]
v_pk_fma_f32 v[126:127],v[22:23],v[62:63],v[126:127] op_sel:[0,0,0] op_sel_hi:[1,0,1]
v_pk_mul_f32 v[108:109],v[108:109],v[78:79] op_sel:[0,0] op_sel_hi:[1,0]
v_pk_mul_f32 v[110:111],v[110:111],v[78:79] op_sel:[0,0] op_sel_hi:[1,0]
v_pk_mul_f32 v[124:125],v[124:125],v[78:79] op_sel:[0,0] op_sel_hi:[1,0]
v_pk_mul_f32 v[126:127],v[126:127],v[78:79] op_sel:[0,0] op_sel_hi:[1,0]
v_cvt_pk_bf16_f32 v108,v108,v109
v_cvt_pk_bf16_f32 v109,v110,v111
v_cvt_pk_bf16_f32 v110,v124,v125
v_cvt_pk_bf16_f32 v111,v126,v127
buffer_store_dwordx4 v[108:111],v1,s[36:39],s50 offen offset:3072 sc1
s_add_u32 s50,s48,131072
v_pk_fma_f32 v[128:129],v[24:25],v[56:57],v[128:129] op_sel:[0,0,0] op_sel_hi:[1,0,1]
v_pk_fma_f32 v[130:131],v[26:27],v[56:57],v[130:131] op_sel:[0,0,0] op_sel_hi:[1,0,1]
v_pk_fma_f32 v[144:145],v[28:29],v[56:57],v[144:145] op_sel:[0,0,0] op_sel_hi:[1,0,1]
v_pk_fma_f32 v[146:147],v[30:31],v[56:57],v[146:147] op_sel:[0,0,0] op_sel_hi:[1,0,1]
v_pk_mul_f32 v[128:129],v[128:129],v[72:73] op_sel:[0,0] op_sel_hi:[1,0]
v_pk_mul_f32 v[130:131],v[130:131],v[72:73] op_sel:[0,0] op_sel_hi:[1,0]
v_pk_mul_f32 v[144:145],v[144:145],v[72:73] op_sel:[0,0] op_sel_hi:[1,0]
v_pk_mul_f32 v[146:147],v[146:147],v[72:73] op_sel:[0,0] op_sel_hi:[1,0]
v_cvt_pk_bf16_f32 v128,v128,v129
v_cvt_pk_bf16_f32 v129,v130,v131
v_cvt_pk_bf16_f32 v130,v144,v145
v_cvt_pk_bf16_f32 v131,v146,v147
buffer_store_dwordx4 v[128:131],v1,s[36:39],s50 offen offset:0 sc1
v_pk_fma_f32 v[132:133],v[24:25],v[58:59],v[132:133] op_sel:[0,0,0] op_sel_hi:[1,0,1]
v_pk_fma_f32 v[134:135],v[26:27],v[58:59],v[134:135] op_sel:[0,0,0] op_sel_hi:[1,0,1]
v_pk_fma_f32 v[148:149],v[28:29],v[58:59],v[148:149] op_sel:[0,0,0] op_sel_hi:[1,0,1]
v_pk_fma_f32 v[150:151],v[30:31],v[58:59],v[150:151] op_sel:[0,0,0] op_sel_hi:[1,0,1]
v_pk_mul_f32 v[132:133],v[132:133],v[74:75] op_sel:[0,0] op_sel_hi:[1,0]
v_pk_mul_f32 v[134:135],v[134:135],v[74:75] op_sel:[0,0] op_sel_hi:[1,0]
v_pk_mul_f32 v[148:149],v[148:149],v[74:75] op_sel:[0,0] op_sel_hi:[1,0]
v_pk_mul_f32 v[150:151],v[150:151],v[74:75] op_sel:[0,0] op_sel_hi:[1,0]
v_cvt_pk_bf16_f32 v132,v132,v133
v_cvt_pk_bf16_f32 v133,v134,v135
v_cvt_pk_bf16_f32 v134,v148,v149
v_cvt_pk_bf16_f32 v135,v150,v151
buffer_store_dwordx4 v[132:135],v1,s[36:39],s50 offen offset:1024 sc1
v_pk_fma_f32 v[136:137],v[24:25],v[60:61],v[136:137] op_sel:[0,0,0] op_sel_hi:[1,0,1]
v_pk_fma_f32 v[138:139],v[26:27],v[60:61],v[138:139] op_sel:[0,0,0] op_sel_hi:[1,0,1]
v_pk_fma_f32 v[152:153],v[28:29],v[60:61],v[152:153] op_sel:[0,0,0] op_sel_hi:[1,0,1]
v_pk_fma_f32 v[154:155],v[30:31],v[60:61],v[154:155] op_sel:[0,0,0] op_sel_hi:[1,0,1]
v_pk_mul_f32 v[136:137],v[136:137],v[76:77] op_sel:[0,0] op_sel_hi:[1,0]
v_pk_mul_f32 v[138:139],v[138:139],v[76:77] op_sel:[0,0] op_sel_hi:[1,0]
v_pk_mul_f32 v[152:153],v[152:153],v[76:77] op_sel:[0,0] op_sel_hi:[1,0]
v_pk_mul_f32 v[154:155],v[154:155],v[76:77] op_sel:[0,0] op_sel_hi:[1,0]
v_cvt_pk_bf16_f32 v136,v136,v137
v_cvt_pk_bf16_f32 v137,v138,v139
v_cvt_pk_bf16_f32 v138,v152,v153
v_cvt_pk_bf16_f32 v139,v154,v155
buffer_store_dwordx4 v[136:139],v1,s[36:39],s50 offen offset:2048 sc1
v_pk_fma_f32 v[140:141],v[24:25],v[62:63],v[140:141] op_sel:[0,0,0] op_sel_hi:[1,0,1]
v_pk_fma_f32 v[142:143],v[26:27],v[62:63],v[142:143] op_sel:[0,0,0] op_sel_hi:[1,0,1]
v_pk_fma_f32 v[156:157],v[28:29],v[62:63],v[156:157] op_sel:[0,0,0] op_sel_hi:[1,0,1]
v_pk_fma_f32 v[158:159],v[30:31],v[62:63],v[158:159] op_sel:[0,0,0] op_sel_hi:[1,0,1]
v_pk_mul_f32 v[140:141],v[140:141],v[78:79] op_sel:[0,0] op_sel_hi:[1,0]
v_pk_mul_f32 v[142:143],v[142:143],v[78:79] op_sel:[0,0] op_sel_hi:[1,0]
v_pk_mul_f32 v[156:157],v[156:157],v[78:79] op_sel:[0,0] op_sel_hi:[1,0]
v_pk_mul_f32 v[158:159],v[158:159],v[78:79] op_sel:[0,0] op_sel_hi:[1,0]
v_cvt_pk_bf16_f32 v140,v140,v141
v_cvt_pk_bf16_f32 v141,v142,v143
v_cvt_pk_bf16_f32 v142,v156,v157
v_cvt_pk_bf16_f32 v143,v158,v159
buffer_store_dwordx4 v[140:143],v1,s[36:39],s50 offen offset:3072 sc1
s_add_u32 s50,s48,4194304
v_pk_fma_f32 v[160:161],v[32:33],v[56:57],v[160:161] op_sel:[0,0,0] op_sel_hi:[1,0,1]
v_pk_fma_f32 v[162:163],v[34:35],v[56:57],v[162:163] op_sel:[0,0,0] op_sel_hi:[1,0,1]
v_pk_fma_f32 v[176:177],v[36:37],v[56:57],v[176:177] op_sel:[0,0,0] op_sel_hi:[1,0,1]
v_pk_fma_f32 v[178:179],v[38:39],v[56:57],v[178:179] op_sel:[0,0,0] op_sel_hi:[1,0,1]
v_pk_mul_f32 v[160:161],v[160:161],v[80:81] op_sel:[0,0] op_sel_hi:[1,0]
v_pk_mul_f32 v[162:163],v[162:163],v[80:81] op_sel:[0,0] op_sel_hi:[1,0]
v_pk_mul_f32 v[176:177],v[176:177],v[80:81] op_sel:[0,0] op_sel_hi:[1,0]
v_pk_mul_f32 v[178:179],v[178:179],v[80:81] op_sel:[0,0] op_sel_hi:[1,0]
v_cvt_pk_bf16_f32 v160,v160,v161
v_cvt_pk_bf16_f32 v161,v162,v163
v_cvt_pk_bf16_f32 v162,v176,v177
v_cvt_pk_bf16_f32 v163,v178,v179
buffer_store_dwordx4 v[160:163],v3,s[36:39],s50 offen offset:0 sc1
v_pk_fma_f32 v[164:165],v[32:33],v[58:59],v[164:165] op_sel:[0,0,0] op_sel_hi:[1,0,1]
v_pk_fma_f32 v[166:167],v[34:35],v[58:59],v[166:167] op_sel:[0,0,0] op_sel_hi:[1,0,1]
v_pk_fma_f32 v[180:181],v[36:37],v[58:59],v[180:181] op_sel:[0,0,0] op_sel_hi:[1,0,1]
v_pk_fma_f32 v[182:183],v[38:39],v[58:59],v[182:183] op_sel:[0,0,0] op_sel_hi:[1,0,1]
v_pk_mul_f32 v[164:165],v[164:165],v[82:83] op_sel:[0,0] op_sel_hi:[1,0]
v_pk_mul_f32 v[166:167],v[166:167],v[82:83] op_sel:[0,0] op_sel_hi:[1,0]
v_pk_mul_f32 v[180:181],v[180:181],v[82:83] op_sel:[0,0] op_sel_hi:[1,0]
v_pk_mul_f32 v[182:183],v[182:183],v[82:83] op_sel:[0,0] op_sel_hi:[1,0]
v_cvt_pk_bf16_f32 v164,v164,v165
v_cvt_pk_bf16_f32 v165,v166,v167
v_cvt_pk_bf16_f32 v166,v180,v181
v_cvt_pk_bf16_f32 v167,v182,v183
buffer_store_dwordx4 v[164:167],v3,s[36:39],s50 offen offset:64 sc1
v_pk_fma_f32 v[168:169],v[32:33],v[60:61],v[168:169] op_sel:[0,0,0] op_sel_hi:[1,0,1]
v_pk_fma_f32 v[170:171],v[34:35],v[60:61],v[170:171] op_sel:[0,0,0] op_sel_hi:[1,0,1]
v_pk_fma_f32 v[184:185],v[36:37],v[60:61],v[184:185] op_sel:[0,0,0] op_sel_hi:[1,0,1]
v_pk_fma_f32 v[186:187],v[38:39],v[60:61],v[186:187] op_sel:[0,0,0] op_sel_hi:[1,0,1]
v_pk_mul_f32 v[168:169],v[168:169],v[84:85] op_sel:[0,0] op_sel_hi:[1,0]
v_pk_mul_f32 v[170:171],v[170:171],v[84:85] op_sel:[0,0] op_sel_hi:[1,0]
v_pk_mul_f32 v[184:185],v[184:185],v[84:85] op_sel:[0,0] op_sel_hi:[1,0]
v_pk_mul_f32 v[186:187],v[186:187],v[84:85] op_sel:[0,0] op_sel_hi:[1,0]
v_cvt_pk_bf16_f32 v168,v168,v169
v_cvt_pk_bf16_f32 v169,v170,v171
v_cvt_pk_bf16_f32 v170,v184,v185
v_cvt_pk_bf16_f32 v171,v186,v187
buffer_store_dwordx4 v[168:171],v3,s[36:39],s50 offen offset:2048 sc1
v_pk_fma_f32 v[172:173],v[32:33],v[62:63],v[172:173] op_sel:[0,0,0] op_sel_hi:[1,0,1]
v_pk_fma_f32 v[174:175],v[34:35],v[62:63],v[174:175] op_sel:[0,0,0] op_sel_hi:[1,0,1]
v_pk_fma_f32 v[188:189],v[36:37],v[62:63],v[188:189] op_sel:[0,0,0] op_sel_hi:[1,0,1]
v_pk_fma_f32 v[190:191],v[38:39],v[62:63],v[190:191] op_sel:[0,0,0] op_sel_hi:[1,0,1]
v_pk_mul_f32 v[172:173],v[172:173],v[86:87] op_sel:[0,0] op_sel_hi:[1,0]
v_pk_mul_f32 v[174:175],v[174:175],v[86:87] op_sel:[0,0] op_sel_hi:[1,0]
v_pk_mul_f32 v[188:189],v[188:189],v[86:87] op_sel:[0,0] op_sel_hi:[1,0]
v_pk_mul_f32 v[190:191],v[190:191],v[86:87] op_sel:[0,0] op_sel_hi:[1,0]
v_cvt_pk_bf16_f32 v172,v172,v173
v_cvt_pk_bf16_f32 v173,v174,v175
v_cvt_pk_bf16_f32 v174,v188,v189
v_cvt_pk_bf16_f32 v175,v190,v191
buffer_store_dwordx4 v[172:175],v3,s[36:39],s50 offen offset:2112 sc1
s_setprio 2
v_mov_b32 v72,v57
v_mov_b32 v74,v59
v_mov_b32 v76,v61
v_mov_b32 v78,v63
v_pk_fma_f32 v[192:193],v[40:41],v[56:57],v[192:193] op_sel:[0,0,0] op_sel_hi:[1,0,1]
v_pk_fma_f32 v[194:195],v[42:43],v[56:57],v[194:195] op_sel:[0,0,0] op_sel_hi:[1,0,1]
v_pk_fma_f32 v[208:209],v[44:45],v[56:57],v[208:209] op_sel:[0,0,0] op_sel_hi:[1,0,1]
v_pk_fma_f32 v[210:211],v[46:47],v[56:57],v[210:211] op_sel:[0,0,0] op_sel_hi:[1,0,1]
v_pk_mul_f32 v[192:193],v[192:193],v[64:65] op_sel:[0,0] op_sel_hi:[1,0]
v_pk_mul_f32 v[194:195],v[194:195],v[64:65] op_sel:[0,0] op_sel_hi:[1,0]
v_pk_mul_f32 v[208:209],v[208:209],v[64:65] op_sel:[0,0] op_sel_hi:[1,0]
v_pk_mul_f32 v[210:211],v[210:211],v[64:65] op_sel:[0,0] op_sel_hi:[1,0]
v_exp_f32 v192,v192
v_exp_f32 v193,v193
v_exp_f32 v194,v194
v_exp_f32 v195,v195
v_exp_f32 v208,v208
v_exp_f32 v209,v209
v_exp_f32 v210,v210
v_exp_f32 v211,v211
v_pk_fma_f32 v[224:225],v[48:49],v[56:57],v[224:225] op_sel:[0,0,0] op_sel_hi:[1,0,1]
v_pk_fma_f32 v[226:227],v[50:51],v[56:57],v[226:227] op_sel:[0,0,0] op_sel_hi:[1,0,1]
v_pk_fma_f32 v[240:241],v[52:53],v[56:57],v[240:241] op_sel:[0,0,0] op_sel_hi:[1,0,1]
v_pk_fma_f32 v[242:243],v[54:55],v[56:57],v[242:243] op_sel:[0,0,0] op_sel_hi:[1,0,1]
v_pk_fma_f32 v[192:193],v[192:193],v[72:73],v[72:73] op_sel:[0,0,0] op_sel_hi:[1,0,0]
v_pk_fma_f32 v[194:195],v[194:195],v[72:73],v[72:73] op_sel:[0,0,0] op_sel_hi:[1,0,0]
v_pk_fma_f32 v[208:209],v[208:209],v[72:73],v[72:73] op_sel:[0,0,0] op_sel_hi:[1,0,0]
v_pk_fma_f32 v[210:211],v[210:211],v[72:73],v[72:73] op_sel:[0,0,0] op_sel_hi:[1,0,0]
v_rcp_f32 v192,v192
v_rcp_f32 v193,v193
v_rcp_f32 v194,v194
v_rcp_f32 v195,v195
v_rcp_f32 v208,v208
v_rcp_f32 v209,v209
v_rcp_f32 v210,v210
v_rcp_f32 v211,v211
s_nop 0
v_pk_mul_f32 v[192:193],v[192:193],v[224:225] op_sel:[0,0] op_sel_hi:[1,1]
v_pk_mul_f32 v[194:195],v[194:195],v[226:227] op_sel:[0,0] op_sel_hi:[1,1]
v_pk_mul_f32 v[208:209],v[208:209],v[240:241] op_sel:[0,0] op_sel_hi:[1,1]
v_pk_mul_f32 v[210:211],v[210:211],v[242:243] op_sel:[0,0] op_sel_hi:[1,1]
v_cvt_pk_bf16_f32 v192,v192,v193
v_cvt_pk_bf16_f32 v193,v194,v195
v_cvt_pk_bf16_f32 v194,v208,v209
v_cvt_pk_bf16_f32 v195,v210,v211
v_pk_fma_f32 v[196:197],v[40:41],v[58:59],v[196:197] op_sel:[0,0,0] op_sel_hi:[1,0,1]
v_pk_fma_f32 v[198:199],v[42:43],v[58:59],v[198:199] op_sel:[0,0,0] op_sel_hi:[1,0,1]
v_pk_fma_f32 v[212:213],v[44:45],v[58:59],v[212:213] op_sel:[0,0,0] op_sel_hi:[1,0,1]
v_pk_fma_f32 v[214:215],v[46:47],v[58:59],v[214:215] op_sel:[0,0,0] op_sel_hi:[1,0,1]
v_pk_mul_f32 v[196:197],v[196:197],v[66:67] op_sel:[0,0] op_sel_hi:[1,0]
v_pk_mul_f32 v[198:199],v[198:199],v[66:67] op_sel:[0,0] op_sel_hi:[1,0]
v_pk_mul_f32 v[212:213],v[212:213],v[66:67] op_sel:[0,0] op_sel_hi:[1,0]
v_pk_mul_f32 v[214:215],v[214:215],v[66:67] op_sel:[0,0] op_sel_hi:[1,0]
v_exp_f32 v196,v196
v_exp_f32 v197,v197
v_exp_f32 v198,v198
v_exp_f32 v199,v199
v_exp_f32 v212,v212
v_exp_f32 v213,v213
v_exp_f32 v214,v214
v_exp_f32 v215,v215
v_pk_fma_f32 v[228:229],v[48:49],v[58:59],v[228:229] op_sel:[0,0,0] op_sel_hi:[1,0,1]
v_pk_fma_f32 v[230:231],v[50:51],v[58:59],v[230:231] op_sel:[0,0,0] op_sel_hi:[1,0,1]
v_pk_fma_f32 v[244:245],v[52:53],v[58:59],v[244:245] op_sel:[0,0,0] op_sel_hi:[1,0,1]
v_pk_fma_f32 v[246:247],v[54:55],v[58:59],v[246:247] op_sel:[0,0,0] op_sel_hi:[1,0,1]
v_pk_fma_f32 v[196:197],v[196:197],v[74:75],v[74:75] op_sel:[0,0,0] op_sel_hi:[1,0,0]
v_pk_fma_f32 v[198:199],v[198:199],v[74:75],v[74:75] op_sel:[0,0,0] op_sel_hi:[1,0,0]
v_pk_fma_f32 v[212:213],v[212:213],v[74:75],v[74:75] op_sel:[0,0,0] op_sel_hi:[1,0,0]
v_pk_fma_f32 v[214:215],v[214:215],v[74:75],v[74:75] op_sel:[0,0,0] op_sel_hi:[1,0,0]
v_rcp_f32 v196,v196
v_rcp_f32 v197,v197
v_rcp_f32 v198,v198
v_rcp_f32 v199,v199
v_rcp_f32 v212,v212
v_rcp_f32 v213,v213
v_rcp_f32 v214,v214
v_rcp_f32 v215,v215
s_nop 0
v_pk_mul_f32 v[196:197],v[196:197],v[228:229] op_sel:[0,0] op_sel_hi:[1,1]
v_pk_mul_f32 v[198:199],v[198:199],v[230:231] op_sel:[0,0] op_sel_hi:[1,1]
v_pk_mul_f32 v[212:213],v[212:213],v[244:245] op_sel:[0,0] op_sel_hi:[1,1]
v_pk_mul_f32 v[214:215],v[214:215],v[246:247] op_sel:[0,0] op_sel_hi:[1,1]
v_cvt_pk_bf16_f32 v196,v196,v197
v_cvt_pk_bf16_f32 v197,v198,v199
v_cvt_pk_bf16_f32 v198,v212,v213
v_cvt_pk_bf16_f32 v199,v214,v215
v_pk_fma_f32 v[200:201],v[40:41],v[60:61],v[200:201] op_sel:[0,0,0] op_sel_hi:[1,0,1]
v_pk_fma_f32 v[202:203],v[42:43],v[60:61],v[202:203] op_sel:[0,0,0] op_sel_hi:[1,0,1]
v_pk_fma_f32 v[216:217],v[44:45],v[60:61],v[216:217] op_sel:[0,0,0] op_sel_hi:[1,0,1]
v_pk_fma_f32 v[218:219],v[46:47],v[60:61],v[218:219] op_sel:[0,0,0] op_sel_hi:[1,0,1]
v_pk_mul_f32 v[200:201],v[200:201],v[68:69] op_sel:[0,0] op_sel_hi:[1,0]
v_pk_mul_f32 v[202:203],v[202:203],v[68:69] op_sel:[0,0] op_sel_hi:[1,0]
v_pk_mul_f32 v[216:217],v[216:217],v[68:69] op_sel:[0,0] op_sel_hi:[1,0]
v_pk_mul_f32 v[218:219],v[218:219],v[68:69] op_sel:[0,0] op_sel_hi:[1,0]
v_exp_f32 v200,v200
v_exp_f32 v201,v201
v_exp_f32 v202,v202
v_exp_f32 v203,v203
v_exp_f32 v216,v216
v_exp_f32 v217,v217
v_exp_f32 v218,v218
v_exp_f32 v219,v219
v_pk_fma_f32 v[232:233],v[48:49],v[60:61],v[232:233] op_sel:[0,0,0] op_sel_hi:[1,0,1]
v_pk_fma_f32 v[234:235],v[50:51],v[60:61],v[234:235] op_sel:[0,0,0] op_sel_hi:[1,0,1]
v_pk_fma_f32 v[248:249],v[52:53],v[60:61],v[248:249] op_sel:[0,0,0] op_sel_hi:[1,0,1]
v_pk_fma_f32 v[250:251],v[54:55],v[60:61],v[250:251] op_sel:[0,0,0] op_sel_hi:[1,0,1]
v_pk_fma_f32 v[200:201],v[200:201],v[76:77],v[76:77] op_sel:[0,0,0] op_sel_hi:[1,0,0]
v_pk_fma_f32 v[202:203],v[202:203],v[76:77],v[76:77] op_sel:[0,0,0] op_sel_hi:[1,0,0]
v_pk_fma_f32 v[216:217],v[216:217],v[76:77],v[76:77] op_sel:[0,0,0] op_sel_hi:[1,0,0]
v_pk_fma_f32 v[218:219],v[218:219],v[76:77],v[76:77] op_sel:[0,0,0] op_sel_hi:[1,0,0]
v_rcp_f32 v200,v200
v_rcp_f32 v201,v201
v_rcp_f32 v202,v202
v_rcp_f32 v203,v203
v_rcp_f32 v216,v216
v_rcp_f32 v217,v217
v_rcp_f32 v218,v218
v_rcp_f32 v219,v219
s_nop 0
v_pk_mul_f32 v[200:201],v[200:201],v[232:233] op_sel:[0,0] op_sel_hi:[1,1]
v_pk_mul_f32 v[202:203],v[202:203],v[234:235] op_sel:[0,0] op_sel_hi:[1,1]
v_pk_mul_f32 v[216:217],v[216:217],v[248:249] op_sel:[0,0] op_sel_hi:[1,1]
v_pk_mul_f32 v[218:219],v[218:219],v[250:251] op_sel:[0,0] op_sel_hi:[1,1]
v_cvt_pk_bf16_f32 v200,v200,v201
v_cvt_pk_bf16_f32 v201,v202,v203
v_cvt_pk_bf16_f32 v202,v216,v217
v_cvt_pk_bf16_f32 v203,v218,v219
v_pk_fma_f32 v[204:205],v[40:41],v[62:63],v[204:205] op_sel:[0,0,0] op_sel_hi:[1,0,1]
v_pk_fma_f32 v[206:207],v[42:43],v[62:63],v[206:207] op_sel:[0,0,0] op_sel_hi:[1,0,1]
v_pk_fma_f32 v[220:221],v[44:45],v[62:63],v[220:221] op_sel:[0,0,0] op_sel_hi:[1,0,1]
v_pk_fma_f32 v[222:223],v[46:47],v[62:63],v[222:223] op_sel:[0,0,0] op_sel_hi:[1,0,1]
v_pk_mul_f32 v[204:205],v[204:205],v[70:71] op_sel:[0,0] op_sel_hi:[1,0]
v_pk_mul_f32 v[206:207],v[206:207],v[70:71] op_sel:[0,0] op_sel_hi:[1,0]
v_pk_mul_f32 v[220:221],v[220:221],v[70:71] op_sel:[0,0] op_sel_hi:[1,0]
v_pk_mul_f32 v[222:223],v[222:223],v[70:71] op_sel:[0,0] op_sel_hi:[1,0]
v_exp_f32 v204,v204
v_exp_f32 v205,v205
v_exp_f32 v206,v206
v_exp_f32 v207,v207
v_exp_f32 v220,v220
v_exp_f32 v221,v221
v_exp_f32 v222,v222
v_exp_f32 v223,v223
v_pk_fma_f32 v[236:237],v[48:49],v[62:63],v[236:237] op_sel:[0,0,0] op_sel_hi:[1,0,1]
v_pk_fma_f32 v[238:239],v[50:51],v[62:63],v[238:239] op_sel:[0,0,0] op_sel_hi:[1,0,1]
v_pk_fma_f32 v[252:253],v[52:53],v[62:63],v[252:253] op_sel:[0,0,0] op_sel_hi:[1,0,1]
v_pk_fma_f32 v[254:255],v[54:55],v[62:63],v[254:255] op_sel:[0,0,0] op_sel_hi:[1,0,1]
v_pk_fma_f32 v[204:205],v[204:205],v[78:79],v[78:79] op_sel:[0,0,0] op_sel_hi:[1,0,0]
v_pk_fma_f32 v[206:207],v[206:207],v[78:79],v[78:79] op_sel:[0,0,0] op_sel_hi:[1,0,0]
v_pk_fma_f32 v[220:221],v[220:221],v[78:79],v[78:79] op_sel:[0,0,0] op_sel_hi:[1,0,0]
v_pk_fma_f32 v[222:223],v[222:223],v[78:79],v[78:79] op_sel:[0,0,0] op_sel_hi:[1,0,0]
v_rcp_f32 v204,v204
v_rcp_f32 v205,v205
v_rcp_f32 v206,v206
v_rcp_f32 v207,v207
v_rcp_f32 v220,v220
v_rcp_f32 v221,v221
v_rcp_f32 v222,v222
v_rcp_f32 v223,v223
s_nop 0
v_pk_mul_f32 v[204:205],v[204:205],v[236:237] op_sel:[0,0] op_sel_hi:[1,1]
v_pk_mul_f32 v[206:207],v[206:207],v[238:239] op_sel:[0,0] op_sel_hi:[1,1]
v_pk_mul_f32 v[220:221],v[220:221],v[252:253] op_sel:[0,0] op_sel_hi:[1,1]
v_pk_mul_f32 v[222:223],v[222:223],v[254:255] op_sel:[0,0] op_sel_hi:[1,1]
v_cvt_pk_bf16_f32 v204,v204,v205
v_cvt_pk_bf16_f32 v205,v206,v207
v_cvt_pk_bf16_f32 v206,v220,v221
v_cvt_pk_bf16_f32 v207,v222,v223
v_mov_b32 v2,161792
v_mov_b32 v3,1
s_waitcnt vmcnt(0)
s_mov_b64 exec,1
ds_add_rtn_u32 v3,v2,v3 offset:48
s_mov_b64 exec,-1
s_add_u32 s50,s49,0
buffer_store_dwordx4 v[192:195],v1,s[36:39],s50 offen sc1
s_add_u32 s50,s49,147456
buffer_store_dwordx4 v[196:199],v1,s[36:39],s50 offen sc1
s_add_u32 s50,s49,294912
buffer_store_dwordx4 v[200:203],v1,s[36:39],s50 offen sc1
s_add_u32 s50,s49,442368
buffer_store_dwordx4 v[204:207],v1,s[36:39],s50 offen sc1
s_lshl_b32 s51,s43,1
s_and_b32 s52,s44,1
s_add_u32 s51,s51,s52
s_lshl_b32 s51,s51,2
s_lshl_b32 s52,s45,13
s_add_u32 s51,s51,s52
s_add_u32 s51,s51,42074112
s_waitcnt lgkmcnt(0)
v_readfirstlane_b32 s52,v3
v_lshlrev_b32 v3,9,v0
s_cmp_lg_u32 s52,7
s_cbranch_scc1 g2_nq2
s_mov_b64 exec,0xffff
buffer_store_dword v2,v3,s[36:39],s51 offen sc1
s_mov_b64 exec,-1
g2_nq2:
s_cmp_eq_u32 s100,-1
s_cbranch_scc1 af_entry
s_branch m_hnext
.p2align 6
g2_sp2:
s_waitcnt lgkmcnt(15)
v_mfma_f32_16x16x32_bf16 v[96:99],v[16:19],v[56:59],v[96:99]
v_mfma_f32_16x16x32_bf16 v[100:103],v[16:19],v[60:63],v[100:103]
v_mfma_f32_16x16x32_bf16 v[104:107],v[16:19],v[64:67],v[104:107]
v_mfma_f32_16x16x32_bf16 v[108:111],v[16:19],v[68:71],v[108:111]
s_waitcnt vmcnt(10) lgkmcnt(0)
s_barrier
s_bitcmp1_b32 s68,0
s_cbranch_scc0 g2_c2_1
v_lshlrev_b32 v12,16,v16
v_and_b32 v13,s69,v16
v_add_f32 v14,v12,v13
v_lshlrev_b32 v12,16,v17
v_and_b32 v13,s69,v17
v_add_f32 v14,v14,v12
v_add_f32 v14,v14,v13
v_lshlrev_b32 v12,16,v18
v_and_b32 v13,s69,v18
v_add_f32 v14,v14,v12
v_add_f32 v14,v14,v13
v_lshlrev_b32 v12,16,v19
v_and_b32 v13,s69,v19
v_add_f32 v14,v14,v12
v_add_f32 v14,v14,v13
g2_c2_1:
ds_read_b64_tr_b16 v[16:17],v1 offset:20480
v_mfma_f32_16x16x32_bf16 v[112:115],v[20:23],v[56:59],v[112:115]
ds_read_b64_tr_b16 v[18:19],v1 offset:21504
v_mfma_f32_16x16x32_bf16 v[116:119],v[20:23],v[60:63],v[116:119]
ds_read_b128 v[72:75],v94 offset:0
v_mfma_f32_16x16x32_bf16 v[120:123],v[20:23],v[64:67],v[120:123]
ds_read_b128 v[76:79],v94 offset:2048
v_mfma_f32_16x16x32_bf16 v[124:127],v[20:23],v[68:71],v[124:127]
s_bitcmp1_b32 s68,1
s_cbranch_scc0 g2_c2_2
v_lshlrev_b32 v12,16,v20
v_and_b32 v13,s69,v20
v_add_f32 v14,v12,v13
v_lshlrev_b32 v12,16,v21
v_and_b32 v13,s69,v21
v_add_f32 v14,v14,v12
v_add_f32 v14,v14,v13
v_lshlrev_b32 v12,16,v22
v_and_b32 v13,s69,v22
v_add_f32 v14,v14,v12
v_add_f32 v14,v14,v13
v_lshlrev_b32 v12,16,v23
v_and_b32 v13,s69,v23
v_add_f32 v14,v14,v12
v_add_f32 v14,v14,v13
g2_c2_2:
ds_read_b64_tr_b16 v[20:21],v2 offset:20480
v_mfma_f32_16x16x32_bf16 v[128:131],v[24:27],v[56:59],v[128:131]
ds_read_b64_tr_b16 v[22:23],v2 offset:21504
v_mfma_f32_16x16x32_bf16 v[132:135],v[24:27],v[60:63],v[132:135]
ds_read_b128 v[80:83],v94 offset:4096
v_mfma_f32_16x16x32_bf16 v[136:139],v[24:27],v[64:67],v[136:139]
ds_read_b128 v[84:87],v94 offset:6144
v_mfma_f32_16x16x32_bf16 v[140:143],v[24:27],v[68:71],v[140:143]
s_bitcmp1_b32 s68,2
s_cbranch_scc0 g2_c2_3
v_lshlrev_b32 v12,16,v24
v_and_b32 v13,s69,v24
v_add_f32 v14,v12,v13
v_lshlrev_b32 v12,16,v25
v_and_b32 v13,s69,v25
v_add_f32 v14,v14,v12
v_add_f32 v14,v14,v13
v_lshlrev_b32 v12,16,v26
v_and_b32 v13,s69,v26
v_add_f32 v14,v14,v12
v_add_f32 v14,v14,v13
v_lshlrev_b32 v12,16,v27
v_and_b32 v13,s69,v27
v_add_f32 v14,v14,v12
v_add_f32 v14,v14,v13
g2_c2_3:
ds_read_b64_tr_b16 v[24:25],v3 offset:20480
v_mfma_f32_16x16x32_bf16 v[144:147],v[28:31],v[56:59],v[144:147]
ds_read_b64_tr_b16 v[26:27],v3 offset:21504
v_mfma_f32_16x16x32_bf16 v[148:151],v[28:31],v[60:63],v[148:151]
s_add_u32 m0,s54,0
s_nop 0
buffer_load_dwordx4 v88,s[20:23],s48 offen lds
v_mfma_f32_16x16x32_bf16 v[152:155],v[28:31],v[64:67],v[152:155]
v_mfma_f32_16x16x32_bf16 v[156:159],v[28:31],v[68:71],v[156:159]
s_bitcmp1_b32 s68,3
s_cbranch_scc0 g2_c2_4
v_lshlrev_b32 v12,16,v28
v_and_b32 v13,s69,v28
v_add_f32 v14,v12,v13
v_lshlrev_b32 v12,16,v29
v_and_b32 v13,s69,v29
v_add_f32 v14,v14,v12
v_add_f32 v14,v14,v13
v_lshlrev_b32 v12,16,v30
v_and_b32 v13,s69,v30
v_add_f32 v14,v14,v12
v_add_f32 v14,v14,v13
v_lshlrev_b32 v12,16,v31
v_and_b32 v13,s69,v31
v_add_f32 v14,v14,v12
v_add_f32 v14,v14,v13
g2_c2_4:
ds_read_b64_tr_b16 v[28:29],v4 offset:20480
v_mfma_f32_16x16x32_bf16 v[160:163],v[32:35],v[56:59],v[160:163]
ds_read_b64_tr_b16 v[30:31],v4 offset:21504
v_mfma_f32_16x16x32_bf16 v[164:167],v[32:35],v[60:63],v[164:167]
s_add_u32 m0,s54,4096
s_nop 0
buffer_load_dwordx4 v89,s[20:23],s48 offen lds
v_mfma_f32_16x16x32_bf16 v[168:171],v[32:35],v[64:67],v[168:171]
v_mfma_f32_16x16x32_bf16 v[172:175],v[32:35],v[68:71],v[172:175]
s_bitcmp1_b32 s68,4
s_cbranch_scc0 g2_c2_5
v_lshlrev_b32 v12,16,v32
v_and_b32 v13,s69,v32
v_add_f32 v15,v12,v13
v_lshlrev_b32 v12,16,v33
v_and_b32 v13,s69,v33
v_add_f32 v15,v15,v12
v_add_f32 v15,v15,v13
v_lshlrev_b32 v12,16,v34
v_and_b32 v13,s69,v34
v_add_f32 v15,v15,v12
v_add_f32 v15,v15,v13
v_lshlrev_b32 v12,16,v35
v_and_b32 v13,s69,v35
v_add_f32 v15,v15,v12
v_add_f32 v15,v15,v13
g2_c2_5:
ds_read_b64_tr_b16 v[32:33],v5 offset:20480
v_mfma_f32_16x16x32_bf16 v[176:179],v[36:39],v[56:59],v[176:179]
ds_read_b64_tr_b16 v[34:35],v5 offset:21504
v_mfma_f32_16x16x32_bf16 v[180:183],v[36:39],v[60:63],v[180:183]
s_add_u32 m0,s54,8192
s_nop 0
buffer_load_dwordx4 v90,s[24:27],s49 offen lds
v_mfma_f32_16x16x32_bf16 v[184:187],v[36:39],v[64:67],v[184:187]
v_mfma_f32_16x16x32_bf16 v[188:191],v[36:39],v[68:71],v[188:191]
s_bitcmp1_b32 s68,5
s_cbranch_scc0 g2_c2_6
v_lshlrev_b32 v12,16,v36
v_and_b32 v13,s69,v36
v_add_f32 v15,v12,v13
v_lshlrev_b32 v12,16,v37
v_and_b32 v13,s69,v37
v_add_f32 v15,v15,v12
v_add_f32 v15,v15,v13
v_lshlrev_b32 v12,16,v38
v_and_b32 v13,s69,v38
v_add_f32 v15,v15,v12
v_add_f32 v15,v15,v13
v_lshlrev_b32 v12,16,v39
v_and_b32 v13,s69,v39
v_add_f32 v15,v15,v12
v_add_f32 v15,v15,v13
g2_c2_6:
ds_read_b64_tr_b16 v[36:37],v6 offset:20480
v_mfma_f32_16x16x32_bf16 v[192:195],v[40:43],v[56:59],v[192:195]
ds_read_b64_tr_b16 v[38:39],v6 offset:21504
v_mfma_f32_16x16x32_bf16 v[196:199],v[40:43],v[60:63],v[196:199]
s_add_u32 m0,s54,12288
s_nop 0
buffer_load_dwordx4 v91,s[32:35],s49 offen lds
v_mfma_f32_16x16x32_bf16 v[200:203],v[40:43],v[64:67],v[200:203]
v_mfma_f32_16x16x32_bf16 v[204:207],v[40:43],v[68:71],v[204:207]
s_bitcmp1_b32 s68,6
s_cbranch_scc0 g2_c2_7
v_lshlrev_b32 v12,16,v40
v_and_b32 v13,s69,v40
v_add_f32 v15,v12,v13
v_lshlrev_b32 v12,16,v41
v_and_b32 v13,s69,v41
v_add_f32 v15,v15,v12
v_add_f32 v15,v15,v13
v_lshlrev_b32 v12,16,v42
v_and_b32 v13,s69,v42
v_add_f32 v15,v15,v12
v_add_f32 v15,v15,v13
v_lshlrev_b32 v12,16,v43
v_and_b32 v13,s69,v43
v_add_f32 v15,v15,v12
v_add_f32 v15,v15,v13
g2_c2_7:
ds_read_b64_tr_b16 v[40:41],v7 offset:20480
v_mfma_f32_16x16x32_bf16 v[208:211],v[44:47],v[56:59],v[208:211]
ds_read_b64_tr_b16 v[42:43],v7 offset:21248
v_mfma_f32_16x16x32_bf16 v[212:215],v[44:47],v[60:63],v[212:215]
s_add_u32 m0,s54,16384
s_nop 0
buffer_load_dwordx4 v92,s[28:31],s49 offen lds
s_add_u32 s48,s48,196608
s_add_u32 s49,s49,229376
v_mfma_f32_16x16x32_bf16 v[216:219],v[44:47],v[64:67],v[216:219]
v_mfma_f32_16x16x32_bf16 v[220:223],v[44:47],v[68:71],v[220:223]
s_bitcmp1_b32 s68,7
s_cbranch_scc0 g2_c2_8
v_lshlrev_b32 v12,16,v44
v_and_b32 v13,s69,v44
v_add_f32 v15,v12,v13
v_lshlrev_b32 v12,16,v45
v_and_b32 v13,s69,v45
v_add_f32 v15,v15,v12
v_add_f32 v15,v15,v13
v_lshlrev_b32 v12,16,v46
v_and_b32 v13,s69,v46
v_add_f32 v15,v15,v12
v_add_f32 v15,v15,v13
v_lshlrev_b32 v12,16,v47
v_and_b32 v13,s69,v47
v_add_f32 v15,v15,v12
v_add_f32 v15,v15,v13
g2_c2_8:
ds_read_b64_tr_b16 v[44:45],v8 offset:20480
v_mfma_f32_16x16x32_bf16 v[224:227],v[48:51],v[56:59],v[224:227]
ds_read_b64_tr_b16 v[46:47],v8 offset:21248
v_mfma_f32_16x16x32_bf16 v[228:231],v[48:51],v[60:63],v[228:231]
v_mfma_f32_16x16x32_bf16 v[232:235],v[48:51],v[64:67],v[232:235]
v_mfma_f32_16x16x32_bf16 v[236:239],v[48:51],v[68:71],v[236:239]
s_bitcmp1_b32 s68,8
s_cbranch_scc0 g2_c2_9
v_lshlrev_b32 v12,16,v48
v_and_b32 v13,s69,v48
v_add_f32 v93,v12,v13
v_lshlrev_b32 v12,16,v49
v_and_b32 v13,s69,v49
v_add_f32 v93,v93,v12
v_add_f32 v93,v93,v13
v_lshlrev_b32 v12,16,v50
v_and_b32 v13,s69,v50
v_add_f32 v93,v93,v12
v_add_f32 v93,v93,v13
v_lshlrev_b32 v12,16,v51
v_and_b32 v13,s69,v51
v_add_f32 v93,v93,v12
v_add_f32 v93,v93,v13
g2_c2_9:
ds_read_b64_tr_b16 v[48:49],v9 offset:20480
v_mfma_f32_16x16x32_bf16 v[240:243],v[52:55],v[56:59],v[240:243]
ds_read_b64_tr_b16 v[50:51],v9 offset:21248
v_mfma_f32_16x16x32_bf16 v[244:247],v[52:55],v[60:63],v[244:247]
v_mfma_f32_16x16x32_bf16 v[248:251],v[52:55],v[64:67],v[248:251]
v_mfma_f32_16x16x32_bf16 v[252:255],v[52:55],v[68:71],v[252:255]
s_bitcmp1_b32 s68,9
s_cbranch_scc0 g2_c2_10
v_lshlrev_b32 v12,16,v52
v_and_b32 v13,s69,v52
v_add_f32 v93,v12,v13
v_lshlrev_b32 v12,16,v53
v_and_b32 v13,s69,v53
v_add_f32 v93,v93,v12
v_add_f32 v93,v93,v13
v_lshlrev_b32 v12,16,v54
v_and_b32 v13,s69,v54
v_add_f32 v93,v93,v12
v_add_f32 v93,v93,v13
v_lshlrev_b32 v12,16,v55
v_and_b32 v13,s69,v55
v_add_f32 v93,v93,v12
v_add_f32 v93,v93,v13
g2_c2_10:
ds_read_b64_tr_b16 v[52:53],v10 offset:20480
ds_read_b64_tr_b16 v[54:55],v10 offset:21248
s_waitcnt lgkmcnt(15)
v_mfma_f32_16x16x32_bf16 v[96:99],v[16:19],v[72:75],v[96:99]
v_mfma_f32_16x16x32_bf16 v[100:103],v[16:19],v[76:79],v[100:103]
v_mfma_f32_16x16x32_bf16 v[104:107],v[16:19],v[80:83],v[104:107]
v_mfma_f32_16x16x32_bf16 v[108:111],v[16:19],v[84:87],v[108:111]
s_waitcnt vmcnt(10) lgkmcnt(0)
s_barrier
s_bitcmp1_b32 s68,0
s_cbranch_scc0 g2_c2_11
v_lshlrev_b32 v12,16,v16
v_and_b32 v13,s69,v16
v_add_f32 v14,v14,v12
v_add_f32 v14,v14,v13
v_lshlrev_b32 v12,16,v17
v_and_b32 v13,s69,v17
v_add_f32 v14,v14,v12
v_add_f32 v14,v14,v13
v_lshlrev_b32 v12,16,v18
v_and_b32 v13,s69,v18
v_add_f32 v14,v14,v12
v_add_f32 v14,v14,v13
v_lshlrev_b32 v12,16,v19
v_and_b32 v13,s69,v19
v_add_f32 v14,v14,v12
v_add_f32 v14,v14,v13
g2_c2_11:
ds_read_b64_tr_b16 v[16:17],v1 offset:40960
v_mfma_f32_16x16x32_bf16 v[112:115],v[20:23],v[72:75],v[112:115]
ds_read_b64_tr_b16 v[18:19],v1 offset:41984
v_mfma_f32_16x16x32_bf16 v[116:119],v[20:23],v[76:79],v[116:119]
ds_read_b128 v[56:59],v11 offset:32768
v_mfma_f32_16x16x32_bf16 v[120:123],v[20:23],v[80:83],v[120:123]
ds_read_b128 v[60:63],v11 offset:34816
v_mfma_f32_16x16x32_bf16 v[124:127],v[20:23],v[84:87],v[124:127]
s_bitcmp1_b32 s68,1
s_cbranch_scc0 g2_c2_12
v_lshlrev_b32 v12,16,v20
v_and_b32 v13,s69,v20
v_add_f32 v14,v14,v12
v_add_f32 v14,v14,v13
v_lshlrev_b32 v12,16,v21
v_and_b32 v13,s69,v21
v_add_f32 v14,v14,v12
v_add_f32 v14,v14,v13
v_lshlrev_b32 v12,16,v22
v_and_b32 v13,s69,v22
v_add_f32 v14,v14,v12
v_add_f32 v14,v14,v13
v_lshlrev_b32 v12,16,v23
v_and_b32 v13,s69,v23
v_add_f32 v14,v14,v12
v_add_f32 v14,v14,v13
g2_c2_12:
ds_read_b64_tr_b16 v[20:21],v2 offset:40960
v_mfma_f32_16x16x32_bf16 v[128:131],v[24:27],v[72:75],v[128:131]
ds_read_b64_tr_b16 v[22:23],v2 offset:41984
v_mfma_f32_16x16x32_bf16 v[132:135],v[24:27],v[76:79],v[132:135]
ds_read_b128 v[64:67],v11 offset:36864
v_mfma_f32_16x16x32_bf16 v[136:139],v[24:27],v[80:83],v[136:139]
ds_read_b128 v[68:71],v11 offset:38912
v_mfma_f32_16x16x32_bf16 v[140:143],v[24:27],v[84:87],v[140:143]
s_bitcmp1_b32 s68,2
s_cbranch_scc0 g2_c2_13
v_lshlrev_b32 v12,16,v24
v_and_b32 v13,s69,v24
v_add_f32 v14,v14,v12
v_add_f32 v14,v14,v13
v_lshlrev_b32 v12,16,v25
v_and_b32 v13,s69,v25
v_add_f32 v14,v14,v12
v_add_f32 v14,v14,v13
v_lshlrev_b32 v12,16,v26
v_and_b32 v13,s69,v26
v_add_f32 v14,v14,v12
v_add_f32 v14,v14,v13
v_lshlrev_b32 v12,16,v27
v_and_b32 v13,s69,v27
v_add_f32 v14,v14,v12
v_add_f32 v14,v14,v13
g2_c2_13:
ds_read_b64_tr_b16 v[24:25],v3 offset:40960
v_mfma_f32_16x16x32_bf16 v[144:147],v[28:31],v[72:75],v[144:147]
ds_read_b64_tr_b16 v[26:27],v3 offset:41984
v_mfma_f32_16x16x32_bf16 v[148:151],v[28:31],v[76:79],v[148:151]
s_add_u32 m0,s54,20480
s_nop 0
buffer_load_dwordx4 v88,s[20:23],s48 offen lds
v_mfma_f32_16x16x32_bf16 v[152:155],v[28:31],v[80:83],v[152:155]
v_mfma_f32_16x16x32_bf16 v[156:159],v[28:31],v[84:87],v[156:159]
s_bitcmp1_b32 s68,3
s_cbranch_scc0 g2_c2_14
v_lshlrev_b32 v12,16,v28
v_and_b32 v13,s69,v28
v_add_f32 v14,v14,v12
v_add_f32 v14,v14,v13
v_lshlrev_b32 v12,16,v29
v_and_b32 v13,s69,v29
v_add_f32 v14,v14,v12
v_add_f32 v14,v14,v13
v_lshlrev_b32 v12,16,v30
v_and_b32 v13,s69,v30
v_add_f32 v14,v14,v12
v_add_f32 v14,v14,v13
v_lshlrev_b32 v12,16,v31
v_and_b32 v13,s69,v31
v_add_f32 v14,v14,v12
v_add_f32 v14,v14,v13
g2_c2_14:
ds_read_b64_tr_b16 v[28:29],v4 offset:40960
v_mfma_f32_16x16x32_bf16 v[160:163],v[32:35],v[72:75],v[160:163]
ds_read_b64_tr_b16 v[30:31],v4 offset:41984
v_mfma_f32_16x16x32_bf16 v[164:167],v[32:35],v[76:79],v[164:167]
s_add_u32 m0,s54,24576
s_nop 0
buffer_load_dwordx4 v89,s[20:23],s48 offen lds
v_mfma_f32_16x16x32_bf16 v[168:171],v[32:35],v[80:83],v[168:171]
v_mfma_f32_16x16x32_bf16 v[172:175],v[32:35],v[84:87],v[172:175]
s_bitcmp1_b32 s68,4
s_cbranch_scc0 g2_c2_15
v_lshlrev_b32 v12,16,v32
v_and_b32 v13,s69,v32
v_add_f32 v15,v15,v12
v_add_f32 v15,v15,v13
v_lshlrev_b32 v12,16,v33
v_and_b32 v13,s69,v33
v_add_f32 v15,v15,v12
v_add_f32 v15,v15,v13
v_lshlrev_b32 v12,16,v34
v_and_b32 v13,s69,v34
v_add_f32 v15,v15,v12
v_add_f32 v15,v15,v13
v_lshlrev_b32 v12,16,v35
v_and_b32 v13,s69,v35
v_add_f32 v15,v15,v12
v_add_f32 v15,v15,v13
g2_c2_15:
ds_read_b64_tr_b16 v[32:33],v5 offset:40960
v_mfma_f32_16x16x32_bf16 v[176:179],v[36:39],v[72:75],v[176:179]
ds_read_b64_tr_b16 v[34:35],v5 offset:41984
v_mfma_f32_16x16x32_bf16 v[180:183],v[36:39],v[76:79],v[180:183]
s_add_u32 m0,s54,28672
s_nop 0
buffer_load_dwordx4 v90,s[24:27],s49 offen lds
v_mfma_f32_16x16x32_bf16 v[184:187],v[36:39],v[80:83],v[184:187]
v_mfma_f32_16x16x32_bf16 v[188:191],v[36:39],v[84:87],v[188:191]
s_bitcmp1_b32 s68,5
s_cbranch_scc0 g2_c2_16
v_lshlrev_b32 v12,16,v36
v_and_b32 v13,s69,v36
v_add_f32 v15,v15,v12
v_add_f32 v15,v15,v13
v_lshlrev_b32 v12,16,v37
v_and_b32 v13,s69,v37
v_add_f32 v15,v15,v12
v_add_f32 v15,v15,v13
v_lshlrev_b32 v12,16,v38
v_and_b32 v13,s69,v38
v_add_f32 v15,v15,v12
v_add_f32 v15,v15,v13
v_lshlrev_b32 v12,16,v39
v_and_b32 v13,s69,v39
v_add_f32 v15,v15,v12
v_add_f32 v15,v15,v13
g2_c2_16:
ds_read_b64_tr_b16 v[36:37],v6 offset:40960
v_mfma_f32_16x16x32_bf16 v[192:195],v[40:43],v[72:75],v[192:195]
ds_read_b64_tr_b16 v[38:39],v6 offset:41984
v_mfma_f32_16x16x32_bf16 v[196:199],v[40:43],v[76:79],v[196:199]
s_add_u32 m0,s54,32768
s_nop 0
buffer_load_dwordx4 v91,s[32:35],s49 offen lds
v_mfma_f32_16x16x32_bf16 v[200:203],v[40:43],v[80:83],v[200:203]
v_mfma_f32_16x16x32_bf16 v[204:207],v[40:43],v[84:87],v[204:207]
s_bitcmp1_b32 s68,6
s_cbranch_scc0 g2_c2_17
v_lshlrev_b32 v12,16,v40
v_and_b32 v13,s69,v40
v_add_f32 v15,v15,v12
v_add_f32 v15,v15,v13
v_lshlrev_b32 v12,16,v41
v_and_b32 v13,s69,v41
v_add_f32 v15,v15,v12
v_add_f32 v15,v15,v13
v_lshlrev_b32 v12,16,v42
v_and_b32 v13,s69,v42
v_add_f32 v15,v15,v12
v_add_f32 v15,v15,v13
v_lshlrev_b32 v12,16,v43
v_and_b32 v13,s69,v43
v_add_f32 v15,v15,v12
v_add_f32 v15,v15,v13
g2_c2_17:
ds_read_b64_tr_b16 v[40:41],v7 offset:40960
v_mfma_f32_16x16x32_bf16 v[208:211],v[44:47],v[72:75],v[208:211]
ds_read_b64_tr_b16 v[42:43],v7 offset:41728
v_mfma_f32_16x16x32_bf16 v[212:215],v[44:47],v[76:79],v[212:215]
s_add_u32 m0,s54,36864
s_nop 0
buffer_load_dwordx4 v92,s[28:31],s49 offen lds
s_add_u32 s48,s48,196608
s_add_u32 s49,s49,229376
v_mfma_f32_16x16x32_bf16 v[216:219],v[44:47],v[80:83],v[216:219]
v_mfma_f32_16x16x32_bf16 v[220:223],v[44:47],v[84:87],v[220:223]
s_bitcmp1_b32 s68,7
s_cbranch_scc0 g2_c2_18
v_lshlrev_b32 v12,16,v44
v_and_b32 v13,s69,v44
v_add_f32 v15,v15,v12
v_add_f32 v15,v15,v13
v_lshlrev_b32 v12,16,v45
v_and_b32 v13,s69,v45
v_add_f32 v15,v15,v12
v_add_f32 v15,v15,v13
v_lshlrev_b32 v12,16,v46
v_and_b32 v13,s69,v46
v_add_f32 v15,v15,v12
v_add_f32 v15,v15,v13
v_lshlrev_b32 v12,16,v47
v_and_b32 v13,s69,v47
v_add_f32 v15,v15,v12
v_add_f32 v15,v15,v13
g2_c2_18:
ds_read_b64_tr_b16 v[44:45],v8 offset:40960
v_mfma_f32_16x16x32_bf16 v[224:227],v[48:51],v[72:75],v[224:227]
ds_read_b64_tr_b16 v[46:47],v8 offset:41728
v_mfma_f32_16x16x32_bf16 v[228:231],v[48:51],v[76:79],v[228:231]
v_mfma_f32_16x16x32_bf16 v[232:235],v[48:51],v[80:83],v[232:235]
v_mfma_f32_16x16x32_bf16 v[236:239],v[48:51],v[84:87],v[236:239]
s_bitcmp1_b32 s68,8
s_cbranch_scc0 g2_c2_19
v_lshlrev_b32 v12,16,v48
v_and_b32 v13,s69,v48
v_add_f32 v93,v93,v12
v_add_f32 v93,v93,v13
v_lshlrev_b32 v12,16,v49
v_and_b32 v13,s69,v49
v_add_f32 v93,v93,v12
v_add_f32 v93,v93,v13
v_lshlrev_b32 v12,16,v50
v_and_b32 v13,s69,v50
v_add_f32 v93,v93,v12
v_add_f32 v93,v93,v13
v_lshlrev_b32 v12,16,v51
v_and_b32 v13,s69,v51
v_add_f32 v93,v93,v12
v_add_f32 v93,v93,v13
g2_c2_19:
ds_read_b64_tr_b16 v[48:49],v9 offset:40960
v_mfma_f32_16x16x32_bf16 v[240:243],v[52:55],v[72:75],v[240:243]
ds_read_b64_tr_b16 v[50:51],v9 offset:41728
v_mfma_f32_16x16x32_bf16 v[244:247],v[52:55],v[76:79],v[244:247]
v_mfma_f32_16x16x32_bf16 v[248:251],v[52:55],v[80:83],v[248:251]
v_mfma_f32_16x16x32_bf16 v[252:255],v[52:55],v[84:87],v[252:255]
s_bitcmp1_b32 s68,9
s_cbranch_scc0 g2_c2_20
v_lshlrev_b32 v12,16,v52
v_and_b32 v13,s69,v52
v_add_f32 v93,v93,v12
v_add_f32 v93,v93,v13
v_lshlrev_b32 v12,16,v53
v_and_b32 v13,s69,v53
v_add_f32 v93,v93,v12
v_add_f32 v93,v93,v13
v_lshlrev_b32 v12,16,v54
v_and_b32 v13,s69,v54
v_add_f32 v93,v93,v12
v_add_f32 v93,v93,v13
v_lshlrev_b32 v12,16,v55
v_and_b32 v13,s69,v55
v_add_f32 v93,v93,v12
v_add_f32 v93,v93,v13
g2_c2_20:
ds_read_b64_tr_b16 v[52:53],v10 offset:40960
ds_read_b64_tr_b16 v[54:55],v10 offset:41728
s_waitcnt lgkmcnt(15)
v_mfma_f32_16x16x32_bf16 v[96:99],v[16:19],v[56:59],v[96:99]
v_mfma_f32_16x16x32_bf16 v[100:103],v[16:19],v[60:63],v[100:103]
v_mfma_f32_16x16x32_bf16 v[104:107],v[16:19],v[64:67],v[104:107]
v_mfma_f32_16x16x32_bf16 v[108:111],v[16:19],v[68:71],v[108:111]
s_waitcnt vmcnt(10) lgkmcnt(0)
s_barrier
s_bitcmp1_b32 s68,0
s_cbranch_scc0 g2_c2_21
v_lshlrev_b32 v12,16,v16
v_and_b32 v13,s69,v16
v_add_f32 v14,v14,v12
v_add_f32 v14,v14,v13
v_lshlrev_b32 v12,16,v17
v_and_b32 v13,s69,v17
v_add_f32 v14,v14,v12
v_add_f32 v14,v14,v13
v_lshlrev_b32 v12,16,v18
v_and_b32 v13,s69,v18
v_add_f32 v14,v14,v12
v_add_f32 v14,v14,v13
v_lshlrev_b32 v12,16,v19
v_and_b32 v13,s69,v19
v_add_f32 v14,v14,v12
v_add_f32 v14,v14,v13
g2_c2_21:
ds_read_b64_tr_b16 v[16:17],v1 offset:61440
v_mfma_f32_16x16x32_bf16 v[112:115],v[20:23],v[56:59],v[112:115]
ds_read_b64_tr_b16 v[18:19],v1 offset:62464
v_mfma_f32_16x16x32_bf16 v[116:119],v[20:23],v[60:63],v[116:119]
ds_read_b128 v[72:75],v94 offset:32768
v_mfma_f32_16x16x32_bf16 v[120:123],v[20:23],v[64:67],v[120:123]
ds_read_b128 v[76:79],v94 offset:34816
v_mfma_f32_16x16x32_bf16 v[124:127],v[20:23],v[68:71],v[124:127]
s_bitcmp1_b32 s68,1
s_cbranch_scc0 g2_c2_22
v_lshlrev_b32 v12,16,v20
v_and_b32 v13,s69,v20
v_add_f32 v14,v14,v12
v_add_f32 v14,v14,v13
v_lshlrev_b32 v12,16,v21
v_and_b32 v13,s69,v21
v_add_f32 v14,v14,v12
v_add_f32 v14,v14,v13
v_lshlrev_b32 v12,16,v22
v_and_b32 v13,s69,v22
v_add_f32 v14,v14,v12
v_add_f32 v14,v14,v13
v_lshlrev_b32 v12,16,v23
v_and_b32 v13,s69,v23
v_add_f32 v14,v14,v12
v_add_f32 v14,v14,v13
g2_c2_22:
ds_read_b64_tr_b16 v[20:21],v2 offset:61440
v_mfma_f32_16x16x32_bf16 v[128:131],v[24:27],v[56:59],v[128:131]
ds_read_b64_tr_b16 v[22:23],v2 offset:62464
v_mfma_f32_16x16x32_bf16 v[132:135],v[24:27],v[60:63],v[132:135]
ds_read_b128 v[80:83],v94 offset:36864
v_mfma_f32_16x16x32_bf16 v[136:139],v[24:27],v[64:67],v[136:139]
ds_read_b128 v[84:87],v94 offset:38912
v_mfma_f32_16x16x32_bf16 v[140:143],v[24:27],v[68:71],v[140:143]
s_bitcmp1_b32 s68,2
s_cbranch_scc0 g2_c2_23
v_lshlrev_b32 v12,16,v24
v_and_b32 v13,s69,v24
v_add_f32 v14,v14,v12
v_add_f32 v14,v14,v13
v_lshlrev_b32 v12,16,v25
v_and_b32 v13,s69,v25
v_add_f32 v14,v14,v12
v_add_f32 v14,v14,v13
v_lshlrev_b32 v12,16,v26
v_and_b32 v13,s69,v26
v_add_f32 v14,v14,v12
v_add_f32 v14,v14,v13
v_lshlrev_b32 v12,16,v27
v_and_b32 v13,s69,v27
v_add_f32 v14,v14,v12
v_add_f32 v14,v14,v13
g2_c2_23:
ds_read_b64_tr_b16 v[24:25],v3 offset:61440
v_mfma_f32_16x16x32_bf16 v[144:147],v[28:31],v[56:59],v[144:147]
ds_read_b64_tr_b16 v[26:27],v3 offset:62464
v_mfma_f32_16x16x32_bf16 v[148:151],v[28:31],v[60:63],v[148:151]
s_add_u32 m0,s54,40960
s_nop 0
buffer_load_dwordx4 v88,s[20:23],s48 offen lds
v_mfma_f32_16x16x32_bf16 v[152:155],v[28:31],v[64:67],v[152:155]
v_mfma_f32_16x16x32_bf16 v[156:159],v[28:31],v[68:71],v[156:159]
s_bitcmp1_b32 s68,3
s_cbranch_scc0 g2_c2_24
v_lshlrev_b32 v12,16,v28
v_and_b32 v13,s69,v28
v_add_f32 v14,v14,v12
v_add_f32 v14,v14,v13
v_lshlrev_b32 v12,16,v29
v_and_b32 v13,s69,v29
v_add_f32 v14,v14,v12
v_add_f32 v14,v14,v13
v_lshlrev_b32 v12,16,v30
v_and_b32 v13,s69,v30
v_add_f32 v14,v14,v12
v_add_f32 v14,v14,v13
v_lshlrev_b32 v12,16,v31
v_and_b32 v13,s69,v31
v_add_f32 v14,v14,v12
v_add_f32 v14,v14,v13
g2_c2_24:
ds_read_b64_tr_b16 v[28:29],v4 offset:61440
v_mfma_f32_16x16x32_bf16 v[160:163],v[32:35],v[56:59],v[160:163]
ds_read_b64_tr_b16 v[30:31],v4 offset:62464
v_mfma_f32_16x16x32_bf16 v[164:167],v[32:35],v[60:63],v[164:167]
s_add_u32 m0,s54,45056
s_nop 0
buffer_load_dwordx4 v89,s[20:23],s48 offen lds
v_mfma_f32_16x16x32_bf16 v[168:171],v[32:35],v[64:67],v[168:171]
v_mfma_f32_16x16x32_bf16 v[172:175],v[32:35],v[68:71],v[172:175]
s_bitcmp1_b32 s68,4
s_cbranch_scc0 g2_c2_25
v_lshlrev_b32 v12,16,v32
v_and_b32 v13,s69,v32
v_add_f32 v15,v15,v12
v_add_f32 v15,v15,v13
v_lshlrev_b32 v12,16,v33
v_and_b32 v13,s69,v33
v_add_f32 v15,v15,v12
v_add_f32 v15,v15,v13
v_lshlrev_b32 v12,16,v34
v_and_b32 v13,s69,v34
v_add_f32 v15,v15,v12
v_add_f32 v15,v15,v13
v_lshlrev_b32 v12,16,v35
v_and_b32 v13,s69,v35
v_add_f32 v15,v15,v12
v_add_f32 v15,v15,v13
g2_c2_25:
ds_read_b64_tr_b16 v[32:33],v5 offset:61440
v_mfma_f32_16x16x32_bf16 v[176:179],v[36:39],v[56:59],v[176:179]
ds_read_b64_tr_b16 v[34:35],v5 offset:62464
v_mfma_f32_16x16x32_bf16 v[180:183],v[36:39],v[60:63],v[180:183]
s_add_u32 m0,s54,49152
s_nop 0
buffer_load_dwordx4 v90,s[24:27],s49 offen lds
v_mfma_f32_16x16x32_bf16 v[184:187],v[36:39],v[64:67],v[184:187]
v_mfma_f32_16x16x32_bf16 v[188:191],v[36:39],v[68:71],v[188:191]
s_bitcmp1_b32 s68,5
s_cbranch_scc0 g2_c2_26
v_lshlrev_b32 v12,16,v36
v_and_b32 v13,s69,v36
v_add_f32 v15,v15,v12
v_add_f32 v15,v15,v13
v_lshlrev_b32 v12,16,v37
v_and_b32 v13,s69,v37
v_add_f32 v15,v15,v12
v_add_f32 v15,v15,v13
v_lshlrev_b32 v12,16,v38
v_and_b32 v13,s69,v38
v_add_f32 v15,v15,v12
v_add_f32 v15,v15,v13
v_lshlrev_b32 v12,16,v39
v_and_b32 v13,s69,v39
v_add_f32 v15,v15,v12
v_add_f32 v15,v15,v13
g2_c2_26:
ds_read_b64_tr_b16 v[36:37],v6 offset:61440
v_mfma_f32_16x16x32_bf16 v[192:195],v[40:43],v[56:59],v[192:195]
ds_read_b64_tr_b16 v[38:39],v6 offset:62464
v_mfma_f32_16x16x32_bf16 v[196:199],v[40:43],v[60:63],v[196:199]
s_add_u32 m0,s54,53248
s_nop 0
buffer_load_dwordx4 v91,s[32:35],s49 offen lds
v_mfma_f32_16x16x32_bf16 v[200:203],v[40:43],v[64:67],v[200:203]
v_mfma_f32_16x16x32_bf16 v[204:207],v[40:43],v[68:71],v[204:207]
s_bitcmp1_b32 s68,6
s_cbranch_scc0 g2_c2_27
v_lshlrev_b32 v12,16,v40
v_and_b32 v13,s69,v40
v_add_f32 v15,v15,v12
v_add_f32 v15,v15,v13
v_lshlrev_b32 v12,16,v41
v_and_b32 v13,s69,v41
v_add_f32 v15,v15,v12
v_add_f32 v15,v15,v13
v_lshlrev_b32 v12,16,v42
v_and_b32 v13,s69,v42
v_add_f32 v15,v15,v12
v_add_f32 v15,v15,v13
v_lshlrev_b32 v12,16,v43
v_and_b32 v13,s69,v43
v_add_f32 v15,v15,v12
v_add_f32 v15,v15,v13
g2_c2_27:
ds_read_b64_tr_b16 v[40:41],v7 offset:61440
v_mfma_f32_16x16x32_bf16 v[208:211],v[44:47],v[56:59],v[208:211]
ds_read_b64_tr_b16 v[42:43],v7 offset:62208
v_mfma_f32_16x16x32_bf16 v[212:215],v[44:47],v[60:63],v[212:215]
s_add_u32 m0,s54,57344
s_nop 0
buffer_load_dwordx4 v92,s[28:31],s49 offen lds
s_add_u32 s48,s48,196608
s_add_u32 s49,s49,229376
v_mfma_f32_16x16x32_bf16 v[216:219],v[44:47],v[64:67],v[216:219]
v_mfma_f32_16x16x32_bf16 v[220:223],v[44:47],v[68:71],v[220:223]
s_bitcmp1_b32 s68,7
s_cbranch_scc0 g2_c2_28
v_lshlrev_b32 v12,16,v44
v_and_b32 v13,s69,v44
v_add_f32 v15,v15,v12
v_add_f32 v15,v15,v13
v_lshlrev_b32 v12,16,v45
v_and_b32 v13,s69,v45
v_add_f32 v15,v15,v12
v_add_f32 v15,v15,v13
v_lshlrev_b32 v12,16,v46
v_and_b32 v13,s69,v46
v_add_f32 v15,v15,v12
v_add_f32 v15,v15,v13
v_lshlrev_b32 v12,16,v47
v_and_b32 v13,s69,v47
v_add_f32 v15,v15,v12
v_add_f32 v15,v15,v13
g2_c2_28:
ds_read_b64_tr_b16 v[44:45],v8 offset:61440
v_mfma_f32_16x16x32_bf16 v[224:227],v[48:51],v[56:59],v[224:227]
ds_read_b64_tr_b16 v[46:47],v8 offset:62208
v_mfma_f32_16x16x32_bf16 v[228:231],v[48:51],v[60:63],v[228:231]
v_mfma_f32_16x16x32_bf16 v[232:235],v[48:51],v[64:67],v[232:235]
v_mfma_f32_16x16x32_bf16 v[236:239],v[48:51],v[68:71],v[236:239]
s_bitcmp1_b32 s68,8
s_cbranch_scc0 g2_c2_29
v_lshlrev_b32 v12,16,v48
v_and_b32 v13,s69,v48
v_add_f32 v93,v93,v12
v_add_f32 v93,v93,v13
v_lshlrev_b32 v12,16,v49
v_and_b32 v13,s69,v49
v_add_f32 v93,v93,v12
v_add_f32 v93,v93,v13
v_lshlrev_b32 v12,16,v50
v_and_b32 v13,s69,v50
v_add_f32 v93,v93,v12
v_add_f32 v93,v93,v13
v_lshlrev_b32 v12,16,v51
v_and_b32 v13,s69,v51
v_add_f32 v93,v93,v12
v_add_f32 v93,v93,v13
g2_c2_29:
ds_read_b64_tr_b16 v[48:49],v9 offset:61440
v_mfma_f32_16x16x32_bf16 v[240:243],v[52:55],v[56:59],v[240:243]
ds_read_b64_tr_b16 v[50:51],v9 offset:62208
v_mfma_f32_16x16x32_bf16 v[244:247],v[52:55],v[60:63],v[244:247]
v_mfma_f32_16x16x32_bf16 v[248:251],v[52:55],v[64:67],v[248:251]
v_mfma_f32_16x16x32_bf16 v[252:255],v[52:55],v[68:71],v[252:255]
s_bitcmp1_b32 s68,9
s_cbranch_scc0 g2_c2_30
v_lshlrev_b32 v12,16,v52
v_and_b32 v13,s69,v52
v_add_f32 v93,v93,v12
v_add_f32 v93,v93,v13
v_lshlrev_b32 v12,16,v53
v_and_b32 v13,s69,v53
v_add_f32 v93,v93,v12
v_add_f32 v93,v93,v13
v_lshlrev_b32 v12,16,v54
v_and_b32 v13,s69,v54
v_add_f32 v93,v93,v12
v_add_f32 v93,v93,v13
v_lshlrev_b32 v12,16,v55
v_and_b32 v13,s69,v55
v_add_f32 v93,v93,v12
v_add_f32 v93,v93,v13
g2_c2_30:
ds_read_b64_tr_b16 v[52:53],v10 offset:61440
ds_read_b64_tr_b16 v[54:55],v10 offset:62208
s_waitcnt lgkmcnt(15)
v_mfma_f32_16x16x32_bf16 v[96:99],v[16:19],v[72:75],v[96:99]
v_mfma_f32_16x16x32_bf16 v[100:103],v[16:19],v[76:79],v[100:103]
v_mfma_f32_16x16x32_bf16 v[104:107],v[16:19],v[80:83],v[104:107]
v_mfma_f32_16x16x32_bf16 v[108:111],v[16:19],v[84:87],v[108:111]
s_waitcnt vmcnt(10) lgkmcnt(0)
s_barrier
s_bitcmp1_b32 s68,0
s_cbranch_scc0 g2_c2_31
v_lshlrev_b32 v12,16,v16
v_and_b32 v13,s69,v16
v_add_f32 v14,v14,v12
v_add_f32 v14,v14,v13
v_lshlrev_b32 v12,16,v17
v_and_b32 v13,s69,v17
v_add_f32 v14,v14,v12
v_add_f32 v14,v14,v13
v_lshlrev_b32 v12,16,v18
v_and_b32 v13,s69,v18
v_add_f32 v14,v14,v12
v_add_f32 v14,v14,v13
v_lshlrev_b32 v12,16,v19
v_and_b32 v13,s69,v19
v_add_f32 v14,v14,v12
v_add_f32 v14,v14,v13
v_and_b32 v12,15,v0
v_lshrrev_b32 v13,4,v0
v_lshlrev_b32 v12,4,v12
v_lshl_add_u32 v12,v13,2,v12
v_add_u32 v12,153600,v12
ds_write_b32 v12,v14 offset:0
g2_c2_31:
ds_read_b64_tr_b16 v[16:17],v1 offset:0
v_mfma_f32_16x16x32_bf16 v[112:115],v[20:23],v[72:75],v[112:115]
ds_read_b64_tr_b16 v[18:19],v1 offset:1024
v_mfma_f32_16x16x32_bf16 v[116:119],v[20:23],v[76:79],v[116:119]
ds_read_b128 v[56:59],v11 offset:0
v_mfma_f32_16x16x32_bf16 v[120:123],v[20:23],v[80:83],v[120:123]
ds_read_b128 v[60:63],v11 offset:2048
v_mfma_f32_16x16x32_bf16 v[124:127],v[20:23],v[84:87],v[124:127]
s_bitcmp1_b32 s68,1
s_cbranch_scc0 g2_c2_32
v_lshlrev_b32 v12,16,v20
v_and_b32 v13,s69,v20
v_add_f32 v14,v14,v12
v_add_f32 v14,v14,v13
v_lshlrev_b32 v12,16,v21
v_and_b32 v13,s69,v21
v_add_f32 v14,v14,v12
v_add_f32 v14,v14,v13
v_lshlrev_b32 v12,16,v22
v_and_b32 v13,s69,v22
v_add_f32 v14,v14,v12
v_add_f32 v14,v14,v13
v_lshlrev_b32 v12,16,v23
v_and_b32 v13,s69,v23
v_add_f32 v14,v14,v12
v_add_f32 v14,v14,v13
v_and_b32 v12,15,v0
v_lshrrev_b32 v13,4,v0
v_lshlrev_b32 v12,4,v12
v_lshl_add_u32 v12,v13,2,v12
v_add_u32 v12,153600,v12
ds_write_b32 v12,v14 offset:256
g2_c2_32:
ds_read_b64_tr_b16 v[20:21],v2 offset:0
v_mfma_f32_16x16x32_bf16 v[128:131],v[24:27],v[72:75],v[128:131]
ds_read_b64_tr_b16 v[22:23],v2 offset:1024
v_mfma_f32_16x16x32_bf16 v[132:135],v[24:27],v[76:79],v[132:135]
ds_read_b128 v[64:67],v11 offset:4096
v_mfma_f32_16x16x32_bf16 v[136:139],v[24:27],v[80:83],v[136:139]
ds_read_b128 v[68:71],v11 offset:6144
v_mfma_f32_16x16x32_bf16 v[140:143],v[24:27],v[84:87],v[140:143]
s_bitcmp1_b32 s68,2
s_cbranch_scc0 g2_c2_33
v_lshlrev_b32 v12,16,v24
v_and_b32 v13,s69,v24
v_add_f32 v14,v14,v12
v_add_f32 v14,v14,v13
v_lshlrev_b32 v12,16,v25
v_and_b32 v13,s69,v25
v_add_f32 v14,v14,v12
v_add_f32 v14,v14,v13
v_lshlrev_b32 v12,16,v26
v_and_b32 v13,s69,v26
v_add_f32 v14,v14,v12
v_add_f32 v14,v14,v13
v_lshlrev_b32 v12,16,v27
v_and_b32 v13,s69,v27
v_add_f32 v14,v14,v12
v_add_f32 v14,v14,v13
v_and_b32 v12,15,v0
v_lshrrev_b32 v13,4,v0
v_lshlrev_b32 v12,4,v12
v_lshl_add_u32 v12,v13,2,v12
v_add_u32 v12,153600,v12
ds_write_b32 v12,v14 offset:512
g2_c2_33:
ds_read_b64_tr_b16 v[24:25],v3 offset:0
v_mfma_f32_16x16x32_bf16 v[144:147],v[28:31],v[72:75],v[144:147]
ds_read_b64_tr_b16 v[26:27],v3 offset:1024
v_mfma_f32_16x16x32_bf16 v[148:151],v[28:31],v[76:79],v[148:151]
s_add_u32 m0,s54,61440
s_nop 0
buffer_load_dwordx4 v88,s[20:23],s48 offen lds
v_mfma_f32_16x16x32_bf16 v[152:155],v[28:31],v[80:83],v[152:155]
v_mfma_f32_16x16x32_bf16 v[156:159],v[28:31],v[84:87],v[156:159]
s_bitcmp1_b32 s68,3
s_cbranch_scc0 g2_c2_34
v_lshlrev_b32 v12,16,v28
v_and_b32 v13,s69,v28
v_add_f32 v14,v14,v12
v_add_f32 v14,v14,v13
v_lshlrev_b32 v12,16,v29
v_and_b32 v13,s69,v29
v_add_f32 v14,v14,v12
v_add_f32 v14,v14,v13
v_lshlrev_b32 v12,16,v30
v_and_b32 v13,s69,v30
v_add_f32 v14,v14,v12
v_add_f32 v14,v14,v13
v_lshlrev_b32 v12,16,v31
v_and_b32 v13,s69,v31
v_add_f32 v14,v14,v12
v_add_f32 v14,v14,v13
v_and_b32 v12,15,v0
v_lshrrev_b32 v13,4,v0
v_lshlrev_b32 v12,4,v12
v_lshl_add_u32 v12,v13,2,v12
v_add_u32 v12,153600,v12
ds_write_b32 v12,v14 offset:768
g2_c2_34:
ds_read_b64_tr_b16 v[28:29],v4 offset:0
v_mfma_f32_16x16x32_bf16 v[160:163],v[32:35],v[72:75],v[160:163]
ds_read_b64_tr_b16 v[30:31],v4 offset:1024
v_mfma_f32_16x16x32_bf16 v[164:167],v[32:35],v[76:79],v[164:167]
s_add_u32 m0,s54,65536
s_nop 0
buffer_load_dwordx4 v89,s[20:23],s48 offen lds
v_mfma_f32_16x16x32_bf16 v[168:171],v[32:35],v[80:83],v[168:171]
v_mfma_f32_16x16x32_bf16 v[172:175],v[32:35],v[84:87],v[172:175]
s_bitcmp1_b32 s68,4
s_cbranch_scc0 g2_c2_35
v_lshlrev_b32 v12,16,v32
v_and_b32 v13,s69,v32
v_add_f32 v15,v15,v12
v_add_f32 v15,v15,v13
v_lshlrev_b32 v12,16,v33
v_and_b32 v13,s69,v33
v_add_f32 v15,v15,v12
v_add_f32 v15,v15,v13
v_lshlrev_b32 v12,16,v34
v_and_b32 v13,s69,v34
v_add_f32 v15,v15,v12
v_add_f32 v15,v15,v13
v_lshlrev_b32 v12,16,v35
v_and_b32 v13,s69,v35
v_add_f32 v15,v15,v12
v_add_f32 v15,v15,v13
v_and_b32 v12,15,v0
v_lshrrev_b32 v13,4,v0
v_lshlrev_b32 v12,4,v12
v_lshl_add_u32 v12,v13,2,v12
v_add_u32 v12,153600,v12
ds_write_b32 v12,v15 offset:1024
g2_c2_35:
ds_read_b64_tr_b16 v[32:33],v5 offset:0
v_mfma_f32_16x16x32_bf16 v[176:179],v[36:39],v[72:75],v[176:179]
ds_read_b64_tr_b16 v[34:35],v5 offset:1024
v_mfma_f32_16x16x32_bf16 v[180:183],v[36:39],v[76:79],v[180:183]
s_add_u32 m0,s54,69632
s_nop 0
buffer_load_dwordx4 v90,s[24:27],s49 offen lds
v_mfma_f32_16x16x32_bf16 v[184:187],v[36:39],v[80:83],v[184:187]
v_mfma_f32_16x16x32_bf16 v[188:191],v[36:39],v[84:87],v[188:191]
s_bitcmp1_b32 s68,5
s_cbranch_scc0 g2_c2_36
v_lshlrev_b32 v12,16,v36
v_and_b32 v13,s69,v36
v_add_f32 v15,v15,v12
v_add_f32 v15,v15,v13
v_lshlrev_b32 v12,16,v37
v_and_b32 v13,s69,v37
v_add_f32 v15,v15,v12
v_add_f32 v15,v15,v13
v_lshlrev_b32 v12,16,v38
v_and_b32 v13,s69,v38
v_add_f32 v15,v15,v12
v_add_f32 v15,v15,v13
v_lshlrev_b32 v12,16,v39
v_and_b32 v13,s69,v39
v_add_f32 v15,v15,v12
v_add_f32 v15,v15,v13
v_and_b32 v12,15,v0
v_lshrrev_b32 v13,4,v0
v_lshlrev_b32 v12,4,v12
v_lshl_add_u32 v12,v13,2,v12
v_add_u32 v12,153600,v12
ds_write_b32 v12,v15 offset:1280
g2_c2_36:
ds_read_b64_tr_b16 v[36:37],v6 offset:0
v_mfma_f32_16x16x32_bf16 v[192:195],v[40:43],v[72:75],v[192:195]
ds_read_b64_tr_b16 v[38:39],v6 offset:1024
v_mfma_f32_16x16x32_bf16 v[196:199],v[40:43],v[76:79],v[196:199]
s_add_u32 m0,s54,73728
s_nop 0
buffer_load_dwordx4 v91,s[32:35],s49 offen lds
v_mfma_f32_16x16x32_bf16 v[200:203],v[40:43],v[80:83],v[200:203]
v_mfma_f32_16x16x32_bf16 v[204:207],v[40:43],v[84:87],v[204:207]
s_bitcmp1_b32 s68,6
s_cbranch_scc0 g2_c2_37
v_lshlrev_b32 v12,16,v40
v_and_b32 v13,s69,v40
v_add_f32 v15,v15,v12
v_add_f32 v15,v15,v13
v_lshlrev_b32 v12,16,v41
v_and_b32 v13,s69,v41
v_add_f32 v15,v15,v12
v_add_f32 v15,v15,v13
v_lshlrev_b32 v12,16,v42
v_and_b32 v13,s69,v42
v_add_f32 v15,v15,v12
v_add_f32 v15,v15,v13
v_lshlrev_b32 v12,16,v43
v_and_b32 v13,s69,v43
v_add_f32 v15,v15,v12
v_add_f32 v15,v15,v13
v_and_b32 v12,15,v0
v_lshrrev_b32 v13,4,v0
v_lshlrev_b32 v12,4,v12
v_lshl_add_u32 v12,v13,2,v12
v_add_u32 v12,153600,v12
ds_write_b32 v12,v15 offset:2048
g2_c2_37:
ds_read_b64_tr_b16 v[40:41],v7 offset:0
v_mfma_f32_16x16x32_bf16 v[208:211],v[44:47],v[72:75],v[208:211]
ds_read_b64_tr_b16 v[42:43],v7 offset:768
v_mfma_f32_16x16x32_bf16 v[212:215],v[44:47],v[76:79],v[212:215]
s_add_u32 m0,s54,77824
s_nop 0
buffer_load_dwordx4 v92,s[28:31],s49 offen lds
s_and_b32 s50,s64,7
s_lshr_b32 s64,s64,4
s_mul_i32 s48,s50,786432
s_add_u32 s48,s48,s65
s_mul_i32 s49,s50,917504
s_add_u32 s49,s49,s66
v_mfma_f32_16x16x32_bf16 v[216:219],v[44:47],v[80:83],v[216:219]
v_mfma_f32_16x16x32_bf16 v[220:223],v[44:47],v[84:87],v[220:223]
s_bitcmp1_b32 s68,7
s_cbranch_scc0 g2_c2_38
v_lshlrev_b32 v12,16,v44
v_and_b32 v13,s69,v44
v_add_f32 v15,v15,v12
v_add_f32 v15,v15,v13
v_lshlrev_b32 v12,16,v45
v_and_b32 v13,s69,v45
v_add_f32 v15,v15,v12
v_add_f32 v15,v15,v13
v_lshlrev_b32 v12,16,v46
v_and_b32 v13,s69,v46
v_add_f32 v15,v15,v12
v_add_f32 v15,v15,v13
v_lshlrev_b32 v12,16,v47
v_and_b32 v13,s69,v47
v_add_f32 v15,v15,v12
v_add_f32 v15,v15,v13
v_and_b32 v12,15,v0
v_lshrrev_b32 v13,4,v0
v_lshlrev_b32 v12,4,v12
v_lshl_add_u32 v12,v13,2,v12
v_add_u32 v12,153600,v12
ds_write_b32 v12,v15 offset:2304
g2_c2_38:
ds_read_b64_tr_b16 v[44:45],v8 offset:0
v_mfma_f32_16x16x32_bf16 v[224:227],v[48:51],v[72:75],v[224:227]
ds_read_b64_tr_b16 v[46:47],v8 offset:768
v_mfma_f32_16x16x32_bf16 v[228:231],v[48:51],v[76:79],v[228:231]
v_mfma_f32_16x16x32_bf16 v[232:235],v[48:51],v[80:83],v[232:235]
v_mfma_f32_16x16x32_bf16 v[236:239],v[48:51],v[84:87],v[236:239]
s_bitcmp1_b32 s68,8
s_cbranch_scc0 g2_c2_39
v_lshlrev_b32 v12,16,v48
v_and_b32 v13,s69,v48
v_add_f32 v93,v93,v12
v_add_f32 v93,v93,v13
v_lshlrev_b32 v12,16,v49
v_and_b32 v13,s69,v49
v_add_f32 v93,v93,v12
v_add_f32 v93,v93,v13
v_lshlrev_b32 v12,16,v50
v_and_b32 v13,s69,v50
v_add_f32 v93,v93,v12
v_add_f32 v93,v93,v13
v_lshlrev_b32 v12,16,v51
v_and_b32 v13,s69,v51
v_add_f32 v93,v93,v12
v_add_f32 v93,v93,v13
v_and_b32 v12,15,v0
v_lshrrev_b32 v13,4,v0
v_lshlrev_b32 v12,4,v12
v_lshl_add_u32 v12,v13,2,v12
v_add_u32 v12,153600,v12
ds_write_b32 v12,v93 offset:3584
g2_c2_39:
ds_read_b64_tr_b16 v[48:49],v9 offset:0
v_mfma_f32_16x16x32_bf16 v[240:243],v[52:55],v[72:75],v[240:243]
ds_read_b64_tr_b16 v[50:51],v9 offset:768
v_mfma_f32_16x16x32_bf16 v[244:247],v[52:55],v[76:79],v[244:247]
v_mfma_f32_16x16x32_bf16 v[248:251],v[52:55],v[80:83],v[248:251]
v_mfma_f32_16x16x32_bf16 v[252:255],v[52:55],v[84:87],v[252:255]
s_bitcmp1_b32 s68,9
s_cbranch_scc0 g2_c2_40
v_lshlrev_b32 v12,16,v52
v_and_b32 v13,s69,v52
v_add_f32 v93,v93,v12
v_add_f32 v93,v93,v13
v_lshlrev_b32 v12,16,v53
v_and_b32 v13,s69,v53
v_add_f32 v93,v93,v12
v_add_f32 v93,v93,v13
v_lshlrev_b32 v12,16,v54
v_and_b32 v13,s69,v54
v_add_f32 v93,v93,v12
v_add_f32 v93,v93,v13
v_lshlrev_b32 v12,16,v55
v_and_b32 v13,s69,v55
v_add_f32 v93,v93,v12
v_add_f32 v93,v93,v13
v_and_b32 v12,15,v0
v_lshrrev_b32 v13,4,v0
v_lshlrev_b32 v12,4,v12
v_lshl_add_u32 v12,v13,2,v12
v_add_u32 v12,153600,v12
ds_write_b32 v12,v93 offset:3840
g2_c2_40:
ds_read_b64_tr_b16 v[52:53],v10 offset:0
ds_read_b64_tr_b16 v[54:55],v10 offset:768
s_sub_u32 s53,s53,1
s_branch g2_loop2
g2_pub2:
s_lshl_b32 s50,s40,10
s_add_u32 s50,s50,153600
v_add_u32 v93,s50,v95
ds_read_b128 v[12:15],v93
v_lshlrev_b32 v93,5,v0
s_lshl_b32 s50,s43,2
s_add_u32 s50,s50,s98
s_waitcnt lgkmcnt(0)
v_add_f32 v12,v12,v13
v_add_f32 v14,v14,v15
v_add_f32 v12,v12,v14
buffer_store_dword v12,v93,s[36:39],s50 offen sc1
s_branch g2_pubr2
g2_sig2:
v_mov_b32 v12,1
s_mov_b64 exec,1
buffer_atomic_add v12,off,s[60:63],0 sc1
s_mov_b64 exec,-1
s_branch g2_sigr2
g2_bad2:
v_lshlrev_b32 v92,2,v0
v_add_u32 v92,151552,v92
ds_write_b32 v92,v92
s_branch g2_badr2
g2_rd2:
ds_read2_b32 v[56:57],v94 offset0:0 offset1:32
ds_read2_b32 v[58:59],v94 offset0:16 offset1:48
ds_read2_b32 v[60:61],v94 offset0:64 offset1:96
ds_read2_b32 v[62:63],v94 offset0:80 offset1:112
ds_read_b128 v[16:19],v92 offset:0
ds_read_b128 v[20:23],v92 offset:64
ds_read_b128 v[24:27],v92 offset:128
ds_read_b128 v[28:31],v92 offset:192
ds_read_b128 v[32:35],v92 offset:256
ds_read_b128 v[36:39],v92 offset:320
ds_read_b128 v[40:43],v92 offset:512
ds_read_b128 v[44:47],v92 offset:576
ds_read_b128 v[48:51],v92 offset:896
ds_read_b128 v[52:55],v92 offset:960
s_waitcnt lgkmcnt(0)
s_branch g2_ep2
g2_v3:
v_lshrrev_b32 v12,3,v0
v_lshrrev_b32 v13,4,v0
v_xor_b32 v13,v13,v0
v_and_b32 v13,7,v13
v_lshlrev_b32 v12,11,v12
v_lshl_add_u32 v88,v13,4,v12
v_xor_b32 v12,64,v88
v_add_u32 v89,15360,v12
s_lshl_b32 s65,s43,19
s_lshl_b32 s50,s41,17
s_add_u32 s65,s65,s50
s_and_b32 s50,s64,7
s_lshr_b32 s64,s64,4
s_mul_i32 s55,s50,256
s_add_u32 s55,s55,s65
s_lshl_b32 s54,s41,13
s_add_u32 s54,s54,81920
s_waitcnt lgkmcnt(0)
s_mov_b32 s56,s4
s_and_b32 s57,s5,0xffff
s_mov_b32 s58,4194304
s_mov_b32 s59,0x00020000
buffer_load_dwordx4 v[96:99],v95,s[56:59],s53 offen offset:0
buffer_load_dwordx4 v[100:103],v95,s[56:59],s53 offen offset:1024
s_add_u32 m0,s54,0
s_nop 0
buffer_load_dwordx4 v88,s[56:59],s55 offen lds
buffer_load_dwordx4 v89,s[56:59],s55 offen offset:1024 lds
s_add_u32 m0,s54,2048
s_add_u32 s51,s55,32768
buffer_load_dwordx4 v88,s[56:59],s51 offen lds
buffer_load_dwordx4 v89,s[56:59],s51 offen offset:1024 lds
s_add_u32 m0,s54,4096
s_add_u32 s51,s55,65536
buffer_load_dwordx4 v88,s[56:59],s51 offen lds
buffer_load_dwordx4 v89,s[56:59],s51 offen offset:1024 lds
s_add_u32 m0,s54,6144
s_add_u32 s51,s55,98304
buffer_load_dwordx4 v88,s[56:59],s51 offen lds
buffer_load_dwordx4 v89,s[56:59],s51 offen offset:1024 lds
s_add_u32 s55,s55,128
s_cmp_eq_u32 s43,0
s_cselect_b32 s64,0x17654320,s64
s_cmp_eq_u32 s43,1
s_cselect_b32 s64,0x17654321,s64
s_cmp_eq_u32 s43,2
s_cselect_b32 s64,0x27654321,s64
s_cmp_eq_u32 s43,3
s_cselect_b32 s64,0x37654321,s64
s_cmp_eq_u32 s43,4
s_cselect_b32 s64,0x37653421,s64
s_cmp_eq_u32 s43,5
s_cselect_b32 s64,0x37643521,s64
s_cmp_eq_u32 s43,6
s_cselect_b32 s64,0x37543621,s64
s_cmp_eq_u32 s43,7
s_cselect_b32 s64,0x36543721,s64
s_lshr_b32 s67,s64,28
s_sub_u32 s67,7,s67
s_sub_u32 s96,s67,1
s_mov_b32 s36,s12
s_and_b32 s37,s13,0xffff
s_mov_b32 s38,50331648
s_mov_b32 s39,0x00020000
s_mov_b32 s60,s18
s_and_b32 s61,s19,0xffff
s_mov_b32 s62,256
s_mov_b32 s63,0x00020000
s_lshl_b32 s68,0x11111111,s41
s_mov_b32 s69,0xffff0000
s_cmp_eq_u32 s40,0
s_cselect_b32 s97,s96,99
s_cmp_eq_u32 s100,-1
s_cselect_b32 s97,s97,99
s_lshl_b32 s98,s44,14
s_lshl_b32 s50,s40,11
s_add_u32 s98,s98,s50
s_add_u32 s98,s98,44040192
s_lshl_b32 s50,s40,8
s_add_u32 s50,s50,147456
v_lshl_add_u32 v12,v0,2,s50
v_mov_b32 v13,0
ds_write_b32 v12,v13 offset:4096
v_lshlrev_b32 v12,2,v0
v_add_u32 v12,161792,v12
ds_write_b32 v12,v13
s_lshl_b32 s50,s2,2
s_add_u32 s50,s50,s41
s_lshl_b32 s50,s50,11
v_lshlrev_b32 v90,5,v0
s_mov_b32 s28,s6
s_and_b32 s29,s7,0xffff
s_mov_b32 s30,6291456
s_mov_b32 s31,0x00020000
s_mov_b32 s48,3145728
s_mov_b32 s49,622592
s_mov_b32 s24,s8
s_and_b32 s25,s9,0xffff
s_mov_b32 s26,7340032
s_mov_b32 s27,0x00020000
s_cmp_ge_u32 s2,76
s_cselect_b32 s28,s24,s28
s_cselect_b32 s29,s25,s29
s_cselect_b32 s30,s26,s30
s_cselect_b32 s48,3047424,s48
s_cselect_b32 s49,737280,s49
s_mov_b32 s24,s10
s_and_b32 s25,s11,0xffff
s_mov_b32 s26,7340032
s_mov_b32 s27,0x00020000
s_cmp_ge_u32 s2,166
s_cselect_b32 s28,s24,s28
s_cselect_b32 s29,s25,s29
s_cselect_b32 s30,s26,s30
s_cselect_b32 s48,2310144,s48
s_cselect_b32 s49,737280,s49
s_add_u32 s48,s48,s50
s_mov_b32 s32,s16
s_and_b32 s33,s17,0xffff
s_mov_b32 s34,7340032
s_mov_b32 s35,0x00020000
s_mov_b32 s94,0
s_mov_b32 s95,1630208
s_mov_b32 s24,s14
s_and_b32 s25,s15,0xffff
s_mov_b32 s26,2097152
s_mov_b32 s27,0x00020000
s_cmp_ge_u32 s2,199
s_cselect_b32 s32,s24,s32
s_cselect_b32 s33,s25,s33
s_cselect_b32 s34,s26,s34
s_cselect_b32 s94,4293337088,s94
s_cselect_b32 s95,466944,s95
s_add_u32 s94,s94,s50
v_bfe_u32 v12,v0,2,2
v_lshrrev_b32 v13,4,v0
v_lshl_add_u32 v14,v13,3,v12
v_and_b32 v15,3,v0
v_lshlrev_b32 v15,3,v15
v_and_b32 v13,1,v13
v_mov_b32 v93,v13
v_lshlrev_b32 v93,5,v93
v_mul_u32_u24 v94,192,v14
v_add_u32 v94,v94,v15
v_xor_b32 v11,64,v93
v_add_u32 v11,8192,v11
v_add_u32 v3,v94,v11
v_xor_b32 v11,96,v93
v_add_u32 v11,8192,v11
v_add_u32 v4,v94,v11
v_xor_b32 v11,64,v93
v_add_u32 v11,14336,v11
v_add_u32 v5,v94,v11
v_xor_b32 v11,96,v93
v_add_u32 v11,14336,v11
v_add_u32 v6,v94,v11
v_xor_b32 v11,128,v93
v_add_u32 v11,8192,v11
v_add_u32 v7,v94,v11
v_xor_b32 v11,160,v93
v_add_u32 v11,8192,v11
v_add_u32 v8,v94,v11
v_xor_b32 v11,128,v93
v_add_u32 v11,14336,v11
v_add_u32 v9,v94,v11
v_xor_b32 v11,160,v93
v_add_u32 v11,14336,v11
v_add_u32 v10,v94,v11
v_lshl_add_u32 v93,v13,2,v12
v_lshlrev_b32 v93,5,v93
v_mul_u32_u24 v94,256,v14
v_add_u32 v94,v94,v15
v_xor_b32 v11,192,v93
v_add_u32 v11,0,v11
v_add_u32 v1,v94,v11
v_xor_b32 v11,224,v93
v_add_u32 v11,0,v11
v_add_u32 v2,v94,v11
s_lshl_b32 s50,s41,13
s_add_u32 s50,s50,81920
v_and_b32 v12,15,v0
v_lshrrev_b32 v13,1,v12
v_lshrrev_b32 v14,4,v0
v_xor_b32 v13,v13,v14
v_lshl_add_u32 v14,v12,7,s50
v_lshl_add_u32 v11,v13,4,v14
v_xor_b32 v94,64,v11
s_waitcnt vmcnt(8)
v_lshlrev_b32 v108,16,v96
v_and_b32 v109,0xffff0000,v96
v_mov_b32 v104,v108
v_mov_b32 v106,v109
v_mul_f32 v105,v108,v108
v_mul_f32 v107,v109,v109
v_lshlrev_b32 v108,16,v97
v_and_b32 v109,0xffff0000,v97
v_add_f32 v104,v104,v108
v_add_f32 v106,v106,v109
v_fmac_f32 v105,v108,v108
v_fmac_f32 v107,v109,v109
v_lshlrev_b32 v108,16,v98
v_and_b32 v109,0xffff0000,v98
v_add_f32 v104,v104,v108
v_add_f32 v106,v106,v109
v_fmac_f32 v105,v108,v108
v_fmac_f32 v107,v109,v109
v_lshlrev_b32 v108,16,v99
v_and_b32 v109,0xffff0000,v99
v_add_f32 v104,v104,v108
v_add_f32 v106,v106,v109
v_fmac_f32 v105,v108,v108
v_fmac_f32 v107,v109,v109
v_lshlrev_b32 v108,16,v100
v_and_b32 v109,0xffff0000,v100
v_add_f32 v104,v104,v108
v_add_f32 v106,v106,v109
v_fmac_f32 v105,v108,v108
v_fmac_f32 v107,v109,v109
v_lshlrev_b32 v108,16,v101
v_and_b32 v109,0xffff0000,v101
v_add_f32 v104,v104,v108
v_add_f32 v106,v106,v109
v_fmac_f32 v105,v108,v108
v_fmac_f32 v107,v109,v109
v_lshlrev_b32 v108,16,v102
v_and_b32 v109,0xffff0000,v102
v_add_f32 v104,v104,v108
v_add_f32 v106,v106,v109
v_fmac_f32 v105,v108,v108
v_fmac_f32 v107,v109,v109
v_lshlrev_b32 v108,16,v103
v_and_b32 v109,0xffff0000,v103
v_add_f32 v104,v104,v108
v_add_f32 v106,v106,v109
v_fmac_f32 v105,v108,v108
v_fmac_f32 v107,v109,v109
v_add_f32 v104,v104,v106
v_add_f32 v105,v105,v107
s_nop 0
s_nop 0
v_add_f32_dpp v104,v104,v104 row_ror:8 row_mask:0xf bank_mask:0xf
v_add_f32_dpp v105,v105,v105 row_ror:8 row_mask:0xf bank_mask:0xf
s_nop 0
v_add_f32_dpp v104,v104,v104 row_ror:4 row_mask:0xf bank_mask:0xf
v_add_f32_dpp v105,v105,v105 row_ror:4 row_mask:0xf bank_mask:0xf
s_nop 0
v_add_f32_dpp v104,v104,v104 row_ror:2 row_mask:0xf bank_mask:0xf
v_add_f32_dpp v105,v105,v105 row_ror:2 row_mask:0xf bank_mask:0xf
s_nop 0
v_add_f32_dpp v104,v104,v104 row_ror:1 row_mask:0xf bank_mask:0xf
v_add_f32_dpp v105,v105,v105 row_ror:1 row_mask:0xf bank_mask:0xf
v_mov_b32 v106,v104
v_mov_b32 v107,v105
s_nop 0
v_permlane16_swap_b32 v104,v106
v_permlane16_swap_b32 v105,v107
v_add_f32 v104,v104,v106
v_add_f32 v105,v105,v107
v_mov_b32 v106,v104
v_mov_b32 v107,v105
s_nop 0
v_permlane32_swap_b32 v104,v106
v_permlane32_swap_b32 v105,v107
v_add_f32 v104,v104,v106
v_add_f32 v105,v105,v107
v_mul_f32 v104,0xba800000,v104
v_mul_f32 v105,0x3a800000,v105
v_fma_f32 v105,-v104,v104,v105
v_max_f32 v105,0,v105
v_cvt_pk_bf16_f32 v104,v104,v105
v_and_b32 v105,0xffff0000,v104
v_lshlrev_b32 v104,16,v104
v_add_f32 v105,0x3727c5ac,v105
v_cvt_pk_bf16_f32 v105,v105,v105
v_and_b32 v105,0xffff0000,v105
v_sqrt_f32 v105,v105
s_nop 0
v_cvt_pk_bf16_f32 v105,v105,v105
v_and_b32 v105,0xffff0000,v105
v_cmp_eq_u32 vcc,0,v0
v_lshlrev_b32 v106,13,v0
s_lshl_b32 s50,s52,2
s_add_u32 s50,s50,42991616
v_cndmask_b32 v104,v105,v104,vcc
s_mov_b64 exec,3
buffer_store_dword v104,v106,s[36:39],s50 offen sc1
s_mov_b64 exec,-1
s_waitcnt vmcnt(1) lgkmcnt(0)
s_barrier
ds_read_b128 v[56:59],v11 offset:0
ds_read_b128 v[60:63],v11 offset:2048
ds_read_b128 v[64:67],v11 offset:4096
ds_read_b128 v[68:71],v11 offset:6144
ds_read_b64_tr_b16 v[16:17],v1 offset:0
ds_read_b64_tr_b16 v[18:19],v1 offset:1024
ds_read_b64_tr_b16 v[20:21],v2 offset:0
ds_read_b64_tr_b16 v[22:23],v2 offset:1024
ds_read_b64_tr_b16 v[24:25],v3 offset:0
ds_read_b64_tr_b16 v[26:27],v3 offset:768
ds_read_b64_tr_b16 v[28:29],v4 offset:0
ds_read_b64_tr_b16 v[30:31],v4 offset:768
ds_read_b64_tr_b16 v[32:33],v5 offset:0
ds_read_b64_tr_b16 v[34:35],v5 offset:768
ds_read_b64_tr_b16 v[36:37],v6 offset:0
ds_read_b64_tr_b16 v[38:39],v6 offset:768
ds_read_b64_tr_b16 v[40:41],v7 offset:0
ds_read_b64_tr_b16 v[42:43],v7 offset:768
ds_read_b64_tr_b16 v[44:45],v8 offset:0
ds_read_b64_tr_b16 v[46:47],v8 offset:768
ds_read_b64_tr_b16 v[48:49],v9 offset:0
ds_read_b64_tr_b16 v[50:51],v9 offset:768
ds_read_b64_tr_b16 v[52:53],v10 offset:0
ds_read_b64_tr_b16 v[54:55],v10 offset:768
s_add_u32 m0,s54,32768
s_nop 0
buffer_load_dwordx4 v88,s[56:59],s55 offen lds
buffer_load_dwordx4 v89,s[56:59],s55 offen offset:1024 lds
s_add_u32 m0,s54,34816
s_add_u32 s51,s55,32768
buffer_load_dwordx4 v88,s[56:59],s51 offen lds
buffer_load_dwordx4 v89,s[56:59],s51 offen offset:1024 lds
s_add_u32 m0,s54,36864
s_add_u32 s51,s55,65536
buffer_load_dwordx4 v88,s[56:59],s51 offen lds
buffer_load_dwordx4 v89,s[56:59],s51 offen offset:1024 lds
s_add_u32 m0,s54,38912
s_add_u32 s51,s55,98304
buffer_load_dwordx4 v88,s[56:59],s51 offen lds
buffer_load_dwordx4 v89,s[56:59],s51 offen offset:1024 lds
s_and_b32 s50,s64,7
s_lshr_b32 s64,s64,4
s_mul_i32 s55,s50,256
s_add_u32 s55,s55,s65
s_waitcnt lgkmcnt(15)
v_mfma_f32_16x16x32_bf16 v[96:99],v[16:19],v[56:59],0
v_mfma_f32_16x16x32_bf16 v[100:103],v[16:19],v[60:63],0
v_mfma_f32_16x16x32_bf16 v[104:107],v[16:19],v[64:67],0
v_mfma_f32_16x16x32_bf16 v[108:111],v[16:19],v[68:71],0
s_waitcnt vmcnt(9) lgkmcnt(0)
s_barrier
ds_read_b64_tr_b16 v[16:17],v1 offset:20480
v_mfma_f32_16x16x32_bf16 v[112:115],v[20:23],v[56:59],0
ds_read_b64_tr_b16 v[18:19],v1 offset:21504
v_mfma_f32_16x16x32_bf16 v[116:119],v[20:23],v[60:63],0
ds_read_b128 v[72:75],v94 offset:0
v_mfma_f32_16x16x32_bf16 v[120:123],v[20:23],v[64:67],0
ds_read_b128 v[76:79],v94 offset:2048
v_mfma_f32_16x16x32_bf16 v[124:127],v[20:23],v[68:71],0
ds_read_b64_tr_b16 v[20:21],v2 offset:20480
v_mfma_f32_16x16x32_bf16 v[128:131],v[24:27],v[56:59],0
ds_read_b64_tr_b16 v[22:23],v2 offset:21504
v_mfma_f32_16x16x32_bf16 v[132:135],v[24:27],v[60:63],0
ds_read_b128 v[80:83],v94 offset:4096
v_mfma_f32_16x16x32_bf16 v[136:139],v[24:27],v[64:67],0
ds_read_b128 v[84:87],v94 offset:6144
v_mfma_f32_16x16x32_bf16 v[140:143],v[24:27],v[68:71],0
ds_read_b64_tr_b16 v[24:25],v3 offset:20480
v_mfma_f32_16x16x32_bf16 v[144:147],v[28:31],v[56:59],0
ds_read_b64_tr_b16 v[26:27],v3 offset:21248
v_mfma_f32_16x16x32_bf16 v[148:151],v[28:31],v[60:63],0
buffer_load_dword v91,v90,s[28:31],s48 offen
s_add_u32 s48,s48,s49
v_mfma_f32_16x16x32_bf16 v[152:155],v[28:31],v[64:67],0
v_mfma_f32_16x16x32_bf16 v[156:159],v[28:31],v[68:71],0
ds_read_b64_tr_b16 v[28:29],v4 offset:20480
v_mfma_f32_16x16x32_bf16 v[160:163],v[32:35],v[56:59],0
ds_read_b64_tr_b16 v[30:31],v4 offset:21248
v_mfma_f32_16x16x32_bf16 v[164:167],v[32:35],v[60:63],0
v_mfma_f32_16x16x32_bf16 v[168:171],v[32:35],v[64:67],0
v_mfma_f32_16x16x32_bf16 v[172:175],v[32:35],v[68:71],0
ds_read_b64_tr_b16 v[32:33],v5 offset:20480
v_mfma_f32_16x16x32_bf16 v[176:179],v[36:39],v[56:59],0
ds_read_b64_tr_b16 v[34:35],v5 offset:21248
v_mfma_f32_16x16x32_bf16 v[180:183],v[36:39],v[60:63],0
v_mfma_f32_16x16x32_bf16 v[184:187],v[36:39],v[64:67],0
v_mfma_f32_16x16x32_bf16 v[188:191],v[36:39],v[68:71],0
ds_read_b64_tr_b16 v[36:37],v6 offset:20480
v_mfma_f32_16x16x32_bf16 v[192:195],v[40:43],v[56:59],0
ds_read_b64_tr_b16 v[38:39],v6 offset:21248
v_mfma_f32_16x16x32_bf16 v[196:199],v[40:43],v[60:63],0
v_mfma_f32_16x16x32_bf16 v[200:203],v[40:43],v[64:67],0
v_mfma_f32_16x16x32_bf16 v[204:207],v[40:43],v[68:71],0
ds_read_b64_tr_b16 v[40:41],v7 offset:20480
v_mfma_f32_16x16x32_bf16 v[208:211],v[44:47],v[56:59],0
ds_read_b64_tr_b16 v[42:43],v7 offset:21248
v_mfma_f32_16x16x32_bf16 v[212:215],v[44:47],v[60:63],0
v_mfma_f32_16x16x32_bf16 v[216:219],v[44:47],v[64:67],0
v_mfma_f32_16x16x32_bf16 v[220:223],v[44:47],v[68:71],0
ds_read_b64_tr_b16 v[44:45],v8 offset:20480
v_mfma_f32_16x16x32_bf16 v[224:227],v[48:51],v[56:59],0
ds_read_b64_tr_b16 v[46:47],v8 offset:21248
v_mfma_f32_16x16x32_bf16 v[228:231],v[48:51],v[60:63],0
v_mfma_f32_16x16x32_bf16 v[232:235],v[48:51],v[64:67],0
v_mfma_f32_16x16x32_bf16 v[236:239],v[48:51],v[68:71],0
ds_read_b64_tr_b16 v[48:49],v9 offset:20480
v_mfma_f32_16x16x32_bf16 v[240:243],v[52:55],v[56:59],0
ds_read_b64_tr_b16 v[50:51],v9 offset:21248
v_mfma_f32_16x16x32_bf16 v[244:247],v[52:55],v[60:63],0
v_mfma_f32_16x16x32_bf16 v[248:251],v[52:55],v[64:67],0
v_mfma_f32_16x16x32_bf16 v[252:255],v[52:55],v[68:71],0
ds_read_b64_tr_b16 v[52:53],v10 offset:20480
ds_read_b64_tr_b16 v[54:55],v10 offset:21248
s_waitcnt lgkmcnt(15)
v_mfma_f32_16x16x32_bf16 v[96:99],v[16:19],v[72:75],v[96:99]
v_mfma_f32_16x16x32_bf16 v[100:103],v[16:19],v[76:79],v[100:103]
v_mfma_f32_16x16x32_bf16 v[104:107],v[16:19],v[80:83],v[104:107]
v_mfma_f32_16x16x32_bf16 v[108:111],v[16:19],v[84:87],v[108:111]
s_waitcnt vmcnt(1) lgkmcnt(0)
s_barrier
ds_read_b64_tr_b16 v[16:17],v1 offset:40960
v_mfma_f32_16x16x32_bf16 v[112:115],v[20:23],v[72:75],v[112:115]
ds_read_b64_tr_b16 v[18:19],v1 offset:41984
v_mfma_f32_16x16x32_bf16 v[116:119],v[20:23],v[76:79],v[116:119]
ds_read_b128 v[56:59],v11 offset:32768
v_mfma_f32_16x16x32_bf16 v[120:123],v[20:23],v[80:83],v[120:123]
ds_read_b128 v[60:63],v11 offset:34816
v_mfma_f32_16x16x32_bf16 v[124:127],v[20:23],v[84:87],v[124:127]
ds_read_b64_tr_b16 v[20:21],v2 offset:40960
v_mfma_f32_16x16x32_bf16 v[128:131],v[24:27],v[72:75],v[128:131]
ds_read_b64_tr_b16 v[22:23],v2 offset:41984
v_mfma_f32_16x16x32_bf16 v[132:135],v[24:27],v[76:79],v[132:135]
ds_read_b128 v[64:67],v11 offset:36864
v_mfma_f32_16x16x32_bf16 v[136:139],v[24:27],v[80:83],v[136:139]
ds_read_b128 v[68:71],v11 offset:38912
v_mfma_f32_16x16x32_bf16 v[140:143],v[24:27],v[84:87],v[140:143]
ds_read_b64_tr_b16 v[24:25],v3 offset:40960
v_mfma_f32_16x16x32_bf16 v[144:147],v[28:31],v[72:75],v[144:147]
ds_read_b64_tr_b16 v[26:27],v3 offset:41728
v_mfma_f32_16x16x32_bf16 v[148:151],v[28:31],v[76:79],v[148:151]
s_add_u32 m0,s54,0
s_nop 0
buffer_load_dwordx4 v88,s[56:59],s55 offen lds
v_mfma_f32_16x16x32_bf16 v[152:155],v[28:31],v[80:83],v[152:155]
v_mfma_f32_16x16x32_bf16 v[156:159],v[28:31],v[84:87],v[156:159]
ds_read_b64_tr_b16 v[28:29],v4 offset:40960
v_mfma_f32_16x16x32_bf16 v[160:163],v[32:35],v[72:75],v[160:163]
ds_read_b64_tr_b16 v[30:31],v4 offset:41728
v_mfma_f32_16x16x32_bf16 v[164:167],v[32:35],v[76:79],v[164:167]
buffer_load_dwordx4 v89,s[56:59],s55 offen offset:1024 lds
v_mfma_f32_16x16x32_bf16 v[168:171],v[32:35],v[80:83],v[168:171]
v_mfma_f32_16x16x32_bf16 v[172:175],v[32:35],v[84:87],v[172:175]
ds_read_b64_tr_b16 v[32:33],v5 offset:40960
v_mfma_f32_16x16x32_bf16 v[176:179],v[36:39],v[72:75],v[176:179]
ds_read_b64_tr_b16 v[34:35],v5 offset:41728
v_mfma_f32_16x16x32_bf16 v[180:183],v[36:39],v[76:79],v[180:183]
s_add_u32 m0,s54,2048
s_add_u32 s51,s55,32768
buffer_load_dwordx4 v88,s[56:59],s51 offen lds
v_mfma_f32_16x16x32_bf16 v[184:187],v[36:39],v[80:83],v[184:187]
v_mfma_f32_16x16x32_bf16 v[188:191],v[36:39],v[84:87],v[188:191]
ds_read_b64_tr_b16 v[36:37],v6 offset:40960
v_mfma_f32_16x16x32_bf16 v[192:195],v[40:43],v[72:75],v[192:195]
ds_read_b64_tr_b16 v[38:39],v6 offset:41728
v_mfma_f32_16x16x32_bf16 v[196:199],v[40:43],v[76:79],v[196:199]
buffer_load_dwordx4 v89,s[56:59],s51 offen offset:1024 lds
v_mfma_f32_16x16x32_bf16 v[200:203],v[40:43],v[80:83],v[200:203]
v_mfma_f32_16x16x32_bf16 v[204:207],v[40:43],v[84:87],v[204:207]
ds_read_b64_tr_b16 v[40:41],v7 offset:40960
v_mfma_f32_16x16x32_bf16 v[208:211],v[44:47],v[72:75],v[208:211]
ds_read_b64_tr_b16 v[42:43],v7 offset:41728
v_mfma_f32_16x16x32_bf16 v[212:215],v[44:47],v[76:79],v[212:215]
s_add_u32 m0,s54,4096
s_add_u32 s51,s55,65536
buffer_load_dwordx4 v88,s[56:59],s51 offen lds
v_mfma_f32_16x16x32_bf16 v[216:219],v[44:47],v[80:83],v[216:219]
v_mfma_f32_16x16x32_bf16 v[220:223],v[44:47],v[84:87],v[220:223]
ds_read_b64_tr_b16 v[44:45],v8 offset:40960
v_mfma_f32_16x16x32_bf16 v[224:227],v[48:51],v[72:75],v[224:227]
ds_read_b64_tr_b16 v[46:47],v8 offset:41728
v_mfma_f32_16x16x32_bf16 v[228:231],v[48:51],v[76:79],v[228:231]
buffer_load_dwordx4 v89,s[56:59],s51 offen offset:1024 lds
v_mfma_f32_16x16x32_bf16 v[232:235],v[48:51],v[80:83],v[232:235]
v_mfma_f32_16x16x32_bf16 v[236:239],v[48:51],v[84:87],v[236:239]
ds_read_b64_tr_b16 v[48:49],v9 offset:40960
v_mfma_f32_16x16x32_bf16 v[240:243],v[52:55],v[72:75],v[240:243]
ds_read_b64_tr_b16 v[50:51],v9 offset:41728
v_mfma_f32_16x16x32_bf16 v[244:247],v[52:55],v[76:79],v[244:247]
s_add_u32 m0,s54,6144
s_add_u32 s51,s55,98304
buffer_load_dwordx4 v88,s[56:59],s51 offen lds
v_mfma_f32_16x16x32_bf16 v[248:251],v[52:55],v[80:83],v[248:251]
buffer_load_dwordx4 v89,s[56:59],s51 offen offset:1024 lds
s_add_u32 s55,s55,128
v_mfma_f32_16x16x32_bf16 v[252:255],v[52:55],v[84:87],v[252:255]
ds_read_b64_tr_b16 v[52:53],v10 offset:40960
ds_read_b64_tr_b16 v[54:55],v10 offset:41728
s_waitcnt lgkmcnt(15)
v_mfma_f32_16x16x32_bf16 v[96:99],v[16:19],v[56:59],v[96:99]
v_mfma_f32_16x16x32_bf16 v[100:103],v[16:19],v[60:63],v[100:103]
v_mfma_f32_16x16x32_bf16 v[104:107],v[16:19],v[64:67],v[104:107]
v_mfma_f32_16x16x32_bf16 v[108:111],v[16:19],v[68:71],v[108:111]
s_waitcnt vmcnt(9) lgkmcnt(0)
s_barrier
ds_read_b64_tr_b16 v[16:17],v1 offset:61440
v_mfma_f32_16x16x32_bf16 v[112:115],v[20:23],v[56:59],v[112:115]
ds_read_b64_tr_b16 v[18:19],v1 offset:62464
v_mfma_f32_16x16x32_bf16 v[116:119],v[20:23],v[60:63],v[116:119]
ds_read_b128 v[72:75],v94 offset:32768
v_mfma_f32_16x16x32_bf16 v[120:123],v[20:23],v[64:67],v[120:123]
ds_read_b128 v[76:79],v94 offset:34816
v_mfma_f32_16x16x32_bf16 v[124:127],v[20:23],v[68:71],v[124:127]
ds_read_b64_tr_b16 v[20:21],v2 offset:61440
v_mfma_f32_16x16x32_bf16 v[128:131],v[24:27],v[56:59],v[128:131]
ds_read_b64_tr_b16 v[22:23],v2 offset:62464
v_mfma_f32_16x16x32_bf16 v[132:135],v[24:27],v[60:63],v[132:135]
ds_read_b128 v[80:83],v94 offset:36864
v_mfma_f32_16x16x32_bf16 v[136:139],v[24:27],v[64:67],v[136:139]
ds_read_b128 v[84:87],v94 offset:38912
v_mfma_f32_16x16x32_bf16 v[140:143],v[24:27],v[68:71],v[140:143]
ds_read_b64_tr_b16 v[24:25],v3 offset:61440
v_mfma_f32_16x16x32_bf16 v[144:147],v[28:31],v[56:59],v[144:147]
ds_read_b64_tr_b16 v[26:27],v3 offset:62208
v_mfma_f32_16x16x32_bf16 v[148:151],v[28:31],v[60:63],v[148:151]
buffer_load_dword v91,v90,s[28:31],s48 offen
s_add_u32 s48,s48,s49
v_mfma_f32_16x16x32_bf16 v[152:155],v[28:31],v[64:67],v[152:155]
v_mfma_f32_16x16x32_bf16 v[156:159],v[28:31],v[68:71],v[156:159]
ds_read_b64_tr_b16 v[28:29],v4 offset:61440
v_mfma_f32_16x16x32_bf16 v[160:163],v[32:35],v[56:59],v[160:163]
ds_read_b64_tr_b16 v[30:31],v4 offset:62208
v_mfma_f32_16x16x32_bf16 v[164:167],v[32:35],v[60:63],v[164:167]
v_mfma_f32_16x16x32_bf16 v[168:171],v[32:35],v[64:67],v[168:171]
v_mfma_f32_16x16x32_bf16 v[172:175],v[32:35],v[68:71],v[172:175]
ds_read_b64_tr_b16 v[32:33],v5 offset:61440
v_mfma_f32_16x16x32_bf16 v[176:179],v[36:39],v[56:59],v[176:179]
ds_read_b64_tr_b16 v[34:35],v5 offset:62208
v_mfma_f32_16x16x32_bf16 v[180:183],v[36:39],v[60:63],v[180:183]
v_mfma_f32_16x16x32_bf16 v[184:187],v[36:39],v[64:67],v[184:187]
v_mfma_f32_16x16x32_bf16 v[188:191],v[36:39],v[68:71],v[188:191]
ds_read_b64_tr_b16 v[36:37],v6 offset:61440
v_mfma_f32_16x16x32_bf16 v[192:195],v[40:43],v[56:59],v[192:195]
ds_read_b64_tr_b16 v[38:39],v6 offset:62208
v_mfma_f32_16x16x32_bf16 v[196:199],v[40:43],v[60:63],v[196:199]
v_mfma_f32_16x16x32_bf16 v[200:203],v[40:43],v[64:67],v[200:203]
v_mfma_f32_16x16x32_bf16 v[204:207],v[40:43],v[68:71],v[204:207]
ds_read_b64_tr_b16 v[40:41],v7 offset:61440
v_mfma_f32_16x16x32_bf16 v[208:211],v[44:47],v[56:59],v[208:211]
ds_read_b64_tr_b16 v[42:43],v7 offset:62208
v_mfma_f32_16x16x32_bf16 v[212:215],v[44:47],v[60:63],v[212:215]
v_mfma_f32_16x16x32_bf16 v[216:219],v[44:47],v[64:67],v[216:219]
v_mfma_f32_16x16x32_bf16 v[220:223],v[44:47],v[68:71],v[220:223]
ds_read_b64_tr_b16 v[44:45],v8 offset:61440
v_mfma_f32_16x16x32_bf16 v[224:227],v[48:51],v[56:59],v[224:227]
ds_read_b64_tr_b16 v[46:47],v8 offset:62208
v_mfma_f32_16x16x32_bf16 v[228:231],v[48:51],v[60:63],v[228:231]
v_mfma_f32_16x16x32_bf16 v[232:235],v[48:51],v[64:67],v[232:235]
v_mfma_f32_16x16x32_bf16 v[236:239],v[48:51],v[68:71],v[236:239]
ds_read_b64_tr_b16 v[48:49],v9 offset:61440
v_mfma_f32_16x16x32_bf16 v[240:243],v[52:55],v[56:59],v[240:243]
ds_read_b64_tr_b16 v[50:51],v9 offset:62208
v_mfma_f32_16x16x32_bf16 v[244:247],v[52:55],v[60:63],v[244:247]
v_mfma_f32_16x16x32_bf16 v[248:251],v[52:55],v[64:67],v[248:251]
v_mfma_f32_16x16x32_bf16 v[252:255],v[52:55],v[68:71],v[252:255]
ds_read_b64_tr_b16 v[52:53],v10 offset:61440
ds_read_b64_tr_b16 v[54:55],v10 offset:62208
s_waitcnt lgkmcnt(15)
v_mfma_f32_16x16x32_bf16 v[96:99],v[16:19],v[72:75],v[96:99]
v_mfma_f32_16x16x32_bf16 v[100:103],v[16:19],v[76:79],v[100:103]
v_mfma_f32_16x16x32_bf16 v[104:107],v[16:19],v[80:83],v[104:107]
v_mfma_f32_16x16x32_bf16 v[108:111],v[16:19],v[84:87],v[108:111]
s_waitcnt vmcnt(1) lgkmcnt(0)
s_barrier
ds_read_b64_tr_b16 v[16:17],v1 offset:0
v_mfma_f32_16x16x32_bf16 v[112:115],v[20:23],v[72:75],v[112:115]
ds_read_b64_tr_b16 v[18:19],v1 offset:1024
v_mfma_f32_16x16x32_bf16 v[116:119],v[20:23],v[76:79],v[116:119]
ds_read_b128 v[56:59],v11 offset:0
v_mfma_f32_16x16x32_bf16 v[120:123],v[20:23],v[80:83],v[120:123]
ds_read_b128 v[60:63],v11 offset:2048
v_mfma_f32_16x16x32_bf16 v[124:127],v[20:23],v[84:87],v[124:127]
ds_read_b64_tr_b16 v[20:21],v2 offset:0
v_mfma_f32_16x16x32_bf16 v[128:131],v[24:27],v[72:75],v[128:131]
ds_read_b64_tr_b16 v[22:23],v2 offset:1024
v_mfma_f32_16x16x32_bf16 v[132:135],v[24:27],v[76:79],v[132:135]
ds_read_b128 v[64:67],v11 offset:4096
v_mfma_f32_16x16x32_bf16 v[136:139],v[24:27],v[80:83],v[136:139]
ds_read_b128 v[68:71],v11 offset:6144
v_mfma_f32_16x16x32_bf16 v[140:143],v[24:27],v[84:87],v[140:143]
ds_read_b64_tr_b16 v[24:25],v3 offset:0
v_mfma_f32_16x16x32_bf16 v[144:147],v[28:31],v[72:75],v[144:147]
ds_read_b64_tr_b16 v[26:27],v3 offset:768
v_mfma_f32_16x16x32_bf16 v[148:151],v[28:31],v[76:79],v[148:151]
s_add_u32 m0,s54,32768
s_nop 0
buffer_load_dwordx4 v88,s[56:59],s55 offen lds
v_mfma_f32_16x16x32_bf16 v[152:155],v[28:31],v[80:83],v[152:155]
v_mfma_f32_16x16x32_bf16 v[156:159],v[28:31],v[84:87],v[156:159]
ds_read_b64_tr_b16 v[28:29],v4 offset:0
v_mfma_f32_16x16x32_bf16 v[160:163],v[32:35],v[72:75],v[160:163]
ds_read_b64_tr_b16 v[30:31],v4 offset:768
v_mfma_f32_16x16x32_bf16 v[164:167],v[32:35],v[76:79],v[164:167]
buffer_load_dwordx4 v89,s[56:59],s55 offen offset:1024 lds
v_mfma_f32_16x16x32_bf16 v[168:171],v[32:35],v[80:83],v[168:171]
v_mfma_f32_16x16x32_bf16 v[172:175],v[32:35],v[84:87],v[172:175]
ds_read_b64_tr_b16 v[32:33],v5 offset:0
v_mfma_f32_16x16x32_bf16 v[176:179],v[36:39],v[72:75],v[176:179]
ds_read_b64_tr_b16 v[34:35],v5 offset:768
v_mfma_f32_16x16x32_bf16 v[180:183],v[36:39],v[76:79],v[180:183]
s_add_u32 m0,s54,34816
s_add_u32 s51,s55,32768
buffer_load_dwordx4 v88,s[56:59],s51 offen lds
v_mfma_f32_16x16x32_bf16 v[184:187],v[36:39],v[80:83],v[184:187]
v_mfma_f32_16x16x32_bf16 v[188:191],v[36:39],v[84:87],v[188:191]
ds_read_b64_tr_b16 v[36:37],v6 offset:0
v_mfma_f32_16x16x32_bf16 v[192:195],v[40:43],v[72:75],v[192:195]
ds_read_b64_tr_b16 v[38:39],v6 offset:768
v_mfma_f32_16x16x32_bf16 v[196:199],v[40:43],v[76:79],v[196:199]
buffer_load_dwordx4 v89,s[56:59],s51 offen offset:1024 lds
v_mfma_f32_16x16x32_bf16 v[200:203],v[40:43],v[80:83],v[200:203]
v_mfma_f32_16x16x32_bf16 v[204:207],v[40:43],v[84:87],v[204:207]
ds_read_b64_tr_b16 v[40:41],v7 offset:0
v_mfma_f32_16x16x32_bf16 v[208:211],v[44:47],v[72:75],v[208:211]
ds_read_b64_tr_b16 v[42:43],v7 offset:768
v_mfma_f32_16x16x32_bf16 v[212:215],v[44:47],v[76:79],v[212:215]
s_add_u32 m0,s54,36864
s_add_u32 s51,s55,65536
buffer_load_dwordx4 v88,s[56:59],s51 offen lds
v_mfma_f32_16x16x32_bf16 v[216:219],v[44:47],v[80:83],v[216:219]
v_mfma_f32_16x16x32_bf16 v[220:223],v[44:47],v[84:87],v[220:223]
ds_read_b64_tr_b16 v[44:45],v8 offset:0
v_mfma_f32_16x16x32_bf16 v[224:227],v[48:51],v[72:75],v[224:227]
ds_read_b64_tr_b16 v[46:47],v8 offset:768
v_mfma_f32_16x16x32_bf16 v[228:231],v[48:51],v[76:79],v[228:231]
buffer_load_dwordx4 v89,s[56:59],s51 offen offset:1024 lds
v_mfma_f32_16x16x32_bf16 v[232:235],v[48:51],v[80:83],v[232:235]
v_mfma_f32_16x16x32_bf16 v[236:239],v[48:51],v[84:87],v[236:239]
ds_read_b64_tr_b16 v[48:49],v9 offset:0
v_mfma_f32_16x16x32_bf16 v[240:243],v[52:55],v[72:75],v[240:243]
ds_read_b64_tr_b16 v[50:51],v9 offset:768
v_mfma_f32_16x16x32_bf16 v[244:247],v[52:55],v[76:79],v[244:247]
s_add_u32 m0,s54,38912
s_add_u32 s51,s55,98304
buffer_load_dwordx4 v88,s[56:59],s51 offen lds
v_mfma_f32_16x16x32_bf16 v[248:251],v[52:55],v[80:83],v[248:251]
buffer_load_dwordx4 v89,s[56:59],s51 offen offset:1024 lds
s_and_b32 s50,s64,7
s_lshr_b32 s64,s64,4
s_mul_i32 s55,s50,256
s_add_u32 s55,s55,s65
v_mfma_f32_16x16x32_bf16 v[252:255],v[52:55],v[84:87],v[252:255]
ds_read_b64_tr_b16 v[52:53],v10 offset:0
ds_read_b64_tr_b16 v[54:55],v10 offset:768
s_mov_b32 s53,6
.p2align 6
g2_loop3:
s_cmp_eq_u32 s53,4
s_cselect_b32 s28,s32,s28
s_cselect_b32 s29,s33,s29
s_cselect_b32 s30,s34,s30
s_cselect_b32 s48,s94,s48
s_cselect_b32 s49,s95,s49
s_cmp_eq_u32 s53,s67
s_cbranch_scc1 g2_sp3
s_waitcnt lgkmcnt(15)
v_mfma_f32_16x16x32_bf16 v[96:99],v[16:19],v[56:59],v[96:99]
v_mfma_f32_16x16x32_bf16 v[100:103],v[16:19],v[60:63],v[100:103]
v_mfma_f32_16x16x32_bf16 v[104:107],v[16:19],v[64:67],v[104:107]
v_mfma_f32_16x16x32_bf16 v[108:111],v[16:19],v[68:71],v[108:111]
s_waitcnt vmcnt(9) lgkmcnt(0)
s_barrier
s_cmp_eq_u32 s53,s96
s_cbranch_scc1 g2_pub3
g2_pubr3:
ds_read_b64_tr_b16 v[16:17],v1 offset:20480
v_mfma_f32_16x16x32_bf16 v[112:115],v[20:23],v[56:59],v[112:115]
ds_read_b64_tr_b16 v[18:19],v1 offset:21504
v_mfma_f32_16x16x32_bf16 v[116:119],v[20:23],v[60:63],v[116:119]
ds_read_b128 v[72:75],v94 offset:0
v_mfma_f32_16x16x32_bf16 v[120:123],v[20:23],v[64:67],v[120:123]
ds_read_b128 v[76:79],v94 offset:2048
v_mfma_f32_16x16x32_bf16 v[124:127],v[20:23],v[68:71],v[124:127]
ds_read_b64_tr_b16 v[20:21],v2 offset:20480
v_mfma_f32_16x16x32_bf16 v[128:131],v[24:27],v[56:59],v[128:131]
ds_read_b64_tr_b16 v[22:23],v2 offset:21504
v_mfma_f32_16x16x32_bf16 v[132:135],v[24:27],v[60:63],v[132:135]
ds_read_b128 v[80:83],v94 offset:4096
v_mfma_f32_16x16x32_bf16 v[136:139],v[24:27],v[64:67],v[136:139]
ds_read_b128 v[84:87],v94 offset:6144
v_mfma_f32_16x16x32_bf16 v[140:143],v[24:27],v[68:71],v[140:143]
ds_read_b64_tr_b16 v[24:25],v3 offset:20480
v_mfma_f32_16x16x32_bf16 v[144:147],v[28:31],v[56:59],v[144:147]
ds_read_b64_tr_b16 v[26:27],v3 offset:21248
v_mfma_f32_16x16x32_bf16 v[148:151],v[28:31],v[60:63],v[148:151]
buffer_load_dword v91,v90,s[28:31],s48 offen
s_add_u32 s48,s48,s49
v_mfma_f32_16x16x32_bf16 v[152:155],v[28:31],v[64:67],v[152:155]
v_mfma_f32_16x16x32_bf16 v[156:159],v[28:31],v[68:71],v[156:159]
ds_read_b64_tr_b16 v[28:29],v4 offset:20480
v_mfma_f32_16x16x32_bf16 v[160:163],v[32:35],v[56:59],v[160:163]
ds_read_b64_tr_b16 v[30:31],v4 offset:21248
v_mfma_f32_16x16x32_bf16 v[164:167],v[32:35],v[60:63],v[164:167]
v_mfma_f32_16x16x32_bf16 v[168:171],v[32:35],v[64:67],v[168:171]
v_mfma_f32_16x16x32_bf16 v[172:175],v[32:35],v[68:71],v[172:175]
ds_read_b64_tr_b16 v[32:33],v5 offset:20480
v_mfma_f32_16x16x32_bf16 v[176:179],v[36:39],v[56:59],v[176:179]
ds_read_b64_tr_b16 v[34:35],v5 offset:21248
v_mfma_f32_16x16x32_bf16 v[180:183],v[36:39],v[60:63],v[180:183]
v_mfma_f32_16x16x32_bf16 v[184:187],v[36:39],v[64:67],v[184:187]
v_mfma_f32_16x16x32_bf16 v[188:191],v[36:39],v[68:71],v[188:191]
ds_read_b64_tr_b16 v[36:37],v6 offset:20480
v_mfma_f32_16x16x32_bf16 v[192:195],v[40:43],v[56:59],v[192:195]
ds_read_b64_tr_b16 v[38:39],v6 offset:21248
v_mfma_f32_16x16x32_bf16 v[196:199],v[40:43],v[60:63],v[196:199]
v_mfma_f32_16x16x32_bf16 v[200:203],v[40:43],v[64:67],v[200:203]
v_mfma_f32_16x16x32_bf16 v[204:207],v[40:43],v[68:71],v[204:207]
ds_read_b64_tr_b16 v[40:41],v7 offset:20480
v_mfma_f32_16x16x32_bf16 v[208:211],v[44:47],v[56:59],v[208:211]
ds_read_b64_tr_b16 v[42:43],v7 offset:21248
v_mfma_f32_16x16x32_bf16 v[212:215],v[44:47],v[60:63],v[212:215]
v_mfma_f32_16x16x32_bf16 v[216:219],v[44:47],v[64:67],v[216:219]
v_mfma_f32_16x16x32_bf16 v[220:223],v[44:47],v[68:71],v[220:223]
ds_read_b64_tr_b16 v[44:45],v8 offset:20480
v_mfma_f32_16x16x32_bf16 v[224:227],v[48:51],v[56:59],v[224:227]
ds_read_b64_tr_b16 v[46:47],v8 offset:21248
v_mfma_f32_16x16x32_bf16 v[228:231],v[48:51],v[60:63],v[228:231]
v_mfma_f32_16x16x32_bf16 v[232:235],v[48:51],v[64:67],v[232:235]
v_mfma_f32_16x16x32_bf16 v[236:239],v[48:51],v[68:71],v[236:239]
ds_read_b64_tr_b16 v[48:49],v9 offset:20480
v_mfma_f32_16x16x32_bf16 v[240:243],v[52:55],v[56:59],v[240:243]
ds_read_b64_tr_b16 v[50:51],v9 offset:21248
v_mfma_f32_16x16x32_bf16 v[244:247],v[52:55],v[60:63],v[244:247]
v_mfma_f32_16x16x32_bf16 v[248:251],v[52:55],v[64:67],v[248:251]
v_mfma_f32_16x16x32_bf16 v[252:255],v[52:55],v[68:71],v[252:255]
ds_read_b64_tr_b16 v[52:53],v10 offset:20480
ds_read_b64_tr_b16 v[54:55],v10 offset:21248
s_waitcnt lgkmcnt(15)
v_mfma_f32_16x16x32_bf16 v[96:99],v[16:19],v[72:75],v[96:99]
v_mfma_f32_16x16x32_bf16 v[100:103],v[16:19],v[76:79],v[100:103]
v_mfma_f32_16x16x32_bf16 v[104:107],v[16:19],v[80:83],v[104:107]
v_mfma_f32_16x16x32_bf16 v[108:111],v[16:19],v[84:87],v[108:111]
s_waitcnt vmcnt(1) lgkmcnt(0)
s_barrier
ds_read_b64_tr_b16 v[16:17],v1 offset:40960
v_mfma_f32_16x16x32_bf16 v[112:115],v[20:23],v[72:75],v[112:115]
ds_read_b64_tr_b16 v[18:19],v1 offset:41984
v_mfma_f32_16x16x32_bf16 v[116:119],v[20:23],v[76:79],v[116:119]
ds_read_b128 v[56:59],v11 offset:32768
v_mfma_f32_16x16x32_bf16 v[120:123],v[20:23],v[80:83],v[120:123]
ds_read_b128 v[60:63],v11 offset:34816
v_mfma_f32_16x16x32_bf16 v[124:127],v[20:23],v[84:87],v[124:127]
ds_read_b64_tr_b16 v[20:21],v2 offset:40960
v_mfma_f32_16x16x32_bf16 v[128:131],v[24:27],v[72:75],v[128:131]
ds_read_b64_tr_b16 v[22:23],v2 offset:41984
v_mfma_f32_16x16x32_bf16 v[132:135],v[24:27],v[76:79],v[132:135]
ds_read_b128 v[64:67],v11 offset:36864
v_mfma_f32_16x16x32_bf16 v[136:139],v[24:27],v[80:83],v[136:139]
ds_read_b128 v[68:71],v11 offset:38912
v_mfma_f32_16x16x32_bf16 v[140:143],v[24:27],v[84:87],v[140:143]
ds_read_b64_tr_b16 v[24:25],v3 offset:40960
v_mfma_f32_16x16x32_bf16 v[144:147],v[28:31],v[72:75],v[144:147]
ds_read_b64_tr_b16 v[26:27],v3 offset:41728
v_mfma_f32_16x16x32_bf16 v[148:151],v[28:31],v[76:79],v[148:151]
s_add_u32 m0,s54,0
s_nop 0
buffer_load_dwordx4 v88,s[56:59],s55 offen lds
v_mfma_f32_16x16x32_bf16 v[152:155],v[28:31],v[80:83],v[152:155]
v_mfma_f32_16x16x32_bf16 v[156:159],v[28:31],v[84:87],v[156:159]
ds_read_b64_tr_b16 v[28:29],v4 offset:40960
v_mfma_f32_16x16x32_bf16 v[160:163],v[32:35],v[72:75],v[160:163]
ds_read_b64_tr_b16 v[30:31],v4 offset:41728
v_mfma_f32_16x16x32_bf16 v[164:167],v[32:35],v[76:79],v[164:167]
buffer_load_dwordx4 v89,s[56:59],s55 offen offset:1024 lds
v_mfma_f32_16x16x32_bf16 v[168:171],v[32:35],v[80:83],v[168:171]
v_mfma_f32_16x16x32_bf16 v[172:175],v[32:35],v[84:87],v[172:175]
ds_read_b64_tr_b16 v[32:33],v5 offset:40960
v_mfma_f32_16x16x32_bf16 v[176:179],v[36:39],v[72:75],v[176:179]
ds_read_b64_tr_b16 v[34:35],v5 offset:41728
v_mfma_f32_16x16x32_bf16 v[180:183],v[36:39],v[76:79],v[180:183]
s_add_u32 m0,s54,2048
s_add_u32 s51,s55,32768
buffer_load_dwordx4 v88,s[56:59],s51 offen lds
v_mfma_f32_16x16x32_bf16 v[184:187],v[36:39],v[80:83],v[184:187]
v_mfma_f32_16x16x32_bf16 v[188:191],v[36:39],v[84:87],v[188:191]
ds_read_b64_tr_b16 v[36:37],v6 offset:40960
v_mfma_f32_16x16x32_bf16 v[192:195],v[40:43],v[72:75],v[192:195]
ds_read_b64_tr_b16 v[38:39],v6 offset:41728
v_mfma_f32_16x16x32_bf16 v[196:199],v[40:43],v[76:79],v[196:199]
buffer_load_dwordx4 v89,s[56:59],s51 offen offset:1024 lds
v_mfma_f32_16x16x32_bf16 v[200:203],v[40:43],v[80:83],v[200:203]
v_mfma_f32_16x16x32_bf16 v[204:207],v[40:43],v[84:87],v[204:207]
ds_read_b64_tr_b16 v[40:41],v7 offset:40960
v_mfma_f32_16x16x32_bf16 v[208:211],v[44:47],v[72:75],v[208:211]
ds_read_b64_tr_b16 v[42:43],v7 offset:41728
v_mfma_f32_16x16x32_bf16 v[212:215],v[44:47],v[76:79],v[212:215]
s_add_u32 m0,s54,4096
s_add_u32 s51,s55,65536
buffer_load_dwordx4 v88,s[56:59],s51 offen lds
v_mfma_f32_16x16x32_bf16 v[216:219],v[44:47],v[80:83],v[216:219]
v_mfma_f32_16x16x32_bf16 v[220:223],v[44:47],v[84:87],v[220:223]
ds_read_b64_tr_b16 v[44:45],v8 offset:40960
v_mfma_f32_16x16x32_bf16 v[224:227],v[48:51],v[72:75],v[224:227]
ds_read_b64_tr_b16 v[46:47],v8 offset:41728
v_mfma_f32_16x16x32_bf16 v[228:231],v[48:51],v[76:79],v[228:231]
buffer_load_dwordx4 v89,s[56:59],s51 offen offset:1024 lds
v_mfma_f32_16x16x32_bf16 v[232:235],v[48:51],v[80:83],v[232:235]
v_mfma_f32_16x16x32_bf16 v[236:239],v[48:51],v[84:87],v[236:239]
ds_read_b64_tr_b16 v[48:49],v9 offset:40960
v_mfma_f32_16x16x32_bf16 v[240:243],v[52:55],v[72:75],v[240:243]
ds_read_b64_tr_b16 v[50:51],v9 offset:41728
v_mfma_f32_16x16x32_bf16 v[244:247],v[52:55],v[76:79],v[244:247]
s_add_u32 m0,s54,6144
s_add_u32 s51,s55,98304
buffer_load_dwordx4 v88,s[56:59],s51 offen lds
v_mfma_f32_16x16x32_bf16 v[248:251],v[52:55],v[80:83],v[248:251]
buffer_load_dwordx4 v89,s[56:59],s51 offen offset:1024 lds
s_add_u32 s55,s55,128
v_mfma_f32_16x16x32_bf16 v[252:255],v[52:55],v[84:87],v[252:255]
ds_read_b64_tr_b16 v[52:53],v10 offset:40960
ds_read_b64_tr_b16 v[54:55],v10 offset:41728
s_waitcnt lgkmcnt(15)
v_mfma_f32_16x16x32_bf16 v[96:99],v[16:19],v[56:59],v[96:99]
v_mfma_f32_16x16x32_bf16 v[100:103],v[16:19],v[60:63],v[100:103]
v_mfma_f32_16x16x32_bf16 v[104:107],v[16:19],v[64:67],v[104:107]
v_mfma_f32_16x16x32_bf16 v[108:111],v[16:19],v[68:71],v[108:111]
s_waitcnt vmcnt(9) lgkmcnt(0)
s_barrier
ds_read_b64_tr_b16 v[16:17],v1 offset:61440
v_mfma_f32_16x16x32_bf16 v[112:115],v[20:23],v[56:59],v[112:115]
ds_read_b64_tr_b16 v[18:19],v1 offset:62464
v_mfma_f32_16x16x32_bf16 v[116:119],v[20:23],v[60:63],v[116:119]
ds_read_b128 v[72:75],v94 offset:32768
v_mfma_f32_16x16x32_bf16 v[120:123],v[20:23],v[64:67],v[120:123]
ds_read_b128 v[76:79],v94 offset:34816
v_mfma_f32_16x16x32_bf16 v[124:127],v[20:23],v[68:71],v[124:127]
ds_read_b64_tr_b16 v[20:21],v2 offset:61440
v_mfma_f32_16x16x32_bf16 v[128:131],v[24:27],v[56:59],v[128:131]
ds_read_b64_tr_b16 v[22:23],v2 offset:62464
v_mfma_f32_16x16x32_bf16 v[132:135],v[24:27],v[60:63],v[132:135]
ds_read_b128 v[80:83],v94 offset:36864
v_mfma_f32_16x16x32_bf16 v[136:139],v[24:27],v[64:67],v[136:139]
ds_read_b128 v[84:87],v94 offset:38912
v_mfma_f32_16x16x32_bf16 v[140:143],v[24:27],v[68:71],v[140:143]
ds_read_b64_tr_b16 v[24:25],v3 offset:61440
v_mfma_f32_16x16x32_bf16 v[144:147],v[28:31],v[56:59],v[144:147]
ds_read_b64_tr_b16 v[26:27],v3 offset:62208
v_mfma_f32_16x16x32_bf16 v[148:151],v[28:31],v[60:63],v[148:151]
buffer_load_dword v91,v90,s[28:31],s48 offen
s_add_u32 s48,s48,s49
v_mfma_f32_16x16x32_bf16 v[152:155],v[28:31],v[64:67],v[152:155]
v_mfma_f32_16x16x32_bf16 v[156:159],v[28:31],v[68:71],v[156:159]
ds_read_b64_tr_b16 v[28:29],v4 offset:61440
v_mfma_f32_16x16x32_bf16 v[160:163],v[32:35],v[56:59],v[160:163]
ds_read_b64_tr_b16 v[30:31],v4 offset:62208
v_mfma_f32_16x16x32_bf16 v[164:167],v[32:35],v[60:63],v[164:167]
v_mfma_f32_16x16x32_bf16 v[168:171],v[32:35],v[64:67],v[168:171]
v_mfma_f32_16x16x32_bf16 v[172:175],v[32:35],v[68:71],v[172:175]
ds_read_b64_tr_b16 v[32:33],v5 offset:61440
v_mfma_f32_16x16x32_bf16 v[176:179],v[36:39],v[56:59],v[176:179]
ds_read_b64_tr_b16 v[34:35],v5 offset:62208
v_mfma_f32_16x16x32_bf16 v[180:183],v[36:39],v[60:63],v[180:183]
v_mfma_f32_16x16x32_bf16 v[184:187],v[36:39],v[64:67],v[184:187]
v_mfma_f32_16x16x32_bf16 v[188:191],v[36:39],v[68:71],v[188:191]
ds_read_b64_tr_b16 v[36:37],v6 offset:61440
v_mfma_f32_16x16x32_bf16 v[192:195],v[40:43],v[56:59],v[192:195]
ds_read_b64_tr_b16 v[38:39],v6 offset:62208
v_mfma_f32_16x16x32_bf16 v[196:199],v[40:43],v[60:63],v[196:199]
v_mfma_f32_16x16x32_bf16 v[200:203],v[40:43],v[64:67],v[200:203]
v_mfma_f32_16x16x32_bf16 v[204:207],v[40:43],v[68:71],v[204:207]
ds_read_b64_tr_b16 v[40:41],v7 offset:61440
v_mfma_f32_16x16x32_bf16 v[208:211],v[44:47],v[56:59],v[208:211]
ds_read_b64_tr_b16 v[42:43],v7 offset:62208
v_mfma_f32_16x16x32_bf16 v[212:215],v[44:47],v[60:63],v[212:215]
v_mfma_f32_16x16x32_bf16 v[216:219],v[44:47],v[64:67],v[216:219]
v_mfma_f32_16x16x32_bf16 v[220:223],v[44:47],v[68:71],v[220:223]
ds_read_b64_tr_b16 v[44:45],v8 offset:61440
v_mfma_f32_16x16x32_bf16 v[224:227],v[48:51],v[56:59],v[224:227]
ds_read_b64_tr_b16 v[46:47],v8 offset:62208
v_mfma_f32_16x16x32_bf16 v[228:231],v[48:51],v[60:63],v[228:231]
v_mfma_f32_16x16x32_bf16 v[232:235],v[48:51],v[64:67],v[232:235]
v_mfma_f32_16x16x32_bf16 v[236:239],v[48:51],v[68:71],v[236:239]
ds_read_b64_tr_b16 v[48:49],v9 offset:61440
v_mfma_f32_16x16x32_bf16 v[240:243],v[52:55],v[56:59],v[240:243]
ds_read_b64_tr_b16 v[50:51],v9 offset:62208
v_mfma_f32_16x16x32_bf16 v[244:247],v[52:55],v[60:63],v[244:247]
v_mfma_f32_16x16x32_bf16 v[248:251],v[52:55],v[64:67],v[248:251]
v_mfma_f32_16x16x32_bf16 v[252:255],v[52:55],v[68:71],v[252:255]
ds_read_b64_tr_b16 v[52:53],v10 offset:61440
ds_read_b64_tr_b16 v[54:55],v10 offset:62208
s_waitcnt lgkmcnt(15)
v_mfma_f32_16x16x32_bf16 v[96:99],v[16:19],v[72:75],v[96:99]
v_mfma_f32_16x16x32_bf16 v[100:103],v[16:19],v[76:79],v[100:103]
v_mfma_f32_16x16x32_bf16 v[104:107],v[16:19],v[80:83],v[104:107]
v_mfma_f32_16x16x32_bf16 v[108:111],v[16:19],v[84:87],v[108:111]
s_waitcnt vmcnt(1) lgkmcnt(0)
s_barrier
ds_read_b64_tr_b16 v[16:17],v1 offset:0
v_mfma_f32_16x16x32_bf16 v[112:115],v[20:23],v[72:75],v[112:115]
ds_read_b64_tr_b16 v[18:19],v1 offset:1024
v_mfma_f32_16x16x32_bf16 v[116:119],v[20:23],v[76:79],v[116:119]
ds_read_b128 v[56:59],v11 offset:0
v_mfma_f32_16x16x32_bf16 v[120:123],v[20:23],v[80:83],v[120:123]
ds_read_b128 v[60:63],v11 offset:2048
v_mfma_f32_16x16x32_bf16 v[124:127],v[20:23],v[84:87],v[124:127]
ds_read_b64_tr_b16 v[20:21],v2 offset:0
v_mfma_f32_16x16x32_bf16 v[128:131],v[24:27],v[72:75],v[128:131]
ds_read_b64_tr_b16 v[22:23],v2 offset:1024
v_mfma_f32_16x16x32_bf16 v[132:135],v[24:27],v[76:79],v[132:135]
ds_read_b128 v[64:67],v11 offset:4096
v_mfma_f32_16x16x32_bf16 v[136:139],v[24:27],v[80:83],v[136:139]
ds_read_b128 v[68:71],v11 offset:6144
v_mfma_f32_16x16x32_bf16 v[140:143],v[24:27],v[84:87],v[140:143]
ds_read_b64_tr_b16 v[24:25],v3 offset:0
v_mfma_f32_16x16x32_bf16 v[144:147],v[28:31],v[72:75],v[144:147]
ds_read_b64_tr_b16 v[26:27],v3 offset:768
v_mfma_f32_16x16x32_bf16 v[148:151],v[28:31],v[76:79],v[148:151]
s_add_u32 m0,s54,32768
s_nop 0
buffer_load_dwordx4 v88,s[56:59],s55 offen lds
v_mfma_f32_16x16x32_bf16 v[152:155],v[28:31],v[80:83],v[152:155]
v_mfma_f32_16x16x32_bf16 v[156:159],v[28:31],v[84:87],v[156:159]
ds_read_b64_tr_b16 v[28:29],v4 offset:0
v_mfma_f32_16x16x32_bf16 v[160:163],v[32:35],v[72:75],v[160:163]
ds_read_b64_tr_b16 v[30:31],v4 offset:768
v_mfma_f32_16x16x32_bf16 v[164:167],v[32:35],v[76:79],v[164:167]
buffer_load_dwordx4 v89,s[56:59],s55 offen offset:1024 lds
v_mfma_f32_16x16x32_bf16 v[168:171],v[32:35],v[80:83],v[168:171]
v_mfma_f32_16x16x32_bf16 v[172:175],v[32:35],v[84:87],v[172:175]
ds_read_b64_tr_b16 v[32:33],v5 offset:0
v_mfma_f32_16x16x32_bf16 v[176:179],v[36:39],v[72:75],v[176:179]
ds_read_b64_tr_b16 v[34:35],v5 offset:768
v_mfma_f32_16x16x32_bf16 v[180:183],v[36:39],v[76:79],v[180:183]
s_add_u32 m0,s54,34816
s_add_u32 s51,s55,32768
buffer_load_dwordx4 v88,s[56:59],s51 offen lds
v_mfma_f32_16x16x32_bf16 v[184:187],v[36:39],v[80:83],v[184:187]
v_mfma_f32_16x16x32_bf16 v[188:191],v[36:39],v[84:87],v[188:191]
ds_read_b64_tr_b16 v[36:37],v6 offset:0
v_mfma_f32_16x16x32_bf16 v[192:195],v[40:43],v[72:75],v[192:195]
ds_read_b64_tr_b16 v[38:39],v6 offset:768
v_mfma_f32_16x16x32_bf16 v[196:199],v[40:43],v[76:79],v[196:199]
buffer_load_dwordx4 v89,s[56:59],s51 offen offset:1024 lds
v_mfma_f32_16x16x32_bf16 v[200:203],v[40:43],v[80:83],v[200:203]
v_mfma_f32_16x16x32_bf16 v[204:207],v[40:43],v[84:87],v[204:207]
ds_read_b64_tr_b16 v[40:41],v7 offset:0
v_mfma_f32_16x16x32_bf16 v[208:211],v[44:47],v[72:75],v[208:211]
ds_read_b64_tr_b16 v[42:43],v7 offset:768
v_mfma_f32_16x16x32_bf16 v[212:215],v[44:47],v[76:79],v[212:215]
s_add_u32 m0,s54,36864
s_add_u32 s51,s55,65536
buffer_load_dwordx4 v88,s[56:59],s51 offen lds
v_mfma_f32_16x16x32_bf16 v[216:219],v[44:47],v[80:83],v[216:219]
v_mfma_f32_16x16x32_bf16 v[220:223],v[44:47],v[84:87],v[220:223]
ds_read_b64_tr_b16 v[44:45],v8 offset:0
v_mfma_f32_16x16x32_bf16 v[224:227],v[48:51],v[72:75],v[224:227]
ds_read_b64_tr_b16 v[46:47],v8 offset:768
v_mfma_f32_16x16x32_bf16 v[228:231],v[48:51],v[76:79],v[228:231]
buffer_load_dwordx4 v89,s[56:59],s51 offen offset:1024 lds
v_mfma_f32_16x16x32_bf16 v[232:235],v[48:51],v[80:83],v[232:235]
v_mfma_f32_16x16x32_bf16 v[236:239],v[48:51],v[84:87],v[236:239]
ds_read_b64_tr_b16 v[48:49],v9 offset:0
v_mfma_f32_16x16x32_bf16 v[240:243],v[52:55],v[72:75],v[240:243]
ds_read_b64_tr_b16 v[50:51],v9 offset:768
v_mfma_f32_16x16x32_bf16 v[244:247],v[52:55],v[76:79],v[244:247]
s_add_u32 m0,s54,38912
s_add_u32 s51,s55,98304
buffer_load_dwordx4 v88,s[56:59],s51 offen lds
v_mfma_f32_16x16x32_bf16 v[248:251],v[52:55],v[80:83],v[248:251]
buffer_load_dwordx4 v89,s[56:59],s51 offen offset:1024 lds
s_and_b32 s50,s64,7
s_lshr_b32 s64,s64,4
s_mul_i32 s55,s50,256
s_add_u32 s55,s55,s65
v_mfma_f32_16x16x32_bf16 v[252:255],v[52:55],v[84:87],v[252:255]
ds_read_b64_tr_b16 v[52:53],v10 offset:0
ds_read_b64_tr_b16 v[54:55],v10 offset:768
s_sub_u32 s53,s53,1
s_cmp_lg_u32 s53,0
s_cbranch_scc1 g2_loop3
s_waitcnt lgkmcnt(15)
v_mfma_f32_16x16x32_bf16 v[96:99],v[16:19],v[56:59],v[96:99]
v_mfma_f32_16x16x32_bf16 v[100:103],v[16:19],v[60:63],v[100:103]
v_mfma_f32_16x16x32_bf16 v[104:107],v[16:19],v[64:67],v[104:107]
v_mfma_f32_16x16x32_bf16 v[108:111],v[16:19],v[68:71],v[108:111]
s_waitcnt vmcnt(9) lgkmcnt(0)
s_barrier
ds_read_b64_tr_b16 v[16:17],v1 offset:20480
v_mfma_f32_16x16x32_bf16 v[112:115],v[20:23],v[56:59],v[112:115]
ds_read_b64_tr_b16 v[18:19],v1 offset:21504
v_mfma_f32_16x16x32_bf16 v[116:119],v[20:23],v[60:63],v[116:119]
ds_read_b128 v[72:75],v94 offset:0
v_mfma_f32_16x16x32_bf16 v[120:123],v[20:23],v[64:67],v[120:123]
ds_read_b128 v[76:79],v94 offset:2048
v_mfma_f32_16x16x32_bf16 v[124:127],v[20:23],v[68:71],v[124:127]
ds_read_b64_tr_b16 v[20:21],v2 offset:20480
v_mfma_f32_16x16x32_bf16 v[128:131],v[24:27],v[56:59],v[128:131]
ds_read_b64_tr_b16 v[22:23],v2 offset:21504
v_mfma_f32_16x16x32_bf16 v[132:135],v[24:27],v[60:63],v[132:135]
ds_read_b128 v[80:83],v94 offset:4096
v_mfma_f32_16x16x32_bf16 v[136:139],v[24:27],v[64:67],v[136:139]
ds_read_b128 v[84:87],v94 offset:6144
v_mfma_f32_16x16x32_bf16 v[140:143],v[24:27],v[68:71],v[140:143]
ds_read_b64_tr_b16 v[24:25],v3 offset:20480
v_mfma_f32_16x16x32_bf16 v[144:147],v[28:31],v[56:59],v[144:147]
ds_read_b64_tr_b16 v[26:27],v3 offset:21248
v_mfma_f32_16x16x32_bf16 v[148:151],v[28:31],v[60:63],v[148:151]
buffer_load_dword v93,off,s[60:63],0 sc1
v_mfma_f32_16x16x32_bf16 v[152:155],v[28:31],v[64:67],v[152:155]
v_mfma_f32_16x16x32_bf16 v[156:159],v[28:31],v[68:71],v[156:159]
ds_read_b64_tr_b16 v[28:29],v4 offset:20480
v_mfma_f32_16x16x32_bf16 v[160:163],v[32:35],v[56:59],v[160:163]
ds_read_b64_tr_b16 v[30:31],v4 offset:21248
v_mfma_f32_16x16x32_bf16 v[164:167],v[32:35],v[60:63],v[164:167]
s_getpc_b64 s[28:29]
g2_cx3:
s_and_b32 s29,s29,0xffff
s_mov_b32 s30,text_end-g2_cx3
s_mov_b32 s31,0x00020000
s_bfe_u32 s48,s2,0x30003
s_lshl_b32 s48,s48,2
s_add_u32 s48,s48,s41
s_lshl_b32 s48,s48,11
s_add_u32 s48,s48,af_entry-g2_cx3
buffer_load_dword v91,v90,s[28:31],s48 offen
v_mfma_f32_16x16x32_bf16 v[168:171],v[32:35],v[64:67],v[168:171]
v_mfma_f32_16x16x32_bf16 v[172:175],v[32:35],v[68:71],v[172:175]
ds_read_b64_tr_b16 v[32:33],v5 offset:20480
v_mfma_f32_16x16x32_bf16 v[176:179],v[36:39],v[56:59],v[176:179]
ds_read_b64_tr_b16 v[34:35],v5 offset:21248
v_mfma_f32_16x16x32_bf16 v[180:183],v[36:39],v[60:63],v[180:183]
v_mfma_f32_16x16x32_bf16 v[184:187],v[36:39],v[64:67],v[184:187]
v_mfma_f32_16x16x32_bf16 v[188:191],v[36:39],v[68:71],v[188:191]
ds_read_b64_tr_b16 v[36:37],v6 offset:20480
v_mfma_f32_16x16x32_bf16 v[192:195],v[40:43],v[56:59],v[192:195]
ds_read_b64_tr_b16 v[38:39],v6 offset:21248
v_mfma_f32_16x16x32_bf16 v[196:199],v[40:43],v[60:63],v[196:199]
v_mfma_f32_16x16x32_bf16 v[200:203],v[40:43],v[64:67],v[200:203]
v_mfma_f32_16x16x32_bf16 v[204:207],v[40:43],v[68:71],v[204:207]
ds_read_b64_tr_b16 v[40:41],v7 offset:20480
v_mfma_f32_16x16x32_bf16 v[208:211],v[44:47],v[56:59],v[208:211]
ds_read_b64_tr_b16 v[42:43],v7 offset:21248
v_mfma_f32_16x16x32_bf16 v[212:215],v[44:47],v[60:63],v[212:215]
v_mfma_f32_16x16x32_bf16 v[216:219],v[44:47],v[64:67],v[216:219]
v_mfma_f32_16x16x32_bf16 v[220:223],v[44:47],v[68:71],v[220:223]
ds_read_b64_tr_b16 v[44:45],v8 offset:20480
v_mfma_f32_16x16x32_bf16 v[224:227],v[48:51],v[56:59],v[224:227]
ds_read_b64_tr_b16 v[46:47],v8 offset:21248
v_mfma_f32_16x16x32_bf16 v[228:231],v[48:51],v[60:63],v[228:231]
v_mfma_f32_16x16x32_bf16 v[232:235],v[48:51],v[64:67],v[232:235]
v_mfma_f32_16x16x32_bf16 v[236:239],v[48:51],v[68:71],v[236:239]
ds_read_b64_tr_b16 v[48:49],v9 offset:20480
v_mfma_f32_16x16x32_bf16 v[240:243],v[52:55],v[56:59],v[240:243]
ds_read_b64_tr_b16 v[50:51],v9 offset:21248
v_mfma_f32_16x16x32_bf16 v[244:247],v[52:55],v[60:63],v[244:247]
v_mfma_f32_16x16x32_bf16 v[248:251],v[52:55],v[64:67],v[248:251]
v_mfma_f32_16x16x32_bf16 v[252:255],v[52:55],v[68:71],v[252:255]
ds_read_b64_tr_b16 v[52:53],v10 offset:20480
ds_read_b64_tr_b16 v[54:55],v10 offset:21248
s_waitcnt lgkmcnt(15)
v_mfma_f32_16x16x32_bf16 v[96:99],v[16:19],v[72:75],v[96:99]
v_mfma_f32_16x16x32_bf16 v[100:103],v[16:19],v[76:79],v[100:103]
v_mfma_f32_16x16x32_bf16 v[104:107],v[16:19],v[80:83],v[104:107]
v_mfma_f32_16x16x32_bf16 v[108:111],v[16:19],v[84:87],v[108:111]
s_waitcnt vmcnt(1) lgkmcnt(0)
s_barrier
v_readfirstlane_b32 s50,v93
s_nop 0
s_cmp_lg_u32 s50,256
s_cbranch_scc1 g2_bad3
g2_badr3:
ds_read_b64_tr_b16 v[16:17],v1 offset:40960
v_mfma_f32_16x16x32_bf16 v[112:115],v[20:23],v[72:75],v[112:115]
ds_read_b64_tr_b16 v[18:19],v1 offset:41984
v_mfma_f32_16x16x32_bf16 v[116:119],v[20:23],v[76:79],v[116:119]
ds_read_b128 v[56:59],v11 offset:32768
v_mfma_f32_16x16x32_bf16 v[120:123],v[20:23],v[80:83],v[120:123]
ds_read_b128 v[60:63],v11 offset:34816
v_mfma_f32_16x16x32_bf16 v[124:127],v[20:23],v[84:87],v[124:127]
ds_read_b64_tr_b16 v[20:21],v2 offset:40960
v_mfma_f32_16x16x32_bf16 v[128:131],v[24:27],v[72:75],v[128:131]
ds_read_b64_tr_b16 v[22:23],v2 offset:41984
v_mfma_f32_16x16x32_bf16 v[132:135],v[24:27],v[76:79],v[132:135]
ds_read_b128 v[64:67],v11 offset:36864
v_mfma_f32_16x16x32_bf16 v[136:139],v[24:27],v[80:83],v[136:139]
ds_read_b128 v[68:71],v11 offset:38912
v_mfma_f32_16x16x32_bf16 v[140:143],v[24:27],v[84:87],v[140:143]
ds_read_b64_tr_b16 v[24:25],v3 offset:40960
v_mfma_f32_16x16x32_bf16 v[144:147],v[28:31],v[72:75],v[144:147]
ds_read_b64_tr_b16 v[26:27],v3 offset:41728
v_mfma_f32_16x16x32_bf16 v[148:151],v[28:31],v[76:79],v[148:151]
v_lshlrev_b32 v92,5,v0
buffer_load_dwordx4 v[12:15],v92,s[36:39],s98 offen sc1
v_mfma_f32_16x16x32_bf16 v[152:155],v[28:31],v[80:83],v[152:155]
v_mfma_f32_16x16x32_bf16 v[156:159],v[28:31],v[84:87],v[156:159]
ds_read_b64_tr_b16 v[28:29],v4 offset:40960
v_mfma_f32_16x16x32_bf16 v[160:163],v[32:35],v[72:75],v[160:163]
ds_read_b64_tr_b16 v[30:31],v4 offset:41728
v_mfma_f32_16x16x32_bf16 v[164:167],v[32:35],v[76:79],v[164:167]
buffer_load_dwordx4 v[88:91],v92,s[36:39],s98 offen offset:16 sc1
v_mfma_f32_16x16x32_bf16 v[168:171],v[32:35],v[80:83],v[168:171]
v_mfma_f32_16x16x32_bf16 v[172:175],v[32:35],v[84:87],v[172:175]
ds_read_b64_tr_b16 v[32:33],v5 offset:40960
v_mfma_f32_16x16x32_bf16 v[176:179],v[36:39],v[72:75],v[176:179]
ds_read_b64_tr_b16 v[34:35],v5 offset:41728
v_mfma_f32_16x16x32_bf16 v[180:183],v[36:39],v[76:79],v[180:183]
v_lshrrev_b32 v93,5,v0
v_mul_u32_u24 v93,8064,v93
v_lshl_add_u32 v93,v0,2,v93
s_lshl_b32 s50,s40,8
s_add_u32 m0,s50,149504
s_lshr_b32 s50,s50,1
s_lshl_b32 s51,s43,10
s_add_u32 s50,s50,s51
s_add_u32 s50,s50,42991616
buffer_load_dword v93,s[36:39],s50 offen sc1 lds
v_mfma_f32_16x16x32_bf16 v[184:187],v[36:39],v[80:83],v[184:187]
v_mfma_f32_16x16x32_bf16 v[188:191],v[36:39],v[84:87],v[188:191]
ds_read_b64_tr_b16 v[36:37],v6 offset:40960
v_mfma_f32_16x16x32_bf16 v[192:195],v[40:43],v[72:75],v[192:195]
ds_read_b64_tr_b16 v[38:39],v6 offset:41728
v_mfma_f32_16x16x32_bf16 v[196:199],v[40:43],v[76:79],v[196:199]
v_mfma_f32_16x16x32_bf16 v[200:203],v[40:43],v[80:83],v[200:203]
v_mfma_f32_16x16x32_bf16 v[204:207],v[40:43],v[84:87],v[204:207]
ds_read_b64_tr_b16 v[40:41],v7 offset:40960
v_mfma_f32_16x16x32_bf16 v[208:211],v[44:47],v[72:75],v[208:211]
ds_read_b64_tr_b16 v[42:43],v7 offset:41728
v_mfma_f32_16x16x32_bf16 v[212:215],v[44:47],v[76:79],v[212:215]
v_mfma_f32_16x16x32_bf16 v[216:219],v[44:47],v[80:83],v[216:219]
v_mfma_f32_16x16x32_bf16 v[220:223],v[44:47],v[84:87],v[220:223]
ds_read_b64_tr_b16 v[44:45],v8 offset:40960
v_mfma_f32_16x16x32_bf16 v[224:227],v[48:51],v[72:75],v[224:227]
ds_read_b64_tr_b16 v[46:47],v8 offset:41728
v_mfma_f32_16x16x32_bf16 v[228:231],v[48:51],v[76:79],v[228:231]
v_mfma_f32_16x16x32_bf16 v[232:235],v[48:51],v[80:83],v[232:235]
v_mfma_f32_16x16x32_bf16 v[236:239],v[48:51],v[84:87],v[236:239]
ds_read_b64_tr_b16 v[48:49],v9 offset:40960
v_mfma_f32_16x16x32_bf16 v[240:243],v[52:55],v[72:75],v[240:243]
ds_read_b64_tr_b16 v[50:51],v9 offset:41728
v_mfma_f32_16x16x32_bf16 v[244:247],v[52:55],v[76:79],v[244:247]
v_mfma_f32_16x16x32_bf16 v[248:251],v[52:55],v[80:83],v[248:251]
v_mfma_f32_16x16x32_bf16 v[252:255],v[52:55],v[84:87],v[252:255]
ds_read_b64_tr_b16 v[52:53],v10 offset:40960
ds_read_b64_tr_b16 v[54:55],v10 offset:41728
s_waitcnt lgkmcnt(15)
v_mfma_f32_16x16x32_bf16 v[96:99],v[16:19],v[56:59],v[96:99]
v_mfma_f32_16x16x32_bf16 v[100:103],v[16:19],v[60:63],v[100:103]
v_mfma_f32_16x16x32_bf16 v[104:107],v[16:19],v[64:67],v[104:107]
v_mfma_f32_16x16x32_bf16 v[108:111],v[16:19],v[68:71],v[108:111]
s_waitcnt vmcnt(0) lgkmcnt(0)
s_barrier
ds_read_b64_tr_b16 v[16:17],v1 offset:61440
v_mfma_f32_16x16x32_bf16 v[112:115],v[20:23],v[56:59],v[112:115]
ds_read_b64_tr_b16 v[18:19],v1 offset:62464
v_mfma_f32_16x16x32_bf16 v[116:119],v[20:23],v[60:63],v[116:119]
ds_read_b128 v[72:75],v94 offset:32768
v_mfma_f32_16x16x32_bf16 v[120:123],v[20:23],v[64:67],v[120:123]
ds_read_b128 v[76:79],v94 offset:34816
v_mfma_f32_16x16x32_bf16 v[124:127],v[20:23],v[68:71],v[124:127]
ds_read_b64_tr_b16 v[20:21],v2 offset:61440
v_mfma_f32_16x16x32_bf16 v[128:131],v[24:27],v[56:59],v[128:131]
ds_read_b64_tr_b16 v[22:23],v2 offset:62464
v_mfma_f32_16x16x32_bf16 v[132:135],v[24:27],v[60:63],v[132:135]
ds_read_b128 v[80:83],v94 offset:36864
v_mfma_f32_16x16x32_bf16 v[136:139],v[24:27],v[64:67],v[136:139]
ds_read_b128 v[84:87],v94 offset:38912
v_mfma_f32_16x16x32_bf16 v[140:143],v[24:27],v[68:71],v[140:143]
ds_read_b64_tr_b16 v[24:25],v3 offset:61440
v_mfma_f32_16x16x32_bf16 v[144:147],v[28:31],v[56:59],v[144:147]
ds_read_b64_tr_b16 v[26:27],v3 offset:62208
v_mfma_f32_16x16x32_bf16 v[148:151],v[28:31],v[60:63],v[148:151]
v_add_f32 v12,v12,v88
v_add_f32 v13,v13,v89
v_add_f32 v14,v14,v90
v_add_f32 v15,v15,v91
v_add_f32 v12,v12,v13
v_add_f32 v14,v14,v15
v_add_f32 v12,v12,v14
s_lshl_b32 s50,s40,8
s_add_u32 s50,s50,147456
v_lshl_add_u32 v92,v0,2,s50
ds_write_b32 v92,v12
v_mfma_f32_16x16x32_bf16 v[152:155],v[28:31],v[64:67],v[152:155]
v_mfma_f32_16x16x32_bf16 v[156:159],v[28:31],v[68:71],v[156:159]
ds_read_b64_tr_b16 v[28:29],v4 offset:61440
v_mfma_f32_16x16x32_bf16 v[160:163],v[32:35],v[56:59],v[160:163]
ds_read_b64_tr_b16 v[30:31],v4 offset:62208
v_mfma_f32_16x16x32_bf16 v[164:167],v[32:35],v[60:63],v[164:167]
v_mfma_f32_16x16x32_bf16 v[168:171],v[32:35],v[64:67],v[168:171]
v_mfma_f32_16x16x32_bf16 v[172:175],v[32:35],v[68:71],v[172:175]
ds_read_b64_tr_b16 v[32:33],v5 offset:61440
v_mfma_f32_16x16x32_bf16 v[176:179],v[36:39],v[56:59],v[176:179]
ds_read_b64_tr_b16 v[34:35],v5 offset:62208
v_mfma_f32_16x16x32_bf16 v[180:183],v[36:39],v[60:63],v[180:183]
v_mfma_f32_16x16x32_bf16 v[184:187],v[36:39],v[64:67],v[184:187]
v_mfma_f32_16x16x32_bf16 v[188:191],v[36:39],v[68:71],v[188:191]
ds_read_b64_tr_b16 v[36:37],v6 offset:61440
v_mfma_f32_16x16x32_bf16 v[192:195],v[40:43],v[56:59],v[192:195]
ds_read_b64_tr_b16 v[38:39],v6 offset:62208
v_mfma_f32_16x16x32_bf16 v[196:199],v[40:43],v[60:63],v[196:199]
v_mfma_f32_16x16x32_bf16 v[200:203],v[40:43],v[64:67],v[200:203]
v_mfma_f32_16x16x32_bf16 v[204:207],v[40:43],v[68:71],v[204:207]
ds_read_b64_tr_b16 v[40:41],v7 offset:61440
v_mfma_f32_16x16x32_bf16 v[208:211],v[44:47],v[56:59],v[208:211]
ds_read_b64_tr_b16 v[42:43],v7 offset:62208
v_mfma_f32_16x16x32_bf16 v[212:215],v[44:47],v[60:63],v[212:215]
v_mfma_f32_16x16x32_bf16 v[216:219],v[44:47],v[64:67],v[216:219]
v_mfma_f32_16x16x32_bf16 v[220:223],v[44:47],v[68:71],v[220:223]
ds_read_b64_tr_b16 v[44:45],v8 offset:61440
v_mfma_f32_16x16x32_bf16 v[224:227],v[48:51],v[56:59],v[224:227]
ds_read_b64_tr_b16 v[46:47],v8 offset:62208
v_mfma_f32_16x16x32_bf16 v[228:231],v[48:51],v[60:63],v[228:231]
v_mfma_f32_16x16x32_bf16 v[232:235],v[48:51],v[64:67],v[232:235]
v_mfma_f32_16x16x32_bf16 v[236:239],v[48:51],v[68:71],v[236:239]
ds_read_b64_tr_b16 v[48:49],v9 offset:61440
v_mfma_f32_16x16x32_bf16 v[240:243],v[52:55],v[56:59],v[240:243]
ds_read_b64_tr_b16 v[50:51],v9 offset:62208
v_mfma_f32_16x16x32_bf16 v[244:247],v[52:55],v[60:63],v[244:247]
v_mfma_f32_16x16x32_bf16 v[248:251],v[52:55],v[64:67],v[248:251]
v_mfma_f32_16x16x32_bf16 v[252:255],v[52:55],v[68:71],v[252:255]
ds_read_b64_tr_b16 v[52:53],v10 offset:61440
ds_read_b64_tr_b16 v[54:55],v10 offset:62208
s_waitcnt lgkmcnt(15)
v_mfma_f32_16x16x32_bf16 v[96:99],v[16:19],v[72:75],v[96:99]
v_lshrrev_b32 v92,4,v0
v_lshlrev_b32 v92,4,v92
v_and_b32 v93,15,v0
v_lshlrev_b32 v93,2,v93
s_lshl_b32 s50,s41,9
v_mfma_f32_16x16x32_bf16 v[100:103],v[16:19],v[76:79],v[100:103]
s_add_u32 s50,s50,149504
v_add_u32 v94,s50,v93
v_add_u32 v95,s50,v92
v_add_u32 v92,147456,v92
v_add_u32 v93,147456,v93
v_mfma_f32_16x16x32_bf16 v[104:107],v[16:19],v[80:83],v[104:107]
v_mfma_f32_16x16x32_bf16 v[108:111],v[16:19],v[84:87],v[108:111]
s_waitcnt lgkmcnt(0)
s_barrier
ds_read_b128 v[16:19],v92 offset:384
v_mfma_f32_16x16x32_bf16 v[112:115],v[20:23],v[72:75],v[112:115]
v_mfma_f32_16x16x32_bf16 v[116:119],v[20:23],v[76:79],v[116:119]
ds_read_b32 v2,v93 offset:4096
v_mfma_f32_16x16x32_bf16 v[120:123],v[20:23],v[80:83],v[120:123]
ds_read2_b32 v[56:57],v94 offset0:0 offset1:32
v_mfma_f32_16x16x32_bf16 v[124:127],v[20:23],v[84:87],v[124:127]
ds_read_b128 v[20:23],v92 offset:448
v_mfma_f32_16x16x32_bf16 v[128:131],v[24:27],v[72:75],v[128:131]
v_mfma_f32_16x16x32_bf16 v[132:135],v[24:27],v[76:79],v[132:135]
ds_read2_b32 v[58:59],v94 offset0:16 offset1:48
v_mfma_f32_16x16x32_bf16 v[136:139],v[24:27],v[80:83],v[136:139]
ds_read2_b32 v[60:61],v94 offset0:64 offset1:96
v_mfma_f32_16x16x32_bf16 v[140:143],v[24:27],v[84:87],v[140:143]
ds_read_b128 v[24:27],v92 offset:640
v_mfma_f32_16x16x32_bf16 v[144:147],v[28:31],v[72:75],v[144:147]
v_mfma_f32_16x16x32_bf16 v[148:151],v[28:31],v[76:79],v[148:151]
ds_read2_b32 v[62:63],v94 offset0:80 offset1:112
v_mfma_f32_16x16x32_bf16 v[152:155],v[28:31],v[80:83],v[152:155]
v_mfma_f32_16x16x32_bf16 v[156:159],v[28:31],v[84:87],v[156:159]
ds_read_b128 v[28:31],v92 offset:704
v_mfma_f32_16x16x32_bf16 v[160:163],v[32:35],v[72:75],v[160:163]
v_mfma_f32_16x16x32_bf16 v[164:167],v[32:35],v[76:79],v[164:167]
v_mfma_f32_16x16x32_bf16 v[168:171],v[32:35],v[80:83],v[168:171]
v_mfma_f32_16x16x32_bf16 v[172:175],v[32:35],v[84:87],v[172:175]
ds_read_b128 v[32:35],v92 offset:1024
v_mfma_f32_16x16x32_bf16 v[176:179],v[36:39],v[72:75],v[176:179]
v_mfma_f32_16x16x32_bf16 v[180:183],v[36:39],v[76:79],v[180:183]
v_mfma_f32_16x16x32_bf16 v[184:187],v[36:39],v[80:83],v[184:187]
v_mfma_f32_16x16x32_bf16 v[188:191],v[36:39],v[84:87],v[188:191]
ds_read_b128 v[36:39],v92 offset:1088
v_mfma_f32_16x16x32_bf16 v[192:195],v[40:43],v[72:75],v[192:195]
v_mfma_f32_16x16x32_bf16 v[196:199],v[40:43],v[76:79],v[196:199]
v_mfma_f32_16x16x32_bf16 v[200:203],v[40:43],v[80:83],v[200:203]
v_mfma_f32_16x16x32_bf16 v[204:207],v[40:43],v[84:87],v[204:207]
ds_read_b128 v[40:43],v92 offset:768
v_mfma_f32_16x16x32_bf16 v[208:211],v[44:47],v[72:75],v[208:211]
v_mfma_f32_16x16x32_bf16 v[212:215],v[44:47],v[76:79],v[212:215]
v_mfma_f32_16x16x32_bf16 v[216:219],v[44:47],v[80:83],v[216:219]
v_mfma_f32_16x16x32_bf16 v[220:223],v[44:47],v[84:87],v[220:223]
ds_read_b128 v[44:47],v92 offset:832
v_mfma_f32_16x16x32_bf16 v[224:227],v[48:51],v[72:75],v[224:227]
v_mfma_f32_16x16x32_bf16 v[228:231],v[48:51],v[76:79],v[228:231]
v_mfma_f32_16x16x32_bf16 v[232:235],v[48:51],v[80:83],v[232:235]
v_mfma_f32_16x16x32_bf16 v[236:239],v[48:51],v[84:87],v[236:239]
ds_read_b128 v[48:51],v92 offset:1152
v_mfma_f32_16x16x32_bf16 v[240:243],v[52:55],v[72:75],v[240:243]
v_mfma_f32_16x16x32_bf16 v[244:247],v[52:55],v[76:79],v[244:247]
v_mfma_f32_16x16x32_bf16 v[248:251],v[52:55],v[80:83],v[248:251]
v_mfma_f32_16x16x32_bf16 v[252:255],v[52:55],v[84:87],v[252:255]
ds_read_b128 v[52:55],v92 offset:1216
s_waitcnt lgkmcnt(4)
v_readfirstlane_b32 s50,v2
v_lshlrev_b32 v1,4,v0
s_cmp_lg_u32 s50,0
s_cbranch_scc1 g2_rec
g2_ep3:
s_load_dwordx2 s[10:11],s[0:1],56
s_mov_b64 s[6:7],s[14:15]
s_mov_b64 s[8:9],s[16:17]
s_setprio 3
v_and_b32 v12,0x33,v0
v_lshlrev_b32 v12,4,v12
v_bfe_u32 v13,v0,2,1
v_lshl_add_u32 v12,v13,7,v12
v_bfe_u32 v13,v0,3,1
v_lshl_add_u32 v3,v13,10,v12
v_rcp_f32 v80,v57
v_rcp_f32 v82,v59
v_rcp_f32 v84,v61
v_rcp_f32 v86,v63
s_lshl_b32 s50,s43,3
s_lshl_b32 s51,s41,1
s_add_u32 s50,s50,s51
s_lshl_b32 s48,s50,11
s_lshl_b32 s51,s45,18
s_add_u32 s48,s48,s51
s_mul_i32 s49,s50,294912
s_lshl_b32 s51,s47,5
s_add_u32 s49,s49,s51
s_add_u32 s49,s49,12582912
v_mul_f32 v64,0xbfb8aa3b,v80
v_mul_f32 v66,0xbfb8aa3b,v82
v_mul_f32 v68,0xbfb8aa3b,v84
v_mul_f32 v70,0xbfb8aa3b,v86
s_waitcnt lgkmcnt(0)
s_add_u32 s50,s48,4325376
v_pk_fma_f32 v[96:97],v[16:17],v[56:57],v[96:97] op_sel:[0,0,0] op_sel_hi:[1,0,1]
v_pk_fma_f32 v[98:99],v[18:19],v[56:57],v[98:99] op_sel:[0,0,0] op_sel_hi:[1,0,1]
v_pk_fma_f32 v[112:113],v[20:21],v[56:57],v[112:113] op_sel:[0,0,0] op_sel_hi:[1,0,1]
v_pk_fma_f32 v[114:115],v[22:23],v[56:57],v[114:115] op_sel:[0,0,0] op_sel_hi:[1,0,1]
v_pk_mul_f32 v[96:97],v[96:97],v[80:81] op_sel:[0,0] op_sel_hi:[1,0]
v_pk_mul_f32 v[98:99],v[98:99],v[80:81] op_sel:[0,0] op_sel_hi:[1,0]
v_pk_mul_f32 v[112:113],v[112:113],v[80:81] op_sel:[0,0] op_sel_hi:[1,0]
v_pk_mul_f32 v[114:115],v[114:115],v[80:81] op_sel:[0,0] op_sel_hi:[1,0]
v_cvt_pk_bf16_f32 v96,v96,v97
v_cvt_pk_bf16_f32 v97,v98,v99
v_cvt_pk_bf16_f32 v98,v112,v113
v_cvt_pk_bf16_f32 v99,v114,v115
buffer_store_dwordx4 v[96:99],v3,s[36:39],s50 offen offset:0 sc1
v_pk_fma_f32 v[100:101],v[16:17],v[58:59],v[100:101] op_sel:[0,0,0] op_sel_hi:[1,0,1]
v_pk_fma_f32 v[102:103],v[18:19],v[58:59],v[102:103] op_sel:[0,0,0] op_sel_hi:[1,0,1]
v_pk_fma_f32 v[116:117],v[20:21],v[58:59],v[116:117] op_sel:[0,0,0] op_sel_hi:[1,0,1]
v_pk_fma_f32 v[118:119],v[22:23],v[58:59],v[118:119] op_sel:[0,0,0] op_sel_hi:[1,0,1]
v_pk_mul_f32 v[100:101],v[100:101],v[82:83] op_sel:[0,0] op_sel_hi:[1,0]
v_pk_mul_f32 v[102:103],v[102:103],v[82:83] op_sel:[0,0] op_sel_hi:[1,0]
v_pk_mul_f32 v[116:117],v[116:117],v[82:83] op_sel:[0,0] op_sel_hi:[1,0]
v_pk_mul_f32 v[118:119],v[118:119],v[82:83] op_sel:[0,0] op_sel_hi:[1,0]
v_cvt_pk_bf16_f32 v100,v100,v101
v_cvt_pk_bf16_f32 v101,v102,v103
v_cvt_pk_bf16_f32 v102,v116,v117
v_cvt_pk_bf16_f32 v103,v118,v119
buffer_store_dwordx4 v[100:103],v3,s[36:39],s50 offen offset:64 sc1
v_pk_fma_f32 v[104:105],v[16:17],v[60:61],v[104:105] op_sel:[0,0,0] op_sel_hi:[1,0,1]
v_pk_fma_f32 v[106:107],v[18:19],v[60:61],v[106:107] op_sel:[0,0,0] op_sel_hi:[1,0,1]
v_pk_fma_f32 v[120:121],v[20:21],v[60:61],v[120:121] op_sel:[0,0,0] op_sel_hi:[1,0,1]
v_pk_fma_f32 v[122:123],v[22:23],v[60:61],v[122:123] op_sel:[0,0,0] op_sel_hi:[1,0,1]
v_pk_mul_f32 v[104:105],v[104:105],v[84:85] op_sel:[0,0] op_sel_hi:[1,0]
v_pk_mul_f32 v[106:107],v[106:107],v[84:85] op_sel:[0,0] op_sel_hi:[1,0]
v_pk_mul_f32 v[120:121],v[120:121],v[84:85] op_sel:[0,0] op_sel_hi:[1,0]
v_pk_mul_f32 v[122:123],v[122:123],v[84:85] op_sel:[0,0] op_sel_hi:[1,0]
v_cvt_pk_bf16_f32 v104,v104,v105
v_cvt_pk_bf16_f32 v105,v106,v107
v_cvt_pk_bf16_f32 v106,v120,v121
v_cvt_pk_bf16_f32 v107,v122,v123
buffer_store_dwordx4 v[104:107],v3,s[36:39],s50 offen offset:2048 sc1
v_pk_fma_f32 v[108:109],v[16:17],v[62:63],v[108:109] op_sel:[0,0,0] op_sel_hi:[1,0,1]
v_pk_fma_f32 v[110:111],v[18:19],v[62:63],v[110:111] op_sel:[0,0,0] op_sel_hi:[1,0,1]
v_pk_fma_f32 v[124:125],v[20:21],v[62:63],v[124:125] op_sel:[0,0,0] op_sel_hi:[1,0,1]
v_pk_fma_f32 v[126:127],v[22:23],v[62:63],v[126:127] op_sel:[0,0,0] op_sel_hi:[1,0,1]
v_pk_mul_f32 v[108:109],v[108:109],v[86:87] op_sel:[0,0] op_sel_hi:[1,0]
v_pk_mul_f32 v[110:111],v[110:111],v[86:87] op_sel:[0,0] op_sel_hi:[1,0]
v_pk_mul_f32 v[124:125],v[124:125],v[86:87] op_sel:[0,0] op_sel_hi:[1,0]
v_pk_mul_f32 v[126:127],v[126:127],v[86:87] op_sel:[0,0] op_sel_hi:[1,0]
v_cvt_pk_bf16_f32 v108,v108,v109
v_cvt_pk_bf16_f32 v109,v110,v111
v_cvt_pk_bf16_f32 v110,v124,v125
v_cvt_pk_bf16_f32 v111,v126,v127
buffer_store_dwordx4 v[108:111],v3,s[36:39],s50 offen offset:2112 sc1
s_setprio 1
v_mov_b32 v72,v57
v_mov_b32 v74,v59
v_mov_b32 v76,v61
v_mov_b32 v78,v63
v_mov_b32 v2,161792
v_mov_b32 v3,1
s_waitcnt vmcnt(0)
s_mov_b64 exec,1
ds_add_rtn_u32 v3,v2,v3 offset:48
s_mov_b64 exec,-1
s_lshl_b32 s51,s43,1
s_and_b32 s52,s44,1
s_add_u32 s51,s51,s52
s_lshl_b32 s51,s51,2
s_lshl_b32 s52,s45,13
s_add_u32 s51,s51,s52
s_add_u32 s51,s51,42074112
s_waitcnt lgkmcnt(0)
v_readfirstlane_b32 s52,v3
v_lshlrev_b32 v3,9,v0
s_cmp_lg_u32 s52,7
s_cbranch_scc1 g2_nq3
s_mov_b64 exec,0xffff
buffer_store_dword v2,v3,s[36:39],s51 offen sc1
s_mov_b64 exec,-1
g2_nq3:
v_pk_fma_f32 v[128:129],v[24:25],v[56:57],v[128:129] op_sel:[0,0,0] op_sel_hi:[1,0,1]
v_pk_fma_f32 v[130:131],v[26:27],v[56:57],v[130:131] op_sel:[0,0,0] op_sel_hi:[1,0,1]
v_pk_fma_f32 v[144:145],v[28:29],v[56:57],v[144:145] op_sel:[0,0,0] op_sel_hi:[1,0,1]
v_pk_fma_f32 v[146:147],v[30:31],v[56:57],v[146:147] op_sel:[0,0,0] op_sel_hi:[1,0,1]
v_pk_mul_f32 v[128:129],v[128:129],v[64:65] op_sel:[0,0] op_sel_hi:[1,0]
v_pk_mul_f32 v[130:131],v[130:131],v[64:65] op_sel:[0,0] op_sel_hi:[1,0]
v_pk_mul_f32 v[144:145],v[144:145],v[64:65] op_sel:[0,0] op_sel_hi:[1,0]
v_pk_mul_f32 v[146:147],v[146:147],v[64:65] op_sel:[0,0] op_sel_hi:[1,0]
v_exp_f32 v128,v128
v_exp_f32 v129,v129
v_exp_f32 v130,v130
v_exp_f32 v131,v131
v_exp_f32 v144,v144
v_exp_f32 v145,v145
v_exp_f32 v146,v146
v_exp_f32 v147,v147
v_pk_fma_f32 v[160:161],v[32:33],v[56:57],v[160:161] op_sel:[0,0,0] op_sel_hi:[1,0,1]
v_pk_fma_f32 v[162:163],v[34:35],v[56:57],v[162:163] op_sel:[0,0,0] op_sel_hi:[1,0,1]
v_pk_fma_f32 v[176:177],v[36:37],v[56:57],v[176:177] op_sel:[0,0,0] op_sel_hi:[1,0,1]
v_pk_fma_f32 v[178:179],v[38:39],v[56:57],v[178:179] op_sel:[0,0,0] op_sel_hi:[1,0,1]
v_pk_fma_f32 v[128:129],v[128:129],v[72:73],v[72:73] op_sel:[0,0,0] op_sel_hi:[1,0,0]
v_pk_fma_f32 v[130:131],v[130:131],v[72:73],v[72:73] op_sel:[0,0,0] op_sel_hi:[1,0,0]
v_pk_fma_f32 v[144:145],v[144:145],v[72:73],v[72:73] op_sel:[0,0,0] op_sel_hi:[1,0,0]
v_pk_fma_f32 v[146:147],v[146:147],v[72:73],v[72:73] op_sel:[0,0,0] op_sel_hi:[1,0,0]
v_rcp_f32 v128,v128
v_rcp_f32 v129,v129
v_rcp_f32 v130,v130
v_rcp_f32 v131,v131
v_rcp_f32 v144,v144
v_rcp_f32 v145,v145
v_rcp_f32 v146,v146
v_rcp_f32 v147,v147
s_nop 0
v_pk_mul_f32 v[128:129],v[128:129],v[160:161] op_sel:[0,0] op_sel_hi:[1,1]
v_pk_mul_f32 v[130:131],v[130:131],v[162:163] op_sel:[0,0] op_sel_hi:[1,1]
v_pk_mul_f32 v[144:145],v[144:145],v[176:177] op_sel:[0,0] op_sel_hi:[1,1]
v_pk_mul_f32 v[146:147],v[146:147],v[178:179] op_sel:[0,0] op_sel_hi:[1,1]
v_cvt_pk_bf16_f32 v128,v128,v129
v_cvt_pk_bf16_f32 v129,v130,v131
v_cvt_pk_bf16_f32 v130,v144,v145
v_cvt_pk_bf16_f32 v131,v146,v147
v_pk_fma_f32 v[132:133],v[24:25],v[58:59],v[132:133] op_sel:[0,0,0] op_sel_hi:[1,0,1]
v_pk_fma_f32 v[134:135],v[26:27],v[58:59],v[134:135] op_sel:[0,0,0] op_sel_hi:[1,0,1]
v_pk_fma_f32 v[148:149],v[28:29],v[58:59],v[148:149] op_sel:[0,0,0] op_sel_hi:[1,0,1]
v_pk_fma_f32 v[150:151],v[30:31],v[58:59],v[150:151] op_sel:[0,0,0] op_sel_hi:[1,0,1]
v_pk_mul_f32 v[132:133],v[132:133],v[66:67] op_sel:[0,0] op_sel_hi:[1,0]
v_pk_mul_f32 v[134:135],v[134:135],v[66:67] op_sel:[0,0] op_sel_hi:[1,0]
v_pk_mul_f32 v[148:149],v[148:149],v[66:67] op_sel:[0,0] op_sel_hi:[1,0]
v_pk_mul_f32 v[150:151],v[150:151],v[66:67] op_sel:[0,0] op_sel_hi:[1,0]
v_exp_f32 v132,v132
v_exp_f32 v133,v133
v_exp_f32 v134,v134
v_exp_f32 v135,v135
v_exp_f32 v148,v148
v_exp_f32 v149,v149
v_exp_f32 v150,v150
v_exp_f32 v151,v151
v_pk_fma_f32 v[164:165],v[32:33],v[58:59],v[164:165] op_sel:[0,0,0] op_sel_hi:[1,0,1]
v_pk_fma_f32 v[166:167],v[34:35],v[58:59],v[166:167] op_sel:[0,0,0] op_sel_hi:[1,0,1]
v_pk_fma_f32 v[180:181],v[36:37],v[58:59],v[180:181] op_sel:[0,0,0] op_sel_hi:[1,0,1]
v_pk_fma_f32 v[182:183],v[38:39],v[58:59],v[182:183] op_sel:[0,0,0] op_sel_hi:[1,0,1]
v_pk_fma_f32 v[132:133],v[132:133],v[74:75],v[74:75] op_sel:[0,0,0] op_sel_hi:[1,0,0]
v_pk_fma_f32 v[134:135],v[134:135],v[74:75],v[74:75] op_sel:[0,0,0] op_sel_hi:[1,0,0]
v_pk_fma_f32 v[148:149],v[148:149],v[74:75],v[74:75] op_sel:[0,0,0] op_sel_hi:[1,0,0]
v_pk_fma_f32 v[150:151],v[150:151],v[74:75],v[74:75] op_sel:[0,0,0] op_sel_hi:[1,0,0]
v_rcp_f32 v132,v132
v_rcp_f32 v133,v133
v_rcp_f32 v134,v134
v_rcp_f32 v135,v135
v_rcp_f32 v148,v148
v_rcp_f32 v149,v149
v_rcp_f32 v150,v150
v_rcp_f32 v151,v151
s_nop 0
v_pk_mul_f32 v[132:133],v[132:133],v[164:165] op_sel:[0,0] op_sel_hi:[1,1]
v_pk_mul_f32 v[134:135],v[134:135],v[166:167] op_sel:[0,0] op_sel_hi:[1,1]
v_pk_mul_f32 v[148:149],v[148:149],v[180:181] op_sel:[0,0] op_sel_hi:[1,1]
v_pk_mul_f32 v[150:151],v[150:151],v[182:183] op_sel:[0,0] op_sel_hi:[1,1]
v_cvt_pk_bf16_f32 v132,v132,v133
v_cvt_pk_bf16_f32 v133,v134,v135
v_cvt_pk_bf16_f32 v134,v148,v149
v_cvt_pk_bf16_f32 v135,v150,v151
v_pk_fma_f32 v[136:137],v[24:25],v[60:61],v[136:137] op_sel:[0,0,0] op_sel_hi:[1,0,1]
v_pk_fma_f32 v[138:139],v[26:27],v[60:61],v[138:139] op_sel:[0,0,0] op_sel_hi:[1,0,1]
v_pk_fma_f32 v[152:153],v[28:29],v[60:61],v[152:153] op_sel:[0,0,0] op_sel_hi:[1,0,1]
v_pk_fma_f32 v[154:155],v[30:31],v[60:61],v[154:155] op_sel:[0,0,0] op_sel_hi:[1,0,1]
v_pk_mul_f32 v[136:137],v[136:137],v[68:69] op_sel:[0,0] op_sel_hi:[1,0]
v_pk_mul_f32 v[138:139],v[138:139],v[68:69] op_sel:[0,0] op_sel_hi:[1,0]
v_pk_mul_f32 v[152:153],v[152:153],v[68:69] op_sel:[0,0] op_sel_hi:[1,0]
v_pk_mul_f32 v[154:155],v[154:155],v[68:69] op_sel:[0,0] op_sel_hi:[1,0]
v_exp_f32 v136,v136
v_exp_f32 v137,v137
v_exp_f32 v138,v138
v_exp_f32 v139,v139
v_exp_f32 v152,v152
v_exp_f32 v153,v153
v_exp_f32 v154,v154
v_exp_f32 v155,v155
v_pk_fma_f32 v[168:169],v[32:33],v[60:61],v[168:169] op_sel:[0,0,0] op_sel_hi:[1,0,1]
v_pk_fma_f32 v[170:171],v[34:35],v[60:61],v[170:171] op_sel:[0,0,0] op_sel_hi:[1,0,1]
v_pk_fma_f32 v[184:185],v[36:37],v[60:61],v[184:185] op_sel:[0,0,0] op_sel_hi:[1,0,1]
v_pk_fma_f32 v[186:187],v[38:39],v[60:61],v[186:187] op_sel:[0,0,0] op_sel_hi:[1,0,1]
v_pk_fma_f32 v[136:137],v[136:137],v[76:77],v[76:77] op_sel:[0,0,0] op_sel_hi:[1,0,0]
v_pk_fma_f32 v[138:139],v[138:139],v[76:77],v[76:77] op_sel:[0,0,0] op_sel_hi:[1,0,0]
v_pk_fma_f32 v[152:153],v[152:153],v[76:77],v[76:77] op_sel:[0,0,0] op_sel_hi:[1,0,0]
v_pk_fma_f32 v[154:155],v[154:155],v[76:77],v[76:77] op_sel:[0,0,0] op_sel_hi:[1,0,0]
v_rcp_f32 v136,v136
v_rcp_f32 v137,v137
v_rcp_f32 v138,v138
v_rcp_f32 v139,v139
v_rcp_f32 v152,v152
v_rcp_f32 v153,v153
v_rcp_f32 v154,v154
v_rcp_f32 v155,v155
s_nop 0
v_pk_mul_f32 v[136:137],v[136:137],v[168:169] op_sel:[0,0] op_sel_hi:[1,1]
v_pk_mul_f32 v[138:139],v[138:139],v[170:171] op_sel:[0,0] op_sel_hi:[1,1]
v_pk_mul_f32 v[152:153],v[152:153],v[184:185] op_sel:[0,0] op_sel_hi:[1,1]
v_pk_mul_f32 v[154:155],v[154:155],v[186:187] op_sel:[0,0] op_sel_hi:[1,1]
v_cvt_pk_bf16_f32 v136,v136,v137
v_cvt_pk_bf16_f32 v137,v138,v139
v_cvt_pk_bf16_f32 v138,v152,v153
v_cvt_pk_bf16_f32 v139,v154,v155
v_pk_fma_f32 v[140:141],v[24:25],v[62:63],v[140:141] op_sel:[0,0,0] op_sel_hi:[1,0,1]
v_pk_fma_f32 v[142:143],v[26:27],v[62:63],v[142:143] op_sel:[0,0,0] op_sel_hi:[1,0,1]
v_pk_fma_f32 v[156:157],v[28:29],v[62:63],v[156:157] op_sel:[0,0,0] op_sel_hi:[1,0,1]
v_pk_fma_f32 v[158:159],v[30:31],v[62:63],v[158:159] op_sel:[0,0,0] op_sel_hi:[1,0,1]
v_pk_mul_f32 v[140:141],v[140:141],v[70:71] op_sel:[0,0] op_sel_hi:[1,0]
v_pk_mul_f32 v[142:143],v[142:143],v[70:71] op_sel:[0,0] op_sel_hi:[1,0]
v_pk_mul_f32 v[156:157],v[156:157],v[70:71] op_sel:[0,0] op_sel_hi:[1,0]
v_pk_mul_f32 v[158:159],v[158:159],v[70:71] op_sel:[0,0] op_sel_hi:[1,0]
v_exp_f32 v140,v140
v_exp_f32 v141,v141
v_exp_f32 v142,v142
v_exp_f32 v143,v143
v_exp_f32 v156,v156
v_exp_f32 v157,v157
v_exp_f32 v158,v158
v_exp_f32 v159,v159
v_pk_fma_f32 v[172:173],v[32:33],v[62:63],v[172:173] op_sel:[0,0,0] op_sel_hi:[1,0,1]
v_pk_fma_f32 v[174:175],v[34:35],v[62:63],v[174:175] op_sel:[0,0,0] op_sel_hi:[1,0,1]
v_pk_fma_f32 v[188:189],v[36:37],v[62:63],v[188:189] op_sel:[0,0,0] op_sel_hi:[1,0,1]
v_pk_fma_f32 v[190:191],v[38:39],v[62:63],v[190:191] op_sel:[0,0,0] op_sel_hi:[1,0,1]
v_pk_fma_f32 v[140:141],v[140:141],v[78:79],v[78:79] op_sel:[0,0,0] op_sel_hi:[1,0,0]
v_pk_fma_f32 v[142:143],v[142:143],v[78:79],v[78:79] op_sel:[0,0,0] op_sel_hi:[1,0,0]
v_pk_fma_f32 v[156:157],v[156:157],v[78:79],v[78:79] op_sel:[0,0,0] op_sel_hi:[1,0,0]
v_pk_fma_f32 v[158:159],v[158:159],v[78:79],v[78:79] op_sel:[0,0,0] op_sel_hi:[1,0,0]
v_rcp_f32 v140,v140
v_rcp_f32 v141,v141
v_rcp_f32 v142,v142
v_rcp_f32 v143,v143
v_rcp_f32 v156,v156
v_rcp_f32 v157,v157
v_rcp_f32 v158,v158
v_rcp_f32 v159,v159
s_nop 0
v_pk_mul_f32 v[140:141],v[140:141],v[172:173] op_sel:[0,0] op_sel_hi:[1,1]
v_pk_mul_f32 v[142:143],v[142:143],v[174:175] op_sel:[0,0] op_sel_hi:[1,1]
v_pk_mul_f32 v[156:157],v[156:157],v[188:189] op_sel:[0,0] op_sel_hi:[1,1]
v_pk_mul_f32 v[158:159],v[158:159],v[190:191] op_sel:[0,0] op_sel_hi:[1,1]
v_cvt_pk_bf16_f32 v140,v140,v141
v_cvt_pk_bf16_f32 v141,v142,v143
v_cvt_pk_bf16_f32 v142,v156,v157
v_cvt_pk_bf16_f32 v143,v158,v159
v_pk_fma_f32 v[192:193],v[40:41],v[56:57],v[192:193] op_sel:[0,0,0] op_sel_hi:[1,0,1]
v_pk_fma_f32 v[194:195],v[42:43],v[56:57],v[194:195] op_sel:[0,0,0] op_sel_hi:[1,0,1]
v_pk_fma_f32 v[208:209],v[44:45],v[56:57],v[208:209] op_sel:[0,0,0] op_sel_hi:[1,0,1]
v_pk_fma_f32 v[210:211],v[46:47],v[56:57],v[210:211] op_sel:[0,0,0] op_sel_hi:[1,0,1]
v_pk_mul_f32 v[192:193],v[192:193],v[64:65] op_sel:[0,0] op_sel_hi:[1,0]
v_pk_mul_f32 v[194:195],v[194:195],v[64:65] op_sel:[0,0] op_sel_hi:[1,0]
v_pk_mul_f32 v[208:209],v[208:209],v[64:65] op_sel:[0,0] op_sel_hi:[1,0]
v_pk_mul_f32 v[210:211],v[210:211],v[64:65] op_sel:[0,0] op_sel_hi:[1,0]
v_exp_f32 v192,v192
v_exp_f32 v193,v193
v_exp_f32 v194,v194
v_exp_f32 v195,v195
v_exp_f32 v208,v208
v_exp_f32 v209,v209
v_exp_f32 v210,v210
v_exp_f32 v211,v211
v_pk_fma_f32 v[224:225],v[48:49],v[56:57],v[224:225] op_sel:[0,0,0] op_sel_hi:[1,0,1]
v_pk_fma_f32 v[226:227],v[50:51],v[56:57],v[226:227] op_sel:[0,0,0] op_sel_hi:[1,0,1]
v_pk_fma_f32 v[240:241],v[52:53],v[56:57],v[240:241] op_sel:[0,0,0] op_sel_hi:[1,0,1]
v_pk_fma_f32 v[242:243],v[54:55],v[56:57],v[242:243] op_sel:[0,0,0] op_sel_hi:[1,0,1]
v_pk_fma_f32 v[192:193],v[192:193],v[72:73],v[72:73] op_sel:[0,0,0] op_sel_hi:[1,0,0]
v_pk_fma_f32 v[194:195],v[194:195],v[72:73],v[72:73] op_sel:[0,0,0] op_sel_hi:[1,0,0]
v_pk_fma_f32 v[208:209],v[208:209],v[72:73],v[72:73] op_sel:[0,0,0] op_sel_hi:[1,0,0]
v_pk_fma_f32 v[210:211],v[210:211],v[72:73],v[72:73] op_sel:[0,0,0] op_sel_hi:[1,0,0]
v_rcp_f32 v192,v192
v_rcp_f32 v193,v193
v_rcp_f32 v194,v194
v_rcp_f32 v195,v195
v_rcp_f32 v208,v208
v_rcp_f32 v209,v209
v_rcp_f32 v210,v210
v_rcp_f32 v211,v211
s_nop 0
v_pk_mul_f32 v[192:193],v[192:193],v[224:225] op_sel:[0,0] op_sel_hi:[1,1]
v_pk_mul_f32 v[194:195],v[194:195],v[226:227] op_sel:[0,0] op_sel_hi:[1,1]
v_pk_mul_f32 v[208:209],v[208:209],v[240:241] op_sel:[0,0] op_sel_hi:[1,1]
v_pk_mul_f32 v[210:211],v[210:211],v[242:243] op_sel:[0,0] op_sel_hi:[1,1]
v_cvt_pk_bf16_f32 v144,v192,v193
v_cvt_pk_bf16_f32 v145,v194,v195
v_cvt_pk_bf16_f32 v146,v208,v209
v_cvt_pk_bf16_f32 v147,v210,v211
v_pk_fma_f32 v[196:197],v[40:41],v[58:59],v[196:197] op_sel:[0,0,0] op_sel_hi:[1,0,1]
v_pk_fma_f32 v[198:199],v[42:43],v[58:59],v[198:199] op_sel:[0,0,0] op_sel_hi:[1,0,1]
v_pk_fma_f32 v[212:213],v[44:45],v[58:59],v[212:213] op_sel:[0,0,0] op_sel_hi:[1,0,1]
v_pk_fma_f32 v[214:215],v[46:47],v[58:59],v[214:215] op_sel:[0,0,0] op_sel_hi:[1,0,1]
v_pk_mul_f32 v[196:197],v[196:197],v[66:67] op_sel:[0,0] op_sel_hi:[1,0]
v_pk_mul_f32 v[198:199],v[198:199],v[66:67] op_sel:[0,0] op_sel_hi:[1,0]
v_pk_mul_f32 v[212:213],v[212:213],v[66:67] op_sel:[0,0] op_sel_hi:[1,0]
v_pk_mul_f32 v[214:215],v[214:215],v[66:67] op_sel:[0,0] op_sel_hi:[1,0]
v_exp_f32 v196,v196
v_exp_f32 v197,v197
v_exp_f32 v198,v198
v_exp_f32 v199,v199
v_exp_f32 v212,v212
v_exp_f32 v213,v213
v_exp_f32 v214,v214
v_exp_f32 v215,v215
v_pk_fma_f32 v[228:229],v[48:49],v[58:59],v[228:229] op_sel:[0,0,0] op_sel_hi:[1,0,1]
v_pk_fma_f32 v[230:231],v[50:51],v[58:59],v[230:231] op_sel:[0,0,0] op_sel_hi:[1,0,1]
v_pk_fma_f32 v[244:245],v[52:53],v[58:59],v[244:245] op_sel:[0,0,0] op_sel_hi:[1,0,1]
v_pk_fma_f32 v[246:247],v[54:55],v[58:59],v[246:247] op_sel:[0,0,0] op_sel_hi:[1,0,1]
v_pk_fma_f32 v[196:197],v[196:197],v[74:75],v[74:75] op_sel:[0,0,0] op_sel_hi:[1,0,0]
v_pk_fma_f32 v[198:199],v[198:199],v[74:75],v[74:75] op_sel:[0,0,0] op_sel_hi:[1,0,0]
v_pk_fma_f32 v[212:213],v[212:213],v[74:75],v[74:75] op_sel:[0,0,0] op_sel_hi:[1,0,0]
v_pk_fma_f32 v[214:215],v[214:215],v[74:75],v[74:75] op_sel:[0,0,0] op_sel_hi:[1,0,0]
v_rcp_f32 v196,v196
v_rcp_f32 v197,v197
v_rcp_f32 v198,v198
v_rcp_f32 v199,v199
v_rcp_f32 v212,v212
v_rcp_f32 v213,v213
v_rcp_f32 v214,v214
v_rcp_f32 v215,v215
s_nop 0
v_pk_mul_f32 v[196:197],v[196:197],v[228:229] op_sel:[0,0] op_sel_hi:[1,1]
v_pk_mul_f32 v[198:199],v[198:199],v[230:231] op_sel:[0,0] op_sel_hi:[1,1]
v_pk_mul_f32 v[212:213],v[212:213],v[244:245] op_sel:[0,0] op_sel_hi:[1,1]
v_pk_mul_f32 v[214:215],v[214:215],v[246:247] op_sel:[0,0] op_sel_hi:[1,1]
v_cvt_pk_bf16_f32 v148,v196,v197
v_cvt_pk_bf16_f32 v149,v198,v199
v_cvt_pk_bf16_f32 v150,v212,v213
v_cvt_pk_bf16_f32 v151,v214,v215
v_pk_fma_f32 v[200:201],v[40:41],v[60:61],v[200:201] op_sel:[0,0,0] op_sel_hi:[1,0,1]
v_pk_fma_f32 v[202:203],v[42:43],v[60:61],v[202:203] op_sel:[0,0,0] op_sel_hi:[1,0,1]
v_pk_fma_f32 v[216:217],v[44:45],v[60:61],v[216:217] op_sel:[0,0,0] op_sel_hi:[1,0,1]
v_pk_fma_f32 v[218:219],v[46:47],v[60:61],v[218:219] op_sel:[0,0,0] op_sel_hi:[1,0,1]
v_pk_mul_f32 v[200:201],v[200:201],v[68:69] op_sel:[0,0] op_sel_hi:[1,0]
v_pk_mul_f32 v[202:203],v[202:203],v[68:69] op_sel:[0,0] op_sel_hi:[1,0]
v_pk_mul_f32 v[216:217],v[216:217],v[68:69] op_sel:[0,0] op_sel_hi:[1,0]
v_pk_mul_f32 v[218:219],v[218:219],v[68:69] op_sel:[0,0] op_sel_hi:[1,0]
v_exp_f32 v200,v200
v_exp_f32 v201,v201
v_exp_f32 v202,v202
v_exp_f32 v203,v203
v_exp_f32 v216,v216
v_exp_f32 v217,v217
v_exp_f32 v218,v218
v_exp_f32 v219,v219
v_pk_fma_f32 v[232:233],v[48:49],v[60:61],v[232:233] op_sel:[0,0,0] op_sel_hi:[1,0,1]
v_pk_fma_f32 v[234:235],v[50:51],v[60:61],v[234:235] op_sel:[0,0,0] op_sel_hi:[1,0,1]
v_pk_fma_f32 v[248:249],v[52:53],v[60:61],v[248:249] op_sel:[0,0,0] op_sel_hi:[1,0,1]
v_pk_fma_f32 v[250:251],v[54:55],v[60:61],v[250:251] op_sel:[0,0,0] op_sel_hi:[1,0,1]
v_pk_fma_f32 v[200:201],v[200:201],v[76:77],v[76:77] op_sel:[0,0,0] op_sel_hi:[1,0,0]
v_pk_fma_f32 v[202:203],v[202:203],v[76:77],v[76:77] op_sel:[0,0,0] op_sel_hi:[1,0,0]
v_pk_fma_f32 v[216:217],v[216:217],v[76:77],v[76:77] op_sel:[0,0,0] op_sel_hi:[1,0,0]
v_pk_fma_f32 v[218:219],v[218:219],v[76:77],v[76:77] op_sel:[0,0,0] op_sel_hi:[1,0,0]
v_rcp_f32 v200,v200
v_rcp_f32 v201,v201
v_rcp_f32 v202,v202
v_rcp_f32 v203,v203
v_rcp_f32 v216,v216
v_rcp_f32 v217,v217
v_rcp_f32 v218,v218
v_rcp_f32 v219,v219
s_nop 0
v_pk_mul_f32 v[200:201],v[200:201],v[232:233] op_sel:[0,0] op_sel_hi:[1,1]
v_pk_mul_f32 v[202:203],v[202:203],v[234:235] op_sel:[0,0] op_sel_hi:[1,1]
v_pk_mul_f32 v[216:217],v[216:217],v[248:249] op_sel:[0,0] op_sel_hi:[1,1]
v_pk_mul_f32 v[218:219],v[218:219],v[250:251] op_sel:[0,0] op_sel_hi:[1,1]
v_cvt_pk_bf16_f32 v152,v200,v201
v_cvt_pk_bf16_f32 v153,v202,v203
v_cvt_pk_bf16_f32 v154,v216,v217
v_cvt_pk_bf16_f32 v155,v218,v219
v_pk_fma_f32 v[204:205],v[40:41],v[62:63],v[204:205] op_sel:[0,0,0] op_sel_hi:[1,0,1]
v_pk_fma_f32 v[206:207],v[42:43],v[62:63],v[206:207] op_sel:[0,0,0] op_sel_hi:[1,0,1]
v_pk_fma_f32 v[220:221],v[44:45],v[62:63],v[220:221] op_sel:[0,0,0] op_sel_hi:[1,0,1]
v_pk_fma_f32 v[222:223],v[46:47],v[62:63],v[222:223] op_sel:[0,0,0] op_sel_hi:[1,0,1]
v_pk_mul_f32 v[204:205],v[204:205],v[70:71] op_sel:[0,0] op_sel_hi:[1,0]
v_pk_mul_f32 v[206:207],v[206:207],v[70:71] op_sel:[0,0] op_sel_hi:[1,0]
v_pk_mul_f32 v[220:221],v[220:221],v[70:71] op_sel:[0,0] op_sel_hi:[1,0]
v_pk_mul_f32 v[222:223],v[222:223],v[70:71] op_sel:[0,0] op_sel_hi:[1,0]
v_exp_f32 v204,v204
v_exp_f32 v205,v205
v_exp_f32 v206,v206
v_exp_f32 v207,v207
v_exp_f32 v220,v220
v_exp_f32 v221,v221
v_exp_f32 v222,v222
v_exp_f32 v223,v223
v_pk_fma_f32 v[236:237],v[48:49],v[62:63],v[236:237] op_sel:[0,0,0] op_sel_hi:[1,0,1]
v_pk_fma_f32 v[238:239],v[50:51],v[62:63],v[238:239] op_sel:[0,0,0] op_sel_hi:[1,0,1]
v_pk_fma_f32 v[252:253],v[52:53],v[62:63],v[252:253] op_sel:[0,0,0] op_sel_hi:[1,0,1]
v_pk_fma_f32 v[254:255],v[54:55],v[62:63],v[254:255] op_sel:[0,0,0] op_sel_hi:[1,0,1]
v_pk_fma_f32 v[204:205],v[204:205],v[78:79],v[78:79] op_sel:[0,0,0] op_sel_hi:[1,0,0]
v_pk_fma_f32 v[206:207],v[206:207],v[78:79],v[78:79] op_sel:[0,0,0] op_sel_hi:[1,0,0]
v_pk_fma_f32 v[220:221],v[220:221],v[78:79],v[78:79] op_sel:[0,0,0] op_sel_hi:[1,0,0]
v_pk_fma_f32 v[222:223],v[222:223],v[78:79],v[78:79] op_sel:[0,0,0] op_sel_hi:[1,0,0]
v_rcp_f32 v204,v204
v_rcp_f32 v205,v205
v_rcp_f32 v206,v206
v_rcp_f32 v207,v207
v_rcp_f32 v220,v220
v_rcp_f32 v221,v221
v_rcp_f32 v222,v222
v_rcp_f32 v223,v223
s_nop 0
v_pk_mul_f32 v[204:205],v[204:205],v[236:237] op_sel:[0,0] op_sel_hi:[1,1]
v_pk_mul_f32 v[206:207],v[206:207],v[238:239] op_sel:[0,0] op_sel_hi:[1,1]
v_pk_mul_f32 v[220:221],v[220:221],v[252:253] op_sel:[0,0] op_sel_hi:[1,1]
v_pk_mul_f32 v[222:223],v[222:223],v[254:255] op_sel:[0,0] op_sel_hi:[1,1]
v_cvt_pk_bf16_f32 v156,v204,v205
v_cvt_pk_bf16_f32 v157,v206,v207
v_cvt_pk_bf16_f32 v158,v220,v221
v_cvt_pk_bf16_f32 v159,v222,v223
s_add_u32 s61,s49,1024
s_mov_b32 s62,1
s_cmp_eq_u32 s100,-1
s_cbranch_scc1 af_entry
s_add_u32 s50,s61,0
buffer_store_dwordx4 v[128:131],v1,s[36:39],s50 offen sc1
s_add_u32 s50,s61,147456
buffer_store_dwordx4 v[132:135],v1,s[36:39],s50 offen sc1
s_add_u32 s50,s61,294912
buffer_store_dwordx4 v[136:139],v1,s[36:39],s50 offen sc1
s_add_u32 s50,s61,442368
buffer_store_dwordx4 v[140:143],v1,s[36:39],s50 offen sc1
s_add_u32 s50,s61,1024
buffer_store_dwordx4 v[144:147],v1,s[36:39],s50 offen sc1
s_add_u32 s50,s61,148480
buffer_store_dwordx4 v[148:151],v1,s[36:39],s50 offen sc1
s_add_u32 s50,s61,295936
buffer_store_dwordx4 v[152:155],v1,s[36:39],s50 offen sc1
s_add_u32 s50,s61,443392
buffer_store_dwordx4 v[156:159],v1,s[36:39],s50 offen sc1
s_branch m_hnext
.p2align 6
g2_sp3:
s_waitcnt lgkmcnt(15)
v_mfma_f32_16x16x32_bf16 v[96:99],v[16:19],v[56:59],v[96:99]
v_mfma_f32_16x16x32_bf16 v[100:103],v[16:19],v[60:63],v[100:103]
v_mfma_f32_16x16x32_bf16 v[104:107],v[16:19],v[64:67],v[104:107]
v_mfma_f32_16x16x32_bf16 v[108:111],v[16:19],v[68:71],v[108:111]
s_waitcnt vmcnt(9) lgkmcnt(0)
s_barrier
s_bitcmp1_b32 s68,2
s_cbranch_scc0 g2_c3_1
v_lshlrev_b32 v12,16,v16
v_and_b32 v13,s69,v16
v_add_f32 v14,v12,v13
v_lshlrev_b32 v12,16,v17
v_and_b32 v13,s69,v17
v_add_f32 v14,v14,v12
v_add_f32 v14,v14,v13
v_lshlrev_b32 v12,16,v18
v_and_b32 v13,s69,v18
v_add_f32 v14,v14,v12
v_add_f32 v14,v14,v13
v_lshlrev_b32 v12,16,v19
v_and_b32 v13,s69,v19
v_add_f32 v14,v14,v12
v_add_f32 v14,v14,v13
g2_c3_1:
ds_read_b64_tr_b16 v[16:17],v1 offset:20480
v_mfma_f32_16x16x32_bf16 v[112:115],v[20:23],v[56:59],v[112:115]
ds_read_b64_tr_b16 v[18:19],v1 offset:21504
v_mfma_f32_16x16x32_bf16 v[116:119],v[20:23],v[60:63],v[116:119]
ds_read_b128 v[72:75],v94 offset:0
v_mfma_f32_16x16x32_bf16 v[120:123],v[20:23],v[64:67],v[120:123]
ds_read_b128 v[76:79],v94 offset:2048
v_mfma_f32_16x16x32_bf16 v[124:127],v[20:23],v[68:71],v[124:127]
s_bitcmp1_b32 s68,3
s_cbranch_scc0 g2_c3_2
v_lshlrev_b32 v12,16,v20
v_and_b32 v13,s69,v20
v_add_f32 v14,v12,v13
v_lshlrev_b32 v12,16,v21
v_and_b32 v13,s69,v21
v_add_f32 v14,v14,v12
v_add_f32 v14,v14,v13
v_lshlrev_b32 v12,16,v22
v_and_b32 v13,s69,v22
v_add_f32 v14,v14,v12
v_add_f32 v14,v14,v13
v_lshlrev_b32 v12,16,v23
v_and_b32 v13,s69,v23
v_add_f32 v14,v14,v12
v_add_f32 v14,v14,v13
g2_c3_2:
ds_read_b64_tr_b16 v[20:21],v2 offset:20480
v_mfma_f32_16x16x32_bf16 v[128:131],v[24:27],v[56:59],v[128:131]
ds_read_b64_tr_b16 v[22:23],v2 offset:21504
v_mfma_f32_16x16x32_bf16 v[132:135],v[24:27],v[60:63],v[132:135]
ds_read_b128 v[80:83],v94 offset:4096
v_mfma_f32_16x16x32_bf16 v[136:139],v[24:27],v[64:67],v[136:139]
ds_read_b128 v[84:87],v94 offset:6144
v_mfma_f32_16x16x32_bf16 v[140:143],v[24:27],v[68:71],v[140:143]
s_bitcmp1_b32 s68,4
s_cbranch_scc0 g2_c3_3
v_lshlrev_b32 v12,16,v24
v_and_b32 v13,s69,v24
v_add_f32 v14,v12,v13
v_lshlrev_b32 v12,16,v25
v_and_b32 v13,s69,v25
v_add_f32 v14,v14,v12
v_add_f32 v14,v14,v13
v_lshlrev_b32 v12,16,v26
v_and_b32 v13,s69,v26
v_add_f32 v14,v14,v12
v_add_f32 v14,v14,v13
v_lshlrev_b32 v12,16,v27
v_and_b32 v13,s69,v27
v_add_f32 v14,v14,v12
v_add_f32 v14,v14,v13
g2_c3_3:
ds_read_b64_tr_b16 v[24:25],v3 offset:20480
v_mfma_f32_16x16x32_bf16 v[144:147],v[28:31],v[56:59],v[144:147]
ds_read_b64_tr_b16 v[26:27],v3 offset:21248
v_mfma_f32_16x16x32_bf16 v[148:151],v[28:31],v[60:63],v[148:151]
buffer_load_dword v91,v90,s[28:31],s48 offen
s_add_u32 s48,s48,s49
v_mfma_f32_16x16x32_bf16 v[152:155],v[28:31],v[64:67],v[152:155]
v_mfma_f32_16x16x32_bf16 v[156:159],v[28:31],v[68:71],v[156:159]
s_bitcmp1_b32 s68,5
s_cbranch_scc0 g2_c3_4
v_lshlrev_b32 v12,16,v28
v_and_b32 v13,s69,v28
v_add_f32 v14,v12,v13
v_lshlrev_b32 v12,16,v29
v_and_b32 v13,s69,v29
v_add_f32 v14,v14,v12
v_add_f32 v14,v14,v13
v_lshlrev_b32 v12,16,v30
v_and_b32 v13,s69,v30
v_add_f32 v14,v14,v12
v_add_f32 v14,v14,v13
v_lshlrev_b32 v12,16,v31
v_and_b32 v13,s69,v31
v_add_f32 v14,v14,v12
v_add_f32 v14,v14,v13
g2_c3_4:
ds_read_b64_tr_b16 v[28:29],v4 offset:20480
v_mfma_f32_16x16x32_bf16 v[160:163],v[32:35],v[56:59],v[160:163]
ds_read_b64_tr_b16 v[30:31],v4 offset:21248
v_mfma_f32_16x16x32_bf16 v[164:167],v[32:35],v[60:63],v[164:167]
v_mfma_f32_16x16x32_bf16 v[168:171],v[32:35],v[64:67],v[168:171]
v_mfma_f32_16x16x32_bf16 v[172:175],v[32:35],v[68:71],v[172:175]
s_bitcmp1_b32 s68,6
s_cbranch_scc0 g2_c3_5
v_lshlrev_b32 v12,16,v32
v_and_b32 v13,s69,v32
v_add_f32 v15,v12,v13
v_lshlrev_b32 v12,16,v33
v_and_b32 v13,s69,v33
v_add_f32 v15,v15,v12
v_add_f32 v15,v15,v13
v_lshlrev_b32 v12,16,v34
v_and_b32 v13,s69,v34
v_add_f32 v15,v15,v12
v_add_f32 v15,v15,v13
v_lshlrev_b32 v12,16,v35
v_and_b32 v13,s69,v35
v_add_f32 v15,v15,v12
v_add_f32 v15,v15,v13
g2_c3_5:
ds_read_b64_tr_b16 v[32:33],v5 offset:20480
v_mfma_f32_16x16x32_bf16 v[176:179],v[36:39],v[56:59],v[176:179]
ds_read_b64_tr_b16 v[34:35],v5 offset:21248
v_mfma_f32_16x16x32_bf16 v[180:183],v[36:39],v[60:63],v[180:183]
v_mfma_f32_16x16x32_bf16 v[184:187],v[36:39],v[64:67],v[184:187]
v_mfma_f32_16x16x32_bf16 v[188:191],v[36:39],v[68:71],v[188:191]
s_bitcmp1_b32 s68,7
s_cbranch_scc0 g2_c3_6
v_lshlrev_b32 v12,16,v36
v_and_b32 v13,s69,v36
v_add_f32 v15,v12,v13
v_lshlrev_b32 v12,16,v37
v_and_b32 v13,s69,v37
v_add_f32 v15,v15,v12
v_add_f32 v15,v15,v13
v_lshlrev_b32 v12,16,v38
v_and_b32 v13,s69,v38
v_add_f32 v15,v15,v12
v_add_f32 v15,v15,v13
v_lshlrev_b32 v12,16,v39
v_and_b32 v13,s69,v39
v_add_f32 v15,v15,v12
v_add_f32 v15,v15,v13
g2_c3_6:
ds_read_b64_tr_b16 v[36:37],v6 offset:20480
v_mfma_f32_16x16x32_bf16 v[192:195],v[40:43],v[56:59],v[192:195]
ds_read_b64_tr_b16 v[38:39],v6 offset:21248
v_mfma_f32_16x16x32_bf16 v[196:199],v[40:43],v[60:63],v[196:199]
v_mfma_f32_16x16x32_bf16 v[200:203],v[40:43],v[64:67],v[200:203]
v_mfma_f32_16x16x32_bf16 v[204:207],v[40:43],v[68:71],v[204:207]
s_bitcmp1_b32 s68,8
s_cbranch_scc0 g2_c3_7
v_lshlrev_b32 v12,16,v40
v_and_b32 v13,s69,v40
v_add_f32 v15,v12,v13
v_lshlrev_b32 v12,16,v41
v_and_b32 v13,s69,v41
v_add_f32 v15,v15,v12
v_add_f32 v15,v15,v13
v_lshlrev_b32 v12,16,v42
v_and_b32 v13,s69,v42
v_add_f32 v15,v15,v12
v_add_f32 v15,v15,v13
v_lshlrev_b32 v12,16,v43
v_and_b32 v13,s69,v43
v_add_f32 v15,v15,v12
v_add_f32 v15,v15,v13
g2_c3_7:
ds_read_b64_tr_b16 v[40:41],v7 offset:20480
v_mfma_f32_16x16x32_bf16 v[208:211],v[44:47],v[56:59],v[208:211]
ds_read_b64_tr_b16 v[42:43],v7 offset:21248
v_mfma_f32_16x16x32_bf16 v[212:215],v[44:47],v[60:63],v[212:215]
v_mfma_f32_16x16x32_bf16 v[216:219],v[44:47],v[64:67],v[216:219]
v_mfma_f32_16x16x32_bf16 v[220:223],v[44:47],v[68:71],v[220:223]
s_bitcmp1_b32 s68,9
s_cbranch_scc0 g2_c3_8
v_lshlrev_b32 v12,16,v44
v_and_b32 v13,s69,v44
v_add_f32 v15,v12,v13
v_lshlrev_b32 v12,16,v45
v_and_b32 v13,s69,v45
v_add_f32 v15,v15,v12
v_add_f32 v15,v15,v13
v_lshlrev_b32 v12,16,v46
v_and_b32 v13,s69,v46
v_add_f32 v15,v15,v12
v_add_f32 v15,v15,v13
v_lshlrev_b32 v12,16,v47
v_and_b32 v13,s69,v47
v_add_f32 v15,v15,v12
v_add_f32 v15,v15,v13
g2_c3_8:
ds_read_b64_tr_b16 v[44:45],v8 offset:20480
v_mfma_f32_16x16x32_bf16 v[224:227],v[48:51],v[56:59],v[224:227]
ds_read_b64_tr_b16 v[46:47],v8 offset:21248
v_mfma_f32_16x16x32_bf16 v[228:231],v[48:51],v[60:63],v[228:231]
v_mfma_f32_16x16x32_bf16 v[232:235],v[48:51],v[64:67],v[232:235]
v_mfma_f32_16x16x32_bf16 v[236:239],v[48:51],v[68:71],v[236:239]
s_bitcmp1_b32 s68,10
s_cbranch_scc0 g2_c3_9
v_lshlrev_b32 v12,16,v48
v_and_b32 v13,s69,v48
v_add_f32 v93,v12,v13
v_lshlrev_b32 v12,16,v49
v_and_b32 v13,s69,v49
v_add_f32 v93,v93,v12
v_add_f32 v93,v93,v13
v_lshlrev_b32 v12,16,v50
v_and_b32 v13,s69,v50
v_add_f32 v93,v93,v12
v_add_f32 v93,v93,v13
v_lshlrev_b32 v12,16,v51
v_and_b32 v13,s69,v51
v_add_f32 v93,v93,v12
v_add_f32 v93,v93,v13
g2_c3_9:
ds_read_b64_tr_b16 v[48:49],v9 offset:20480
v_mfma_f32_16x16x32_bf16 v[240:243],v[52:55],v[56:59],v[240:243]
ds_read_b64_tr_b16 v[50:51],v9 offset:21248
v_mfma_f32_16x16x32_bf16 v[244:247],v[52:55],v[60:63],v[244:247]
v_mfma_f32_16x16x32_bf16 v[248:251],v[52:55],v[64:67],v[248:251]
v_mfma_f32_16x16x32_bf16 v[252:255],v[52:55],v[68:71],v[252:255]
s_bitcmp1_b32 s68,11
s_cbranch_scc0 g2_c3_10
v_lshlrev_b32 v12,16,v52
v_and_b32 v13,s69,v52
v_add_f32 v93,v12,v13
v_lshlrev_b32 v12,16,v53
v_and_b32 v13,s69,v53
v_add_f32 v93,v93,v12
v_add_f32 v93,v93,v13
v_lshlrev_b32 v12,16,v54
v_and_b32 v13,s69,v54
v_add_f32 v93,v93,v12
v_add_f32 v93,v93,v13
v_lshlrev_b32 v12,16,v55
v_and_b32 v13,s69,v55
v_add_f32 v93,v93,v12
v_add_f32 v93,v93,v13
g2_c3_10:
ds_read_b64_tr_b16 v[52:53],v10 offset:20480
ds_read_b64_tr_b16 v[54:55],v10 offset:21248
s_waitcnt lgkmcnt(15)
v_mfma_f32_16x16x32_bf16 v[96:99],v[16:19],v[72:75],v[96:99]
v_mfma_f32_16x16x32_bf16 v[100:103],v[16:19],v[76:79],v[100:103]
v_mfma_f32_16x16x32_bf16 v[104:107],v[16:19],v[80:83],v[104:107]
v_mfma_f32_16x16x32_bf16 v[108:111],v[16:19],v[84:87],v[108:111]
s_waitcnt vmcnt(1) lgkmcnt(0)
s_barrier
s_bitcmp1_b32 s68,2
s_cbranch_scc0 g2_c3_11
v_lshlrev_b32 v12,16,v16
v_and_b32 v13,s69,v16
v_add_f32 v14,v14,v12
v_add_f32 v14,v14,v13
v_lshlrev_b32 v12,16,v17
v_and_b32 v13,s69,v17
v_add_f32 v14,v14,v12
v_add_f32 v14,v14,v13
v_lshlrev_b32 v12,16,v18
v_and_b32 v13,s69,v18
v_add_f32 v14,v14,v12
v_add_f32 v14,v14,v13
v_lshlrev_b32 v12,16,v19
v_and_b32 v13,s69,v19
v_add_f32 v14,v14,v12
v_add_f32 v14,v14,v13
g2_c3_11:
ds_read_b64_tr_b16 v[16:17],v1 offset:40960
v_mfma_f32_16x16x32_bf16 v[112:115],v[20:23],v[72:75],v[112:115]
ds_read_b64_tr_b16 v[18:19],v1 offset:41984
v_mfma_f32_16x16x32_bf16 v[116:119],v[20:23],v[76:79],v[116:119]
ds_read_b128 v[56:59],v11 offset:32768
v_mfma_f32_16x16x32_bf16 v[120:123],v[20:23],v[80:83],v[120:123]
ds_read_b128 v[60:63],v11 offset:34816
v_mfma_f32_16x16x32_bf16 v[124:127],v[20:23],v[84:87],v[124:127]
s_bitcmp1_b32 s68,3
s_cbranch_scc0 g2_c3_12
v_lshlrev_b32 v12,16,v20
v_and_b32 v13,s69,v20
v_add_f32 v14,v14,v12
v_add_f32 v14,v14,v13
v_lshlrev_b32 v12,16,v21
v_and_b32 v13,s69,v21
v_add_f32 v14,v14,v12
v_add_f32 v14,v14,v13
v_lshlrev_b32 v12,16,v22
v_and_b32 v13,s69,v22
v_add_f32 v14,v14,v12
v_add_f32 v14,v14,v13
v_lshlrev_b32 v12,16,v23
v_and_b32 v13,s69,v23
v_add_f32 v14,v14,v12
v_add_f32 v14,v14,v13
g2_c3_12:
ds_read_b64_tr_b16 v[20:21],v2 offset:40960
v_mfma_f32_16x16x32_bf16 v[128:131],v[24:27],v[72:75],v[128:131]
ds_read_b64_tr_b16 v[22:23],v2 offset:41984
v_mfma_f32_16x16x32_bf16 v[132:135],v[24:27],v[76:79],v[132:135]
ds_read_b128 v[64:67],v11 offset:36864
v_mfma_f32_16x16x32_bf16 v[136:139],v[24:27],v[80:83],v[136:139]
ds_read_b128 v[68:71],v11 offset:38912
v_mfma_f32_16x16x32_bf16 v[140:143],v[24:27],v[84:87],v[140:143]
s_bitcmp1_b32 s68,4
s_cbranch_scc0 g2_c3_13
v_lshlrev_b32 v12,16,v24
v_and_b32 v13,s69,v24
v_add_f32 v14,v14,v12
v_add_f32 v14,v14,v13
v_lshlrev_b32 v12,16,v25
v_and_b32 v13,s69,v25
v_add_f32 v14,v14,v12
v_add_f32 v14,v14,v13
v_lshlrev_b32 v12,16,v26
v_and_b32 v13,s69,v26
v_add_f32 v14,v14,v12
v_add_f32 v14,v14,v13
v_lshlrev_b32 v12,16,v27
v_and_b32 v13,s69,v27
v_add_f32 v14,v14,v12
v_add_f32 v14,v14,v13
g2_c3_13:
ds_read_b64_tr_b16 v[24:25],v3 offset:40960
v_mfma_f32_16x16x32_bf16 v[144:147],v[28:31],v[72:75],v[144:147]
ds_read_b64_tr_b16 v[26:27],v3 offset:41728
v_mfma_f32_16x16x32_bf16 v[148:151],v[28:31],v[76:79],v[148:151]
s_add_u32 m0,s54,0
s_nop 0
buffer_load_dwordx4 v88,s[56:59],s55 offen lds
v_mfma_f32_16x16x32_bf16 v[152:155],v[28:31],v[80:83],v[152:155]
v_mfma_f32_16x16x32_bf16 v[156:159],v[28:31],v[84:87],v[156:159]
s_bitcmp1_b32 s68,5
s_cbranch_scc0 g2_c3_14
v_lshlrev_b32 v12,16,v28
v_and_b32 v13,s69,v28
v_add_f32 v14,v14,v12
v_add_f32 v14,v14,v13
v_lshlrev_b32 v12,16,v29
v_and_b32 v13,s69,v29
v_add_f32 v14,v14,v12
v_add_f32 v14,v14,v13
v_lshlrev_b32 v12,16,v30
v_and_b32 v13,s69,v30
v_add_f32 v14,v14,v12
v_add_f32 v14,v14,v13
v_lshlrev_b32 v12,16,v31
v_and_b32 v13,s69,v31
v_add_f32 v14,v14,v12
v_add_f32 v14,v14,v13
g2_c3_14:
ds_read_b64_tr_b16 v[28:29],v4 offset:40960
v_mfma_f32_16x16x32_bf16 v[160:163],v[32:35],v[72:75],v[160:163]
ds_read_b64_tr_b16 v[30:31],v4 offset:41728
v_mfma_f32_16x16x32_bf16 v[164:167],v[32:35],v[76:79],v[164:167]
buffer_load_dwordx4 v89,s[56:59],s55 offen offset:1024 lds
v_mfma_f32_16x16x32_bf16 v[168:171],v[32:35],v[80:83],v[168:171]
v_mfma_f32_16x16x32_bf16 v[172:175],v[32:35],v[84:87],v[172:175]
s_bitcmp1_b32 s68,6
s_cbranch_scc0 g2_c3_15
v_lshlrev_b32 v12,16,v32
v_and_b32 v13,s69,v32
v_add_f32 v15,v15,v12
v_add_f32 v15,v15,v13
v_lshlrev_b32 v12,16,v33
v_and_b32 v13,s69,v33
v_add_f32 v15,v15,v12
v_add_f32 v15,v15,v13
v_lshlrev_b32 v12,16,v34
v_and_b32 v13,s69,v34
v_add_f32 v15,v15,v12
v_add_f32 v15,v15,v13
v_lshlrev_b32 v12,16,v35
v_and_b32 v13,s69,v35
v_add_f32 v15,v15,v12
v_add_f32 v15,v15,v13
g2_c3_15:
ds_read_b64_tr_b16 v[32:33],v5 offset:40960
v_mfma_f32_16x16x32_bf16 v[176:179],v[36:39],v[72:75],v[176:179]
ds_read_b64_tr_b16 v[34:35],v5 offset:41728
v_mfma_f32_16x16x32_bf16 v[180:183],v[36:39],v[76:79],v[180:183]
s_add_u32 m0,s54,2048
s_add_u32 s51,s55,32768
buffer_load_dwordx4 v88,s[56:59],s51 offen lds
v_mfma_f32_16x16x32_bf16 v[184:187],v[36:39],v[80:83],v[184:187]
v_mfma_f32_16x16x32_bf16 v[188:191],v[36:39],v[84:87],v[188:191]
s_bitcmp1_b32 s68,7
s_cbranch_scc0 g2_c3_16
v_lshlrev_b32 v12,16,v36
v_and_b32 v13,s69,v36
v_add_f32 v15,v15,v12
v_add_f32 v15,v15,v13
v_lshlrev_b32 v12,16,v37
v_and_b32 v13,s69,v37
v_add_f32 v15,v15,v12
v_add_f32 v15,v15,v13
v_lshlrev_b32 v12,16,v38
v_and_b32 v13,s69,v38
v_add_f32 v15,v15,v12
v_add_f32 v15,v15,v13
v_lshlrev_b32 v12,16,v39
v_and_b32 v13,s69,v39
v_add_f32 v15,v15,v12
v_add_f32 v15,v15,v13
g2_c3_16:
ds_read_b64_tr_b16 v[36:37],v6 offset:40960
v_mfma_f32_16x16x32_bf16 v[192:195],v[40:43],v[72:75],v[192:195]
ds_read_b64_tr_b16 v[38:39],v6 offset:41728
v_mfma_f32_16x16x32_bf16 v[196:199],v[40:43],v[76:79],v[196:199]
buffer_load_dwordx4 v89,s[56:59],s51 offen offset:1024 lds
v_mfma_f32_16x16x32_bf16 v[200:203],v[40:43],v[80:83],v[200:203]
v_mfma_f32_16x16x32_bf16 v[204:207],v[40:43],v[84:87],v[204:207]
s_bitcmp1_b32 s68,8
s_cbranch_scc0 g2_c3_17
v_lshlrev_b32 v12,16,v40
v_and_b32 v13,s69,v40
v_add_f32 v15,v15,v12
v_add_f32 v15,v15,v13
v_lshlrev_b32 v12,16,v41
v_and_b32 v13,s69,v41
v_add_f32 v15,v15,v12
v_add_f32 v15,v15,v13
v_lshlrev_b32 v12,16,v42
v_and_b32 v13,s69,v42
v_add_f32 v15,v15,v12
v_add_f32 v15,v15,v13
v_lshlrev_b32 v12,16,v43
v_and_b32 v13,s69,v43
v_add_f32 v15,v15,v12
v_add_f32 v15,v15,v13
g2_c3_17:
ds_read_b64_tr_b16 v[40:41],v7 offset:40960
v_mfma_f32_16x16x32_bf16 v[208:211],v[44:47],v[72:75],v[208:211]
ds_read_b64_tr_b16 v[42:43],v7 offset:41728
v_mfma_f32_16x16x32_bf16 v[212:215],v[44:47],v[76:79],v[212:215]
s_add_u32 m0,s54,4096
s_add_u32 s51,s55,65536
buffer_load_dwordx4 v88,s[56:59],s51 offen lds
v_mfma_f32_16x16x32_bf16 v[216:219],v[44:47],v[80:83],v[216:219]
v_mfma_f32_16x16x32_bf16 v[220:223],v[44:47],v[84:87],v[220:223]
s_bitcmp1_b32 s68,9
s_cbranch_scc0 g2_c3_18
v_lshlrev_b32 v12,16,v44
v_and_b32 v13,s69,v44
v_add_f32 v15,v15,v12
v_add_f32 v15,v15,v13
v_lshlrev_b32 v12,16,v45
v_and_b32 v13,s69,v45
v_add_f32 v15,v15,v12
v_add_f32 v15,v15,v13
v_lshlrev_b32 v12,16,v46
v_and_b32 v13,s69,v46
v_add_f32 v15,v15,v12
v_add_f32 v15,v15,v13
v_lshlrev_b32 v12,16,v47
v_and_b32 v13,s69,v47
v_add_f32 v15,v15,v12
v_add_f32 v15,v15,v13
g2_c3_18:
ds_read_b64_tr_b16 v[44:45],v8 offset:40960
v_mfma_f32_16x16x32_bf16 v[224:227],v[48:51],v[72:75],v[224:227]
ds_read_b64_tr_b16 v[46:47],v8 offset:41728
v_mfma_f32_16x16x32_bf16 v[228:231],v[48:51],v[76:79],v[228:231]
buffer_load_dwordx4 v89,s[56:59],s51 offen offset:1024 lds
v_mfma_f32_16x16x32_bf16 v[232:235],v[48:51],v[80:83],v[232:235]
v_mfma_f32_16x16x32_bf16 v[236:239],v[48:51],v[84:87],v[236:239]
s_bitcmp1_b32 s68,10
s_cbranch_scc0 g2_c3_19
v_lshlrev_b32 v12,16,v48
v_and_b32 v13,s69,v48
v_add_f32 v93,v93,v12
v_add_f32 v93,v93,v13
v_lshlrev_b32 v12,16,v49
v_and_b32 v13,s69,v49
v_add_f32 v93,v93,v12
v_add_f32 v93,v93,v13
v_lshlrev_b32 v12,16,v50
v_and_b32 v13,s69,v50
v_add_f32 v93,v93,v12
v_add_f32 v93,v93,v13
v_lshlrev_b32 v12,16,v51
v_and_b32 v13,s69,v51
v_add_f32 v93,v93,v12
v_add_f32 v93,v93,v13
g2_c3_19:
ds_read_b64_tr_b16 v[48:49],v9 offset:40960
v_mfma_f32_16x16x32_bf16 v[240:243],v[52:55],v[72:75],v[240:243]
ds_read_b64_tr_b16 v[50:51],v9 offset:41728
v_mfma_f32_16x16x32_bf16 v[244:247],v[52:55],v[76:79],v[244:247]
s_add_u32 m0,s54,6144
s_add_u32 s51,s55,98304
buffer_load_dwordx4 v88,s[56:59],s51 offen lds
v_mfma_f32_16x16x32_bf16 v[248:251],v[52:55],v[80:83],v[248:251]
buffer_load_dwordx4 v89,s[56:59],s51 offen offset:1024 lds
s_add_u32 s55,s55,128
v_mfma_f32_16x16x32_bf16 v[252:255],v[52:55],v[84:87],v[252:255]
s_bitcmp1_b32 s68,11
s_cbranch_scc0 g2_c3_20
v_lshlrev_b32 v12,16,v52
v_and_b32 v13,s69,v52
v_add_f32 v93,v93,v12
v_add_f32 v93,v93,v13
v_lshlrev_b32 v12,16,v53
v_and_b32 v13,s69,v53
v_add_f32 v93,v93,v12
v_add_f32 v93,v93,v13
v_lshlrev_b32 v12,16,v54
v_and_b32 v13,s69,v54
v_add_f32 v93,v93,v12
v_add_f32 v93,v93,v13
v_lshlrev_b32 v12,16,v55
v_and_b32 v13,s69,v55
v_add_f32 v93,v93,v12
v_add_f32 v93,v93,v13
g2_c3_20:
ds_read_b64_tr_b16 v[52:53],v10 offset:40960
ds_read_b64_tr_b16 v[54:55],v10 offset:41728
s_waitcnt lgkmcnt(15)
v_mfma_f32_16x16x32_bf16 v[96:99],v[16:19],v[56:59],v[96:99]
v_mfma_f32_16x16x32_bf16 v[100:103],v[16:19],v[60:63],v[100:103]
v_mfma_f32_16x16x32_bf16 v[104:107],v[16:19],v[64:67],v[104:107]
v_mfma_f32_16x16x32_bf16 v[108:111],v[16:19],v[68:71],v[108:111]
s_waitcnt vmcnt(9) lgkmcnt(0)
s_barrier
s_bitcmp1_b32 s68,2
s_cbranch_scc0 g2_c3_21
v_lshlrev_b32 v12,16,v16
v_and_b32 v13,s69,v16
v_add_f32 v14,v14,v12
v_add_f32 v14,v14,v13
v_lshlrev_b32 v12,16,v17
v_and_b32 v13,s69,v17
v_add_f32 v14,v14,v12
v_add_f32 v14,v14,v13
v_lshlrev_b32 v12,16,v18
v_and_b32 v13,s69,v18
v_add_f32 v14,v14,v12
v_add_f32 v14,v14,v13
v_lshlrev_b32 v12,16,v19
v_and_b32 v13,s69,v19
v_add_f32 v14,v14,v12
v_add_f32 v14,v14,v13
g2_c3_21:
ds_read_b64_tr_b16 v[16:17],v1 offset:61440
v_mfma_f32_16x16x32_bf16 v[112:115],v[20:23],v[56:59],v[112:115]
ds_read_b64_tr_b16 v[18:19],v1 offset:62464
v_mfma_f32_16x16x32_bf16 v[116:119],v[20:23],v[60:63],v[116:119]
ds_read_b128 v[72:75],v94 offset:32768
v_mfma_f32_16x16x32_bf16 v[120:123],v[20:23],v[64:67],v[120:123]
ds_read_b128 v[76:79],v94 offset:34816
v_mfma_f32_16x16x32_bf16 v[124:127],v[20:23],v[68:71],v[124:127]
s_bitcmp1_b32 s68,3
s_cbranch_scc0 g2_c3_22
v_lshlrev_b32 v12,16,v20
v_and_b32 v13,s69,v20
v_add_f32 v14,v14,v12
v_add_f32 v14,v14,v13
v_lshlrev_b32 v12,16,v21
v_and_b32 v13,s69,v21
v_add_f32 v14,v14,v12
v_add_f32 v14,v14,v13
v_lshlrev_b32 v12,16,v22
v_and_b32 v13,s69,v22
v_add_f32 v14,v14,v12
v_add_f32 v14,v14,v13
v_lshlrev_b32 v12,16,v23
v_and_b32 v13,s69,v23
v_add_f32 v14,v14,v12
v_add_f32 v14,v14,v13
g2_c3_22:
ds_read_b64_tr_b16 v[20:21],v2 offset:61440
v_mfma_f32_16x16x32_bf16 v[128:131],v[24:27],v[56:59],v[128:131]
ds_read_b64_tr_b16 v[22:23],v2 offset:62464
v_mfma_f32_16x16x32_bf16 v[132:135],v[24:27],v[60:63],v[132:135]
ds_read_b128 v[80:83],v94 offset:36864
v_mfma_f32_16x16x32_bf16 v[136:139],v[24:27],v[64:67],v[136:139]
ds_read_b128 v[84:87],v94 offset:38912
v_mfma_f32_16x16x32_bf16 v[140:143],v[24:27],v[68:71],v[140:143]
s_bitcmp1_b32 s68,4
s_cbranch_scc0 g2_c3_23
v_lshlrev_b32 v12,16,v24
v_and_b32 v13,s69,v24
v_add_f32 v14,v14,v12
v_add_f32 v14,v14,v13
v_lshlrev_b32 v12,16,v25
v_and_b32 v13,s69,v25
v_add_f32 v14,v14,v12
v_add_f32 v14,v14,v13
v_lshlrev_b32 v12,16,v26
v_and_b32 v13,s69,v26
v_add_f32 v14,v14,v12
v_add_f32 v14,v14,v13
v_lshlrev_b32 v12,16,v27
v_and_b32 v13,s69,v27
v_add_f32 v14,v14,v12
v_add_f32 v14,v14,v13
g2_c3_23:
ds_read_b64_tr_b16 v[24:25],v3 offset:61440
v_mfma_f32_16x16x32_bf16 v[144:147],v[28:31],v[56:59],v[144:147]
ds_read_b64_tr_b16 v[26:27],v3 offset:62208
v_mfma_f32_16x16x32_bf16 v[148:151],v[28:31],v[60:63],v[148:151]
buffer_load_dword v91,v90,s[28:31],s48 offen
s_add_u32 s48,s48,s49
v_mfma_f32_16x16x32_bf16 v[152:155],v[28:31],v[64:67],v[152:155]
v_mfma_f32_16x16x32_bf16 v[156:159],v[28:31],v[68:71],v[156:159]
s_bitcmp1_b32 s68,5
s_cbranch_scc0 g2_c3_24
v_lshlrev_b32 v12,16,v28
v_and_b32 v13,s69,v28
v_add_f32 v14,v14,v12
v_add_f32 v14,v14,v13
v_lshlrev_b32 v12,16,v29
v_and_b32 v13,s69,v29
v_add_f32 v14,v14,v12
v_add_f32 v14,v14,v13
v_lshlrev_b32 v12,16,v30
v_and_b32 v13,s69,v30
v_add_f32 v14,v14,v12
v_add_f32 v14,v14,v13
v_lshlrev_b32 v12,16,v31
v_and_b32 v13,s69,v31
v_add_f32 v14,v14,v12
v_add_f32 v14,v14,v13
g2_c3_24:
ds_read_b64_tr_b16 v[28:29],v4 offset:61440
v_mfma_f32_16x16x32_bf16 v[160:163],v[32:35],v[56:59],v[160:163]
ds_read_b64_tr_b16 v[30:31],v4 offset:62208
v_mfma_f32_16x16x32_bf16 v[164:167],v[32:35],v[60:63],v[164:167]
v_mfma_f32_16x16x32_bf16 v[168:171],v[32:35],v[64:67],v[168:171]
v_mfma_f32_16x16x32_bf16 v[172:175],v[32:35],v[68:71],v[172:175]
s_bitcmp1_b32 s68,6
s_cbranch_scc0 g2_c3_25
v_lshlrev_b32 v12,16,v32
v_and_b32 v13,s69,v32
v_add_f32 v15,v15,v12
v_add_f32 v15,v15,v13
v_lshlrev_b32 v12,16,v33
v_and_b32 v13,s69,v33
v_add_f32 v15,v15,v12
v_add_f32 v15,v15,v13
v_lshlrev_b32 v12,16,v34
v_and_b32 v13,s69,v34
v_add_f32 v15,v15,v12
v_add_f32 v15,v15,v13
v_lshlrev_b32 v12,16,v35
v_and_b32 v13,s69,v35
v_add_f32 v15,v15,v12
v_add_f32 v15,v15,v13
g2_c3_25:
ds_read_b64_tr_b16 v[32:33],v5 offset:61440
v_mfma_f32_16x16x32_bf16 v[176:179],v[36:39],v[56:59],v[176:179]
ds_read_b64_tr_b16 v[34:35],v5 offset:62208
v_mfma_f32_16x16x32_bf16 v[180:183],v[36:39],v[60:63],v[180:183]
v_mfma_f32_16x16x32_bf16 v[184:187],v[36:39],v[64:67],v[184:187]
v_mfma_f32_16x16x32_bf16 v[188:191],v[36:39],v[68:71],v[188:191]
s_bitcmp1_b32 s68,7
s_cbranch_scc0 g2_c3_26
v_lshlrev_b32 v12,16,v36
v_and_b32 v13,s69,v36
v_add_f32 v15,v15,v12
v_add_f32 v15,v15,v13
v_lshlrev_b32 v12,16,v37
v_and_b32 v13,s69,v37
v_add_f32 v15,v15,v12
v_add_f32 v15,v15,v13
v_lshlrev_b32 v12,16,v38
v_and_b32 v13,s69,v38
v_add_f32 v15,v15,v12
v_add_f32 v15,v15,v13
v_lshlrev_b32 v12,16,v39
v_and_b32 v13,s69,v39
v_add_f32 v15,v15,v12
v_add_f32 v15,v15,v13
g2_c3_26:
ds_read_b64_tr_b16 v[36:37],v6 offset:61440
v_mfma_f32_16x16x32_bf16 v[192:195],v[40:43],v[56:59],v[192:195]
ds_read_b64_tr_b16 v[38:39],v6 offset:62208
v_mfma_f32_16x16x32_bf16 v[196:199],v[40:43],v[60:63],v[196:199]
v_mfma_f32_16x16x32_bf16 v[200:203],v[40:43],v[64:67],v[200:203]
v_mfma_f32_16x16x32_bf16 v[204:207],v[40:43],v[68:71],v[204:207]
s_bitcmp1_b32 s68,8
s_cbranch_scc0 g2_c3_27
v_lshlrev_b32 v12,16,v40
v_and_b32 v13,s69,v40
v_add_f32 v15,v15,v12
v_add_f32 v15,v15,v13
v_lshlrev_b32 v12,16,v41
v_and_b32 v13,s69,v41
v_add_f32 v15,v15,v12
v_add_f32 v15,v15,v13
v_lshlrev_b32 v12,16,v42
v_and_b32 v13,s69,v42
v_add_f32 v15,v15,v12
v_add_f32 v15,v15,v13
v_lshlrev_b32 v12,16,v43
v_and_b32 v13,s69,v43
v_add_f32 v15,v15,v12
v_add_f32 v15,v15,v13
g2_c3_27:
ds_read_b64_tr_b16 v[40:41],v7 offset:61440
v_mfma_f32_16x16x32_bf16 v[208:211],v[44:47],v[56:59],v[208:211]
ds_read_b64_tr_b16 v[42:43],v7 offset:62208
v_mfma_f32_16x16x32_bf16 v[212:215],v[44:47],v[60:63],v[212:215]
v_mfma_f32_16x16x32_bf16 v[216:219],v[44:47],v[64:67],v[216:219]
v_mfma_f32_16x16x32_bf16 v[220:223],v[44:47],v[68:71],v[220:223]
s_bitcmp1_b32 s68,9
s_cbranch_scc0 g2_c3_28
v_lshlrev_b32 v12,16,v44
v_and_b32 v13,s69,v44
v_add_f32 v15,v15,v12
v_add_f32 v15,v15,v13
v_lshlrev_b32 v12,16,v45
v_and_b32 v13,s69,v45
v_add_f32 v15,v15,v12
v_add_f32 v15,v15,v13
v_lshlrev_b32 v12,16,v46
v_and_b32 v13,s69,v46
v_add_f32 v15,v15,v12
v_add_f32 v15,v15,v13
v_lshlrev_b32 v12,16,v47
v_and_b32 v13,s69,v47
v_add_f32 v15,v15,v12
v_add_f32 v15,v15,v13
g2_c3_28:
ds_read_b64_tr_b16 v[44:45],v8 offset:61440
v_mfma_f32_16x16x32_bf16 v[224:227],v[48:51],v[56:59],v[224:227]
ds_read_b64_tr_b16 v[46:47],v8 offset:62208
v_mfma_f32_16x16x32_bf16 v[228:231],v[48:51],v[60:63],v[228:231]
v_mfma_f32_16x16x32_bf16 v[232:235],v[48:51],v[64:67],v[232:235]
v_mfma_f32_16x16x32_bf16 v[236:239],v[48:51],v[68:71],v[236:239]
s_bitcmp1_b32 s68,10
s_cbranch_scc0 g2_c3_29
v_lshlrev_b32 v12,16,v48
v_and_b32 v13,s69,v48
v_add_f32 v93,v93,v12
v_add_f32 v93,v93,v13
v_lshlrev_b32 v12,16,v49
v_and_b32 v13,s69,v49
v_add_f32 v93,v93,v12
v_add_f32 v93,v93,v13
v_lshlrev_b32 v12,16,v50
v_and_b32 v13,s69,v50
v_add_f32 v93,v93,v12
v_add_f32 v93,v93,v13
v_lshlrev_b32 v12,16,v51
v_and_b32 v13,s69,v51
v_add_f32 v93,v93,v12
v_add_f32 v93,v93,v13
g2_c3_29:
ds_read_b64_tr_b16 v[48:49],v9 offset:61440
v_mfma_f32_16x16x32_bf16 v[240:243],v[52:55],v[56:59],v[240:243]
ds_read_b64_tr_b16 v[50:51],v9 offset:62208
v_mfma_f32_16x16x32_bf16 v[244:247],v[52:55],v[60:63],v[244:247]
v_mfma_f32_16x16x32_bf16 v[248:251],v[52:55],v[64:67],v[248:251]
v_mfma_f32_16x16x32_bf16 v[252:255],v[52:55],v[68:71],v[252:255]
s_bitcmp1_b32 s68,11
s_cbranch_scc0 g2_c3_30
v_lshlrev_b32 v12,16,v52
v_and_b32 v13,s69,v52
v_add_f32 v93,v93,v12
v_add_f32 v93,v93,v13
v_lshlrev_b32 v12,16,v53
v_and_b32 v13,s69,v53
v_add_f32 v93,v93,v12
v_add_f32 v93,v93,v13
v_lshlrev_b32 v12,16,v54
v_and_b32 v13,s69,v54
v_add_f32 v93,v93,v12
v_add_f32 v93,v93,v13
v_lshlrev_b32 v12,16,v55
v_and_b32 v13,s69,v55
v_add_f32 v93,v93,v12
v_add_f32 v93,v93,v13
g2_c3_30:
ds_read_b64_tr_b16 v[52:53],v10 offset:61440
ds_read_b64_tr_b16 v[54:55],v10 offset:62208
s_waitcnt lgkmcnt(15)
v_mfma_f32_16x16x32_bf16 v[96:99],v[16:19],v[72:75],v[96:99]
v_mfma_f32_16x16x32_bf16 v[100:103],v[16:19],v[76:79],v[100:103]
v_mfma_f32_16x16x32_bf16 v[104:107],v[16:19],v[80:83],v[104:107]
v_mfma_f32_16x16x32_bf16 v[108:111],v[16:19],v[84:87],v[108:111]
s_waitcnt vmcnt(1) lgkmcnt(0)
s_barrier
s_bitcmp1_b32 s68,2
s_cbranch_scc0 g2_c3_31
v_lshlrev_b32 v12,16,v16
v_and_b32 v13,s69,v16
v_add_f32 v14,v14,v12
v_add_f32 v14,v14,v13
v_lshlrev_b32 v12,16,v17
v_and_b32 v13,s69,v17
v_add_f32 v14,v14,v12
v_add_f32 v14,v14,v13
v_lshlrev_b32 v12,16,v18
v_and_b32 v13,s69,v18
v_add_f32 v14,v14,v12
v_add_f32 v14,v14,v13
v_lshlrev_b32 v12,16,v19
v_and_b32 v13,s69,v19
v_add_f32 v14,v14,v12
v_add_f32 v14,v14,v13
v_and_b32 v12,15,v0
v_lshrrev_b32 v13,4,v0
v_lshlrev_b32 v12,4,v12
v_lshl_add_u32 v12,v13,2,v12
v_add_u32 v12,153600,v12
ds_write_b32 v12,v14 offset:1536
g2_c3_31:
ds_read_b64_tr_b16 v[16:17],v1 offset:0
v_mfma_f32_16x16x32_bf16 v[112:115],v[20:23],v[72:75],v[112:115]
ds_read_b64_tr_b16 v[18:19],v1 offset:1024
v_mfma_f32_16x16x32_bf16 v[116:119],v[20:23],v[76:79],v[116:119]
ds_read_b128 v[56:59],v11 offset:0
v_mfma_f32_16x16x32_bf16 v[120:123],v[20:23],v[80:83],v[120:123]
ds_read_b128 v[60:63],v11 offset:2048
v_mfma_f32_16x16x32_bf16 v[124:127],v[20:23],v[84:87],v[124:127]
s_bitcmp1_b32 s68,3
s_cbranch_scc0 g2_c3_32
v_lshlrev_b32 v12,16,v20
v_and_b32 v13,s69,v20
v_add_f32 v14,v14,v12
v_add_f32 v14,v14,v13
v_lshlrev_b32 v12,16,v21
v_and_b32 v13,s69,v21
v_add_f32 v14,v14,v12
v_add_f32 v14,v14,v13
v_lshlrev_b32 v12,16,v22
v_and_b32 v13,s69,v22
v_add_f32 v14,v14,v12
v_add_f32 v14,v14,v13
v_lshlrev_b32 v12,16,v23
v_and_b32 v13,s69,v23
v_add_f32 v14,v14,v12
v_add_f32 v14,v14,v13
v_and_b32 v12,15,v0
v_lshrrev_b32 v13,4,v0
v_lshlrev_b32 v12,4,v12
v_lshl_add_u32 v12,v13,2,v12
v_add_u32 v12,153600,v12
ds_write_b32 v12,v14 offset:1792
g2_c3_32:
ds_read_b64_tr_b16 v[20:21],v2 offset:0
v_mfma_f32_16x16x32_bf16 v[128:131],v[24:27],v[72:75],v[128:131]
ds_read_b64_tr_b16 v[22:23],v2 offset:1024
v_mfma_f32_16x16x32_bf16 v[132:135],v[24:27],v[76:79],v[132:135]
ds_read_b128 v[64:67],v11 offset:4096
v_mfma_f32_16x16x32_bf16 v[136:139],v[24:27],v[80:83],v[136:139]
ds_read_b128 v[68:71],v11 offset:6144
v_mfma_f32_16x16x32_bf16 v[140:143],v[24:27],v[84:87],v[140:143]
s_bitcmp1_b32 s68,4
s_cbranch_scc0 g2_c3_33
v_lshlrev_b32 v12,16,v24
v_and_b32 v13,s69,v24
v_add_f32 v14,v14,v12
v_add_f32 v14,v14,v13
v_lshlrev_b32 v12,16,v25
v_and_b32 v13,s69,v25
v_add_f32 v14,v14,v12
v_add_f32 v14,v14,v13
v_lshlrev_b32 v12,16,v26
v_and_b32 v13,s69,v26
v_add_f32 v14,v14,v12
v_add_f32 v14,v14,v13
v_lshlrev_b32 v12,16,v27
v_and_b32 v13,s69,v27
v_add_f32 v14,v14,v12
v_add_f32 v14,v14,v13
v_and_b32 v12,15,v0
v_lshrrev_b32 v13,4,v0
v_lshlrev_b32 v12,4,v12
v_lshl_add_u32 v12,v13,2,v12
v_add_u32 v12,153600,v12
ds_write_b32 v12,v14 offset:2560
g2_c3_33:
ds_read_b64_tr_b16 v[24:25],v3 offset:0
v_mfma_f32_16x16x32_bf16 v[144:147],v[28:31],v[72:75],v[144:147]
ds_read_b64_tr_b16 v[26:27],v3 offset:768
v_mfma_f32_16x16x32_bf16 v[148:151],v[28:31],v[76:79],v[148:151]
s_add_u32 m0,s54,32768
s_nop 0
buffer_load_dwordx4 v88,s[56:59],s55 offen lds
v_mfma_f32_16x16x32_bf16 v[152:155],v[28:31],v[80:83],v[152:155]
v_mfma_f32_16x16x32_bf16 v[156:159],v[28:31],v[84:87],v[156:159]
s_bitcmp1_b32 s68,5
s_cbranch_scc0 g2_c3_34
v_lshlrev_b32 v12,16,v28
v_and_b32 v13,s69,v28
v_add_f32 v14,v14,v12
v_add_f32 v14,v14,v13
v_lshlrev_b32 v12,16,v29
v_and_b32 v13,s69,v29
v_add_f32 v14,v14,v12
v_add_f32 v14,v14,v13
v_lshlrev_b32 v12,16,v30
v_and_b32 v13,s69,v30
v_add_f32 v14,v14,v12
v_add_f32 v14,v14,v13
v_lshlrev_b32 v12,16,v31
v_and_b32 v13,s69,v31
v_add_f32 v14,v14,v12
v_add_f32 v14,v14,v13
v_and_b32 v12,15,v0
v_lshrrev_b32 v13,4,v0
v_lshlrev_b32 v12,4,v12
v_lshl_add_u32 v12,v13,2,v12
v_add_u32 v12,153600,v12
ds_write_b32 v12,v14 offset:2816
g2_c3_34:
ds_read_b64_tr_b16 v[28:29],v4 offset:0
v_mfma_f32_16x16x32_bf16 v[160:163],v[32:35],v[72:75],v[160:163]
ds_read_b64_tr_b16 v[30:31],v4 offset:768
v_mfma_f32_16x16x32_bf16 v[164:167],v[32:35],v[76:79],v[164:167]
buffer_load_dwordx4 v89,s[56:59],s55 offen offset:1024 lds
v_mfma_f32_16x16x32_bf16 v[168:171],v[32:35],v[80:83],v[168:171]
v_mfma_f32_16x16x32_bf16 v[172:175],v[32:35],v[84:87],v[172:175]
s_bitcmp1_b32 s68,6
s_cbranch_scc0 g2_c3_35
v_lshlrev_b32 v12,16,v32
v_and_b32 v13,s69,v32
v_add_f32 v15,v15,v12
v_add_f32 v15,v15,v13
v_lshlrev_b32 v12,16,v33
v_and_b32 v13,s69,v33
v_add_f32 v15,v15,v12
v_add_f32 v15,v15,v13
v_lshlrev_b32 v12,16,v34
v_and_b32 v13,s69,v34
v_add_f32 v15,v15,v12
v_add_f32 v15,v15,v13
v_lshlrev_b32 v12,16,v35
v_and_b32 v13,s69,v35
v_add_f32 v15,v15,v12
v_add_f32 v15,v15,v13
v_and_b32 v12,15,v0
v_lshrrev_b32 v13,4,v0
v_lshlrev_b32 v12,4,v12
v_lshl_add_u32 v12,v13,2,v12
v_add_u32 v12,153600,v12
ds_write_b32 v12,v15 offset:4096
g2_c3_35:
ds_read_b64_tr_b16 v[32:33],v5 offset:0
v_mfma_f32_16x16x32_bf16 v[176:179],v[36:39],v[72:75],v[176:179]
ds_read_b64_tr_b16 v[34:35],v5 offset:768
v_mfma_f32_16x16x32_bf16 v[180:183],v[36:39],v[76:79],v[180:183]
s_add_u32 m0,s54,34816
s_add_u32 s51,s55,32768
buffer_load_dwordx4 v88,s[56:59],s51 offen lds
v_mfma_f32_16x16x32_bf16 v[184:187],v[36:39],v[80:83],v[184:187]
v_mfma_f32_16x16x32_bf16 v[188:191],v[36:39],v[84:87],v[188:191]
s_bitcmp1_b32 s68,7
s_cbranch_scc0 g2_c3_36
v_lshlrev_b32 v12,16,v36
v_and_b32 v13,s69,v36
v_add_f32 v15,v15,v12
v_add_f32 v15,v15,v13
v_lshlrev_b32 v12,16,v37
v_and_b32 v13,s69,v37
v_add_f32 v15,v15,v12
v_add_f32 v15,v15,v13
v_lshlrev_b32 v12,16,v38
v_and_b32 v13,s69,v38
v_add_f32 v15,v15,v12
v_add_f32 v15,v15,v13
v_lshlrev_b32 v12,16,v39
v_and_b32 v13,s69,v39
v_add_f32 v15,v15,v12
v_add_f32 v15,v15,v13
v_and_b32 v12,15,v0
v_lshrrev_b32 v13,4,v0
v_lshlrev_b32 v12,4,v12
v_lshl_add_u32 v12,v13,2,v12
v_add_u32 v12,153600,v12
ds_write_b32 v12,v15 offset:4352
g2_c3_36:
ds_read_b64_tr_b16 v[36:37],v6 offset:0
v_mfma_f32_16x16x32_bf16 v[192:195],v[40:43],v[72:75],v[192:195]
ds_read_b64_tr_b16 v[38:39],v6 offset:768
v_mfma_f32_16x16x32_bf16 v[196:199],v[40:43],v[76:79],v[196:199]
buffer_load_dwordx4 v89,s[56:59],s51 offen offset:1024 lds
v_mfma_f32_16x16x32_bf16 v[200:203],v[40:43],v[80:83],v[200:203]
v_mfma_f32_16x16x32_bf16 v[204:207],v[40:43],v[84:87],v[204:207]
s_bitcmp1_b32 s68,8
s_cbranch_scc0 g2_c3_37
v_lshlrev_b32 v12,16,v40
v_and_b32 v13,s69,v40
v_add_f32 v15,v15,v12
v_add_f32 v15,v15,v13
v_lshlrev_b32 v12,16,v41
v_and_b32 v13,s69,v41
v_add_f32 v15,v15,v12
v_add_f32 v15,v15,v13
v_lshlrev_b32 v12,16,v42
v_and_b32 v13,s69,v42
v_add_f32 v15,v15,v12
v_add_f32 v15,v15,v13
v_lshlrev_b32 v12,16,v43
v_and_b32 v13,s69,v43
v_add_f32 v15,v15,v12
v_add_f32 v15,v15,v13
v_and_b32 v12,15,v0
v_lshrrev_b32 v13,4,v0
v_lshlrev_b32 v12,4,v12
v_lshl_add_u32 v12,v13,2,v12
v_add_u32 v12,153600,v12
ds_write_b32 v12,v15 offset:3072
g2_c3_37:
ds_read_b64_tr_b16 v[40:41],v7 offset:0
v_mfma_f32_16x16x32_bf16 v[208:211],v[44:47],v[72:75],v[208:211]
ds_read_b64_tr_b16 v[42:43],v7 offset:768
v_mfma_f32_16x16x32_bf16 v[212:215],v[44:47],v[76:79],v[212:215]
s_add_u32 m0,s54,36864
s_add_u32 s51,s55,65536
buffer_load_dwordx4 v88,s[56:59],s51 offen lds
v_mfma_f32_16x16x32_bf16 v[216:219],v[44:47],v[80:83],v[216:219]
v_mfma_f32_16x16x32_bf16 v[220:223],v[44:47],v[84:87],v[220:223]
s_bitcmp1_b32 s68,9
s_cbranch_scc0 g2_c3_38
v_lshlrev_b32 v12,16,v44
v_and_b32 v13,s69,v44
v_add_f32 v15,v15,v12
v_add_f32 v15,v15,v13
v_lshlrev_b32 v12,16,v45
v_and_b32 v13,s69,v45
v_add_f32 v15,v15,v12
v_add_f32 v15,v15,v13
v_lshlrev_b32 v12,16,v46
v_and_b32 v13,s69,v46
v_add_f32 v15,v15,v12
v_add_f32 v15,v15,v13
v_lshlrev_b32 v12,16,v47
v_and_b32 v13,s69,v47
v_add_f32 v15,v15,v12
v_add_f32 v15,v15,v13
v_and_b32 v12,15,v0
v_lshrrev_b32 v13,4,v0
v_lshlrev_b32 v12,4,v12
v_lshl_add_u32 v12,v13,2,v12
v_add_u32 v12,153600,v12
ds_write_b32 v12,v15 offset:3328
g2_c3_38:
ds_read_b64_tr_b16 v[44:45],v8 offset:0
v_mfma_f32_16x16x32_bf16 v[224:227],v[48:51],v[72:75],v[224:227]
ds_read_b64_tr_b16 v[46:47],v8 offset:768
v_mfma_f32_16x16x32_bf16 v[228:231],v[48:51],v[76:79],v[228:231]
buffer_load_dwordx4 v89,s[56:59],s51 offen offset:1024 lds
v_mfma_f32_16x16x32_bf16 v[232:235],v[48:51],v[80:83],v[232:235]
v_mfma_f32_16x16x32_bf16 v[236:239],v[48:51],v[84:87],v[236:239]
s_bitcmp1_b32 s68,10
s_cbranch_scc0 g2_c3_39
v_lshlrev_b32 v12,16,v48
v_and_b32 v13,s69,v48
v_add_f32 v93,v93,v12
v_add_f32 v93,v93,v13
v_lshlrev_b32 v12,16,v49
v_and_b32 v13,s69,v49
v_add_f32 v93,v93,v12
v_add_f32 v93,v93,v13
v_lshlrev_b32 v12,16,v50
v_and_b32 v13,s69,v50
v_add_f32 v93,v93,v12
v_add_f32 v93,v93,v13
v_lshlrev_b32 v12,16,v51
v_and_b32 v13,s69,v51
v_add_f32 v93,v93,v12
v_add_f32 v93,v93,v13
v_and_b32 v12,15,v0
v_lshrrev_b32 v13,4,v0
v_lshlrev_b32 v12,4,v12
v_lshl_add_u32 v12,v13,2,v12
v_add_u32 v12,153600,v12
ds_write_b32 v12,v93 offset:4608
g2_c3_39:
ds_read_b64_tr_b16 v[48:49],v9 offset:0
v_mfma_f32_16x16x32_bf16 v[240:243],v[52:55],v[72:75],v[240:243]
ds_read_b64_tr_b16 v[50:51],v9 offset:768
v_mfma_f32_16x16x32_bf16 v[244:247],v[52:55],v[76:79],v[244:247]
s_add_u32 m0,s54,38912
s_add_u32 s51,s55,98304
buffer_load_dwordx4 v88,s[56:59],s51 offen lds
v_mfma_f32_16x16x32_bf16 v[248:251],v[52:55],v[80:83],v[248:251]
buffer_load_dwordx4 v89,s[56:59],s51 offen offset:1024 lds
s_and_b32 s50,s64,7
s_lshr_b32 s64,s64,4
s_mul_i32 s55,s50,256
s_add_u32 s55,s55,s65
v_mfma_f32_16x16x32_bf16 v[252:255],v[52:55],v[84:87],v[252:255]
s_bitcmp1_b32 s68,11
s_cbranch_scc0 g2_c3_40
v_lshlrev_b32 v12,16,v52
v_and_b32 v13,s69,v52
v_add_f32 v93,v93,v12
v_add_f32 v93,v93,v13
v_lshlrev_b32 v12,16,v53
v_and_b32 v13,s69,v53
v_add_f32 v93,v93,v12
v_add_f32 v93,v93,v13
v_lshlrev_b32 v12,16,v54
v_and_b32 v13,s69,v54
v_add_f32 v93,v93,v12
v_add_f32 v93,v93,v13
v_lshlrev_b32 v12,16,v55
v_and_b32 v13,s69,v55
v_add_f32 v93,v93,v12
v_add_f32 v93,v93,v13
v_and_b32 v12,15,v0
v_lshrrev_b32 v13,4,v0
v_lshlrev_b32 v12,4,v12
v_lshl_add_u32 v12,v13,2,v12
v_add_u32 v12,153600,v12
ds_write_b32 v12,v93 offset:4864
g2_c3_40:
ds_read_b64_tr_b16 v[52:53],v10 offset:0
ds_read_b64_tr_b16 v[54:55],v10 offset:768
s_sub_u32 s53,s53,1
s_branch g2_loop3
g2_pub3:
s_lshl_b32 s50,s40,10
s_add_u32 s50,s50,153600
v_add_u32 v93,s50,v95
ds_read_b128 v[12:15],v93
v_lshlrev_b32 v93,5,v0
s_lshl_b32 s50,s43,2
s_add_u32 s50,s50,s98
s_waitcnt lgkmcnt(0)
v_add_f32 v12,v12,v13
v_add_f32 v14,v14,v15
v_add_f32 v12,v12,v14
buffer_store_dword v12,v93,s[36:39],s50 offen sc1
s_branch g2_pubr3
g2_bad3:
v_lshlrev_b32 v92,2,v0
v_add_u32 v92,151552,v92
ds_write_b32 v92,v92
s_branch g2_badr3
g2_rd3:
ds_read2_b32 v[56:57],v94 offset0:0 offset1:32
ds_read2_b32 v[58:59],v94 offset0:16 offset1:48
ds_read2_b32 v[60:61],v94 offset0:64 offset1:96
ds_read2_b32 v[62:63],v94 offset0:80 offset1:112
ds_read_b128 v[16:19],v92 offset:384
ds_read_b128 v[20:23],v92 offset:448
ds_read_b128 v[24:27],v92 offset:640
ds_read_b128 v[28:31],v92 offset:704
ds_read_b128 v[32:35],v92 offset:1024
ds_read_b128 v[36:39],v92 offset:1088
ds_read_b128 v[40:43],v92 offset:768
ds_read_b128 v[44:47],v92 offset:832
ds_read_b128 v[48:51],v92 offset:1152
ds_read_b128 v[52:55],v92 offset:1216
s_waitcnt lgkmcnt(0)
s_branch g2_ep3
g2_rec:
s_waitcnt vmcnt(0) lgkmcnt(0)
s_mov_b32 s20,s6
s_and_b32 s21,s7,0xffff
s_mov_b32 s22,6291456
s_mov_b32 s23,0x00020000
s_mov_b32 s24,s8
s_and_b32 s25,s9,0xffff
s_mov_b32 s26,7340032
s_mov_b32 s27,0x00020000
s_mov_b32 s28,s10
s_and_b32 s29,s11,0xffff
s_mov_b32 s30,7340032
s_mov_b32 s31,0x00020000
s_mov_b32 s53,2000
s_cmp_eq_u32 s100,-1
s_cselect_b32 s53,s53,1
g2_rpoll:
buffer_load_dword v16,off,s[60:63],0 sc1
s_waitcnt vmcnt(0)
v_readfirstlane_b32 s50,v16
s_nop 0
s_cmp_eq_u32 s50,256
s_cbranch_scc1 g2_rok
s_sleep 2
s_sub_u32 s53,s53,1
s_cmp_lg_u32 s53,0
s_cbranch_scc1 g2_rpoll
s_lshl_b32 s51,s43,19
s_lshl_b32 s50,s40,16
s_add_u32 s51,s51,s50
s_lshl_b32 s50,s40,8
s_add_u32 s50,s50,149504
v_mov_b32 v30,s50
s_mov_b32 s53,32
g2_rst:
buffer_load_dwordx4 v[16:19],v1,s[56:59],s51 offen offset:0
buffer_load_dwordx4 v[20:23],v1,s[56:59],s51 offen offset:1024
s_waitcnt vmcnt(0)
v_lshlrev_b32 v28,16,v16
v_and_b32 v29,0xffff0000,v16
v_mov_b32 v24,v28
v_mov_b32 v26,v29
v_mul_f32 v25,v28,v28
v_mul_f32 v27,v29,v29
v_lshlrev_b32 v28,16,v17
v_and_b32 v29,0xffff0000,v17
v_add_f32 v24,v24,v28
v_add_f32 v26,v26,v29
v_fmac_f32 v25,v28,v28
v_fmac_f32 v27,v29,v29
v_lshlrev_b32 v28,16,v18
v_and_b32 v29,0xffff0000,v18
v_add_f32 v24,v24,v28
v_add_f32 v26,v26,v29
v_fmac_f32 v25,v28,v28
v_fmac_f32 v27,v29,v29
v_lshlrev_b32 v28,16,v19
v_and_b32 v29,0xffff0000,v19
v_add_f32 v24,v24,v28
v_add_f32 v26,v26,v29
v_fmac_f32 v25,v28,v28
v_fmac_f32 v27,v29,v29
v_lshlrev_b32 v28,16,v20
v_and_b32 v29,0xffff0000,v20
v_add_f32 v24,v24,v28
v_add_f32 v26,v26,v29
v_fmac_f32 v25,v28,v28
v_fmac_f32 v27,v29,v29
v_lshlrev_b32 v28,16,v21
v_and_b32 v29,0xffff0000,v21
v_add_f32 v24,v24,v28
v_add_f32 v26,v26,v29
v_fmac_f32 v25,v28,v28
v_fmac_f32 v27,v29,v29
v_lshlrev_b32 v28,16,v22
v_and_b32 v29,0xffff0000,v22
v_add_f32 v24,v24,v28
v_add_f32 v26,v26,v29
v_fmac_f32 v25,v28,v28
v_fmac_f32 v27,v29,v29
v_lshlrev_b32 v28,16,v23
v_and_b32 v29,0xffff0000,v23
v_add_f32 v24,v24,v28
v_add_f32 v26,v26,v29
v_fmac_f32 v25,v28,v28
v_fmac_f32 v27,v29,v29
v_add_f32 v24,v24,v26
v_add_f32 v25,v25,v27
s_nop 0
s_nop 0
v_add_f32_dpp v24,v24,v24 row_ror:8 row_mask:0xf bank_mask:0xf
v_add_f32_dpp v25,v25,v25 row_ror:8 row_mask:0xf bank_mask:0xf
s_nop 0
v_add_f32_dpp v24,v24,v24 row_ror:4 row_mask:0xf bank_mask:0xf
v_add_f32_dpp v25,v25,v25 row_ror:4 row_mask:0xf bank_mask:0xf
s_nop 0
v_add_f32_dpp v24,v24,v24 row_ror:2 row_mask:0xf bank_mask:0xf
v_add_f32_dpp v25,v25,v25 row_ror:2 row_mask:0xf bank_mask:0xf
s_nop 0
v_add_f32_dpp v24,v24,v24 row_ror:1 row_mask:0xf bank_mask:0xf
v_add_f32_dpp v25,v25,v25 row_ror:1 row_mask:0xf bank_mask:0xf
v_mov_b32 v26,v24
v_mov_b32 v27,v25
s_nop 0
v_permlane16_swap_b32 v24,v26
v_permlane16_swap_b32 v25,v27
v_add_f32 v24,v24,v26
v_add_f32 v25,v25,v27
v_mov_b32 v26,v24
v_mov_b32 v27,v25
s_nop 0
v_permlane32_swap_b32 v24,v26
v_permlane32_swap_b32 v25,v27
v_add_f32 v24,v24,v26
v_add_f32 v25,v25,v27
v_mul_f32 v24,0xba800000,v24
v_mul_f32 v25,0x3a800000,v25
v_fma_f32 v25,-v24,v24,v25
v_max_f32 v25,0,v25
v_cvt_pk_bf16_f32 v24,v24,v25
v_and_b32 v25,0xffff0000,v24
v_lshlrev_b32 v24,16,v24
v_add_f32 v25,0x3727c5ac,v25
v_cvt_pk_bf16_f32 v25,v25,v25
v_and_b32 v25,0xffff0000,v25
v_sqrt_f32 v25,v25
s_nop 0
v_cvt_pk_bf16_f32 v25,v25,v25
v_and_b32 v25,0xffff0000,v25
ds_write2_b32 v30,v24,v25 offset1:32
v_add_u32 v30,4,v30
s_add_u32 s51,s51,2048
s_sub_u32 s53,s53,1
s_cmp_lg_u32 s53,0
s_cbranch_scc1 g2_rst
s_lshl_b32 s50,s40,6
v_add_u32 v16,s50,v0
v_mov_b32 v17,0x40000000
s_lshl_b32 s50,s46,6
s_add_u32 s50,s50,64
s_lshl_b32 s51,s46,5
s_sub_u32 s51,128,s51
v_lshrrev_b32 v18,6,v16
v_lshlrev_b32 v18,11,v18
v_lshl_add_u32 v18,v0,1,v18
v_cmp_gt_u32 vcc,s50,v16
v_subrev_u32 v16,s50,v16
v_lshlrev_b32 v19,1,v16
v_cndmask_b32 v18,v17,v18,vcc
v_cmp_gt_u32 vcc,s51,v16
v_subrev_u32 v16,s51,v16
v_lshlrev_b32 v20,1,v16
v_cndmask_b32 v19,v17,v19,vcc
v_cmp_gt_u32 vcc,s51,v16
v_mov_b32 v24,0
s_nop 0
v_cndmask_b32 v20,v17,v20,vcc
s_lshl_b32 s48,s45,7
s_cmp_eq_u32 s46,0
s_cselect_b32 s50,4096,0
s_add_u32 s48,s48,s50
s_lshl_b32 s49,s47,1
s_mov_b32 s53,1024
g2_rcs:
buffer_load_ushort v21,v18,s[20:23],s48 offen
buffer_load_ushort v22,v19,s[24:27],s49 offen
buffer_load_ushort v23,v20,s[28:31],s49 offen
s_add_u32 s48,s48,6144
s_add_u32 s49,s49,7168
s_waitcnt vmcnt(0)
v_or3_b32 v21,v21,v22,v23
v_lshlrev_b32 v21,16,v21
v_add_f32 v24,v24,v21
s_sub_u32 s53,s53,1
s_cmp_lg_u32 s53,0
s_cbranch_scc1 g2_rcs
s_lshl_b32 s50,s40,8
s_add_u32 s50,s50,147456
v_lshl_add_u32 v16,v0,2,s50
ds_write_b32 v16,v24
s_branch g2_rjoin
g2_rok:
v_lshlrev_b32 v24,5,v0
buffer_load_dwordx4 v[16:19],v24,s[36:39],s98 offen sc1
buffer_load_dwordx4 v[20:23],v24,s[36:39],s98 offen offset:16 sc1
v_lshrrev_b32 v25,5,v0
v_mul_u32_u24 v25,8064,v25
v_lshl_add_u32 v25,v0,2,v25
s_lshl_b32 s50,s40,8
s_add_u32 m0,s50,149504
s_lshr_b32 s50,s50,1
s_lshl_b32 s51,s43,10
s_add_u32 s50,s50,s51
s_add_u32 s50,s50,42991616
buffer_load_dword v25,s[36:39],s50 offen sc1 lds
s_waitcnt vmcnt(0)
v_add_f32 v16,v16,v20
v_add_f32 v17,v17,v21
v_add_f32 v18,v18,v22
v_add_f32 v19,v19,v23
v_add_f32 v16,v16,v17
v_add_f32 v18,v18,v19
v_add_f32 v16,v16,v18
s_lshl_b32 s50,s40,8
s_add_u32 s50,s50,147456
v_lshl_add_u32 v24,v0,2,s50
ds_write_b32 v24,v16
g2_rjoin:
s_waitcnt lgkmcnt(0)
s_barrier
s_cmp_eq_u32 s99,0
s_cbranch_scc1 g2_rj0
s_cmp_eq_u32 s99,1
s_cbranch_scc1 g2_rj1
s_cmp_eq_u32 s99,2
s_cbranch_scc1 g2_rj2
s_branch g2_rd3
g2_rj0:
s_branch g2_rd0
g2_rj1:
s_branch g2_rd1
g2_rj2:
s_branch g2_rd2
g2_exit:
s_endpgm
m_help:
s_setprio 0
s_mov_b32 s100,-1
m_hnext:
s_waitcnt vmcnt(0) lgkmcnt(0)
s_barrier
s_add_u32 s100,s100,1
s_mov_b32 s2,s100
v_mbcnt_lo_u32_b32 v0,-1,0
v_mbcnt_hi_u32_b32 v0,-1,v0
s_cmp_ge_u32 s100,256
s_cbranch_scc1 m_self
s_lshl_b32 s50,s40,6
v_add_u32 v0,s50,v0
s_branch g2_re
m_self:
s_mov_b32 s2,s101
s_mov_b32 s62,2
v_lshlrev_b32 v12,2,v0
v_add_u32 v12,161792,v12
v_mov_b32 v13,0
ds_write_b32 v12,v13
s_waitcnt lgkmcnt(0)
s_barrier
s_branch af_entry
.p2align 6
af_entry:
s_lshr_b32 s44,s2,3
s_and_b32 s44,s44,3
s_and_b32 s46,s2,7
s_lshl_b32 s46,s46,2
s_add_u32 s46,s46,s44
s_bfe_u32 s41,s2,0x20001
s_lshl_b32 s41,s41,2
s_add_u32 s41,s41,s44
v_lshlrev_b32 v1,4,v0
s_and_b32 s47,s40,3
s_lshl_b32 s49,s47,13
s_lshl_b32 s48,s46,17
s_and_b32 s43,s49,8192
s_add_u32 s48,s48,s43
s_cmp_ge_u32 s47,2
s_cselect_b32 s43,8388608,0
s_max_u32 s43,s43,4194304
s_add_u32 s48,s48,s43
s_and_b32 s60,s48,0xfffe0000
s_lshr_b32 s43,s2,5
s_lshl_b32 s43,s43,14
s_add_u32 s48,s48,s43
s_and_b32 s42,s2,1
s_lshl_b32 s42,s42,3
s_lshr_b32 s43,s2,5
s_xor_b32 s43,s43,0
s_add_u32 s42,s42,s43
s_cmp_ge_u32 s40,4
s_cbranch_scc1 af_gemm
s_setprio 1
s_lshr_b32 s58,s2,5
s_xor_b32 s58,s58,0
s_lshl_b32 s51,s58,2
s_add_u32 s51,s51,s40
s_lshl_b32 s51,s51,1
s_lshl_b32 s43,s51,11
s_lshl_b32 s44,s46,17
s_add_u32 s43,s43,s44
s_waitcnt lgkmcnt(0)
s_mov_b32 s32,s12
s_and_b32 s33,s13,0xffff
s_mov_b32 s34,268435456
s_mov_b32 s35,0x00020000
s_waitcnt vmcnt(0)
v_mov_b32 v6,161792
v_mov_b32 v7,1
s_mov_b64 exec,1
ds_add_rtn_u32 v7,v6,v7 offset:52
s_mov_b64 exec,-1
s_and_b32 s55,s2,0xe0
s_lshl_b32 s55,s55,7
s_add_u32 s55,s55,s46
s_lshl_b32 s55,s55,2
s_add_u32 s55,s55,41943040
s_waitcnt lgkmcnt(0)
v_readfirstlane_b32 s56,v7
v_lshlrev_b32 v7,9,v0
s_cmp_lg_u32 s56,7
s_cbranch_scc1 af_nh0
s_mov_b32 exec_hi,0
buffer_store_dword v6,v7,s[32:35],s55 offen sc1
s_mov_b32 exec_hi,-1
af_nh0:
s_cmp_lg_u32 s100,-1
s_cbranch_scc1 af_qok
s_lshr_b32 s55,s46,1
s_lshl_b32 s55,s55,3
s_lshr_b32 s56,s2,5
s_add_u32 s55,s55,s56
s_lshl_b32 s55,s55,1
s_and_b32 s56,s46,1
s_add_u32 s55,s55,s56
s_lshl_b32 s55,s55,9
s_add_u32 s55,s55,42074112
s_xor_b32 s56,s56,1
s_lshl_b32 s56,s56,2
s_add_u32 s55,s55,s56
s_lshl_b32 s56,s58,3
s_add_u32 s55,s55,s56
v_mov_b32 v6,161792
s_mov_b32 s45,3000
af_qpoll:
buffer_load_dword v5,off,s[32:35],s55 sc1
s_waitcnt vmcnt(0)
v_readfirstlane_b32 s56,v5
s_nop 0
s_cmp_eq_u32 s56,0
s_cbranch_scc1 af_qwait
af_qown:
af_qspin:
ds_read_b32 v7,v6 offset:48
s_waitcnt lgkmcnt(0)
v_readfirstlane_b32 s44,v7
s_nop 0
s_cmp_lt_u32 s44,8
s_cbranch_scc1 af_qspin
af_qok:
s_add_u32 m0,s49,0
s_nop 0
buffer_load_dwordx4 v1,s[32:35],s48 offen offset:0 sc1 lds
buffer_load_dwordx4 v1,s[32:35],s48 offen offset:1024 sc1 lds
buffer_load_dwordx4 v[8:11],v1,s[32:35],s43 offen offset:0 sc1
buffer_load_dwordx4 v[12:15],v1,s[32:35],s43 offen offset:1024 sc1
buffer_load_dwordx4 v[16:19],v1,s[32:35],s43 offen offset:2048 sc1
buffer_load_dwordx4 v[20:23],v1,s[32:35],s43 offen offset:3072 sc1
buffer_load_dwordx4 v1,s[32:35],s48 offen offset:2048 sc1 lds
buffer_load_dwordx4 v1,s[32:35],s48 offen offset:3072 sc1 lds
s_add_u32 s48,s48,4096
s_add_u32 m0,s49,4096
s_nop 0
buffer_load_dwordx4 v1,s[32:35],s48 offen offset:0 sc1 lds
buffer_load_dwordx4 v1,s[32:35],s48 offen offset:1024 sc1 lds
buffer_load_dwordx4 v1,s[32:35],s48 offen offset:2048 sc1 lds
buffer_load_dwordx4 v1,s[32:35],s48 offen offset:3072 sc1 lds
s_add_u32 s48,s48,12288
s_and_b32 s48,s48,0x1ffff
s_or_b32 s48,s48,s60
s_mov_b32 s16,s4
s_and_b32 s17,s5,0xffff
s_mov_b32 s18,4194304
s_mov_b32 s19,0x00020000
s_mov_b32 s28,s10
s_and_b32 s29,s11,0xffff
s_mov_b32 s30,4194304
s_mov_b32 s31,0x00020000
v_bfe_u32 v4,v0,4,1
v_mul_u32_u24 v4,147456,v4
v_lshrrev_b32 v5,5,v0
v_lshl_add_u32 v4,v5,8,v4
v_and_b32 v5,15,v0
v_lshl_add_u32 v2,v5,4,v4
v_and_b32 v4,3,v0
v_cmp_eq_u32 vcc,0,v4
v_mov_b32 v4,0x3f803f80
v_mov_b32 v60,0xdddd
v_cndmask_b32 v56,0,v4,vcc
v_cndmask_b32 v57,0,v4,vcc
v_cndmask_b32 v58,0,v4,vcc
v_cndmask_b32 v59,0,v4,vcc
v_and_b32 v4,31,v0
v_lshlrev_b32 v4,11,v4
v_lshrrev_b32 v5,5,v0
v_lshl_add_u32 v3,v5,4,v4
s_lshl_b32 s50,s41,18
s_lshl_b32 s43,s40,16
s_add_u32 s50,s50,s43
s_lshl_b32 s43,s42,7
s_add_u32 s50,s50,s43
v_mov_b32 v144,0
v_mov_b32 v145,0
v_mov_b32 v146,0
v_mov_b32 v147,0
v_mov_b32 v148,0
v_mov_b32 v149,0
v_mov_b32 v150,0
v_mov_b32 v151,0
v_mov_b32 v152,0
v_mov_b32 v153,0
v_mov_b32 v154,0
v_mov_b32 v155,0
v_mov_b32 v156,0
v_mov_b32 v157,0
v_mov_b32 v158,0
v_mov_b32 v159,0
v_mov_b32 v48,0
v_mov_b32 v49,0
v_mov_b32 v50,0
v_mov_b32 v51,0
v_mov_b32 v52,0
v_mov_b32 v53,0
v_mov_b32 v54,0
v_mov_b32 v55,0
v_mov_b32 v6,161792
v_mov_b32 v7,1
s_mov_b64 exec,1
s_waitcnt vmcnt(0)
ds_add_u32 v6,v7 offset:60
s_mov_b64 exec,-1
af_p:
ds_read_b32 v7,v6 offset:60
s_waitcnt lgkmcnt(0)
v_readfirstlane_b32 s44,v7
s_nop 0
s_cmp_lt_u32 s44,4
s_cbranch_scc1 af_p
ds_read_b128 v[24:27],v1 offset:0
ds_read_b128 v[28:31],v1 offset:1024
ds_read_b128 v[40:43],v1 offset:16384
ds_read_b128 v[44:47],v1 offset:17408
buffer_load_dwordx4 v[176:179],v3,s[16:19],s50 offen offset:0
buffer_load_dwordx4 v[180:183],v3,s[16:19],s50 offen offset:32
buffer_load_dwordx4 v[184:187],v3,s[16:19],s50 offen offset:64
buffer_load_dwordx4 v[188:191],v3,s[16:19],s50 offen offset:96
v_mov_b32 v96,0
v_mov_b32 v97,0
v_mov_b32 v98,0
v_mov_b32 v99,0
v_mov_b32 v100,0
v_mov_b32 v101,0
v_mov_b32 v102,0
v_mov_b32 v103,0
v_mov_b32 v104,0
v_mov_b32 v105,0
v_mov_b32 v106,0
v_mov_b32 v107,0
v_mov_b32 v108,0
v_mov_b32 v109,0
v_mov_b32 v110,0
v_mov_b32 v111,0
v_mov_b32 v112,0
v_mov_b32 v113,0
v_mov_b32 v114,0
v_mov_b32 v115,0
v_mov_b32 v116,0
v_mov_b32 v117,0
v_mov_b32 v118,0
v_mov_b32 v119,0
v_mov_b32 v120,0
v_mov_b32 v121,0
v_mov_b32 v122,0
v_mov_b32 v123,0
v_mov_b32 v124,0
v_mov_b32 v125,0
v_mov_b32 v126,0
v_mov_b32 v127,0
s_waitcnt lgkmcnt(2)
v_mfma_f32_16x16x32_bf16 v[64:67],v[24:27],v[8:11],0
v_mfma_f32_16x16x32_bf16 v[68:71],v[28:31],v[8:11],0
v_mfma_f32_16x16x32_bf16 v[72:75],v[24:27],v[12:15],0
v_mfma_f32_16x16x32_bf16 v[76:79],v[28:31],v[12:15],0
v_mfma_f32_16x16x32_bf16 v[80:83],v[24:27],v[16:19],0
v_mfma_f32_16x16x32_bf16 v[84:87],v[28:31],v[16:19],0
v_mfma_f32_16x16x32_bf16 v[88:91],v[24:27],v[20:23],0
v_mfma_f32_16x16x32_bf16 v[92:95],v[28:31],v[20:23],0
s_nop 1
v_max3_f32 v128,v64,v65,v66
v_max3_f32 v128,v128,v67,v68
v_max3_f32 v128,v128,v69,v70
v_max_f32 v128,v128,v71
v_max3_f32 v132,v72,v73,v74
v_max3_f32 v132,v132,v75,v76
v_max3_f32 v132,v132,v77,v78
v_max_f32 v132,v132,v79
v_max3_f32 v136,v80,v81,v82
v_max3_f32 v136,v136,v83,v84
v_max3_f32 v136,v136,v85,v86
v_max_f32 v136,v136,v87
v_max3_f32 v140,v88,v89,v90
v_max3_f32 v140,v140,v91,v92
v_max3_f32 v140,v140,v93,v94
v_max_f32 v140,v140,v95
v_mov_b32 v129,v128
v_mov_b32 v133,v132
v_mov_b32 v137,v136
v_mov_b32 v141,v140
s_nop 1
v_permlane32_swap_b32 v128,v129
v_permlane32_swap_b32 v132,v133
v_permlane32_swap_b32 v136,v137
v_permlane32_swap_b32 v140,v141
s_nop 0
v_max_f32 v128,v128,v129
v_max_f32 v132,v132,v133
v_max_f32 v136,v136,v137
v_max_f32 v140,v140,v141
v_mov_b32 v129,v128
v_mov_b32 v133,v132
v_mov_b32 v137,v136
v_mov_b32 v141,v140
s_nop 1
v_permlane16_swap_b32 v128,v129
v_permlane16_swap_b32 v132,v133
v_permlane16_swap_b32 v136,v137
v_permlane16_swap_b32 v140,v141
s_nop 0
v_max_f32 v128,v128,v129
v_max_f32 v132,v132,v133
v_max_f32 v136,v136,v137
v_max_f32 v140,v140,v141
v_sub_f32 v131,0,v128
v_sub_f32 v135,0,v132
v_sub_f32 v139,0,v136
v_sub_f32 v143,0,v140
v_sub_f32 v130,0,v128
v_sub_f32 v134,0,v132
v_sub_f32 v138,0,v136
v_sub_f32 v142,0,v140
v_sub_f32 v129,0,v128
v_sub_f32 v133,0,v132
v_sub_f32 v137,0,v136
v_sub_f32 v141,0,v140
v_sub_f32 v128,0,v128
v_sub_f32 v132,0,v132
v_sub_f32 v136,0,v136
v_sub_f32 v140,0,v140
v_add_f32 v64,v64,v128
v_add_f32 v65,v65,v128
v_add_f32 v66,v66,v128
v_add_f32 v67,v67,v128
v_add_f32 v68,v68,v128
v_add_f32 v69,v69,v128
v_add_f32 v70,v70,v128
v_add_f32 v71,v71,v128
v_add_f32 v72,v72,v132
v_add_f32 v73,v73,v132
v_add_f32 v74,v74,v132
v_add_f32 v75,v75,v132
v_add_f32 v76,v76,v132
v_add_f32 v77,v77,v132
v_add_f32 v78,v78,v132
v_add_f32 v79,v79,v132
v_mov_b32 v88,0
v_mov_b32 v89,0
v_mov_b32 v90,0
v_mov_b32 v91,0
v_mov_b32 v92,0
v_mov_b32 v93,0
v_mov_b32 v94,0
v_mov_b32 v95,0
s_mov_b32 s45,4
s_waitcnt lgkmcnt(0)
.p2align 6
af_aloop:
v_mfma_f32_16x16x32_bf16 v[80:83],v[24:27],v[16:19],v[136:139]
ds_read_b128 v[32:35],v1 offset:2048
ds_read_b128 v[36:39],v1 offset:3072
v_exp_f32 v64,v64
v_mfma_f32_16x16x32_bf16 v[84:87],v[28:31],v[16:19],v[136:139]
v_exp_f32 v65,v65
v_exp_f32 v66,v66
v_smfmac_f32_16x16x64_bf16 v[120:123],v[48:51],v[88:95],v60
v_exp_f32 v67,v67
v_exp_f32 v68,v68
v_smfmac_f32_16x16x64_bf16 v[124:127],v[52:55],v[88:95],v60
v_exp_f32 v69,v69
v_exp_f32 v70,v70
v_smfmac_f32_16x16x64_bf16 v[156:159],v[56:59],v[88:95],v60
v_exp_f32 v71,v71
v_mfma_f32_16x16x32_bf16 v[88:91],v[24:27],v[20:23],v[140:143]
ds_read_b128 v[48:51],v1 offset:18432
ds_read_b128 v[52:55],v1 offset:19456
v_exp_f32 v72,v72
v_mfma_f32_16x16x32_bf16 v[92:95],v[28:31],v[20:23],v[140:143]
v_exp_f32 v73,v73
v_exp_f32 v74,v74
v_smfmac_f32_16x16x64_bf16 v[96:99],v[40:43],v[64:71],v60
v_exp_f32 v75,v75
v_exp_f32 v76,v76
v_smfmac_f32_16x16x64_bf16 v[100:103],v[44:47],v[64:71],v60
v_exp_f32 v77,v77
v_exp_f32 v78,v78
v_smfmac_f32_16x16x64_bf16 v[144:147],v[56:59],v[64:71],v60
v_exp_f32 v79,v79
s_waitcnt lgkmcnt(0)
v_mfma_f32_16x16x32_bf16 v[64:67],v[32:35],v[8:11],v[128:131]
v_exp_f32 v80,v80
v_mfma_f32_16x16x32_bf16 v[68:71],v[36:39],v[8:11],v[128:131]
v_exp_f32 v81,v81
v_exp_f32 v82,v82
v_smfmac_f32_16x16x64_bf16 v[104:107],v[40:43],v[72:79],v60
v_exp_f32 v83,v83
v_exp_f32 v84,v84
v_smfmac_f32_16x16x64_bf16 v[108:111],v[44:47],v[72:79],v60
v_exp_f32 v85,v85
v_exp_f32 v86,v86
v_smfmac_f32_16x16x64_bf16 v[148:151],v[56:59],v[72:79],v60
v_exp_f32 v87,v87
v_mfma_f32_16x16x32_bf16 v[72:75],v[32:35],v[12:15],v[132:135]
v_exp_f32 v88,v88
v_mfma_f32_16x16x32_bf16 v[76:79],v[36:39],v[12:15],v[132:135]
v_exp_f32 v89,v89
v_exp_f32 v90,v90
v_smfmac_f32_16x16x64_bf16 v[112:115],v[40:43],v[80:87],v60
v_exp_f32 v91,v91
v_exp_f32 v92,v92
v_smfmac_f32_16x16x64_bf16 v[116:119],v[44:47],v[80:87],v60
v_exp_f32 v93,v93
v_exp_f32 v94,v94
v_smfmac_f32_16x16x64_bf16 v[152:155],v[56:59],v[80:87],v60
v_exp_f32 v95,v95
v_mfma_f32_16x16x32_bf16 v[80:83],v[32:35],v[16:19],v[136:139]
ds_read_b128 v[24:27],v1 offset:4096
ds_read_b128 v[28:31],v1 offset:5120
v_exp_f32 v64,v64
v_mfma_f32_16x16x32_bf16 v[84:87],v[36:39],v[16:19],v[136:139]
v_exp_f32 v65,v65
v_exp_f32 v66,v66
v_smfmac_f32_16x16x64_bf16 v[120:123],v[40:43],v[88:95],v60
v_exp_f32 v67,v67
v_exp_f32 v68,v68
v_smfmac_f32_16x16x64_bf16 v[124:127],v[44:47],v[88:95],v60
v_exp_f32 v69,v69
v_exp_f32 v70,v70
v_smfmac_f32_16x16x64_bf16 v[156:159],v[56:59],v[88:95],v60
v_exp_f32 v71,v71
v_mfma_f32_16x16x32_bf16 v[88:91],v[32:35],v[20:23],v[140:143]
ds_read_b128 v[40:43],v1 offset:20480
ds_read_b128 v[44:47],v1 offset:21504
v_exp_f32 v72,v72
v_mfma_f32_16x16x32_bf16 v[92:95],v[36:39],v[20:23],v[140:143]
v_exp_f32 v73,v73
v_exp_f32 v74,v74
v_smfmac_f32_16x16x64_bf16 v[96:99],v[48:51],v[64:71],v60
v_exp_f32 v75,v75
v_exp_f32 v76,v76
v_smfmac_f32_16x16x64_bf16 v[100:103],v[52:55],v[64:71],v60
v_exp_f32 v77,v77
v_exp_f32 v78,v78
v_smfmac_f32_16x16x64_bf16 v[144:147],v[56:59],v[64:71],v60
v_exp_f32 v79,v79
s_waitcnt lgkmcnt(0)
v_mfma_f32_16x16x32_bf16 v[64:67],v[24:27],v[8:11],v[128:131]
v_exp_f32 v80,v80
v_mfma_f32_16x16x32_bf16 v[68:71],v[28:31],v[8:11],v[128:131]
v_exp_f32 v81,v81
v_exp_f32 v82,v82
v_smfmac_f32_16x16x64_bf16 v[104:107],v[48:51],v[72:79],v60
v_exp_f32 v83,v83
v_exp_f32 v84,v84
v_smfmac_f32_16x16x64_bf16 v[108:111],v[52:55],v[72:79],v60
v_exp_f32 v85,v85
v_exp_f32 v86,v86
v_smfmac_f32_16x16x64_bf16 v[148:151],v[56:59],v[72:79],v60
v_exp_f32 v87,v87
v_mfma_f32_16x16x32_bf16 v[72:75],v[24:27],v[12:15],v[132:135]
v_exp_f32 v88,v88
v_mfma_f32_16x16x32_bf16 v[76:79],v[28:31],v[12:15],v[132:135]
v_exp_f32 v89,v89
v_exp_f32 v90,v90
v_smfmac_f32_16x16x64_bf16 v[112:115],v[48:51],v[80:87],v60
v_exp_f32 v91,v91
v_exp_f32 v92,v92
v_smfmac_f32_16x16x64_bf16 v[116:119],v[52:55],v[80:87],v60
v_exp_f32 v93,v93
v_exp_f32 v94,v94
v_smfmac_f32_16x16x64_bf16 v[152:155],v[56:59],v[80:87],v60
v_exp_f32 v95,v95
v_mfma_f32_16x16x32_bf16 v[80:83],v[24:27],v[16:19],v[136:139]
ds_read_b128 v[32:35],v1 offset:6144
ds_read_b128 v[36:39],v1 offset:7168
v_exp_f32 v64,v64
v_mfma_f32_16x16x32_bf16 v[84:87],v[28:31],v[16:19],v[136:139]
v_exp_f32 v65,v65
v_exp_f32 v66,v66
v_smfmac_f32_16x16x64_bf16 v[120:123],v[48:51],v[88:95],v60
v_exp_f32 v67,v67
v_exp_f32 v68,v68
v_smfmac_f32_16x16x64_bf16 v[124:127],v[52:55],v[88:95],v60
v_exp_f32 v69,v69
v_exp_f32 v70,v70
v_smfmac_f32_16x16x64_bf16 v[156:159],v[56:59],v[88:95],v60
v_exp_f32 v71,v71
v_mfma_f32_16x16x32_bf16 v[88:91],v[24:27],v[20:23],v[140:143]
ds_read_b128 v[48:51],v1 offset:22528
ds_read_b128 v[52:55],v1 offset:23552
v_exp_f32 v72,v72
v_mfma_f32_16x16x32_bf16 v[92:95],v[28:31],v[20:23],v[140:143]
v_exp_f32 v73,v73
v_exp_f32 v74,v74
v_smfmac_f32_16x16x64_bf16 v[96:99],v[40:43],v[64:71],v60
v_exp_f32 v75,v75
v_exp_f32 v76,v76
v_smfmac_f32_16x16x64_bf16 v[100:103],v[44:47],v[64:71],v60
v_exp_f32 v77,v77
v_exp_f32 v78,v78
v_smfmac_f32_16x16x64_bf16 v[144:147],v[56:59],v[64:71],v60
v_exp_f32 v79,v79
s_waitcnt lgkmcnt(0)
v_mfma_f32_16x16x32_bf16 v[64:67],v[32:35],v[8:11],v[128:131]
v_exp_f32 v80,v80
v_mfma_f32_16x16x32_bf16 v[68:71],v[36:39],v[8:11],v[128:131]
v_exp_f32 v81,v81
v_exp_f32 v82,v82
v_smfmac_f32_16x16x64_bf16 v[104:107],v[40:43],v[72:79],v60
v_exp_f32 v83,v83
v_exp_f32 v84,v84
v_smfmac_f32_16x16x64_bf16 v[108:111],v[44:47],v[72:79],v60
v_exp_f32 v85,v85
v_exp_f32 v86,v86
v_smfmac_f32_16x16x64_bf16 v[148:151],v[56:59],v[72:79],v60
v_exp_f32 v87,v87
v_mfma_f32_16x16x32_bf16 v[72:75],v[32:35],v[12:15],v[132:135]
v_exp_f32 v88,v88
v_mfma_f32_16x16x32_bf16 v[76:79],v[36:39],v[12:15],v[132:135]
v_exp_f32 v89,v89
v_exp_f32 v90,v90
v_smfmac_f32_16x16x64_bf16 v[112:115],v[40:43],v[80:87],v60
v_exp_f32 v91,v91
v_exp_f32 v92,v92
v_smfmac_f32_16x16x64_bf16 v[116:119],v[44:47],v[80:87],v60
v_exp_f32 v93,v93
v_exp_f32 v94,v94
v_smfmac_f32_16x16x64_bf16 v[152:155],v[56:59],v[80:87],v60
v_exp_f32 v95,v95
v_mfma_f32_16x16x32_bf16 v[80:83],v[32:35],v[16:19],v[136:139]
ds_read_b128 v[24:27],v1 offset:8192
ds_read_b128 v[28:31],v1 offset:9216
v_exp_f32 v64,v64
v_mfma_f32_16x16x32_bf16 v[84:87],v[36:39],v[16:19],v[136:139]
v_exp_f32 v65,v65
v_exp_f32 v66,v66
v_smfmac_f32_16x16x64_bf16 v[120:123],v[40:43],v[88:95],v60
v_exp_f32 v67,v67
v_exp_f32 v68,v68
v_smfmac_f32_16x16x64_bf16 v[124:127],v[44:47],v[88:95],v60
v_exp_f32 v69,v69
v_exp_f32 v70,v70
v_smfmac_f32_16x16x64_bf16 v[156:159],v[56:59],v[88:95],v60
v_exp_f32 v71,v71
v_mfma_f32_16x16x32_bf16 v[88:91],v[32:35],v[20:23],v[140:143]
ds_read_b128 v[40:43],v1 offset:24576
ds_read_b128 v[44:47],v1 offset:25600
v_exp_f32 v72,v72
v_mfma_f32_16x16x32_bf16 v[92:95],v[36:39],v[20:23],v[140:143]
v_exp_f32 v73,v73
v_exp_f32 v74,v74
v_smfmac_f32_16x16x64_bf16 v[96:99],v[48:51],v[64:71],v60
v_exp_f32 v75,v75
v_exp_f32 v76,v76
v_smfmac_f32_16x16x64_bf16 v[100:103],v[52:55],v[64:71],v60
v_exp_f32 v77,v77
v_exp_f32 v78,v78
v_smfmac_f32_16x16x64_bf16 v[144:147],v[56:59],v[64:71],v60
v_exp_f32 v79,v79
s_waitcnt lgkmcnt(0)
v_mfma_f32_16x16x32_bf16 v[64:67],v[24:27],v[8:11],v[128:131]
v_exp_f32 v80,v80
v_mfma_f32_16x16x32_bf16 v[68:71],v[28:31],v[8:11],v[128:131]
v_exp_f32 v81,v81
v_exp_f32 v82,v82
v_smfmac_f32_16x16x64_bf16 v[104:107],v[48:51],v[72:79],v60
v_exp_f32 v83,v83
v_exp_f32 v84,v84
v_smfmac_f32_16x16x64_bf16 v[108:111],v[52:55],v[72:79],v60
v_exp_f32 v85,v85
v_exp_f32 v86,v86
v_smfmac_f32_16x16x64_bf16 v[148:151],v[56:59],v[72:79],v60
v_exp_f32 v87,v87
v_mfma_f32_16x16x32_bf16 v[72:75],v[24:27],v[12:15],v[132:135]
v_exp_f32 v88,v88
v_mfma_f32_16x16x32_bf16 v[76:79],v[28:31],v[12:15],v[132:135]
v_exp_f32 v89,v89
v_exp_f32 v90,v90
v_smfmac_f32_16x16x64_bf16 v[112:115],v[48:51],v[80:87],v60
v_exp_f32 v91,v91
v_exp_f32 v92,v92
v_smfmac_f32_16x16x64_bf16 v[116:119],v[52:55],v[80:87],v60
v_exp_f32 v93,v93
v_exp_f32 v94,v94
v_smfmac_f32_16x16x64_bf16 v[152:155],v[56:59],v[80:87],v60
v_exp_f32 v95,v95
v_mfma_f32_16x16x32_bf16 v[80:83],v[24:27],v[16:19],v[136:139]
ds_read_b128 v[32:35],v1 offset:10240
ds_read_b128 v[36:39],v1 offset:11264
v_exp_f32 v64,v64
v_mfma_f32_16x16x32_bf16 v[84:87],v[28:31],v[16:19],v[136:139]
v_exp_f32 v65,v65
v_exp_f32 v66,v66
v_smfmac_f32_16x16x64_bf16 v[120:123],v[48:51],v[88:95],v60
v_exp_f32 v67,v67
v_exp_f32 v68,v68
v_smfmac_f32_16x16x64_bf16 v[124:127],v[52:55],v[88:95],v60
v_exp_f32 v69,v69
v_exp_f32 v70,v70
v_smfmac_f32_16x16x64_bf16 v[156:159],v[56:59],v[88:95],v60
v_exp_f32 v71,v71
v_mfma_f32_16x16x32_bf16 v[88:91],v[24:27],v[20:23],v[140:143]
ds_read_b128 v[48:51],v1 offset:26624
ds_read_b128 v[52:55],v1 offset:27648
v_exp_f32 v72,v72
v_mfma_f32_16x16x32_bf16 v[92:95],v[28:31],v[20:23],v[140:143]
v_exp_f32 v73,v73
v_exp_f32 v74,v74
v_smfmac_f32_16x16x64_bf16 v[96:99],v[40:43],v[64:71],v60
v_exp_f32 v75,v75
v_exp_f32 v76,v76
v_smfmac_f32_16x16x64_bf16 v[100:103],v[44:47],v[64:71],v60
v_exp_f32 v77,v77
v_exp_f32 v78,v78
v_smfmac_f32_16x16x64_bf16 v[144:147],v[56:59],v[64:71],v60
v_exp_f32 v79,v79
s_waitcnt lgkmcnt(0)
v_mfma_f32_16x16x32_bf16 v[64:67],v[32:35],v[8:11],v[128:131]
v_exp_f32 v80,v80
v_mfma_f32_16x16x32_bf16 v[68:71],v[36:39],v[8:11],v[128:131]
v_exp_f32 v81,v81
v_exp_f32 v82,v82
v_smfmac_f32_16x16x64_bf16 v[104:107],v[40:43],v[72:79],v60
v_exp_f32 v83,v83
v_exp_f32 v84,v84
v_smfmac_f32_16x16x64_bf16 v[108:111],v[44:47],v[72:79],v60
v_exp_f32 v85,v85
v_exp_f32 v86,v86
v_smfmac_f32_16x16x64_bf16 v[148:151],v[56:59],v[72:79],v60
v_exp_f32 v87,v87
v_mfma_f32_16x16x32_bf16 v[72:75],v[32:35],v[12:15],v[132:135]
v_exp_f32 v88,v88
v_mfma_f32_16x16x32_bf16 v[76:79],v[36:39],v[12:15],v[132:135]
v_exp_f32 v89,v89
v_exp_f32 v90,v90
v_smfmac_f32_16x16x64_bf16 v[112:115],v[40:43],v[80:87],v60
v_exp_f32 v91,v91
v_exp_f32 v92,v92
v_smfmac_f32_16x16x64_bf16 v[116:119],v[44:47],v[80:87],v60
v_exp_f32 v93,v93
v_exp_f32 v94,v94
v_smfmac_f32_16x16x64_bf16 v[152:155],v[56:59],v[80:87],v60
v_exp_f32 v95,v95
v_mfma_f32_16x16x32_bf16 v[80:83],v[32:35],v[16:19],v[136:139]
ds_read_b128 v[24:27],v1 offset:12288
ds_read_b128 v[28:31],v1 offset:13312
v_exp_f32 v64,v64
v_mfma_f32_16x16x32_bf16 v[84:87],v[36:39],v[16:19],v[136:139]
v_exp_f32 v65,v65
v_exp_f32 v66,v66
v_smfmac_f32_16x16x64_bf16 v[120:123],v[40:43],v[88:95],v60
v_exp_f32 v67,v67
v_exp_f32 v68,v68
v_smfmac_f32_16x16x64_bf16 v[124:127],v[44:47],v[88:95],v60
v_exp_f32 v69,v69
v_exp_f32 v70,v70
v_smfmac_f32_16x16x64_bf16 v[156:159],v[56:59],v[88:95],v60
v_exp_f32 v71,v71
v_mfma_f32_16x16x32_bf16 v[88:91],v[32:35],v[20:23],v[140:143]
ds_read_b128 v[40:43],v1 offset:28672
ds_read_b128 v[44:47],v1 offset:29696
v_exp_f32 v72,v72
v_mfma_f32_16x16x32_bf16 v[92:95],v[36:39],v[20:23],v[140:143]
v_exp_f32 v73,v73
v_exp_f32 v74,v74
v_smfmac_f32_16x16x64_bf16 v[96:99],v[48:51],v[64:71],v60
v_exp_f32 v75,v75
v_exp_f32 v76,v76
v_smfmac_f32_16x16x64_bf16 v[100:103],v[52:55],v[64:71],v60
v_exp_f32 v77,v77
v_exp_f32 v78,v78
v_smfmac_f32_16x16x64_bf16 v[144:147],v[56:59],v[64:71],v60
v_exp_f32 v79,v79
s_waitcnt lgkmcnt(0)
v_mfma_f32_16x16x32_bf16 v[64:67],v[24:27],v[8:11],v[128:131]
v_exp_f32 v80,v80
v_mfma_f32_16x16x32_bf16 v[68:71],v[28:31],v[8:11],v[128:131]
v_exp_f32 v81,v81
v_exp_f32 v82,v82
v_smfmac_f32_16x16x64_bf16 v[104:107],v[48:51],v[72:79],v60
v_exp_f32 v83,v83
v_exp_f32 v84,v84
v_smfmac_f32_16x16x64_bf16 v[108:111],v[52:55],v[72:79],v60
v_exp_f32 v85,v85
v_exp_f32 v86,v86
v_smfmac_f32_16x16x64_bf16 v[148:151],v[56:59],v[72:79],v60
v_exp_f32 v87,v87
v_mfma_f32_16x16x32_bf16 v[72:75],v[24:27],v[12:15],v[132:135]
v_exp_f32 v88,v88
v_mfma_f32_16x16x32_bf16 v[76:79],v[28:31],v[12:15],v[132:135]
v_exp_f32 v89,v89
v_exp_f32 v90,v90
v_smfmac_f32_16x16x64_bf16 v[112:115],v[48:51],v[80:87],v60
v_exp_f32 v91,v91
v_exp_f32 v92,v92
v_smfmac_f32_16x16x64_bf16 v[116:119],v[52:55],v[80:87],v60
v_exp_f32 v93,v93
v_exp_f32 v94,v94
v_smfmac_f32_16x16x64_bf16 v[152:155],v[56:59],v[80:87],v60
v_exp_f32 v95,v95
v_mfma_f32_16x16x32_bf16 v[80:83],v[24:27],v[16:19],v[136:139]
ds_read_b128 v[32:35],v1 offset:14336
ds_read_b128 v[36:39],v1 offset:15360
v_exp_f32 v64,v64
v_mfma_f32_16x16x32_bf16 v[84:87],v[28:31],v[16:19],v[136:139]
v_exp_f32 v65,v65
v_exp_f32 v66,v66
v_smfmac_f32_16x16x64_bf16 v[120:123],v[48:51],v[88:95],v60
v_exp_f32 v67,v67
v_exp_f32 v68,v68
v_smfmac_f32_16x16x64_bf16 v[124:127],v[52:55],v[88:95],v60
v_exp_f32 v69,v69
v_exp_f32 v70,v70
v_smfmac_f32_16x16x64_bf16 v[156:159],v[56:59],v[88:95],v60
v_exp_f32 v71,v71
v_mfma_f32_16x16x32_bf16 v[88:91],v[24:27],v[20:23],v[140:143]
ds_read_b128 v[48:51],v1 offset:30720
ds_read_b128 v[52:55],v1 offset:31744
v_exp_f32 v72,v72
v_mfma_f32_16x16x32_bf16 v[92:95],v[28:31],v[20:23],v[140:143]
v_exp_f32 v73,v73
v_exp_f32 v74,v74
v_smfmac_f32_16x16x64_bf16 v[96:99],v[40:43],v[64:71],v60
v_exp_f32 v75,v75
v_exp_f32 v76,v76
v_smfmac_f32_16x16x64_bf16 v[100:103],v[44:47],v[64:71],v60
v_exp_f32 v77,v77
v_exp_f32 v78,v78
v_smfmac_f32_16x16x64_bf16 v[144:147],v[56:59],v[64:71],v60
v_exp_f32 v79,v79
s_waitcnt lgkmcnt(0)
s_barrier
v_mfma_f32_16x16x32_bf16 v[64:67],v[32:35],v[8:11],v[128:131]
v_exp_f32 v80,v80
v_mfma_f32_16x16x32_bf16 v[68:71],v[36:39],v[8:11],v[128:131]
v_exp_f32 v81,v81
v_exp_f32 v82,v82
v_smfmac_f32_16x16x64_bf16 v[104:107],v[40:43],v[72:79],v60
v_exp_f32 v83,v83
v_exp_f32 v84,v84
v_smfmac_f32_16x16x64_bf16 v[108:111],v[44:47],v[72:79],v60
v_exp_f32 v85,v85
v_exp_f32 v86,v86
v_smfmac_f32_16x16x64_bf16 v[148:151],v[56:59],v[72:79],v60
v_exp_f32 v87,v87
v_mfma_f32_16x16x32_bf16 v[72:75],v[32:35],v[12:15],v[132:135]
v_exp_f32 v88,v88
v_mfma_f32_16x16x32_bf16 v[76:79],v[36:39],v[12:15],v[132:135]
v_exp_f32 v89,v89
v_exp_f32 v90,v90
v_smfmac_f32_16x16x64_bf16 v[112:115],v[40:43],v[80:87],v60
v_exp_f32 v91,v91
v_exp_f32 v92,v92
v_smfmac_f32_16x16x64_bf16 v[116:119],v[44:47],v[80:87],v60
v_exp_f32 v93,v93
v_exp_f32 v94,v94
v_smfmac_f32_16x16x64_bf16 v[152:155],v[56:59],v[80:87],v60
v_exp_f32 v95,v95
v_mfma_f32_16x16x32_bf16 v[80:83],v[32:35],v[16:19],v[136:139]
ds_read_b128 v[24:27],v1 offset:32768
ds_read_b128 v[28:31],v1 offset:33792
v_exp_f32 v64,v64
v_mfma_f32_16x16x32_bf16 v[84:87],v[36:39],v[16:19],v[136:139]
v_exp_f32 v65,v65
v_exp_f32 v66,v66
v_smfmac_f32_16x16x64_bf16 v[120:123],v[40:43],v[88:95],v60
v_exp_f32 v67,v67
v_exp_f32 v68,v68
v_smfmac_f32_16x16x64_bf16 v[124:127],v[44:47],v[88:95],v60
v_exp_f32 v69,v69
v_exp_f32 v70,v70
v_smfmac_f32_16x16x64_bf16 v[156:159],v[56:59],v[88:95],v60
v_exp_f32 v71,v71
v_mfma_f32_16x16x32_bf16 v[88:91],v[32:35],v[20:23],v[140:143]
ds_read_b128 v[40:43],v1 offset:49152
ds_read_b128 v[44:47],v1 offset:50176
v_exp_f32 v72,v72
v_mfma_f32_16x16x32_bf16 v[92:95],v[36:39],v[20:23],v[140:143]
v_exp_f32 v73,v73
v_exp_f32 v74,v74
v_smfmac_f32_16x16x64_bf16 v[96:99],v[48:51],v[64:71],v60
v_exp_f32 v75,v75
v_exp_f32 v76,v76
v_smfmac_f32_16x16x64_bf16 v[100:103],v[52:55],v[64:71],v60
v_exp_f32 v77,v77
v_exp_f32 v78,v78
v_smfmac_f32_16x16x64_bf16 v[144:147],v[56:59],v[64:71],v60
v_exp_f32 v79,v79
s_waitcnt lgkmcnt(0)
v_mfma_f32_16x16x32_bf16 v[64:67],v[24:27],v[8:11],v[128:131]
v_exp_f32 v80,v80
v_mfma_f32_16x16x32_bf16 v[68:71],v[28:31],v[8:11],v[128:131]
v_exp_f32 v81,v81
v_exp_f32 v82,v82
v_smfmac_f32_16x16x64_bf16 v[104:107],v[48:51],v[72:79],v60
v_exp_f32 v83,v83
v_exp_f32 v84,v84
v_smfmac_f32_16x16x64_bf16 v[108:111],v[52:55],v[72:79],v60
v_exp_f32 v85,v85
v_exp_f32 v86,v86
v_smfmac_f32_16x16x64_bf16 v[148:151],v[56:59],v[72:79],v60
v_exp_f32 v87,v87
v_mfma_f32_16x16x32_bf16 v[72:75],v[24:27],v[12:15],v[132:135]
v_exp_f32 v88,v88
v_mfma_f32_16x16x32_bf16 v[76:79],v[28:31],v[12:15],v[132:135]
v_exp_f32 v89,v89
v_exp_f32 v90,v90
v_smfmac_f32_16x16x64_bf16 v[112:115],v[48:51],v[80:87],v60
v_exp_f32 v91,v91
v_exp_f32 v92,v92
v_smfmac_f32_16x16x64_bf16 v[116:119],v[52:55],v[80:87],v60
v_exp_f32 v93,v93
v_exp_f32 v94,v94
v_smfmac_f32_16x16x64_bf16 v[152:155],v[56:59],v[80:87],v60
v_exp_f32 v95,v95
v_mfma_f32_16x16x32_bf16 v[80:83],v[24:27],v[16:19],v[136:139]
ds_read_b128 v[32:35],v1 offset:34816
ds_read_b128 v[36:39],v1 offset:35840
v_exp_f32 v64,v64
v_mfma_f32_16x16x32_bf16 v[84:87],v[28:31],v[16:19],v[136:139]
v_exp_f32 v65,v65
v_exp_f32 v66,v66
v_smfmac_f32_16x16x64_bf16 v[120:123],v[48:51],v[88:95],v60
v_exp_f32 v67,v67
v_exp_f32 v68,v68
v_smfmac_f32_16x16x64_bf16 v[124:127],v[52:55],v[88:95],v60
v_exp_f32 v69,v69
v_exp_f32 v70,v70
v_smfmac_f32_16x16x64_bf16 v[156:159],v[56:59],v[88:95],v60
v_exp_f32 v71,v71
v_mfma_f32_16x16x32_bf16 v[88:91],v[24:27],v[20:23],v[140:143]
ds_read_b128 v[48:51],v1 offset:51200
ds_read_b128 v[52:55],v1 offset:52224
v_exp_f32 v72,v72
v_mfma_f32_16x16x32_bf16 v[92:95],v[28:31],v[20:23],v[140:143]
v_exp_f32 v73,v73
v_exp_f32 v74,v74
v_smfmac_f32_16x16x64_bf16 v[96:99],v[40:43],v[64:71],v60
v_exp_f32 v75,v75
v_exp_f32 v76,v76
v_smfmac_f32_16x16x64_bf16 v[100:103],v[44:47],v[64:71],v60
v_exp_f32 v77,v77
v_exp_f32 v78,v78
v_smfmac_f32_16x16x64_bf16 v[144:147],v[56:59],v[64:71],v60
v_exp_f32 v79,v79
s_waitcnt lgkmcnt(0)
v_mfma_f32_16x16x32_bf16 v[64:67],v[32:35],v[8:11],v[128:131]
v_exp_f32 v80,v80
v_mfma_f32_16x16x32_bf16 v[68:71],v[36:39],v[8:11],v[128:131]
v_exp_f32 v81,v81
v_exp_f32 v82,v82
v_smfmac_f32_16x16x64_bf16 v[104:107],v[40:43],v[72:79],v60
v_exp_f32 v83,v83
v_exp_f32 v84,v84
v_smfmac_f32_16x16x64_bf16 v[108:111],v[44:47],v[72:79],v60
v_exp_f32 v85,v85
v_exp_f32 v86,v86
v_smfmac_f32_16x16x64_bf16 v[148:151],v[56:59],v[72:79],v60
v_exp_f32 v87,v87
v_mfma_f32_16x16x32_bf16 v[72:75],v[32:35],v[12:15],v[132:135]
v_exp_f32 v88,v88
v_mfma_f32_16x16x32_bf16 v[76:79],v[36:39],v[12:15],v[132:135]
v_exp_f32 v89,v89
v_exp_f32 v90,v90
v_smfmac_f32_16x16x64_bf16 v[112:115],v[40:43],v[80:87],v60
v_exp_f32 v91,v91
v_exp_f32 v92,v92
v_smfmac_f32_16x16x64_bf16 v[116:119],v[44:47],v[80:87],v60
v_exp_f32 v93,v93
v_exp_f32 v94,v94
v_smfmac_f32_16x16x64_bf16 v[152:155],v[56:59],v[80:87],v60
v_exp_f32 v95,v95
v_mfma_f32_16x16x32_bf16 v[80:83],v[32:35],v[16:19],v[136:139]
ds_read_b128 v[24:27],v1 offset:36864
ds_read_b128 v[28:31],v1 offset:37888
v_exp_f32 v64,v64
v_mfma_f32_16x16x32_bf16 v[84:87],v[36:39],v[16:19],v[136:139]
v_exp_f32 v65,v65
v_exp_f32 v66,v66
v_smfmac_f32_16x16x64_bf16 v[120:123],v[40:43],v[88:95],v60
v_exp_f32 v67,v67
v_exp_f32 v68,v68
v_smfmac_f32_16x16x64_bf16 v[124:127],v[44:47],v[88:95],v60
v_exp_f32 v69,v69
v_exp_f32 v70,v70
v_smfmac_f32_16x16x64_bf16 v[156:159],v[56:59],v[88:95],v60
v_exp_f32 v71,v71
v_mfma_f32_16x16x32_bf16 v[88:91],v[32:35],v[20:23],v[140:143]
ds_read_b128 v[40:43],v1 offset:53248
ds_read_b128 v[44:47],v1 offset:54272
v_exp_f32 v72,v72
v_mfma_f32_16x16x32_bf16 v[92:95],v[36:39],v[20:23],v[140:143]
v_exp_f32 v73,v73
v_exp_f32 v74,v74
v_smfmac_f32_16x16x64_bf16 v[96:99],v[48:51],v[64:71],v60
v_exp_f32 v75,v75
v_exp_f32 v76,v76
v_smfmac_f32_16x16x64_bf16 v[100:103],v[52:55],v[64:71],v60
v_exp_f32 v77,v77
v_exp_f32 v78,v78
v_smfmac_f32_16x16x64_bf16 v[144:147],v[56:59],v[64:71],v60
v_exp_f32 v79,v79
s_waitcnt lgkmcnt(0)
v_mfma_f32_16x16x32_bf16 v[64:67],v[24:27],v[8:11],v[128:131]
v_exp_f32 v80,v80
v_mfma_f32_16x16x32_bf16 v[68:71],v[28:31],v[8:11],v[128:131]
v_exp_f32 v81,v81
v_exp_f32 v82,v82
v_smfmac_f32_16x16x64_bf16 v[104:107],v[48:51],v[72:79],v60
v_exp_f32 v83,v83
v_exp_f32 v84,v84
v_smfmac_f32_16x16x64_bf16 v[108:111],v[52:55],v[72:79],v60
v_exp_f32 v85,v85
v_exp_f32 v86,v86
v_smfmac_f32_16x16x64_bf16 v[148:151],v[56:59],v[72:79],v60
v_exp_f32 v87,v87
v_mfma_f32_16x16x32_bf16 v[72:75],v[24:27],v[12:15],v[132:135]
v_exp_f32 v88,v88
v_mfma_f32_16x16x32_bf16 v[76:79],v[28:31],v[12:15],v[132:135]
v_exp_f32 v89,v89
v_exp_f32 v90,v90
v_smfmac_f32_16x16x64_bf16 v[112:115],v[48:51],v[80:87],v60
v_exp_f32 v91,v91
v_exp_f32 v92,v92
v_smfmac_f32_16x16x64_bf16 v[116:119],v[52:55],v[80:87],v60
v_exp_f32 v93,v93
v_exp_f32 v94,v94
v_smfmac_f32_16x16x64_bf16 v[152:155],v[56:59],v[80:87],v60
v_exp_f32 v95,v95
v_mfma_f32_16x16x32_bf16 v[80:83],v[24:27],v[16:19],v[136:139]
ds_read_b128 v[32:35],v1 offset:38912
ds_read_b128 v[36:39],v1 offset:39936
v_exp_f32 v64,v64
v_mfma_f32_16x16x32_bf16 v[84:87],v[28:31],v[16:19],v[136:139]
v_exp_f32 v65,v65
v_exp_f32 v66,v66
v_smfmac_f32_16x16x64_bf16 v[120:123],v[48:51],v[88:95],v60
v_exp_f32 v67,v67
v_exp_f32 v68,v68
v_smfmac_f32_16x16x64_bf16 v[124:127],v[52:55],v[88:95],v60
v_exp_f32 v69,v69
v_exp_f32 v70,v70
v_smfmac_f32_16x16x64_bf16 v[156:159],v[56:59],v[88:95],v60
v_exp_f32 v71,v71
v_mfma_f32_16x16x32_bf16 v[88:91],v[24:27],v[20:23],v[140:143]
ds_read_b128 v[48:51],v1 offset:55296
ds_read_b128 v[52:55],v1 offset:56320
v_exp_f32 v72,v72
v_mfma_f32_16x16x32_bf16 v[92:95],v[28:31],v[20:23],v[140:143]
v_exp_f32 v73,v73
v_exp_f32 v74,v74
v_smfmac_f32_16x16x64_bf16 v[96:99],v[40:43],v[64:71],v60
v_exp_f32 v75,v75
v_exp_f32 v76,v76
v_smfmac_f32_16x16x64_bf16 v[100:103],v[44:47],v[64:71],v60
v_exp_f32 v77,v77
v_exp_f32 v78,v78
v_smfmac_f32_16x16x64_bf16 v[144:147],v[56:59],v[64:71],v60
v_exp_f32 v79,v79
s_waitcnt lgkmcnt(0)
v_mfma_f32_16x16x32_bf16 v[64:67],v[32:35],v[8:11],v[128:131]
v_exp_f32 v80,v80
v_mfma_f32_16x16x32_bf16 v[68:71],v[36:39],v[8:11],v[128:131]
v_exp_f32 v81,v81
v_exp_f32 v82,v82
v_smfmac_f32_16x16x64_bf16 v[104:107],v[40:43],v[72:79],v60
v_exp_f32 v83,v83
v_exp_f32 v84,v84
v_smfmac_f32_16x16x64_bf16 v[108:111],v[44:47],v[72:79],v60
v_exp_f32 v85,v85
v_exp_f32 v86,v86
v_smfmac_f32_16x16x64_bf16 v[148:151],v[56:59],v[72:79],v60
v_exp_f32 v87,v87
v_mfma_f32_16x16x32_bf16 v[72:75],v[32:35],v[12:15],v[132:135]
v_exp_f32 v88,v88
v_mfma_f32_16x16x32_bf16 v[76:79],v[36:39],v[12:15],v[132:135]
v_exp_f32 v89,v89
v_exp_f32 v90,v90
v_smfmac_f32_16x16x64_bf16 v[112:115],v[40:43],v[80:87],v60
v_exp_f32 v91,v91
v_exp_f32 v92,v92
v_smfmac_f32_16x16x64_bf16 v[116:119],v[44:47],v[80:87],v60
v_exp_f32 v93,v93
v_exp_f32 v94,v94
v_smfmac_f32_16x16x64_bf16 v[152:155],v[56:59],v[80:87],v60
v_exp_f32 v95,v95
v_mfma_f32_16x16x32_bf16 v[80:83],v[32:35],v[16:19],v[136:139]
ds_read_b128 v[24:27],v1 offset:40960
ds_read_b128 v[28:31],v1 offset:41984
v_exp_f32 v64,v64
v_mfma_f32_16x16x32_bf16 v[84:87],v[36:39],v[16:19],v[136:139]
v_exp_f32 v65,v65
v_exp_f32 v66,v66
v_smfmac_f32_16x16x64_bf16 v[120:123],v[40:43],v[88:95],v60
v_exp_f32 v67,v67
v_exp_f32 v68,v68
v_smfmac_f32_16x16x64_bf16 v[124:127],v[44:47],v[88:95],v60
v_exp_f32 v69,v69
v_exp_f32 v70,v70
v_smfmac_f32_16x16x64_bf16 v[156:159],v[56:59],v[88:95],v60
v_exp_f32 v71,v71
v_mfma_f32_16x16x32_bf16 v[88:91],v[32:35],v[20:23],v[140:143]
ds_read_b128 v[40:43],v1 offset:57344
ds_read_b128 v[44:47],v1 offset:58368
v_exp_f32 v72,v72
v_mfma_f32_16x16x32_bf16 v[92:95],v[36:39],v[20:23],v[140:143]
v_exp_f32 v73,v73
v_exp_f32 v74,v74
v_smfmac_f32_16x16x64_bf16 v[96:99],v[48:51],v[64:71],v60
v_exp_f32 v75,v75
v_exp_f32 v76,v76
v_smfmac_f32_16x16x64_bf16 v[100:103],v[52:55],v[64:71],v60
v_exp_f32 v77,v77
v_exp_f32 v78,v78
v_smfmac_f32_16x16x64_bf16 v[144:147],v[56:59],v[64:71],v60
v_exp_f32 v79,v79
s_waitcnt lgkmcnt(0)
v_mfma_f32_16x16x32_bf16 v[64:67],v[24:27],v[8:11],v[128:131]
v_exp_f32 v80,v80
v_mfma_f32_16x16x32_bf16 v[68:71],v[28:31],v[8:11],v[128:131]
v_exp_f32 v81,v81
v_exp_f32 v82,v82
v_smfmac_f32_16x16x64_bf16 v[104:107],v[48:51],v[72:79],v60
v_exp_f32 v83,v83
v_exp_f32 v84,v84
v_smfmac_f32_16x16x64_bf16 v[108:111],v[52:55],v[72:79],v60
v_exp_f32 v85,v85
v_exp_f32 v86,v86
v_smfmac_f32_16x16x64_bf16 v[148:151],v[56:59],v[72:79],v60
v_exp_f32 v87,v87
v_mfma_f32_16x16x32_bf16 v[72:75],v[24:27],v[12:15],v[132:135]
v_exp_f32 v88,v88
v_mfma_f32_16x16x32_bf16 v[76:79],v[28:31],v[12:15],v[132:135]
v_exp_f32 v89,v89
v_exp_f32 v90,v90
v_smfmac_f32_16x16x64_bf16 v[112:115],v[48:51],v[80:87],v60
v_exp_f32 v91,v91
v_exp_f32 v92,v92
v_smfmac_f32_16x16x64_bf16 v[116:119],v[52:55],v[80:87],v60
v_exp_f32 v93,v93
v_exp_f32 v94,v94
v_smfmac_f32_16x16x64_bf16 v[152:155],v[56:59],v[80:87],v60
v_exp_f32 v95,v95
v_mfma_f32_16x16x32_bf16 v[80:83],v[24:27],v[16:19],v[136:139]
ds_read_b128 v[32:35],v1 offset:43008
ds_read_b128 v[36:39],v1 offset:44032
v_exp_f32 v64,v64
v_mfma_f32_16x16x32_bf16 v[84:87],v[28:31],v[16:19],v[136:139]
v_exp_f32 v65,v65
v_exp_f32 v66,v66
v_smfmac_f32_16x16x64_bf16 v[120:123],v[48:51],v[88:95],v60
v_exp_f32 v67,v67
v_exp_f32 v68,v68
v_smfmac_f32_16x16x64_bf16 v[124:127],v[52:55],v[88:95],v60
v_exp_f32 v69,v69
v_exp_f32 v70,v70
v_smfmac_f32_16x16x64_bf16 v[156:159],v[56:59],v[88:95],v60
v_exp_f32 v71,v71
v_mfma_f32_16x16x32_bf16 v[88:91],v[24:27],v[20:23],v[140:143]
ds_read_b128 v[48:51],v1 offset:59392
ds_read_b128 v[52:55],v1 offset:60416
v_exp_f32 v72,v72
v_mfma_f32_16x16x32_bf16 v[92:95],v[28:31],v[20:23],v[140:143]
v_exp_f32 v73,v73
v_exp_f32 v74,v74
v_smfmac_f32_16x16x64_bf16 v[96:99],v[40:43],v[64:71],v60
v_exp_f32 v75,v75
v_exp_f32 v76,v76
v_smfmac_f32_16x16x64_bf16 v[100:103],v[44:47],v[64:71],v60
v_exp_f32 v77,v77
v_exp_f32 v78,v78
v_smfmac_f32_16x16x64_bf16 v[144:147],v[56:59],v[64:71],v60
v_exp_f32 v79,v79
s_waitcnt lgkmcnt(0)
v_mfma_f32_16x16x32_bf16 v[64:67],v[32:35],v[8:11],v[128:131]
v_exp_f32 v80,v80
v_mfma_f32_16x16x32_bf16 v[68:71],v[36:39],v[8:11],v[128:131]
v_exp_f32 v81,v81
v_exp_f32 v82,v82
v_smfmac_f32_16x16x64_bf16 v[104:107],v[40:43],v[72:79],v60
v_exp_f32 v83,v83
v_exp_f32 v84,v84
v_smfmac_f32_16x16x64_bf16 v[108:111],v[44:47],v[72:79],v60
v_exp_f32 v85,v85
v_exp_f32 v86,v86
v_smfmac_f32_16x16x64_bf16 v[148:151],v[56:59],v[72:79],v60
v_exp_f32 v87,v87
v_mfma_f32_16x16x32_bf16 v[72:75],v[32:35],v[12:15],v[132:135]
v_exp_f32 v88,v88
v_mfma_f32_16x16x32_bf16 v[76:79],v[36:39],v[12:15],v[132:135]
v_exp_f32 v89,v89
v_exp_f32 v90,v90
v_smfmac_f32_16x16x64_bf16 v[112:115],v[40:43],v[80:87],v60
v_exp_f32 v91,v91
v_exp_f32 v92,v92
v_smfmac_f32_16x16x64_bf16 v[116:119],v[44:47],v[80:87],v60
v_exp_f32 v93,v93
v_exp_f32 v94,v94
v_smfmac_f32_16x16x64_bf16 v[152:155],v[56:59],v[80:87],v60
v_exp_f32 v95,v95
v_mfma_f32_16x16x32_bf16 v[80:83],v[32:35],v[16:19],v[136:139]
ds_read_b128 v[24:27],v1 offset:45056
ds_read_b128 v[28:31],v1 offset:46080
v_exp_f32 v64,v64
v_mfma_f32_16x16x32_bf16 v[84:87],v[36:39],v[16:19],v[136:139]
v_exp_f32 v65,v65
v_exp_f32 v66,v66
v_smfmac_f32_16x16x64_bf16 v[120:123],v[40:43],v[88:95],v60
v_exp_f32 v67,v67
v_exp_f32 v68,v68
v_smfmac_f32_16x16x64_bf16 v[124:127],v[44:47],v[88:95],v60
v_exp_f32 v69,v69
v_exp_f32 v70,v70
v_smfmac_f32_16x16x64_bf16 v[156:159],v[56:59],v[88:95],v60
v_exp_f32 v71,v71
v_mfma_f32_16x16x32_bf16 v[88:91],v[32:35],v[20:23],v[140:143]
ds_read_b128 v[40:43],v1 offset:61440
ds_read_b128 v[44:47],v1 offset:62464
v_exp_f32 v72,v72
v_mfma_f32_16x16x32_bf16 v[92:95],v[36:39],v[20:23],v[140:143]
v_exp_f32 v73,v73
v_exp_f32 v74,v74
v_smfmac_f32_16x16x64_bf16 v[96:99],v[48:51],v[64:71],v60
v_exp_f32 v75,v75
v_exp_f32 v76,v76
v_smfmac_f32_16x16x64_bf16 v[100:103],v[52:55],v[64:71],v60
v_exp_f32 v77,v77
v_exp_f32 v78,v78
v_smfmac_f32_16x16x64_bf16 v[144:147],v[56:59],v[64:71],v60
v_exp_f32 v79,v79
s_waitcnt lgkmcnt(0)
v_mfma_f32_16x16x32_bf16 v[64:67],v[24:27],v[8:11],v[128:131]
v_exp_f32 v80,v80
v_mfma_f32_16x16x32_bf16 v[68:71],v[28:31],v[8:11],v[128:131]
v_exp_f32 v81,v81
v_exp_f32 v82,v82
v_smfmac_f32_16x16x64_bf16 v[104:107],v[48:51],v[72:79],v60
v_exp_f32 v83,v83
v_exp_f32 v84,v84
v_smfmac_f32_16x16x64_bf16 v[108:111],v[52:55],v[72:79],v60
v_exp_f32 v85,v85
v_exp_f32 v86,v86
v_smfmac_f32_16x16x64_bf16 v[148:151],v[56:59],v[72:79],v60
v_exp_f32 v87,v87
v_mfma_f32_16x16x32_bf16 v[72:75],v[24:27],v[12:15],v[132:135]
v_exp_f32 v88,v88
v_mfma_f32_16x16x32_bf16 v[76:79],v[28:31],v[12:15],v[132:135]
v_exp_f32 v89,v89
v_exp_f32 v90,v90
v_smfmac_f32_16x16x64_bf16 v[112:115],v[48:51],v[80:87],v60
v_exp_f32 v91,v91
v_exp_f32 v92,v92
v_smfmac_f32_16x16x64_bf16 v[116:119],v[52:55],v[80:87],v60
v_exp_f32 v93,v93
v_exp_f32 v94,v94
v_smfmac_f32_16x16x64_bf16 v[152:155],v[56:59],v[80:87],v60
v_exp_f32 v95,v95
v_mfma_f32_16x16x32_bf16 v[80:83],v[24:27],v[16:19],v[136:139]
ds_read_b128 v[32:35],v1 offset:47104
ds_read_b128 v[36:39],v1 offset:48128
v_exp_f32 v64,v64
v_mfma_f32_16x16x32_bf16 v[84:87],v[28:31],v[16:19],v[136:139]
v_exp_f32 v65,v65
v_exp_f32 v66,v66
v_smfmac_f32_16x16x64_bf16 v[120:123],v[48:51],v[88:95],v60
v_exp_f32 v67,v67
v_exp_f32 v68,v68
v_smfmac_f32_16x16x64_bf16 v[124:127],v[52:55],v[88:95],v60
v_exp_f32 v69,v69
v_exp_f32 v70,v70
v_smfmac_f32_16x16x64_bf16 v[156:159],v[56:59],v[88:95],v60
v_exp_f32 v71,v71
v_mfma_f32_16x16x32_bf16 v[88:91],v[24:27],v[20:23],v[140:143]
ds_read_b128 v[48:51],v1 offset:63488
ds_read_b128 v[52:55],v1 offset:64512
v_exp_f32 v72,v72
v_mfma_f32_16x16x32_bf16 v[92:95],v[28:31],v[20:23],v[140:143]
v_exp_f32 v73,v73
v_exp_f32 v74,v74
v_smfmac_f32_16x16x64_bf16 v[96:99],v[40:43],v[64:71],v60
v_exp_f32 v75,v75
v_exp_f32 v76,v76
v_smfmac_f32_16x16x64_bf16 v[100:103],v[44:47],v[64:71],v60
v_exp_f32 v77,v77
v_exp_f32 v78,v78
v_smfmac_f32_16x16x64_bf16 v[144:147],v[56:59],v[64:71],v60
v_exp_f32 v79,v79
s_waitcnt lgkmcnt(0)
s_barrier
v_mfma_f32_16x16x32_bf16 v[64:67],v[32:35],v[8:11],v[128:131]
v_exp_f32 v80,v80
v_mfma_f32_16x16x32_bf16 v[68:71],v[36:39],v[8:11],v[128:131]
v_exp_f32 v81,v81
v_exp_f32 v82,v82
v_smfmac_f32_16x16x64_bf16 v[104:107],v[40:43],v[72:79],v60
v_exp_f32 v83,v83
v_exp_f32 v84,v84
v_smfmac_f32_16x16x64_bf16 v[108:111],v[44:47],v[72:79],v60
v_exp_f32 v85,v85
v_exp_f32 v86,v86
v_smfmac_f32_16x16x64_bf16 v[148:151],v[56:59],v[72:79],v60
v_exp_f32 v87,v87
v_mfma_f32_16x16x32_bf16 v[72:75],v[32:35],v[12:15],v[132:135]
v_exp_f32 v88,v88
v_mfma_f32_16x16x32_bf16 v[76:79],v[36:39],v[12:15],v[132:135]
v_exp_f32 v89,v89
v_exp_f32 v90,v90
v_smfmac_f32_16x16x64_bf16 v[112:115],v[40:43],v[80:87],v60
v_exp_f32 v91,v91
v_exp_f32 v92,v92
v_smfmac_f32_16x16x64_bf16 v[116:119],v[44:47],v[80:87],v60
v_exp_f32 v93,v93
v_exp_f32 v94,v94
v_smfmac_f32_16x16x64_bf16 v[152:155],v[56:59],v[80:87],v60
v_exp_f32 v95,v95
v_mfma_f32_16x16x32_bf16 v[80:83],v[32:35],v[16:19],v[136:139]
ds_read_b128 v[24:27],v1 offset:0
ds_read_b128 v[28:31],v1 offset:1024
v_exp_f32 v64,v64
v_mfma_f32_16x16x32_bf16 v[84:87],v[36:39],v[16:19],v[136:139]
v_exp_f32 v65,v65
v_exp_f32 v66,v66
v_smfmac_f32_16x16x64_bf16 v[120:123],v[40:43],v[88:95],v60
v_exp_f32 v67,v67
v_exp_f32 v68,v68
v_smfmac_f32_16x16x64_bf16 v[124:127],v[44:47],v[88:95],v60
v_exp_f32 v69,v69
v_exp_f32 v70,v70
v_smfmac_f32_16x16x64_bf16 v[156:159],v[56:59],v[88:95],v60
v_exp_f32 v71,v71
v_mfma_f32_16x16x32_bf16 v[88:91],v[32:35],v[20:23],v[140:143]
ds_read_b128 v[40:43],v1 offset:16384
ds_read_b128 v[44:47],v1 offset:17408
v_exp_f32 v72,v72
v_mfma_f32_16x16x32_bf16 v[92:95],v[36:39],v[20:23],v[140:143]
v_exp_f32 v73,v73
v_exp_f32 v74,v74
v_smfmac_f32_16x16x64_bf16 v[96:99],v[48:51],v[64:71],v60
v_exp_f32 v75,v75
v_exp_f32 v76,v76
v_smfmac_f32_16x16x64_bf16 v[100:103],v[52:55],v[64:71],v60
v_exp_f32 v77,v77
v_exp_f32 v78,v78
v_smfmac_f32_16x16x64_bf16 v[144:147],v[56:59],v[64:71],v60
v_exp_f32 v79,v79
s_waitcnt lgkmcnt(0)
v_mfma_f32_16x16x32_bf16 v[64:67],v[24:27],v[8:11],v[128:131]
v_exp_f32 v80,v80
v_mfma_f32_16x16x32_bf16 v[68:71],v[28:31],v[8:11],v[128:131]
v_exp_f32 v81,v81
v_exp_f32 v82,v82
v_smfmac_f32_16x16x64_bf16 v[104:107],v[48:51],v[72:79],v60
v_exp_f32 v83,v83
v_exp_f32 v84,v84
v_smfmac_f32_16x16x64_bf16 v[108:111],v[52:55],v[72:79],v60
v_exp_f32 v85,v85
v_exp_f32 v86,v86
v_smfmac_f32_16x16x64_bf16 v[148:151],v[56:59],v[72:79],v60
v_exp_f32 v87,v87
v_mfma_f32_16x16x32_bf16 v[72:75],v[24:27],v[12:15],v[132:135]
s_sub_u32 s45,s45,1
s_cmp_lg_u32 s45,0
v_exp_f32 v88,v88
v_mfma_f32_16x16x32_bf16 v[76:79],v[28:31],v[12:15],v[132:135]
v_exp_f32 v89,v89
v_exp_f32 v90,v90
v_smfmac_f32_16x16x64_bf16 v[112:115],v[48:51],v[80:87],v60
v_exp_f32 v91,v91
v_exp_f32 v92,v92
v_smfmac_f32_16x16x64_bf16 v[116:119],v[52:55],v[80:87],v60
v_exp_f32 v93,v93
v_exp_f32 v94,v94
v_smfmac_f32_16x16x64_bf16 v[152:155],v[56:59],v[80:87],v60
v_exp_f32 v95,v95
s_cbranch_scc1 af_aloop
ds_read_b32 v7,v6 offset:56
v_smfmac_f32_16x16x64_bf16 v[120:123],v[48:51],v[88:95],v60
v_smfmac_f32_16x16x64_bf16 v[124:127],v[52:55],v[88:95],v60
v_smfmac_f32_16x16x64_bf16 v[156:159],v[56:59],v[88:95],v60
s_waitcnt vmcnt(0)
v_max3_f32 v4,|v96|,|v97|,|v98|
v_max3_f32 v4,v4,|v99|,|v100|
v_max3_f32 v4,v4,|v101|,|v102|
v_max3_f32 v4,v4,|v103|,|v104|
v_max3_f32 v4,v4,|v105|,|v106|
v_max3_f32 v4,v4,|v107|,|v108|
v_max3_f32 v4,v4,|v109|,|v110|
v_max3_f32 v4,v4,|v111|,|v112|
v_max3_f32 v4,v4,|v113|,|v114|
v_max3_f32 v4,v4,|v115|,|v116|
v_max3_f32 v4,v4,|v117|,|v118|
v_max3_f32 v4,v4,|v119|,|v120|
v_max3_f32 v4,v4,|v121|,|v122|
v_max3_f32 v4,v4,|v123|,|v124|
v_max3_f32 v4,v4,|v125|,|v126|
v_max_f32 v4,v4,|v127|
v_add_f32 v5,v144,v148
v_add_f32 v6,v152,v156
v_add_f32 v5,v5,v6
v_mov_b32 v6,0x7e800000
v_cmp_ngt_f32 vcc,0x4b800000,v5
v_cmp_nlt_f32 s[62:63],v4,v6
s_waitcnt lgkmcnt(0)
v_readfirstlane_b32 s43,v7
s_nop 0
s_cmp_lg_u32 s43,0
s_cbranch_scc1 af_fin
s_or_b64 vcc,vcc,s[62:63]
s_cmp_lg_u64 vcc,0
s_cbranch_scc1 af_redo
v_rcp_f32 v144,v144
v_rcp_f32 v148,v148
v_rcp_f32 v152,v152
v_rcp_f32 v156,v156
s_mul_i32 s43,s51,294912
s_lshl_b32 s44,s46,10
s_add_u32 s43,s43,s44
s_add_u32 s43,s43,12697600
v_mul_f32 v96,v144,v96
v_mul_f32 v97,v144,v97
v_mul_f32 v98,v144,v98
v_mul_f32 v99,v144,v99
v_mul_f32 v100,v144,v100
v_mul_f32 v101,v144,v101
v_mul_f32 v102,v144,v102
v_mul_f32 v103,v144,v103
v_cvt_pk_bf16_f32 v64,v96,v97
v_cvt_pk_bf16_f32 v65,v98,v99
v_cvt_pk_bf16_f32 v66,v100,v101
v_cvt_pk_bf16_f32 v67,v102,v103
buffer_store_dwordx4 v[64:67],v1,s[32:35],s43 offen sc1
s_add_u32 s43,s43,147456
v_mul_f32 v104,v148,v104
v_mul_f32 v105,v148,v105
v_mul_f32 v106,v148,v106
v_mul_f32 v107,v148,v107
v_mul_f32 v108,v148,v108
v_mul_f32 v109,v148,v109
v_mul_f32 v110,v148,v110
v_mul_f32 v111,v148,v111
v_cvt_pk_bf16_f32 v72,v104,v105
v_cvt_pk_bf16_f32 v73,v106,v107
v_cvt_pk_bf16_f32 v74,v108,v109
v_cvt_pk_bf16_f32 v75,v110,v111
buffer_store_dwordx4 v[72:75],v1,s[32:35],s43 offen sc1
s_add_u32 s43,s43,147456
v_mul_f32 v112,v152,v112
v_mul_f32 v113,v152,v113
v_mul_f32 v114,v152,v114
v_mul_f32 v115,v152,v115
v_mul_f32 v116,v152,v116
v_mul_f32 v117,v152,v117
v_mul_f32 v118,v152,v118
v_mul_f32 v119,v152,v119
v_cvt_pk_bf16_f32 v80,v112,v113
v_cvt_pk_bf16_f32 v81,v114,v115
v_cvt_pk_bf16_f32 v82,v116,v117
v_cvt_pk_bf16_f32 v83,v118,v119
buffer_store_dwordx4 v[80:83],v1,s[32:35],s43 offen sc1
s_add_u32 s43,s43,147456
v_mul_f32 v120,v156,v120
v_mul_f32 v121,v156,v121
v_mul_f32 v122,v156,v122
v_mul_f32 v123,v156,v123
v_mul_f32 v124,v156,v124
v_mul_f32 v125,v156,v125
v_mul_f32 v126,v156,v126
v_mul_f32 v127,v156,v127
v_cvt_pk_bf16_f32 v88,v120,v121
v_cvt_pk_bf16_f32 v89,v122,v123
v_cvt_pk_bf16_f32 v90,v124,v125
v_cvt_pk_bf16_f32 v91,v126,v127
buffer_store_dwordx4 v[88:91],v1,s[32:35],s43 offen sc1
af_signal:
v_lshlrev_b32 v16,16,v176
v_and_b32 v17,0xffff0000,v176
v_lshlrev_b32 v18,16,v177
v_and_b32 v19,0xffff0000,v177
v_lshlrev_b32 v20,16,v178
v_and_b32 v21,0xffff0000,v178
v_lshlrev_b32 v22,16,v179
v_and_b32 v23,0xffff0000,v179
v_lshlrev_b32 v24,16,v180
v_and_b32 v25,0xffff0000,v180
v_lshlrev_b32 v26,16,v181
v_and_b32 v27,0xffff0000,v181
v_lshlrev_b32 v28,16,v182
v_and_b32 v29,0xffff0000,v182
v_lshlrev_b32 v30,16,v183
v_and_b32 v31,0xffff0000,v183
v_lshlrev_b32 v32,16,v184
v_and_b32 v33,0xffff0000,v184
v_lshlrev_b32 v34,16,v185
v_and_b32 v35,0xffff0000,v185
v_lshlrev_b32 v36,16,v186
v_and_b32 v37,0xffff0000,v186
v_lshlrev_b32 v38,16,v187
v_and_b32 v39,0xffff0000,v187
v_lshlrev_b32 v40,16,v188
v_and_b32 v41,0xffff0000,v188
v_lshlrev_b32 v42,16,v189
v_and_b32 v43,0xffff0000,v189
v_lshlrev_b32 v44,16,v190
v_and_b32 v45,0xffff0000,v190
v_lshlrev_b32 v46,16,v191
v_and_b32 v47,0xffff0000,v191
v_lshrrev_b32 v5,5,v0
v_bfe_u32 v4,v0,2,2
v_lshl_add_u32 v5,v5,2,v4
v_lshlrev_b32 v5,7,v5
v_lshrrev_b32 v4,1,v4
v_lshl_add_u32 v5,v4,6,v5
v_lshrrev_b32 v4,1,v0
v_xor_b32 v4,v4,v0
v_bfe_u32 v4,v4,4,1
v_lshl_add_u32 v5,v4,5,v5
v_and_b32 v4,1,v0
v_lshl_add_u32 v5,v4,4,v5
v_bfe_u32 v4,v0,1,1
v_lshl_add_u32 v10,v4,3,v5
v_add_u32 v8,131072,v10
v_xor_b32 v9,64,v8
v_mov_b32 v6,161792
s_lshl_b32 s59,s41,2
s_add_u32 s59,s59,s40
s_mul_i32 s59,s59,294912
s_add_u32 s59,s59,12697600
v_mov_b32 v5,1
v_lshlrev_b32 v4,9,v0
s_mov_b64 exec,1
s_and_b32 s43,s2,0xe0
s_lshl_b32 s43,s43,7
s_add_u32 s43,s43,s46
s_lshl_b32 s43,s43,2
s_add_u32 s43,s43,41943168
s_waitcnt vmcnt(0) lgkmcnt(0)
ds_add_rtn_u32 v7,v6,v5 offset:0
s_waitcnt lgkmcnt(0)
v_readfirstlane_b32 s44,v7
s_mov_b32 exec_lo,-1
s_cmp_lg_u32 s44,3
s_cbranch_scc1 af_nosig
buffer_store_dword v5,v4,s[32:35],s43 offen sc1
s_mov_b64 exec,-1
v_and_b32 v4,31,v0
v_lshlrev_b32 v4,2,v4
s_lshl_b32 s43,s41,4
s_add_u32 s43,s43,s42
s_lshl_b32 s43,s43,9
s_add_u32 s43,s43,41943168
s_mov_b32 s45,3000
s_cmp_lg_u32 s100,-1
s_cbranch_scc1 af_pto
af_poll:
buffer_load_dword v5,v4,s[32:35],s43 offen sc1
v_mov_b32 v7,1
s_waitcnt vmcnt(0)
v_cmp_eq_u32 vcc,0,v5
s_nop 1
s_cmp_eq_u64 vcc,0
s_cbranch_scc1 af_pok
s_sleep 2
s_sub_u32 s45,s45,1
s_cmp_lg_u32 s45,0
s_cbranch_scc1 af_poll
ds_write_b32 v6,v6 offset:56
af_pto:
v_mov_b32 v7,2
ds_write_b32 v6,v7 offset:4
af_tmo:
s_cmp_eq_u32 s100,-1
s_cbranch_scc1 af_fin
s_mov_b32 s52,1
s_mov_b32 s53,0
s_mov_b32 s54,32
s_lshl_b32 s56,s41,2
s_add_u32 s56,s56,s40
s_add_u32 s57,s56,1
s_branch af_slow
af_nosig:
s_mov_b64 exec,-1
s_setprio 0
af_hw:
ds_read_b32 v7,v6 offset:4
s_waitcnt lgkmcnt(0)
v_readfirstlane_b32 s44,v7
s_nop 0
s_cmp_lt_u32 s44,1
s_cbranch_scc1 af_hw
s_setprio 1
s_cmp_eq_u32 s44,2
s_cbranch_scc1 af_tmo
s_branch af_oph
af_pok:
ds_write_b32 v6,v7 offset:4
af_oph:
buffer_load_dwordx4 v[64:67],v2,s[32:35],s59 offen offset:0 sc1
buffer_load_dwordx4 v[68:71],v2,s[32:35],s59 offen offset:512 sc1
buffer_load_dwordx4 v[72:75],v2,s[32:35],s59 offen offset:1024 sc1
buffer_load_dwordx4 v[76:79],v2,s[32:35],s59 offen offset:1536 sc1
buffer_load_dwordx4 v[80:83],v2,s[32:35],s59 offen offset:2048 sc1
buffer_load_dwordx4 v[84:87],v2,s[32:35],s59 offen offset:2560 sc1
buffer_load_dwordx4 v[88:91],v2,s[32:35],s59 offen offset:3072 sc1
buffer_load_dwordx4 v[92:95],v2,s[32:35],s59 offen offset:3584 sc1
s_add_u32 s59,s59,4096
buffer_load_dwordx4 v[96:99],v2,s[32:35],s59 offen offset:0 sc1
buffer_load_dwordx4 v[100:103],v2,s[32:35],s59 offen offset:512 sc1
buffer_load_dwordx4 v[104:107],v2,s[32:35],s59 offen offset:1024 sc1
buffer_load_dwordx4 v[108:111],v2,s[32:35],s59 offen offset:1536 sc1
ds_read_b64_tr_b16 v[48:49],v8 offset:0
ds_read_b64_tr_b16 v[50:51],v8 offset:2048
ds_read_b64_tr_b16 v[52:53],v9 offset:0
ds_read_b64_tr_b16 v[54:55],v9 offset:2048
ds_read_b64_tr_b16 v[56:57],v8 offset:1024
ds_read_b64_tr_b16 v[58:59],v8 offset:3072
ds_read_b64_tr_b16 v[60:61],v9 offset:1024
ds_read_b64_tr_b16 v[62:63],v9 offset:3072
s_waitcnt vmcnt(11) lgkmcnt(6)
v_mfma_f32_32x32x16_bf16 v[16:31],v[48:51],v[64:67],v[16:31]
ds_read_b64_tr_b16 v[48:49],v8 offset:4096
ds_read_b64_tr_b16 v[50:51],v8 offset:6144
s_waitcnt lgkmcnt(6)
v_mfma_f32_32x32x16_bf16 v[32:47],v[52:55],v[64:67],v[32:47]
ds_read_b64_tr_b16 v[52:53],v9 offset:4096
ds_read_b64_tr_b16 v[54:55],v9 offset:6144
s_waitcnt vmcnt(10) lgkmcnt(6)
v_mfma_f32_32x32x16_bf16 v[16:31],v[56:59],v[68:71],v[16:31]
ds_read_b64_tr_b16 v[56:57],v8 offset:5120
ds_read_b64_tr_b16 v[58:59],v8 offset:7168
s_waitcnt lgkmcnt(6)
v_mfma_f32_32x32x16_bf16 v[32:47],v[60:63],v[68:71],v[32:47]
ds_read_b64_tr_b16 v[60:61],v9 offset:5120
ds_read_b64_tr_b16 v[62:63],v9 offset:7168
buffer_load_dwordx4 v[64:67],v2,s[32:35],s59 offen offset:2048 sc1
buffer_load_dwordx4 v[68:71],v2,s[32:35],s59 offen offset:2560 sc1
s_waitcnt vmcnt(11) lgkmcnt(6)
v_mfma_f32_32x32x16_bf16 v[16:31],v[48:51],v[72:75],v[16:31]
ds_read_b64_tr_b16 v[48:49],v8 offset:8192
ds_read_b64_tr_b16 v[50:51],v8 offset:10240
s_waitcnt lgkmcnt(6)
v_mfma_f32_32x32x16_bf16 v[32:47],v[52:55],v[72:75],v[32:47]
ds_read_b64_tr_b16 v[52:53],v9 offset:8192
ds_read_b64_tr_b16 v[54:55],v9 offset:10240
s_waitcnt vmcnt(10) lgkmcnt(6)
v_mfma_f32_32x32x16_bf16 v[16:31],v[56:59],v[76:79],v[16:31]
ds_read_b64_tr_b16 v[56:57],v8 offset:9216
ds_read_b64_tr_b16 v[58:59],v8 offset:11264
s_waitcnt lgkmcnt(6)
v_mfma_f32_32x32x16_bf16 v[32:47],v[60:63],v[76:79],v[32:47]
ds_read_b64_tr_b16 v[60:61],v9 offset:9216
ds_read_b64_tr_b16 v[62:63],v9 offset:11264
buffer_load_dwordx4 v[72:75],v2,s[32:35],s59 offen offset:3072 sc1
buffer_load_dwordx4 v[76:79],v2,s[32:35],s59 offen offset:3584 sc1
s_waitcnt vmcnt(11) lgkmcnt(6)
v_mfma_f32_32x32x16_bf16 v[16:31],v[48:51],v[80:83],v[16:31]
ds_read_b64_tr_b16 v[48:49],v8 offset:12288
ds_read_b64_tr_b16 v[50:51],v8 offset:14336
s_waitcnt lgkmcnt(6)
v_mfma_f32_32x32x16_bf16 v[32:47],v[52:55],v[80:83],v[32:47]
ds_read_b64_tr_b16 v[52:53],v9 offset:12288
ds_read_b64_tr_b16 v[54:55],v9 offset:14336
s_waitcnt vmcnt(10) lgkmcnt(6)
v_mfma_f32_32x32x16_bf16 v[16:31],v[56:59],v[84:87],v[16:31]
ds_read_b64_tr_b16 v[56:57],v8 offset:13312
ds_read_b64_tr_b16 v[58:59],v8 offset:15360
s_waitcnt lgkmcnt(6)
v_mfma_f32_32x32x16_bf16 v[32:47],v[60:63],v[84:87],v[32:47]
ds_read_b64_tr_b16 v[60:61],v9 offset:13312
ds_read_b64_tr_b16 v[62:63],v9 offset:15360
s_add_u32 s59,s59,4096
buffer_load_dwordx4 v[80:83],v2,s[32:35],s59 offen offset:0 sc1
buffer_load_dwordx4 v[84:87],v2,s[32:35],s59 offen offset:512 sc1
s_waitcnt vmcnt(11) lgkmcnt(6)
v_mfma_f32_32x32x16_bf16 v[16:31],v[48:51],v[88:91],v[16:31]
ds_read_b64_tr_b16 v[48:49],v8 offset:16384
ds_read_b64_tr_b16 v[50:51],v8 offset:18432
s_waitcnt lgkmcnt(6)
v_mfma_f32_32x32x16_bf16 v[32:47],v[52:55],v[88:91],v[32:47]
ds_read_b64_tr_b16 v[52:53],v9 offset:16384
ds_read_b64_tr_b16 v[54:55],v9 offset:18432
s_waitcnt vmcnt(10) lgkmcnt(6)
v_mfma_f32_32x32x16_bf16 v[16:31],v[56:59],v[92:95],v[16:31]
ds_read_b64_tr_b16 v[56:57],v8 offset:17408
ds_read_b64_tr_b16 v[58:59],v8 offset:19456
s_waitcnt lgkmcnt(6)
v_mfma_f32_32x32x16_bf16 v[32:47],v[60:63],v[92:95],v[32:47]
ds_read_b64_tr_b16 v[60:61],v9 offset:17408
ds_read_b64_tr_b16 v[62:63],v9 offset:19456
buffer_load_dwordx4 v[88:91],v2,s[32:35],s59 offen offset:1024 sc1
buffer_load_dwordx4 v[92:95],v2,s[32:35],s59 offen offset:1536 sc1
s_waitcnt vmcnt(11) lgkmcnt(6)
v_mfma_f32_32x32x16_bf16 v[16:31],v[48:51],v[96:99],v[16:31]
ds_read_b64_tr_b16 v[48:49],v8 offset:20480
ds_read_b64_tr_b16 v[50:51],v8 offset:22528
s_waitcnt lgkmcnt(6)
v_mfma_f32_32x32x16_bf16 v[32:47],v[52:55],v[96:99],v[32:47]
ds_read_b64_tr_b16 v[52:53],v9 offset:20480
ds_read_b64_tr_b16 v[54:55],v9 offset:22528
s_waitcnt vmcnt(10) lgkmcnt(6)
v_mfma_f32_32x32x16_bf16 v[16:31],v[56:59],v[100:103],v[16:31]
ds_read_b64_tr_b16 v[56:57],v8 offset:21504
ds_read_b64_tr_b16 v[58:59],v8 offset:23552
s_waitcnt lgkmcnt(6)
v_mfma_f32_32x32x16_bf16 v[32:47],v[60:63],v[100:103],v[32:47]
ds_read_b64_tr_b16 v[60:61],v9 offset:21504
ds_read_b64_tr_b16 v[62:63],v9 offset:23552
buffer_load_dwordx4 v[96:99],v2,s[32:35],s59 offen offset:2048 sc1
buffer_load_dwordx4 v[100:103],v2,s[32:35],s59 offen offset:2560 sc1
s_waitcnt vmcnt(11) lgkmcnt(6)
v_mfma_f32_32x32x16_bf16 v[16:31],v[48:51],v[104:107],v[16:31]
ds_read_b64_tr_b16 v[48:49],v8 offset:24576
ds_read_b64_tr_b16 v[50:51],v8 offset:26624
s_waitcnt lgkmcnt(6)
v_mfma_f32_32x32x16_bf16 v[32:47],v[52:55],v[104:107],v[32:47]
ds_read_b64_tr_b16 v[52:53],v9 offset:24576
ds_read_b64_tr_b16 v[54:55],v9 offset:26624
s_waitcnt vmcnt(10) lgkmcnt(6)
v_mfma_f32_32x32x16_bf16 v[16:31],v[56:59],v[108:111],v[16:31]
ds_read_b64_tr_b16 v[56:57],v8 offset:25600
ds_read_b64_tr_b16 v[58:59],v8 offset:27648
s_waitcnt lgkmcnt(6)
v_mfma_f32_32x32x16_bf16 v[32:47],v[60:63],v[108:111],v[32:47]
ds_read_b64_tr_b16 v[60:61],v9 offset:25600
ds_read_b64_tr_b16 v[62:63],v9 offset:27648
buffer_load_dwordx4 v[104:107],v2,s[32:35],s59 offen offset:3072 sc1
buffer_load_dwordx4 v[108:111],v2,s[32:35],s59 offen offset:3584 sc1
s_waitcnt vmcnt(11) lgkmcnt(6)
v_mfma_f32_32x32x16_bf16 v[16:31],v[48:51],v[64:67],v[16:31]
v_add_u32 v8,0,v10
v_xor_b32 v9,64,v8
ds_read_b64_tr_b16 v[48:49],v8 offset:0
ds_read_b64_tr_b16 v[50:51],v8 offset:2048
s_waitcnt lgkmcnt(6)
v_mfma_f32_32x32x16_bf16 v[32:47],v[52:55],v[64:67],v[32:47]
ds_read_b64_tr_b16 v[52:53],v9 offset:0
ds_read_b64_tr_b16 v[54:55],v9 offset:2048
s_waitcnt vmcnt(10) lgkmcnt(6)
v_mfma_f32_32x32x16_bf16 v[16:31],v[56:59],v[68:71],v[16:31]
ds_read_b64_tr_b16 v[56:57],v8 offset:1024
ds_read_b64_tr_b16 v[58:59],v8 offset:3072
s_waitcnt lgkmcnt(6)
v_mfma_f32_32x32x16_bf16 v[32:47],v[60:63],v[68:71],v[32:47]
ds_read_b64_tr_b16 v[60:61],v9 offset:1024
ds_read_b64_tr_b16 v[62:63],v9 offset:3072
s_add_u32 s59,s59,4096
buffer_load_dwordx4 v[64:67],v2,s[32:35],s59 offen offset:0 sc1
buffer_load_dwordx4 v[68:71],v2,s[32:35],s59 offen offset:512 sc1
s_waitcnt vmcnt(11) lgkmcnt(6)
v_mfma_f32_32x32x16_bf16 v[16:31],v[48:51],v[72:75],v[16:31]
ds_read_b64_tr_b16 v[48:49],v8 offset:4096
ds_read_b64_tr_b16 v[50:51],v8 offset:6144
s_waitcnt lgkmcnt(6)
v_mfma_f32_32x32x16_bf16 v[32:47],v[52:55],v[72:75],v[32:47]
ds_read_b64_tr_b16 v[52:53],v9 offset:4096
ds_read_b64_tr_b16 v[54:55],v9 offset:6144
s_waitcnt vmcnt(10) lgkmcnt(6)
v_mfma_f32_32x32x16_bf16 v[16:31],v[56:59],v[76:79],v[16:31]
ds_read_b64_tr_b16 v[56:57],v8 offset:5120
ds_read_b64_tr_b16 v[58:59],v8 offset:7168
s_waitcnt lgkmcnt(6)
v_mfma_f32_32x32x16_bf16 v[32:47],v[60:63],v[76:79],v[32:47]
ds_read_b64_tr_b16 v[60:61],v9 offset:5120
ds_read_b64_tr_b16 v[62:63],v9 offset:7168
buffer_load_dwordx4 v[72:75],v2,s[32:35],s59 offen offset:1024 sc1
buffer_load_dwordx4 v[76:79],v2,s[32:35],s59 offen offset:1536 sc1
s_waitcnt vmcnt(11) lgkmcnt(6)
v_mfma_f32_32x32x16_bf16 v[16:31],v[48:51],v[80:83],v[16:31]
ds_read_b64_tr_b16 v[48:49],v8 offset:8192
ds_read_b64_tr_b16 v[50:51],v8 offset:10240
s_waitcnt lgkmcnt(6)
v_mfma_f32_32x32x16_bf16 v[32:47],v[52:55],v[80:83],v[32:47]
ds_read_b64_tr_b16 v[52:53],v9 offset:8192
ds_read_b64_tr_b16 v[54:55],v9 offset:10240
s_waitcnt vmcnt(10) lgkmcnt(6)
v_mfma_f32_32x32x16_bf16 v[16:31],v[56:59],v[84:87],v[16:31]
ds_read_b64_tr_b16 v[56:57],v8 offset:9216
ds_read_b64_tr_b16 v[58:59],v8 offset:11264
s_waitcnt lgkmcnt(6)
v_mfma_f32_32x32x16_bf16 v[32:47],v[60:63],v[84:87],v[32:47]
ds_read_b64_tr_b16 v[60:61],v9 offset:9216
ds_read_b64_tr_b16 v[62:63],v9 offset:11264
buffer_load_dwordx4 v[80:83],v2,s[32:35],s59 offen offset:2048 sc1
buffer_load_dwordx4 v[84:87],v2,s[32:35],s59 offen offset:2560 sc1
s_waitcnt vmcnt(11) lgkmcnt(6)
v_mfma_f32_32x32x16_bf16 v[16:31],v[48:51],v[88:91],v[16:31]
ds_read_b64_tr_b16 v[48:49],v8 offset:12288
ds_read_b64_tr_b16 v[50:51],v8 offset:14336
s_waitcnt lgkmcnt(6)
v_mfma_f32_32x32x16_bf16 v[32:47],v[52:55],v[88:91],v[32:47]
ds_read_b64_tr_b16 v[52:53],v9 offset:12288
ds_read_b64_tr_b16 v[54:55],v9 offset:14336
s_waitcnt vmcnt(10) lgkmcnt(6)
v_mfma_f32_32x32x16_bf16 v[16:31],v[56:59],v[92:95],v[16:31]
ds_read_b64_tr_b16 v[56:57],v8 offset:13312
ds_read_b64_tr_b16 v[58:59],v8 offset:15360
s_waitcnt lgkmcnt(6)
v_mfma_f32_32x32x16_bf16 v[32:47],v[60:63],v[92:95],v[32:47]
ds_read_b64_tr_b16 v[60:61],v9 offset:13312
ds_read_b64_tr_b16 v[62:63],v9 offset:15360
buffer_load_dwordx4 v[88:91],v2,s[32:35],s59 offen offset:3072 sc1
buffer_load_dwordx4 v[92:95],v2,s[32:35],s59 offen offset:3584 sc1
s_waitcnt vmcnt(11) lgkmcnt(6)
v_mfma_f32_32x32x16_bf16 v[16:31],v[48:51],v[96:99],v[16:31]
ds_read_b64_tr_b16 v[48:49],v8 offset:16384
ds_read_b64_tr_b16 v[50:51],v8 offset:18432
s_waitcnt lgkmcnt(6)
v_mfma_f32_32x32x16_bf16 v[32:47],v[52:55],v[96:99],v[32:47]
ds_read_b64_tr_b16 v[52:53],v9 offset:16384
ds_read_b64_tr_b16 v[54:55],v9 offset:18432
s_waitcnt vmcnt(10) lgkmcnt(6)
v_mfma_f32_32x32x16_bf16 v[16:31],v[56:59],v[100:103],v[16:31]
ds_read_b64_tr_b16 v[56:57],v8 offset:17408
ds_read_b64_tr_b16 v[58:59],v8 offset:19456
s_waitcnt lgkmcnt(6)
v_mfma_f32_32x32x16_bf16 v[32:47],v[60:63],v[100:103],v[32:47]
ds_read_b64_tr_b16 v[60:61],v9 offset:17408
ds_read_b64_tr_b16 v[62:63],v9 offset:19456
s_add_u32 s59,s59,4096
buffer_load_dwordx4 v[96:99],v2,s[32:35],s59 offen offset:0 sc1
buffer_load_dwordx4 v[100:103],v2,s[32:35],s59 offen offset:512 sc1
s_waitcnt vmcnt(11) lgkmcnt(6)
v_mfma_f32_32x32x16_bf16 v[16:31],v[48:51],v[104:107],v[16:31]
ds_read_b64_tr_b16 v[48:49],v8 offset:20480
ds_read_b64_tr_b16 v[50:51],v8 offset:22528
s_waitcnt lgkmcnt(6)
v_mfma_f32_32x32x16_bf16 v[32:47],v[52:55],v[104:107],v[32:47]
ds_read_b64_tr_b16 v[52:53],v9 offset:20480
ds_read_b64_tr_b16 v[54:55],v9 offset:22528
s_waitcnt vmcnt(10) lgkmcnt(6)
v_mfma_f32_32x32x16_bf16 v[16:31],v[56:59],v[108:111],v[16:31]
ds_read_b64_tr_b16 v[56:57],v8 offset:21504
ds_read_b64_tr_b16 v[58:59],v8 offset:23552
s_waitcnt lgkmcnt(6)
v_mfma_f32_32x32x16_bf16 v[32:47],v[60:63],v[108:111],v[32:47]
ds_read_b64_tr_b16 v[60:61],v9 offset:21504
ds_read_b64_tr_b16 v[62:63],v9 offset:23552
buffer_load_dwordx4 v[104:107],v2,s[32:35],s59 offen offset:1024 sc1
buffer_load_dwordx4 v[108:111],v2,s[32:35],s59 offen offset:1536 sc1
s_waitcnt vmcnt(11) lgkmcnt(6)
v_mfma_f32_32x32x16_bf16 v[16:31],v[48:51],v[64:67],v[16:31]
ds_read_b64_tr_b16 v[48:49],v8 offset:24576
ds_read_b64_tr_b16 v[50:51],v8 offset:26624
s_waitcnt lgkmcnt(6)
v_mfma_f32_32x32x16_bf16 v[32:47],v[52:55],v[64:67],v[32:47]
ds_read_b64_tr_b16 v[52:53],v9 offset:24576
ds_read_b64_tr_b16 v[54:55],v9 offset:26624
s_waitcnt vmcnt(10) lgkmcnt(6)
v_mfma_f32_32x32x16_bf16 v[16:31],v[56:59],v[68:71],v[16:31]
ds_read_b64_tr_b16 v[56:57],v8 offset:25600
ds_read_b64_tr_b16 v[58:59],v8 offset:27648
s_waitcnt lgkmcnt(6)
v_mfma_f32_32x32x16_bf16 v[32:47],v[60:63],v[68:71],v[32:47]
ds_read_b64_tr_b16 v[60:61],v9 offset:25600
ds_read_b64_tr_b16 v[62:63],v9 offset:27648
buffer_load_dwordx4 v[64:67],v2,s[32:35],s59 offen offset:2048 sc1
buffer_load_dwordx4 v[68:71],v2,s[32:35],s59 offen offset:2560 sc1
s_waitcnt vmcnt(11) lgkmcnt(6)
v_mfma_f32_32x32x16_bf16 v[16:31],v[48:51],v[72:75],v[16:31]
ds_read_b64_tr_b16 v[48:49],v8 offset:28672
ds_read_b64_tr_b16 v[50:51],v8 offset:30720
s_waitcnt lgkmcnt(6)
v_mfma_f32_32x32x16_bf16 v[32:47],v[52:55],v[72:75],v[32:47]
ds_read_b64_tr_b16 v[52:53],v9 offset:28672
ds_read_b64_tr_b16 v[54:55],v9 offset:30720
s_waitcnt vmcnt(10) lgkmcnt(6)
v_mfma_f32_32x32x16_bf16 v[16:31],v[56:59],v[76:79],v[16:31]
ds_read_b64_tr_b16 v[56:57],v8 offset:29696
ds_read_b64_tr_b16 v[58:59],v8 offset:31744
s_waitcnt lgkmcnt(6)
v_mfma_f32_32x32x16_bf16 v[32:47],v[60:63],v[76:79],v[32:47]
ds_read_b64_tr_b16 v[60:61],v9 offset:29696
ds_read_b64_tr_b16 v[62:63],v9 offset:31744
buffer_load_dwordx4 v[72:75],v2,s[32:35],s59 offen offset:3072 sc1
buffer_load_dwordx4 v[76:79],v2,s[32:35],s59 offen offset:3584 sc1
af_w1:
ds_read_b32 v7,v6 offset:8
s_waitcnt lgkmcnt(0)
v_readfirstlane_b32 s44,v7
s_nop 0
s_cmp_lt_u32 s44,4
s_cbranch_scc1 af_w1
s_waitcnt vmcnt(11)
v_mfma_f32_32x32x16_bf16 v[16:31],v[48:51],v[80:83],v[16:31]
ds_read_b64_tr_b16 v[48:49],v8 offset:32768
ds_read_b64_tr_b16 v[50:51],v8 offset:34816
v_mfma_f32_32x32x16_bf16 v[32:47],v[52:55],v[80:83],v[32:47]
ds_read_b64_tr_b16 v[52:53],v9 offset:32768
ds_read_b64_tr_b16 v[54:55],v9 offset:34816
s_waitcnt vmcnt(10)
v_mfma_f32_32x32x16_bf16 v[16:31],v[56:59],v[84:87],v[16:31]
ds_read_b64_tr_b16 v[56:57],v8 offset:33792
ds_read_b64_tr_b16 v[58:59],v8 offset:35840
v_mfma_f32_32x32x16_bf16 v[32:47],v[60:63],v[84:87],v[32:47]
ds_read_b64_tr_b16 v[60:61],v9 offset:33792
ds_read_b64_tr_b16 v[62:63],v9 offset:35840
s_add_u32 s59,s59,4096
buffer_load_dwordx4 v[80:83],v2,s[32:35],s59 offen offset:0 sc1
buffer_load_dwordx4 v[84:87],v2,s[32:35],s59 offen offset:512 sc1
s_waitcnt vmcnt(11) lgkmcnt(6)
v_mfma_f32_32x32x16_bf16 v[16:31],v[48:51],v[88:91],v[16:31]
ds_read_b64_tr_b16 v[48:49],v8 offset:36864
ds_read_b64_tr_b16 v[50:51],v8 offset:38912
s_waitcnt lgkmcnt(6)
v_mfma_f32_32x32x16_bf16 v[32:47],v[52:55],v[88:91],v[32:47]
ds_read_b64_tr_b16 v[52:53],v9 offset:36864
ds_read_b64_tr_b16 v[54:55],v9 offset:38912
s_waitcnt vmcnt(10) lgkmcnt(6)
v_mfma_f32_32x32x16_bf16 v[16:31],v[56:59],v[92:95],v[16:31]
ds_read_b64_tr_b16 v[56:57],v8 offset:37888
ds_read_b64_tr_b16 v[58:59],v8 offset:39936
s_waitcnt lgkmcnt(6)
v_mfma_f32_32x32x16_bf16 v[32:47],v[60:63],v[92:95],v[32:47]
ds_read_b64_tr_b16 v[60:61],v9 offset:37888
ds_read_b64_tr_b16 v[62:63],v9 offset:39936
buffer_load_dwordx4 v[88:91],v2,s[32:35],s59 offen offset:1024 sc1
buffer_load_dwordx4 v[92:95],v2,s[32:35],s59 offen offset:1536 sc1
s_waitcnt vmcnt(11) lgkmcnt(6)
v_mfma_f32_32x32x16_bf16 v[16:31],v[48:51],v[96:99],v[16:31]
ds_read_b64_tr_b16 v[48:49],v8 offset:40960
ds_read_b64_tr_b16 v[50:51],v8 offset:43008
s_waitcnt lgkmcnt(6)
v_mfma_f32_32x32x16_bf16 v[32:47],v[52:55],v[96:99],v[32:47]
ds_read_b64_tr_b16 v[52:53],v9 offset:40960
ds_read_b64_tr_b16 v[54:55],v9 offset:43008
s_waitcnt vmcnt(10) lgkmcnt(6)
v_mfma_f32_32x32x16_bf16 v[16:31],v[56:59],v[100:103],v[16:31]
ds_read_b64_tr_b16 v[56:57],v8 offset:41984
ds_read_b64_tr_b16 v[58:59],v8 offset:44032
s_waitcnt lgkmcnt(6)
v_mfma_f32_32x32x16_bf16 v[32:47],v[60:63],v[100:103],v[32:47]
ds_read_b64_tr_b16 v[60:61],v9 offset:41984
ds_read_b64_tr_b16 v[62:63],v9 offset:44032
buffer_load_dwordx4 v[96:99],v2,s[32:35],s59 offen offset:2048 sc1
buffer_load_dwordx4 v[100:103],v2,s[32:35],s59 offen offset:2560 sc1
s_waitcnt vmcnt(11) lgkmcnt(6)
v_mfma_f32_32x32x16_bf16 v[16:31],v[48:51],v[104:107],v[16:31]
ds_read_b64_tr_b16 v[48:49],v8 offset:45056
ds_read_b64_tr_b16 v[50:51],v8 offset:47104
s_waitcnt lgkmcnt(6)
v_mfma_f32_32x32x16_bf16 v[32:47],v[52:55],v[104:107],v[32:47]
ds_read_b64_tr_b16 v[52:53],v9 offset:45056
ds_read_b64_tr_b16 v[54:55],v9 offset:47104
s_waitcnt vmcnt(10) lgkmcnt(6)
v_mfma_f32_32x32x16_bf16 v[16:31],v[56:59],v[108:111],v[16:31]
ds_read_b64_tr_b16 v[56:57],v8 offset:46080
ds_read_b64_tr_b16 v[58:59],v8 offset:48128
s_waitcnt lgkmcnt(6)
v_mfma_f32_32x32x16_bf16 v[32:47],v[60:63],v[108:111],v[32:47]
ds_read_b64_tr_b16 v[60:61],v9 offset:46080
ds_read_b64_tr_b16 v[62:63],v9 offset:48128
buffer_load_dwordx4 v[104:107],v2,s[32:35],s59 offen offset:3072 sc1
buffer_load_dwordx4 v[108:111],v2,s[32:35],s59 offen offset:3584 sc1
s_waitcnt vmcnt(11) lgkmcnt(6)
v_mfma_f32_32x32x16_bf16 v[16:31],v[48:51],v[64:67],v[16:31]
ds_read_b64_tr_b16 v[48:49],v8 offset:49152
ds_read_b64_tr_b16 v[50:51],v8 offset:51200
s_waitcnt lgkmcnt(6)
v_mfma_f32_32x32x16_bf16 v[32:47],v[52:55],v[64:67],v[32:47]
ds_read_b64_tr_b16 v[52:53],v9 offset:49152
ds_read_b64_tr_b16 v[54:55],v9 offset:51200
s_waitcnt vmcnt(10) lgkmcnt(6)
v_mfma_f32_32x32x16_bf16 v[16:31],v[56:59],v[68:71],v[16:31]
ds_read_b64_tr_b16 v[56:57],v8 offset:50176
ds_read_b64_tr_b16 v[58:59],v8 offset:52224
s_waitcnt lgkmcnt(6)
v_mfma_f32_32x32x16_bf16 v[32:47],v[60:63],v[68:71],v[32:47]
ds_read_b64_tr_b16 v[60:61],v9 offset:50176
ds_read_b64_tr_b16 v[62:63],v9 offset:52224
s_add_u32 s59,s59,4096
buffer_load_dwordx4 v[64:67],v2,s[32:35],s59 offen offset:0 sc1
buffer_load_dwordx4 v[68:71],v2,s[32:35],s59 offen offset:512 sc1
s_waitcnt vmcnt(11) lgkmcnt(6)
v_mfma_f32_32x32x16_bf16 v[16:31],v[48:51],v[72:75],v[16:31]
ds_read_b64_tr_b16 v[48:49],v8 offset:53248
ds_read_b64_tr_b16 v[50:51],v8 offset:55296
s_waitcnt lgkmcnt(6)
v_mfma_f32_32x32x16_bf16 v[32:47],v[52:55],v[72:75],v[32:47]
ds_read_b64_tr_b16 v[52:53],v9 offset:53248
ds_read_b64_tr_b16 v[54:55],v9 offset:55296
s_waitcnt vmcnt(10) lgkmcnt(6)
v_mfma_f32_32x32x16_bf16 v[16:31],v[56:59],v[76:79],v[16:31]
ds_read_b64_tr_b16 v[56:57],v8 offset:54272
ds_read_b64_tr_b16 v[58:59],v8 offset:56320
s_waitcnt lgkmcnt(6)
v_mfma_f32_32x32x16_bf16 v[32:47],v[60:63],v[76:79],v[32:47]
ds_read_b64_tr_b16 v[60:61],v9 offset:54272
ds_read_b64_tr_b16 v[62:63],v9 offset:56320
buffer_load_dwordx4 v[72:75],v2,s[32:35],s59 offen offset:1024 sc1
buffer_load_dwordx4 v[76:79],v2,s[32:35],s59 offen offset:1536 sc1
s_waitcnt vmcnt(11) lgkmcnt(6)
v_mfma_f32_32x32x16_bf16 v[16:31],v[48:51],v[80:83],v[16:31]
ds_read_b64_tr_b16 v[48:49],v8 offset:57344
ds_read_b64_tr_b16 v[50:51],v8 offset:59392
s_waitcnt lgkmcnt(6)
v_mfma_f32_32x32x16_bf16 v[32:47],v[52:55],v[80:83],v[32:47]
ds_read_b64_tr_b16 v[52:53],v9 offset:57344
ds_read_b64_tr_b16 v[54:55],v9 offset:59392
s_waitcnt vmcnt(10) lgkmcnt(6)
v_mfma_f32_32x32x16_bf16 v[16:31],v[56:59],v[84:87],v[16:31]
ds_read_b64_tr_b16 v[56:57],v8 offset:58368
ds_read_b64_tr_b16 v[58:59],v8 offset:60416
s_waitcnt lgkmcnt(6)
v_mfma_f32_32x32x16_bf16 v[32:47],v[60:63],v[84:87],v[32:47]
ds_read_b64_tr_b16 v[60:61],v9 offset:58368
ds_read_b64_tr_b16 v[62:63],v9 offset:60416
buffer_load_dwordx4 v[80:83],v2,s[32:35],s59 offen offset:2048 sc1
buffer_load_dwordx4 v[84:87],v2,s[32:35],s59 offen offset:2560 sc1
s_waitcnt vmcnt(11) lgkmcnt(6)
v_mfma_f32_32x32x16_bf16 v[16:31],v[48:51],v[88:91],v[16:31]
ds_read_b64_tr_b16 v[48:49],v8 offset:61440
ds_read_b64_tr_b16 v[50:51],v8 offset:63488
s_waitcnt lgkmcnt(6)
v_mfma_f32_32x32x16_bf16 v[32:47],v[52:55],v[88:91],v[32:47]
ds_read_b64_tr_b16 v[52:53],v9 offset:61440
ds_read_b64_tr_b16 v[54:55],v9 offset:63488
s_waitcnt vmcnt(10) lgkmcnt(6)
v_mfma_f32_32x32x16_bf16 v[16:31],v[56:59],v[92:95],v[16:31]
ds_read_b64_tr_b16 v[56:57],v8 offset:62464
ds_read_b64_tr_b16 v[58:59],v8 offset:64512
s_waitcnt lgkmcnt(6)
v_mfma_f32_32x32x16_bf16 v[32:47],v[60:63],v[92:95],v[32:47]
ds_read_b64_tr_b16 v[60:61],v9 offset:62464
ds_read_b64_tr_b16 v[62:63],v9 offset:64512
buffer_load_dwordx4 v[88:91],v2,s[32:35],s59 offen offset:3072 sc1
buffer_load_dwordx4 v[92:95],v2,s[32:35],s59 offen offset:3584 sc1
af_w2:
ds_read_b32 v7,v6 offset:12
s_waitcnt lgkmcnt(0)
v_readfirstlane_b32 s44,v7
s_nop 0
s_cmp_lt_u32 s44,4
s_cbranch_scc1 af_w2
s_waitcnt vmcnt(11)
v_mfma_f32_32x32x16_bf16 v[16:31],v[48:51],v[96:99],v[16:31]
v_add_u32 v8,98304,v10
v_xor_b32 v9,64,v8
ds_read_b64_tr_b16 v[48:49],v8 offset:8192
ds_read_b64_tr_b16 v[50:51],v8 offset:10240
v_mfma_f32_32x32x16_bf16 v[32:47],v[52:55],v[96:99],v[32:47]
ds_read_b64_tr_b16 v[52:53],v9 offset:8192
ds_read_b64_tr_b16 v[54:55],v9 offset:10240
s_waitcnt vmcnt(10)
v_mfma_f32_32x32x16_bf16 v[16:31],v[56:59],v[100:103],v[16:31]
ds_read_b64_tr_b16 v[56:57],v8 offset:9216
ds_read_b64_tr_b16 v[58:59],v8 offset:11264
v_mfma_f32_32x32x16_bf16 v[32:47],v[60:63],v[100:103],v[32:47]
ds_read_b64_tr_b16 v[60:61],v9 offset:9216
ds_read_b64_tr_b16 v[62:63],v9 offset:11264
s_add_u32 s59,s59,4096
buffer_load_dwordx4 v[96:99],v2,s[32:35],s59 offen offset:0 sc1
buffer_load_dwordx4 v[100:103],v2,s[32:35],s59 offen offset:512 sc1
s_waitcnt vmcnt(11) lgkmcnt(6)
v_mfma_f32_32x32x16_bf16 v[16:31],v[48:51],v[104:107],v[16:31]
ds_read_b64_tr_b16 v[48:49],v8 offset:12288
ds_read_b64_tr_b16 v[50:51],v8 offset:14336
s_waitcnt lgkmcnt(6)
v_mfma_f32_32x32x16_bf16 v[32:47],v[52:55],v[104:107],v[32:47]
ds_read_b64_tr_b16 v[52:53],v9 offset:12288
ds_read_b64_tr_b16 v[54:55],v9 offset:14336
s_waitcnt vmcnt(10) lgkmcnt(6)
v_mfma_f32_32x32x16_bf16 v[16:31],v[56:59],v[108:111],v[16:31]
ds_read_b64_tr_b16 v[56:57],v8 offset:13312
ds_read_b64_tr_b16 v[58:59],v8 offset:15360
s_waitcnt lgkmcnt(6)
v_mfma_f32_32x32x16_bf16 v[32:47],v[60:63],v[108:111],v[32:47]
ds_read_b64_tr_b16 v[60:61],v9 offset:13312
ds_read_b64_tr_b16 v[62:63],v9 offset:15360
buffer_load_dwordx4 v[104:107],v2,s[32:35],s59 offen offset:1024 sc1
buffer_load_dwordx4 v[108:111],v2,s[32:35],s59 offen offset:1536 sc1
s_waitcnt vmcnt(11) lgkmcnt(6)
v_mfma_f32_32x32x16_bf16 v[16:31],v[48:51],v[64:67],v[16:31]
ds_read_b64_tr_b16 v[48:49],v8 offset:24576
ds_read_b64_tr_b16 v[50:51],v8 offset:26624
s_waitcnt lgkmcnt(6)
v_mfma_f32_32x32x16_bf16 v[32:47],v[52:55],v[64:67],v[32:47]
ds_read_b64_tr_b16 v[52:53],v9 offset:24576
ds_read_b64_tr_b16 v[54:55],v9 offset:26624
s_waitcnt vmcnt(10) lgkmcnt(6)
v_mfma_f32_32x32x16_bf16 v[16:31],v[56:59],v[68:71],v[16:31]
ds_read_b64_tr_b16 v[56:57],v8 offset:25600
ds_read_b64_tr_b16 v[58:59],v8 offset:27648
s_waitcnt lgkmcnt(6)
v_mfma_f32_32x32x16_bf16 v[32:47],v[60:63],v[68:71],v[32:47]
ds_read_b64_tr_b16 v[60:61],v9 offset:25600
ds_read_b64_tr_b16 v[62:63],v9 offset:27648
buffer_load_dwordx4 v[64:67],v2,s[32:35],s59 offen offset:2048 sc1
buffer_load_dwordx4 v[68:71],v2,s[32:35],s59 offen offset:2560 sc1
s_waitcnt vmcnt(11) lgkmcnt(6)
v_mfma_f32_32x32x16_bf16 v[16:31],v[48:51],v[72:75],v[16:31]
ds_read_b64_tr_b16 v[48:49],v8 offset:28672
ds_read_b64_tr_b16 v[50:51],v8 offset:30720
s_waitcnt lgkmcnt(6)
v_mfma_f32_32x32x16_bf16 v[32:47],v[52:55],v[72:75],v[32:47]
ds_read_b64_tr_b16 v[52:53],v9 offset:28672
ds_read_b64_tr_b16 v[54:55],v9 offset:30720
s_waitcnt vmcnt(10) lgkmcnt(6)
v_mfma_f32_32x32x16_bf16 v[16:31],v[56:59],v[76:79],v[16:31]
ds_read_b64_tr_b16 v[56:57],v8 offset:29696
ds_read_b64_tr_b16 v[58:59],v8 offset:31744
s_waitcnt lgkmcnt(6)
v_mfma_f32_32x32x16_bf16 v[32:47],v[60:63],v[76:79],v[32:47]
ds_read_b64_tr_b16 v[60:61],v9 offset:29696
ds_read_b64_tr_b16 v[62:63],v9 offset:31744
buffer_load_dwordx4 v[72:75],v2,s[32:35],s59 offen offset:3072 sc1
buffer_load_dwordx4 v[76:79],v2,s[32:35],s59 offen offset:3584 sc1
s_xor_b32 s43,s40,3
s_lshl_b32 s43,s43,14
s_add_u32 s43,s43,65536
v_add_u32 v11,s43,v1
s_waitcnt vmcnt(11) lgkmcnt(6)
v_mfma_f32_32x32x16_bf16 v[16:31],v[48:51],v[80:83],v[16:31]
ds_read_b128 v[112:115],v11 offset:0
v_add_u32 v8,65536,v10
v_xor_b32 v9,64,v8
ds_read_b64_tr_b16 v[48:49],v8 offset:8192
ds_read_b64_tr_b16 v[50:51],v8 offset:10240
s_waitcnt lgkmcnt(7)
v_mfma_f32_32x32x16_bf16 v[32:47],v[52:55],v[80:83],v[32:47]
ds_read_b128 v[116:119],v11 offset:1024
ds_read_b64_tr_b16 v[52:53],v9 offset:8192
ds_read_b64_tr_b16 v[54:55],v9 offset:10240
s_waitcnt vmcnt(10) lgkmcnt(8)
v_mfma_f32_32x32x16_bf16 v[16:31],v[56:59],v[84:87],v[16:31]
ds_read_b128 v[120:123],v11 offset:2048
ds_read_b64_tr_b16 v[56:57],v8 offset:9216
ds_read_b64_tr_b16 v[58:59],v8 offset:11264
s_waitcnt lgkmcnt(9)
v_mfma_f32_32x32x16_bf16 v[32:47],v[60:63],v[84:87],v[32:47]
ds_read_b128 v[124:127],v11 offset:3072
ds_read_b64_tr_b16 v[60:61],v9 offset:9216
ds_read_b64_tr_b16 v[62:63],v9 offset:11264
s_waitcnt vmcnt(9) lgkmcnt(9)
v_mfma_f32_32x32x16_bf16 v[16:31],v[48:51],v[88:91],v[16:31]
ds_read_b64_tr_b16 v[48:49],v8 offset:12288
ds_read_b64_tr_b16 v[50:51],v8 offset:14336
s_waitcnt lgkmcnt(8)
v_mfma_f32_32x32x16_bf16 v[32:47],v[52:55],v[88:91],v[32:47]
ds_read_b64_tr_b16 v[52:53],v9 offset:12288
ds_read_b64_tr_b16 v[54:55],v9 offset:14336
s_waitcnt vmcnt(8) lgkmcnt(7)
v_mfma_f32_32x32x16_bf16 v[16:31],v[56:59],v[92:95],v[16:31]
ds_read_b64_tr_b16 v[56:57],v8 offset:13312
ds_read_b64_tr_b16 v[58:59],v8 offset:15360
s_waitcnt lgkmcnt(6)
v_mfma_f32_32x32x16_bf16 v[32:47],v[60:63],v[92:95],v[32:47]
ds_read_b64_tr_b16 v[60:61],v9 offset:13312
ds_read_b64_tr_b16 v[62:63],v9 offset:15360
s_waitcnt vmcnt(7) lgkmcnt(6)
v_mfma_f32_32x32x16_bf16 v[16:31],v[48:51],v[96:99],v[16:31]
ds_read_b64_tr_b16 v[48:49],v8 offset:24576
ds_read_b64_tr_b16 v[50:51],v8 offset:26624
v_lshlrev_b32 v128,16,v112
v_and_b32 v129,0xffff0000,v112
v_lshlrev_b32 v130,16,v113
v_and_b32 v131,0xffff0000,v113
s_waitcnt lgkmcnt(6)
v_mfma_f32_32x32x16_bf16 v[32:47],v[52:55],v[96:99],v[32:47]
ds_read_b64_tr_b16 v[52:53],v9 offset:24576
ds_read_b64_tr_b16 v[54:55],v9 offset:26624
v_lshlrev_b32 v132,16,v114
v_and_b32 v133,0xffff0000,v114
v_lshlrev_b32 v134,16,v115
v_and_b32 v135,0xffff0000,v115
s_waitcnt vmcnt(6) lgkmcnt(6)
v_mfma_f32_32x32x16_bf16 v[16:31],v[56:59],v[100:103],v[16:31]
ds_read_b64_tr_b16 v[56:57],v8 offset:25600
ds_read_b64_tr_b16 v[58:59],v8 offset:27648
v_lshlrev_b32 v136,16,v116
v_and_b32 v137,0xffff0000,v116
v_lshlrev_b32 v138,16,v117
v_and_b32 v139,0xffff0000,v117
s_waitcnt lgkmcnt(6)
v_mfma_f32_32x32x16_bf16 v[32:47],v[60:63],v[100:103],v[32:47]
ds_read_b64_tr_b16 v[60:61],v9 offset:25600
ds_read_b64_tr_b16 v[62:63],v9 offset:27648
v_lshlrev_b32 v140,16,v118
v_and_b32 v141,0xffff0000,v118
v_lshlrev_b32 v142,16,v119
v_and_b32 v143,0xffff0000,v119
s_waitcnt vmcnt(5) lgkmcnt(6)
v_mfma_f32_32x32x16_bf16 v[16:31],v[48:51],v[104:107],v[16:31]
ds_read_b64_tr_b16 v[48:49],v8 offset:28672
ds_read_b64_tr_b16 v[50:51],v8 offset:30720
v_lshlrev_b32 v144,16,v120
v_and_b32 v145,0xffff0000,v120
v_lshlrev_b32 v146,16,v121
v_and_b32 v147,0xffff0000,v121
s_waitcnt lgkmcnt(6)
v_mfma_f32_32x32x16_bf16 v[32:47],v[52:55],v[104:107],v[32:47]
ds_read_b64_tr_b16 v[52:53],v9 offset:28672
ds_read_b64_tr_b16 v[54:55],v9 offset:30720
v_lshlrev_b32 v148,16,v122
v_and_b32 v149,0xffff0000,v122
v_lshlrev_b32 v150,16,v123
v_and_b32 v151,0xffff0000,v123
s_waitcnt vmcnt(4) lgkmcnt(6)
v_mfma_f32_32x32x16_bf16 v[16:31],v[56:59],v[108:111],v[16:31]
ds_read_b64_tr_b16 v[56:57],v8 offset:29696
ds_read_b64_tr_b16 v[58:59],v8 offset:31744
v_lshlrev_b32 v152,16,v124
v_and_b32 v153,0xffff0000,v124
v_lshlrev_b32 v154,16,v125
v_and_b32 v155,0xffff0000,v125
s_waitcnt lgkmcnt(6)
v_mfma_f32_32x32x16_bf16 v[32:47],v[60:63],v[108:111],v[32:47]
ds_read_b64_tr_b16 v[60:61],v9 offset:29696
ds_read_b64_tr_b16 v[62:63],v9 offset:31744
v_lshlrev_b32 v156,16,v126
v_and_b32 v157,0xffff0000,v126
v_lshlrev_b32 v158,16,v127
v_and_b32 v159,0xffff0000,v127
s_waitcnt vmcnt(3) lgkmcnt(6)
v_mfma_f32_32x32x16_bf16 v[16:31],v[48:51],v[64:67],v[16:31]
ds_read_b64_tr_b16 v[48:49],v8 offset:4096
ds_read_b64_tr_b16 v[50:51],v8 offset:6144
s_waitcnt lgkmcnt(6)
v_mfma_f32_32x32x16_bf16 v[32:47],v[52:55],v[64:67],v[32:47]
ds_read_b64_tr_b16 v[52:53],v9 offset:4096
ds_read_b64_tr_b16 v[54:55],v9 offset:6144
s_waitcnt vmcnt(2) lgkmcnt(6)
v_mfma_f32_32x32x16_bf16 v[16:31],v[56:59],v[68:71],v[16:31]
ds_read_b64_tr_b16 v[56:57],v8 offset:5120
ds_read_b64_tr_b16 v[58:59],v8 offset:7168
s_waitcnt lgkmcnt(6)
v_mfma_f32_32x32x16_bf16 v[32:47],v[60:63],v[68:71],v[32:47]
ds_read_b64_tr_b16 v[60:61],v9 offset:5120
ds_read_b64_tr_b16 v[62:63],v9 offset:7168
s_waitcnt vmcnt(1) lgkmcnt(6)
v_mfma_f32_32x32x16_bf16 v[16:31],v[48:51],v[72:75],v[16:31]
s_waitcnt lgkmcnt(4)
v_mfma_f32_32x32x16_bf16 v[32:47],v[52:55],v[72:75],v[32:47]
s_waitcnt vmcnt(0) lgkmcnt(2)
v_mfma_f32_32x32x16_bf16 v[16:31],v[56:59],v[76:79],v[16:31]
s_waitcnt lgkmcnt(0)
v_mfma_f32_32x32x16_bf16 v[32:47],v[60:63],v[76:79],v[32:47]
s_nop 9
v_pk_add_f32 v[16:17],v[16:17],v[128:129]
v_pk_add_f32 v[18:19],v[18:19],v[130:131]
v_pk_add_f32 v[20:21],v[20:21],v[132:133]
v_pk_add_f32 v[22:23],v[22:23],v[134:135]
v_cvt_pk_bf16_f32 v112,v16,v17
v_cvt_pk_bf16_f32 v113,v18,v19
v_cvt_pk_bf16_f32 v114,v20,v21
v_cvt_pk_bf16_f32 v115,v22,v23
buffer_store_dwordx4 v[112:115],v3,s[28:31],s50 offen offset:0
v_pk_add_f32 v[24:25],v[24:25],v[136:137]
v_pk_add_f32 v[26:27],v[26:27],v[138:139]
v_pk_add_f32 v[28:29],v[28:29],v[140:141]
v_pk_add_f32 v[30:31],v[30:31],v[142:143]
v_cvt_pk_bf16_f32 v116,v24,v25
v_cvt_pk_bf16_f32 v117,v26,v27
v_cvt_pk_bf16_f32 v118,v28,v29
v_cvt_pk_bf16_f32 v119,v30,v31
buffer_store_dwordx4 v[116:119],v3,s[28:31],s50 offen offset:32
v_pk_add_f32 v[32:33],v[32:33],v[144:145]
v_pk_add_f32 v[34:35],v[34:35],v[146:147]
v_pk_add_f32 v[36:37],v[36:37],v[148:149]
v_pk_add_f32 v[38:39],v[38:39],v[150:151]
v_cvt_pk_bf16_f32 v120,v32,v33
v_cvt_pk_bf16_f32 v121,v34,v35
v_cvt_pk_bf16_f32 v122,v36,v37
v_cvt_pk_bf16_f32 v123,v38,v39
buffer_store_dwordx4 v[120:123],v3,s[28:31],s50 offen offset:64
v_pk_add_f32 v[40:41],v[40:41],v[152:153]
v_pk_add_f32 v[42:43],v[42:43],v[154:155]
v_pk_add_f32 v[44:45],v[44:45],v[156:157]
v_pk_add_f32 v[46:47],v[46:47],v[158:159]
v_cvt_pk_bf16_f32 v124,v40,v41
v_cvt_pk_bf16_f32 v125,v42,v43
v_cvt_pk_bf16_f32 v126,v44,v45
v_cvt_pk_bf16_f32 v127,v46,v47
buffer_store_dwordx4 v[124:127],v3,s[28:31],s50 offen offset:96
s_barrier
s_endpgm
af_qwait:
s_sleep 1
s_sub_u32 s45,s45,1
s_cbranch_scc0 af_qpoll
v_mov_b32 v6,161792
ds_write_b32 v6,v6 offset:56
s_branch af_qown
af_redo:
s_mov_b32 s52,0
s_mov_b32 s53,s46
s_add_u32 s54,s46,1
s_mov_b32 s56,s51
s_add_u32 s57,s51,2
af_slow:
s_mov_b32 s55,s56
s_waitcnt vmcnt(0) lgkmcnt(0)
af_slow_b:
s_lshl_b32 s48,s53,17
s_lshl_b32 s43,s55,11
s_add_u32 s43,s43,s48
buffer_load_dwordx4 v[8:11],v1,s[32:35],s43 offen offset:0 sc1
buffer_load_dwordx4 v[12:15],v1,s[32:35],s43 offen offset:1024 sc1
s_add_u32 s48,s48,4194304
s_mov_b32 s43,s48
s_mov_b32 s45,64
v_mov_b32 v128,0xff800000
v_mov_b32 v132,0xff800000
v_and_b32 v4,3,v0
v_cmp_eq_u32 vcc,0,v4
v_mov_b32 v4,0x3f803f80
v_mov_b32 v60,0xdddd
v_cndmask_b32 v56,0,v4,vcc
v_cndmask_b32 v57,0,v4,vcc
v_cndmask_b32 v58,0,v4,vcc
v_cndmask_b32 v59,0,v4,vcc
af_slow_p1:
buffer_load_dwordx4 v[24:27],v1,s[32:35],s43 offen offset:0 sc1
buffer_load_dwordx4 v[28:31],v1,s[32:35],s43 offen offset:1024 sc1
s_waitcnt vmcnt(0)
v_mfma_f32_16x16x32_bf16 v[64:67],v[24:27],v[8:11],0
v_mfma_f32_16x16x32_bf16 v[68:71],v[28:31],v[8:11],0
v_mfma_f32_16x16x32_bf16 v[72:75],v[24:27],v[12:15],0
v_mfma_f32_16x16x32_bf16 v[76:79],v[28:31],v[12:15],0
s_nop 7
v_max3_f32 v128,v128,v64,v65
v_max3_f32 v128,v128,v66,v67
v_max3_f32 v128,v128,v68,v69
v_max3_f32 v128,v128,v70,v71
v_max3_f32 v132,v132,v72,v73
v_max3_f32 v132,v132,v74,v75
v_max3_f32 v132,v132,v76,v77
v_max3_f32 v132,v132,v78,v79
s_add_u32 s43,s43,2048
s_sub_u32 s45,s45,1
s_cmp_lg_u32 s45,0
s_cbranch_scc1 af_slow_p1
v_mov_b32 v129,v128
v_mov_b32 v133,v132
s_nop 1
v_permlane32_swap_b32 v128,v129
v_permlane32_swap_b32 v132,v133
s_nop 0
v_max_f32 v128,v128,v129
v_max_f32 v132,v132,v133
v_mov_b32 v129,v128
v_mov_b32 v133,v132
s_nop 1
v_permlane16_swap_b32 v128,v129
v_permlane16_swap_b32 v132,v133
s_nop 0
v_max_f32 v128,v128,v129
v_max_f32 v132,v132,v133
v_sub_f32 v131,0,v128
v_sub_f32 v135,0,v132
v_sub_f32 v130,0,v128
v_sub_f32 v134,0,v132
v_sub_f32 v129,0,v128
v_sub_f32 v133,0,v132
v_sub_f32 v128,0,v128
v_sub_f32 v132,0,v132
v_mov_b32 v96,0
v_mov_b32 v97,0
v_mov_b32 v98,0
v_mov_b32 v99,0
v_mov_b32 v100,0
v_mov_b32 v101,0
v_mov_b32 v102,0
v_mov_b32 v103,0
v_mov_b32 v104,0
v_mov_b32 v105,0
v_mov_b32 v106,0
v_mov_b32 v107,0
v_mov_b32 v108,0
v_mov_b32 v109,0
v_mov_b32 v110,0
v_mov_b32 v111,0
v_mov_b32 v144,0
v_mov_b32 v145,0
v_mov_b32 v146,0
v_mov_b32 v147,0
v_mov_b32 v148,0
v_mov_b32 v149,0
v_mov_b32 v150,0
v_mov_b32 v151,0
s_mov_b32 s45,64
af_slow_p2:
s_add_u32 s43,s48,4194304
buffer_load_dwordx4 v[24:27],v1,s[32:35],s48 offen offset:0 sc1
buffer_load_dwordx4 v[28:31],v1,s[32:35],s48 offen offset:1024 sc1
buffer_load_dwordx4 v[40:43],v1,s[32:35],s43 offen offset:0 sc1
buffer_load_dwordx4 v[44:47],v1,s[32:35],s43 offen offset:1024 sc1
s_waitcnt vmcnt(0)
v_mfma_f32_16x16x32_bf16 v[64:67],v[24:27],v[8:11],v[128:131]
v_mfma_f32_16x16x32_bf16 v[68:71],v[28:31],v[8:11],v[128:131]
v_mfma_f32_16x16x32_bf16 v[72:75],v[24:27],v[12:15],v[132:135]
v_mfma_f32_16x16x32_bf16 v[76:79],v[28:31],v[12:15],v[132:135]
s_nop 7
v_exp_f32 v64,v64
v_exp_f32 v65,v65
v_exp_f32 v66,v66
v_exp_f32 v67,v67
v_exp_f32 v68,v68
v_exp_f32 v69,v69
v_exp_f32 v70,v70
v_exp_f32 v71,v71
v_exp_f32 v72,v72
v_exp_f32 v73,v73
v_exp_f32 v74,v74
v_exp_f32 v75,v75
v_exp_f32 v76,v76
v_exp_f32 v77,v77
v_exp_f32 v78,v78
v_exp_f32 v79,v79
s_nop 1
v_smfmac_f32_16x16x64_bf16 v[96:99],v[40:43],v[64:71],v60
v_smfmac_f32_16x16x64_bf16 v[100:103],v[44:47],v[64:71],v60
v_smfmac_f32_16x16x64_bf16 v[144:147],v[56:59],v[64:71],v60
v_smfmac_f32_16x16x64_bf16 v[104:107],v[40:43],v[72:79],v60
v_smfmac_f32_16x16x64_bf16 v[108:111],v[44:47],v[72:79],v60
v_smfmac_f32_16x16x64_bf16 v[148:151],v[56:59],v[72:79],v60
s_add_u32 s48,s48,2048
s_sub_u32 s45,s45,1
s_cmp_lg_u32 s45,0
s_nop 7
s_cbranch_scc1 af_slow_p2
v_rcp_f32 v144,v144
v_rcp_f32 v148,v148
s_mul_i32 s43,s55,294912
s_lshl_b32 s44,s53,10
s_add_u32 s43,s43,s44
s_add_u32 s43,s43,12697600
v_mul_f32 v96,v144,v96
v_mul_f32 v97,v144,v97
v_mul_f32 v98,v144,v98
v_mul_f32 v99,v144,v99
v_mul_f32 v100,v144,v100
v_mul_f32 v101,v144,v101
v_mul_f32 v102,v144,v102
v_mul_f32 v103,v144,v103
v_cvt_pk_bf16_f32 v64,v96,v97
v_cvt_pk_bf16_f32 v65,v98,v99
v_cvt_pk_bf16_f32 v66,v100,v101
v_cvt_pk_bf16_f32 v67,v102,v103
buffer_store_dwordx4 v[64:67],v1,s[32:35],s43 offen sc1
s_add_u32 s43,s43,147456
v_mul_f32 v104,v148,v104
v_mul_f32 v105,v148,v105
v_mul_f32 v106,v148,v106
v_mul_f32 v107,v148,v107
v_mul_f32 v108,v148,v108
v_mul_f32 v109,v148,v109
v_mul_f32 v110,v148,v110
v_mul_f32 v111,v148,v111
v_cvt_pk_bf16_f32 v72,v104,v105
v_cvt_pk_bf16_f32 v73,v106,v107
v_cvt_pk_bf16_f32 v74,v108,v109
v_cvt_pk_bf16_f32 v75,v110,v111
buffer_store_dwordx4 v[72:75],v1,s[32:35],s43 offen sc1
s_waitcnt vmcnt(0)
s_add_u32 s55,s55,1
s_cmp_lt_u32 s55,s57
s_cbranch_scc1 af_slow_b
s_add_u32 s53,s53,1
s_cmp_lt_u32 s53,s54
s_cbranch_scc1 af_slow
s_cmp_eq_u32 s52,0
s_cbranch_scc1 af_signal
v_lshlrev_b32 v16,16,v176
v_and_b32 v17,0xffff0000,v176
v_lshlrev_b32 v18,16,v177
v_and_b32 v19,0xffff0000,v177
v_lshlrev_b32 v20,16,v178
v_and_b32 v21,0xffff0000,v178
v_lshlrev_b32 v22,16,v179
v_and_b32 v23,0xffff0000,v179
v_lshlrev_b32 v24,16,v180
v_and_b32 v25,0xffff0000,v180
v_lshlrev_b32 v26,16,v181
v_and_b32 v27,0xffff0000,v181
v_lshlrev_b32 v28,16,v182
v_and_b32 v29,0xffff0000,v182
v_lshlrev_b32 v30,16,v183
v_and_b32 v31,0xffff0000,v183
v_lshlrev_b32 v32,16,v184
v_and_b32 v33,0xffff0000,v184
v_lshlrev_b32 v34,16,v185
v_and_b32 v35,0xffff0000,v185
v_lshlrev_b32 v36,16,v186
v_and_b32 v37,0xffff0000,v186
v_lshlrev_b32 v38,16,v187
v_and_b32 v39,0xffff0000,v187
v_lshlrev_b32 v40,16,v188
v_and_b32 v41,0xffff0000,v188
v_lshlrev_b32 v42,16,v189
v_and_b32 v43,0xffff0000,v189
v_lshlrev_b32 v44,16,v190
v_and_b32 v45,0xffff0000,v190
v_lshlrev_b32 v46,16,v191
v_and_b32 v47,0xffff0000,v191
v_lshrrev_b32 v5,5,v0
v_bfe_u32 v4,v0,2,2
v_lshl_add_u32 v5,v5,2,v4
v_lshlrev_b32 v5,7,v5
v_lshrrev_b32 v4,1,v4
v_lshl_add_u32 v5,v4,6,v5
v_lshrrev_b32 v4,1,v0
v_xor_b32 v4,v4,v0
v_bfe_u32 v4,v4,4,1
v_lshl_add_u32 v5,v4,5,v5
v_and_b32 v4,1,v0
v_lshl_add_u32 v5,v4,4,v5
v_bfe_u32 v4,v0,1,1
v_lshl_add_u32 v10,v4,3,v5
v_add_u32 v8,131072,v10
v_xor_b32 v9,64,v8
v_mov_b32 v6,161792
s_lshl_b32 s59,s41,2
s_add_u32 s59,s59,s40
s_mul_i32 s59,s59,294912
s_add_u32 s59,s59,12697600
s_branch af_oph
.p2align 6
af_gemm:
v_lshrrev_b32 v4,3,v0
v_and_b32 v5,7,v0
v_and_b32 v6,2,v4
v_lshlrev_b32 v6,1,v6
v_xor_b32 v5,v5,v6
v_lshrrev_b32 v6,1,v4
v_and_b32 v6,2,v6
v_xor_b32 v5,v5,v6
v_lshlrev_b32 v4,11,v4
v_lshl_add_u32 v12,v5,4,v4
v_add_u32 v13,15360,v12
v_add_u32 v14,30720,v12
v_add_u32 v15,46080,v12
s_lshl_b32 s54,s42,7
s_lshl_b32 s43,s47,16
s_add_u32 s52,s54,s43
s_add_u32 s54,s52,s43
s_lshl_b32 s53,s47,14
s_xor_b32 s55,s53,0x8000
s_add_u32 s53,s53,65536
s_add_u32 s55,s55,65536
s_add_u32 s48,s48,16384
s_and_b32 s48,s48,0x1ffff
s_or_b32 s48,s48,s60
s_mul_i32 s51,s41,1179648
s_lshl_b32 s43,s47,10
s_add_u32 s51,s51,s43
s_add_u32 s51,s51,12582912
s_xor_b32 s43,s47,0
s_mul_i32 s43,s43,294912
v_add_u32 v8,s43,v1
s_xor_b32 s43,s47,1
s_mul_i32 s43,s43,294912
v_add_u32 v9,s43,v1
s_xor_b32 s43,s47,2
s_mul_i32 s43,s43,294912
v_add_u32 v10,s43,v1
s_xor_b32 s43,s47,3
s_mul_i32 s43,s43,294912
v_add_u32 v11,s43,v1
s_add_u32 s57,s51,147456
v_lshrrev_b32 v6,2,v0
v_lshlrev_b32 v6,7,v6
v_bfe_u32 v7,v0,3,1
v_lshl_add_u32 v6,v7,6,v6
v_bfe_u32 v7,v0,4,1
v_lshl_add_u32 v6,v7,5,v6
v_and_b32 v7,3,v0
v_lshl_add_u32 v6,v7,3,v6
v_add_u32 v2,s53,v6
v_xor_b32 v3,32,v2
v_xor_b32 v4,64,v2
v_xor_b32 v5,96,v2
s_waitcnt lgkmcnt(0)
s_mov_b32 s20,s8
s_and_b32 s21,s9,0xffff
s_mov_b32 s22,7340032
s_mov_b32 s23,0x00020000
s_mov_b32 s32,s12
s_and_b32 s33,s13,0xffff
s_mov_b32 s34,268435456
s_mov_b32 s35,0x00020000
s_mov_b32 s24,s6
s_and_b32 s25,s7,0xffff
s_mov_b32 s26,2097152
s_mov_b32 s27,0x00020000
s_mov_b32 s58,0
s_lshr_b32 s44,s46,1
s_lshl_b32 s44,s44,3
s_lshr_b32 s43,s2,5
s_add_u32 s44,s44,s43
s_lshl_b32 s44,s44,1
s_and_b32 s43,s46,1
s_add_u32 s44,s44,s43
s_lshl_b32 s44,s44,9
s_add_u32 s44,s44,131072
s_lshl_b32 s43,s41,4
s_add_u32 s43,s43,s42
s_lshl_b32 s43,s43,9
s_add_u32 s43,s43,0
v_cmp_gt_u32 vcc,32,v0
v_and_b32 v16,15,v0
v_lshl_add_u32 v16,v16,2,s44
v_lshl_add_u32 v17,v0,2,s43
v_cndmask_b32 v16,v16,v17,vcc
s_mov_b32 s59,41943040
v_mov_b32 v6,v16
s_mov_b32 s45,3000
s_cmp_lg_u32 s100,-1
s_cbranch_scc1 af_kok
af_kpoll:
buffer_load_dword v7,v6,s[32:35],s59 offen sc1
s_waitcnt vmcnt(0)
v_cmp_eq_u32 vcc,0,v7
s_nop 1
s_cmp_lg_u32 vcc_hi,0
s_cbranch_scc1 af_kwait
af_kst:
af_kok:
s_add_u32 m0,s49,32768
s_nop 0
buffer_load_dwordx4 v1,s[32:35],s48 offen offset:0 sc1 lds
buffer_load_dwordx4 v1,s[32:35],s48 offen offset:1024 sc1 lds
buffer_load_dwordx4 v1,s[32:35],s48 offen offset:2048 sc1 lds
buffer_load_dwordx4 v1,s[32:35],s48 offen offset:3072 sc1 lds
s_add_u32 s48,s48,4096
s_add_u32 m0,s49,36864
s_nop 0
buffer_load_dwordx4 v1,s[32:35],s48 offen offset:0 sc1 lds
buffer_load_dwordx4 v1,s[32:35],s48 offen offset:1024 sc1 lds
buffer_load_dwordx4 v1,s[32:35],s48 offen offset:2048 sc1 lds
buffer_load_dwordx4 v1,s[32:35],s48 offen offset:3072 sc1 lds
s_add_u32 s48,s48,12288
s_and_b32 s48,s48,0x1ffff
s_or_b32 s48,s48,s60
s_cmp_lg_u32 s100,-1
s_cbranch_scc1 af_kns
s_add_u32 s43,s61,0
buffer_store_dwordx4 v[128:131],v1,s[32:35],s43 offen sc1
s_add_u32 s43,s61,147456
buffer_store_dwordx4 v[132:135],v1,s[32:35],s43 offen sc1
s_add_u32 s43,s61,294912
buffer_store_dwordx4 v[136:139],v1,s[32:35],s43 offen sc1
s_add_u32 s43,s61,442368
buffer_store_dwordx4 v[140:143],v1,s[32:35],s43 offen sc1
s_add_u32 s43,s61,1024
buffer_store_dwordx4 v[144:147],v1,s[32:35],s43 offen sc1
s_add_u32 s43,s61,148480
buffer_store_dwordx4 v[148:151],v1,s[32:35],s43 offen sc1
s_add_u32 s43,s61,295936
buffer_store_dwordx4 v[152:155],v1,s[32:35],s43 offen sc1
s_add_u32 s43,s61,443392
buffer_store_dwordx4 v[156:159],v1,s[32:35],s43 offen sc1
af_kns:
s_waitcnt vmcnt(0)
v_mov_b32 v6,161792
v_mov_b32 v7,1
s_mov_b64 exec,1
ds_add_rtn_u32 v7,v6,v7 offset:52
s_mov_b64 exec,-1
s_and_b32 s43,s2,0xe0
s_lshl_b32 s43,s43,7
s_add_u32 s43,s43,s46
s_lshl_b32 s43,s43,2
s_add_u32 s43,s43,41943040
s_waitcnt lgkmcnt(0)
v_readfirstlane_b32 s44,v7
v_lshlrev_b32 v7,9,v0
s_cmp_lg_u32 s44,7
s_cbranch_scc1 af_nh2
s_mov_b32 exec_hi,0
buffer_store_dword v6,v7,s[32:35],s43 offen sc1
s_mov_b32 exec_hi,-1
af_nh2:
s_waitcnt vmcnt(0)
s_barrier
s_add_u32 m0,s49,0
s_nop 0
buffer_load_dwordx4 v1,s[32:35],s48 offen offset:0 sc1 lds
buffer_load_dwordx4 v1,s[32:35],s48 offen offset:1024 sc1 lds
buffer_load_dwordx4 v1,s[32:35],s48 offen offset:2048 sc1 lds
buffer_load_dwordx4 v1,s[32:35],s48 offen offset:3072 sc1 lds
s_add_u32 s48,s48,4096
s_add_u32 m0,s49,4096
s_nop 0
buffer_load_dwordx4 v1,s[32:35],s48 offen offset:0 sc1 lds
buffer_load_dwordx4 v1,s[32:35],s48 offen offset:1024 sc1 lds
buffer_load_dwordx4 v1,s[32:35],s48 offen offset:2048 sc1 lds
buffer_load_dwordx4 v1,s[32:35],s48 offen offset:3072 sc1 lds
s_add_u32 s48,s48,12288
s_and_b32 s48,s48,0x1ffff
s_or_b32 s48,s48,s60
v_mov_b32 v6,v16
s_mov_b32 s45,3000
s_cmp_lg_u32 s100,-1
s_cbranch_scc1 af_hok
af_hpoll:
buffer_load_dword v7,v6,s[32:35],s59 offen sc1
s_waitcnt vmcnt(0)
v_cmp_eq_u32 vcc,0,v7
s_nop 1
s_lshr_b32 s43,vcc_lo,4
s_or_b32 s43,s43,vcc_lo
s_lshr_b32 s44,s43,2
s_or_b32 s43,s43,s44
s_lshr_b32 s44,s43,1
s_or_b32 s43,s43,s44
s_cmp_lg_u32 vcc_hi,0
s_cselect_b32 s43,-1,s43
s_andn2_b32 s43,0x01010101,s43
s_cbranch_scc0 af_hwait
s_ff1_i32_b32 s58,s43
s_mul_i32 s43,s58,3584
s_add_u32 s51,s51,s43
s_add_u32 s57,s57,s43
s_lshl_b32 s43,s43,6
s_add_u32 s52,s52,s43
af_hok:
s_add_u32 m0,s53,0
s_nop 0
buffer_load_dwordx4 v12,s[20:23],s52 offen offset:0 lds
buffer_load_dwordx4 v13,s[20:23],s52 offen offset:1024 lds
buffer_load_dwordx4 v14,s[20:23],s52 offen offset:2048 lds
buffer_load_dwordx4 v15,s[20:23],s52 offen offset:3072 lds
s_add_u32 s52,s52,262144
buffer_load_dwordx4 v[32:35],v8,s[32:35],s51 offen sc1
buffer_load_dwordx4 v[36:39],v9,s[32:35],s51 offen sc1
buffer_load_dwordx4 v[40:43],v10,s[32:35],s51 offen sc1
buffer_load_dwordx4 v[44:47],v11,s[32:35],s51 offen sc1
s_add_u32 s51,s51,4096
buffer_load_dwordx4 v[48:51],v8,s[32:35],s57 offen sc1
buffer_load_dwordx4 v[52:55],v9,s[32:35],s57 offen sc1
buffer_load_dwordx4 v[56:59],v10,s[32:35],s57 offen sc1
buffer_load_dwordx4 v[60:63],v11,s[32:35],s57 offen sc1
s_add_u32 s57,s57,4096
s_add_u32 m0,s53,4096
s_nop 0
buffer_load_dwordx4 v12,s[20:23],s52 offen offset:0 lds
buffer_load_dwordx4 v13,s[20:23],s52 offen offset:1024 lds
buffer_load_dwordx4 v14,s[20:23],s52 offen offset:2048 lds
buffer_load_dwordx4 v15,s[20:23],s52 offen offset:3072 lds
s_add_u32 s52,s52,262144
buffer_load_dwordx4 v[64:67],v8,s[32:35],s51 offen sc1
buffer_load_dwordx4 v[68:71],v9,s[32:35],s51 offen sc1
buffer_load_dwordx4 v[72:75],v10,s[32:35],s51 offen sc1
buffer_load_dwordx4 v[76:79],v11,s[32:35],s51 offen sc1
s_add_u32 s51,s51,4096
buffer_load_dwordx4 v[80:83],v8,s[32:35],s57 offen sc1
buffer_load_dwordx4 v[84:87],v9,s[32:35],s57 offen sc1
buffer_load_dwordx4 v[88:91],v10,s[32:35],s57 offen sc1
buffer_load_dwordx4 v[92:95],v11,s[32:35],s57 offen sc1
s_add_u32 s57,s57,4096
s_add_u32 m0,s53,8192
s_nop 0
buffer_load_dwordx4 v12,s[20:23],s52 offen offset:0 lds
buffer_load_dwordx4 v13,s[20:23],s52 offen offset:1024 lds
buffer_load_dwordx4 v14,s[20:23],s52 offen offset:2048 lds
buffer_load_dwordx4 v15,s[20:23],s52 offen offset:3072 lds
s_add_u32 s52,s52,262144
buffer_load_dwordx4 v[96:99],v8,s[32:35],s51 offen sc1
buffer_load_dwordx4 v[100:103],v9,s[32:35],s51 offen sc1
buffer_load_dwordx4 v[104:107],v10,s[32:35],s51 offen sc1
buffer_load_dwordx4 v[108:111],v11,s[32:35],s51 offen sc1
s_add_u32 s51,s51,4096
buffer_load_dwordx4 v[112:115],v8,s[32:35],s57 offen sc1
buffer_load_dwordx4 v[116:119],v9,s[32:35],s57 offen sc1
buffer_load_dwordx4 v[120:123],v10,s[32:35],s57 offen sc1
buffer_load_dwordx4 v[124:127],v11,s[32:35],s57 offen sc1
s_add_u32 s57,s57,4096
s_add_u32 m0,s53,12288
s_nop 0
buffer_load_dwordx4 v12,s[20:23],s52 offen offset:0 lds
buffer_load_dwordx4 v13,s[20:23],s52 offen offset:1024 lds
buffer_load_dwordx4 v14,s[20:23],s52 offen offset:2048 lds
buffer_load_dwordx4 v15,s[20:23],s52 offen offset:3072 lds
s_add_u32 s52,s52,262144
s_setprio 0
s_waitcnt vmcnt(36)
ds_read_b64_tr_b16 v[16:17],v2 offset:0
ds_read_b64_tr_b16 v[18:19],v2 offset:2048
ds_read_b64_tr_b16 v[20:21],v3 offset:0
ds_read_b64_tr_b16 v[22:23],v3 offset:2048
ds_read_b64_tr_b16 v[24:25],v4 offset:0
ds_read_b64_tr_b16 v[26:27],v4 offset:2048
ds_read_b64_tr_b16 v[28:29],v5 offset:0
ds_read_b64_tr_b16 v[30:31],v5 offset:2048
s_waitcnt vmcnt(40)
s_barrier
s_waitcnt vmcnt(32) lgkmcnt(6)
v_mfma_f32_16x16x32_bf16 v[128:131],v[16:19],v[32:35],0
v_mfma_f32_16x16x32_bf16 v[160:163],v[16:19],v[36:39],0
s_add_u32 m0,s49,32768
s_nop 0
buffer_load_dwordx4 v1,s[32:35],s48 offen offset:0 sc1 lds
v_mfma_f32_16x16x32_bf16 v[192:195],v[16:19],v[40:43],0
v_mfma_f32_16x16x32_bf16 v[224:227],v[16:19],v[44:47],0
buffer_load_dwordx4 v1,s[32:35],s48 offen offset:1024 sc1 lds
s_waitcnt lgkmcnt(4)
v_mfma_f32_16x16x32_bf16 v[132:135],v[20:23],v[32:35],0
v_mfma_f32_16x16x32_bf16 v[164:167],v[20:23],v[36:39],0
buffer_load_dwordx4 v1,s[32:35],s48 offen offset:2048 sc1 lds
v_mfma_f32_16x16x32_bf16 v[196:199],v[20:23],v[40:43],0
v_mfma_f32_16x16x32_bf16 v[228:231],v[20:23],v[44:47],0
buffer_load_dwordx4 v1,s[32:35],s48 offen offset:3072 sc1 lds
s_add_u32 s48,s48,4096
s_waitcnt lgkmcnt(2)
v_mfma_f32_16x16x32_bf16 v[136:139],v[24:27],v[32:35],0
v_mfma_f32_16x16x32_bf16 v[168:171],v[24:27],v[36:39],0
v_mfma_f32_16x16x32_bf16 v[200:203],v[24:27],v[40:43],0
v_mfma_f32_16x16x32_bf16 v[232:235],v[24:27],v[44:47],0
s_waitcnt lgkmcnt(0)
v_mfma_f32_16x16x32_bf16 v[140:143],v[28:31],v[32:35],0
buffer_load_dwordx4 v[32:35],v8,s[32:35],s51 offen sc1
v_mfma_f32_16x16x32_bf16 v[172:175],v[28:31],v[36:39],0
buffer_load_dwordx4 v[36:39],v9,s[32:35],s51 offen sc1
v_mfma_f32_16x16x32_bf16 v[204:207],v[28:31],v[40:43],0
buffer_load_dwordx4 v[40:43],v10,s[32:35],s51 offen sc1
v_mfma_f32_16x16x32_bf16 v[236:239],v[28:31],v[44:47],0
buffer_load_dwordx4 v[44:47],v11,s[32:35],s51 offen sc1
s_add_u32 s51,s51,4096
s_waitcnt vmcnt(32)
v_mfma_f32_16x16x32_bf16 v[144:147],v[16:19],v[48:51],0
v_mfma_f32_16x16x32_bf16 v[176:179],v[16:19],v[52:55],0
s_add_u32 m0,s53,0
s_nop 0
buffer_load_dwordx4 v12,s[20:23],s52 offen offset:0 lds
v_mfma_f32_16x16x32_bf16 v[208:211],v[16:19],v[56:59],0
v_mfma_f32_16x16x32_bf16 v[240:243],v[16:19],v[60:63],0
buffer_load_dwordx4 v13,s[20:23],s52 offen offset:1024 lds
ds_read_b64_tr_b16 v[16:17],v2 offset:4096
ds_read_b64_tr_b16 v[18:19],v2 offset:6144
v_mfma_f32_16x16x32_bf16 v[148:151],v[20:23],v[48:51],0
v_mfma_f32_16x16x32_bf16 v[180:183],v[20:23],v[52:55],0
buffer_load_dwordx4 v14,s[20:23],s52 offen offset:2048 lds
v_mfma_f32_16x16x32_bf16 v[212:215],v[20:23],v[56:59],0
v_mfma_f32_16x16x32_bf16 v[244:247],v[20:23],v[60:63],0
buffer_load_dwordx4 v15,s[20:23],s52 offen offset:3072 lds
s_add_u32 s52,s52,262144
ds_read_b64_tr_b16 v[20:21],v3 offset:4096
ds_read_b64_tr_b16 v[22:23],v3 offset:6144
v_mfma_f32_16x16x32_bf16 v[152:155],v[24:27],v[48:51],0
v_mfma_f32_16x16x32_bf16 v[184:187],v[24:27],v[52:55],0
v_mfma_f32_16x16x32_bf16 v[216:219],v[24:27],v[56:59],0
v_mfma_f32_16x16x32_bf16 v[248:251],v[24:27],v[60:63],0
ds_read_b64_tr_b16 v[24:25],v4 offset:4096
ds_read_b64_tr_b16 v[26:27],v4 offset:6144
v_mfma_f32_16x16x32_bf16 v[156:159],v[28:31],v[48:51],0
buffer_load_dwordx4 v[48:51],v8,s[32:35],s57 offen sc1
v_mfma_f32_16x16x32_bf16 v[188:191],v[28:31],v[52:55],0
buffer_load_dwordx4 v[52:55],v9,s[32:35],s57 offen sc1
v_mfma_f32_16x16x32_bf16 v[220:223],v[28:31],v[56:59],0
buffer_load_dwordx4 v[56:59],v10,s[32:35],s57 offen sc1
v_mfma_f32_16x16x32_bf16 v[252:255],v[28:31],v[60:63],0
buffer_load_dwordx4 v[60:63],v11,s[32:35],s57 offen sc1
s_add_u32 s57,s57,4096
ds_read_b64_tr_b16 v[28:29],v5 offset:4096
ds_read_b64_tr_b16 v[30:31],v5 offset:6144
s_waitcnt vmcnt(36) lgkmcnt(6)
v_mfma_f32_16x16x32_bf16 v[128:131],v[16:19],v[64:67],v[128:131]
v_mfma_f32_16x16x32_bf16 v[160:163],v[16:19],v[68:71],v[160:163]
s_add_u32 m0,s49,36864
s_nop 0
buffer_load_dwordx4 v1,s[32:35],s48 offen offset:0 sc1 lds
v_mfma_f32_16x16x32_bf16 v[192:195],v[16:19],v[72:75],v[192:195]
v_mfma_f32_16x16x32_bf16 v[224:227],v[16:19],v[76:79],v[224:227]
buffer_load_dwordx4 v1,s[32:35],s48 offen offset:1024 sc1 lds
s_waitcnt lgkmcnt(4)
v_mfma_f32_16x16x32_bf16 v[132:135],v[20:23],v[64:67],v[132:135]
v_mfma_f32_16x16x32_bf16 v[164:167],v[20:23],v[68:71],v[164:167]
buffer_load_dwordx4 v1,s[32:35],s48 offen offset:2048 sc1 lds
v_mfma_f32_16x16x32_bf16 v[196:199],v[20:23],v[72:75],v[196:199]
v_mfma_f32_16x16x32_bf16 v[228:231],v[20:23],v[76:79],v[228:231]
buffer_load_dwordx4 v1,s[32:35],s48 offen offset:3072 sc1 lds
s_add_u32 s48,s48,12288
s_and_b32 s48,s48,0x1ffff
s_or_b32 s48,s48,s60
s_waitcnt lgkmcnt(2)
v_mfma_f32_16x16x32_bf16 v[136:139],v[24:27],v[64:67],v[136:139]
v_mfma_f32_16x16x32_bf16 v[168:171],v[24:27],v[68:71],v[168:171]
v_mfma_f32_16x16x32_bf16 v[200:203],v[24:27],v[72:75],v[200:203]
v_mfma_f32_16x16x32_bf16 v[232:235],v[24:27],v[76:79],v[232:235]
s_waitcnt lgkmcnt(0)
v_mfma_f32_16x16x32_bf16 v[140:143],v[28:31],v[64:67],v[140:143]
buffer_load_dwordx4 v[64:67],v8,s[32:35],s51 offen sc1
v_mfma_f32_16x16x32_bf16 v[172:175],v[28:31],v[68:71],v[172:175]
buffer_load_dwordx4 v[68:71],v9,s[32:35],s51 offen sc1
v_mfma_f32_16x16x32_bf16 v[204:207],v[28:31],v[72:75],v[204:207]
buffer_load_dwordx4 v[72:75],v10,s[32:35],s51 offen sc1
v_mfma_f32_16x16x32_bf16 v[236:239],v[28:31],v[76:79],v[236:239]
buffer_load_dwordx4 v[76:79],v11,s[32:35],s51 offen sc1
s_add_u32 s51,s51,4096
s_waitcnt vmcnt(36)
v_mfma_f32_16x16x32_bf16 v[144:147],v[16:19],v[80:83],v[144:147]
v_mfma_f32_16x16x32_bf16 v[176:179],v[16:19],v[84:87],v[176:179]
s_add_u32 m0,s53,4096
s_nop 0
buffer_load_dwordx4 v12,s[20:23],s52 offen offset:0 lds
v_mfma_f32_16x16x32_bf16 v[208:211],v[16:19],v[88:91],v[208:211]
v_mfma_f32_16x16x32_bf16 v[240:243],v[16:19],v[92:95],v[240:243]
buffer_load_dwordx4 v13,s[20:23],s52 offen offset:1024 lds
ds_read_b64_tr_b16 v[16:17],v2 offset:8192
ds_read_b64_tr_b16 v[18:19],v2 offset:10240
v_mfma_f32_16x16x32_bf16 v[148:151],v[20:23],v[80:83],v[148:151]
v_mfma_f32_16x16x32_bf16 v[180:183],v[20:23],v[84:87],v[180:183]
buffer_load_dwordx4 v14,s[20:23],s52 offen offset:2048 lds
v_mfma_f32_16x16x32_bf16 v[212:215],v[20:23],v[88:91],v[212:215]
v_mfma_f32_16x16x32_bf16 v[244:247],v[20:23],v[92:95],v[244:247]
buffer_load_dwordx4 v15,s[20:23],s52 offen offset:3072 lds
s_add_u32 s52,s52,262144
ds_read_b64_tr_b16 v[20:21],v3 offset:8192
ds_read_b64_tr_b16 v[22:23],v3 offset:10240
v_mfma_f32_16x16x32_bf16 v[152:155],v[24:27],v[80:83],v[152:155]
v_mfma_f32_16x16x32_bf16 v[184:187],v[24:27],v[84:87],v[184:187]
v_mfma_f32_16x16x32_bf16 v[216:219],v[24:27],v[88:91],v[216:219]
v_mfma_f32_16x16x32_bf16 v[248:251],v[24:27],v[92:95],v[248:251]
ds_read_b64_tr_b16 v[24:25],v4 offset:8192
ds_read_b64_tr_b16 v[26:27],v4 offset:10240
v_mfma_f32_16x16x32_bf16 v[156:159],v[28:31],v[80:83],v[156:159]
buffer_load_dwordx4 v[80:83],v8,s[32:35],s57 offen sc1
v_mfma_f32_16x16x32_bf16 v[188:191],v[28:31],v[84:87],v[188:191]
buffer_load_dwordx4 v[84:87],v9,s[32:35],s57 offen sc1
v_mfma_f32_16x16x32_bf16 v[220:223],v[28:31],v[88:91],v[220:223]
buffer_load_dwordx4 v[88:91],v10,s[32:35],s57 offen sc1
v_mfma_f32_16x16x32_bf16 v[252:255],v[28:31],v[92:95],v[252:255]
buffer_load_dwordx4 v[92:95],v11,s[32:35],s57 offen sc1
s_add_u32 s57,s57,4096
ds_read_b64_tr_b16 v[28:29],v5 offset:8192
ds_read_b64_tr_b16 v[30:31],v5 offset:10240
s_waitcnt vmcnt(40) lgkmcnt(6)
v_mfma_f32_16x16x32_bf16 v[128:131],v[16:19],v[96:99],v[128:131]
v_mfma_f32_16x16x32_bf16 v[160:163],v[16:19],v[100:103],v[160:163]
s_add_u32 m0,s49,131072
s_add_u32 s44,s54,0
buffer_load_dwordx4 v12,s[24:27],s44 offen offset:0 lds
v_mfma_f32_16x16x32_bf16 v[192:195],v[16:19],v[104:107],v[192:195]
v_mfma_f32_16x16x32_bf16 v[224:227],v[16:19],v[108:111],v[224:227]
buffer_load_dwordx4 v13,s[24:27],s44 offen offset:1024 lds
s_waitcnt lgkmcnt(4)
v_mfma_f32_16x16x32_bf16 v[132:135],v[20:23],v[96:99],v[132:135]
v_mfma_f32_16x16x32_bf16 v[164:167],v[20:23],v[100:103],v[164:167]
buffer_load_dwordx4 v14,s[24:27],s44 offen offset:2048 lds
v_mfma_f32_16x16x32_bf16 v[196:199],v[20:23],v[104:107],v[196:199]
v_mfma_f32_16x16x32_bf16 v[228:231],v[20:23],v[108:111],v[228:231]
buffer_load_dwordx4 v15,s[24:27],s44 offen offset:3072 lds
s_waitcnt lgkmcnt(2)
v_mfma_f32_16x16x32_bf16 v[136:139],v[24:27],v[96:99],v[136:139]
v_mfma_f32_16x16x32_bf16 v[168:171],v[24:27],v[100:103],v[168:171]
v_mfma_f32_16x16x32_bf16 v[200:203],v[24:27],v[104:107],v[200:203]
v_mfma_f32_16x16x32_bf16 v[232:235],v[24:27],v[108:111],v[232:235]
s_waitcnt lgkmcnt(0)
v_mfma_f32_16x16x32_bf16 v[140:143],v[28:31],v[96:99],v[140:143]
buffer_load_dwordx4 v[96:99],v8,s[32:35],s51 offen sc1
v_mfma_f32_16x16x32_bf16 v[172:175],v[28:31],v[100:103],v[172:175]
buffer_load_dwordx4 v[100:103],v9,s[32:35],s51 offen sc1
v_mfma_f32_16x16x32_bf16 v[204:207],v[28:31],v[104:107],v[204:207]
buffer_load_dwordx4 v[104:107],v10,s[32:35],s51 offen sc1
v_mfma_f32_16x16x32_bf16 v[236:239],v[28:31],v[108:111],v[236:239]
buffer_load_dwordx4 v[108:111],v11,s[32:35],s51 offen sc1
s_add_u32 s51,s51,4096
s_waitcnt vmcnt(40)
v_mfma_f32_16x16x32_bf16 v[144:147],v[16:19],v[112:115],v[144:147]
v_mfma_f32_16x16x32_bf16 v[176:179],v[16:19],v[116:119],v[176:179]
s_add_u32 m0,s53,8192
s_nop 0
buffer_load_dwordx4 v12,s[20:23],s52 offen offset:0 lds
v_mfma_f32_16x16x32_bf16 v[208:211],v[16:19],v[120:123],v[208:211]
v_mfma_f32_16x16x32_bf16 v[240:243],v[16:19],v[124:127],v[240:243]
buffer_load_dwordx4 v13,s[20:23],s52 offen offset:1024 lds
ds_read_b64_tr_b16 v[16:17],v2 offset:12288
ds_read_b64_tr_b16 v[18:19],v2 offset:14336
v_mfma_f32_16x16x32_bf16 v[148:151],v[20:23],v[112:115],v[148:151]
v_mfma_f32_16x16x32_bf16 v[180:183],v[20:23],v[116:119],v[180:183]
buffer_load_dwordx4 v14,s[20:23],s52 offen offset:2048 lds
v_mfma_f32_16x16x32_bf16 v[212:215],v[20:23],v[120:123],v[212:215]
v_mfma_f32_16x16x32_bf16 v[244:247],v[20:23],v[124:127],v[244:247]
buffer_load_dwordx4 v15,s[20:23],s52 offen offset:3072 lds
s_add_u32 s52,s52,262144
s_cmp_eq_u32 s58,24
s_cselect_b32 s43,7340032,0
s_sub_u32 s52,s52,s43
ds_read_b64_tr_b16 v[20:21],v3 offset:12288
ds_read_b64_tr_b16 v[22:23],v3 offset:14336
v_mfma_f32_16x16x32_bf16 v[152:155],v[24:27],v[112:115],v[152:155]
v_mfma_f32_16x16x32_bf16 v[184:187],v[24:27],v[116:119],v[184:187]
v_mfma_f32_16x16x32_bf16 v[216:219],v[24:27],v[120:123],v[216:219]
v_mfma_f32_16x16x32_bf16 v[248:251],v[24:27],v[124:127],v[248:251]
ds_read_b64_tr_b16 v[24:25],v4 offset:12288
ds_read_b64_tr_b16 v[26:27],v4 offset:14336
v_mfma_f32_16x16x32_bf16 v[156:159],v[28:31],v[112:115],v[156:159]
buffer_load_dwordx4 v[112:115],v8,s[32:35],s57 offen sc1
v_mfma_f32_16x16x32_bf16 v[188:191],v[28:31],v[116:119],v[188:191]
buffer_load_dwordx4 v[116:119],v9,s[32:35],s57 offen sc1
v_mfma_f32_16x16x32_bf16 v[220:223],v[28:31],v[120:123],v[220:223]
buffer_load_dwordx4 v[120:123],v10,s[32:35],s57 offen sc1
v_mfma_f32_16x16x32_bf16 v[252:255],v[28:31],v[124:127],v[252:255]
buffer_load_dwordx4 v[124:127],v11,s[32:35],s57 offen sc1
s_add_u32 s57,s57,4096
ds_read_b64_tr_b16 v[28:29],v5 offset:12288
ds_read_b64_tr_b16 v[30:31],v5 offset:14336
s_waitcnt vmcnt(40) lgkmcnt(6)
s_cmp_eq_u32 s47,3
s_cbranch_scc1 af_ge1
s_add_u32 m0,s49,135168
s_add_u32 s44,s54,65536
buffer_load_dwordx4 v12,s[24:27],s44 offen offset:0 lds
buffer_load_dwordx4 v13,s[24:27],s44 offen offset:1024 lds
buffer_load_dwordx4 v14,s[24:27],s44 offen offset:2048 lds
buffer_load_dwordx4 v15,s[24:27],s44 offen offset:3072 lds
af_ge1:
v_mfma_f32_16x16x32_bf16 v[128:131],v[16:19],v[32:35],v[128:131]
v_mfma_f32_16x16x32_bf16 v[160:163],v[16:19],v[36:39],v[160:163]
v_mfma_f32_16x16x32_bf16 v[192:195],v[16:19],v[40:43],v[192:195]
v_mfma_f32_16x16x32_bf16 v[224:227],v[16:19],v[44:47],v[224:227]
s_waitcnt lgkmcnt(4)
v_mfma_f32_16x16x32_bf16 v[132:135],v[20:23],v[32:35],v[132:135]
v_mfma_f32_16x16x32_bf16 v[164:167],v[20:23],v[36:39],v[164:167]
v_mfma_f32_16x16x32_bf16 v[196:199],v[20:23],v[40:43],v[196:199]
v_mfma_f32_16x16x32_bf16 v[228:231],v[20:23],v[44:47],v[228:231]
s_waitcnt lgkmcnt(2)
v_mfma_f32_16x16x32_bf16 v[136:139],v[24:27],v[32:35],v[136:139]
v_mfma_f32_16x16x32_bf16 v[168:171],v[24:27],v[36:39],v[168:171]
v_mfma_f32_16x16x32_bf16 v[200:203],v[24:27],v[40:43],v[200:203]
v_mfma_f32_16x16x32_bf16 v[232:235],v[24:27],v[44:47],v[232:235]
buffer_load_dword v7,v6,s[32:35],s59 offen sc1
s_waitcnt lgkmcnt(0)
v_mfma_f32_16x16x32_bf16 v[140:143],v[28:31],v[32:35],v[140:143]
buffer_load_dwordx4 v[32:35],v8,s[32:35],s51 offen sc1
v_mfma_f32_16x16x32_bf16 v[172:175],v[28:31],v[36:39],v[172:175]
buffer_load_dwordx4 v[36:39],v9,s[32:35],s51 offen sc1
v_mfma_f32_16x16x32_bf16 v[204:207],v[28:31],v[40:43],v[204:207]
buffer_load_dwordx4 v[40:43],v10,s[32:35],s51 offen sc1
v_mfma_f32_16x16x32_bf16 v[236:239],v[28:31],v[44:47],v[236:239]
buffer_load_dwordx4 v[44:47],v11,s[32:35],s51 offen sc1
s_add_u32 s51,s51,4096
s_cmp_eq_u32 s58,24
s_cselect_b32 s43,114688,0
s_sub_u32 s51,s51,s43
s_waitcnt vmcnt(37)
v_mfma_f32_16x16x32_bf16 v[144:147],v[16:19],v[48:51],v[144:147]
v_mfma_f32_16x16x32_bf16 v[176:179],v[16:19],v[52:55],v[176:179]
s_add_u32 m0,s53,12288
s_nop 0
buffer_load_dwordx4 v12,s[20:23],s52 offen offset:0 lds
v_mfma_f32_16x16x32_bf16 v[208:211],v[16:19],v[56:59],v[208:211]
v_mfma_f32_16x16x32_bf16 v[240:243],v[16:19],v[60:63],v[240:243]
buffer_load_dwordx4 v13,s[20:23],s52 offen offset:1024 lds
ds_read_b64_tr_b16 v[16:17],v2 offset:0
ds_read_b64_tr_b16 v[18:19],v2 offset:2048
v_mfma_f32_16x16x32_bf16 v[148:151],v[20:23],v[48:51],v[148:151]
v_mfma_f32_16x16x32_bf16 v[180:183],v[20:23],v[52:55],v[180:183]
buffer_load_dwordx4 v14,s[20:23],s52 offen offset:2048 lds
v_mfma_f32_16x16x32_bf16 v[212:215],v[20:23],v[56:59],v[212:215]
v_mfma_f32_16x16x32_bf16 v[244:247],v[20:23],v[60:63],v[244:247]
buffer_load_dwordx4 v15,s[20:23],s52 offen offset:3072 lds
s_add_u32 s52,s52,262144
ds_read_b64_tr_b16 v[20:21],v3 offset:0
ds_read_b64_tr_b16 v[22:23],v3 offset:2048
v_mfma_f32_16x16x32_bf16 v[152:155],v[24:27],v[48:51],v[152:155]
v_mfma_f32_16x16x32_bf16 v[184:187],v[24:27],v[52:55],v[184:187]
v_mfma_f32_16x16x32_bf16 v[216:219],v[24:27],v[56:59],v[216:219]
v_mfma_f32_16x16x32_bf16 v[248:251],v[24:27],v[60:63],v[248:251]
ds_read_b64_tr_b16 v[24:25],v4 offset:0
ds_read_b64_tr_b16 v[26:27],v4 offset:2048
v_mfma_f32_16x16x32_bf16 v[156:159],v[28:31],v[48:51],v[156:159]
buffer_load_dwordx4 v[48:51],v8,s[32:35],s57 offen sc1
v_mfma_f32_16x16x32_bf16 v[188:191],v[28:31],v[52:55],v[188:191]
buffer_load_dwordx4 v[52:55],v9,s[32:35],s57 offen sc1
v_mfma_f32_16x16x32_bf16 v[220:223],v[28:31],v[56:59],v[220:223]
buffer_load_dwordx4 v[56:59],v10,s[32:35],s57 offen sc1
v_mfma_f32_16x16x32_bf16 v[252:255],v[28:31],v[60:63],v[252:255]
buffer_load_dwordx4 v[60:63],v11,s[32:35],s57 offen sc1
s_add_u32 s57,s57,4096
s_cmp_eq_u32 s58,24
s_cselect_b32 s43,114688,0
s_sub_u32 s57,s57,s43
ds_read_b64_tr_b16 v[28:29],v5 offset:0
ds_read_b64_tr_b16 v[30:31],v5 offset:2048
s_waitcnt vmcnt(41)
s_barrier
s_waitcnt vmcnt(37) lgkmcnt(6)
v_mfma_f32_16x16x32_bf16 v[128:131],v[16:19],v[64:67],v[128:131]
v_mfma_f32_16x16x32_bf16 v[160:163],v[16:19],v[68:71],v[160:163]
s_add_u32 m0,s49,0
s_nop 0
buffer_load_dwordx4 v1,s[32:35],s48 offen offset:0 sc1 lds
v_mfma_f32_16x16x32_bf16 v[192:195],v[16:19],v[72:75],v[192:195]
v_mfma_f32_16x16x32_bf16 v[224:227],v[16:19],v[76:79],v[224:227]
buffer_load_dwordx4 v1,s[32:35],s48 offen offset:1024 sc1 lds
s_waitcnt lgkmcnt(4)
v_mfma_f32_16x16x32_bf16 v[132:135],v[20:23],v[64:67],v[132:135]
v_mfma_f32_16x16x32_bf16 v[164:167],v[20:23],v[68:71],v[164:167]
buffer_load_dwordx4 v1,s[32:35],s48 offen offset:2048 sc1 lds
v_mfma_f32_16x16x32_bf16 v[196:199],v[20:23],v[72:75],v[196:199]
v_mfma_f32_16x16x32_bf16 v[228:231],v[20:23],v[76:79],v[228:231]
buffer_load_dwordx4 v1,s[32:35],s48 offen offset:3072 sc1 lds
s_add_u32 s48,s48,4096
s_waitcnt lgkmcnt(2)
v_mfma_f32_16x16x32_bf16 v[136:139],v[24:27],v[64:67],v[136:139]
v_mfma_f32_16x16x32_bf16 v[168:171],v[24:27],v[68:71],v[168:171]
v_mfma_f32_16x16x32_bf16 v[200:203],v[24:27],v[72:75],v[200:203]
v_mfma_f32_16x16x32_bf16 v[232:235],v[24:27],v[76:79],v[232:235]
s_waitcnt vmcnt(16)
v_cmp_eq_u32 vcc,0,v7
s_mov_b32 s45,3000
s_nop 0
s_cbranch_vccnz af_h2
af_h2r:
s_waitcnt lgkmcnt(0)
v_mfma_f32_16x16x32_bf16 v[140:143],v[28:31],v[64:67],v[140:143]
buffer_load_dwordx4 v[64:67],v8,s[32:35],s51 offen sc1
v_mfma_f32_16x16x32_bf16 v[172:175],v[28:31],v[68:71],v[172:175]
buffer_load_dwordx4 v[68:71],v9,s[32:35],s51 offen sc1
v_mfma_f32_16x16x32_bf16 v[204:207],v[28:31],v[72:75],v[204:207]
buffer_load_dwordx4 v[72:75],v10,s[32:35],s51 offen sc1
v_mfma_f32_16x16x32_bf16 v[236:239],v[28:31],v[76:79],v[236:239]
buffer_load_dwordx4 v[76:79],v11,s[32:35],s51 offen sc1
s_add_u32 s51,s51,4096
s_waitcnt vmcnt(37)
v_mfma_f32_16x16x32_bf16 v[144:147],v[16:19],v[80:83],v[144:147]
v_mfma_f32_16x16x32_bf16 v[176:179],v[16:19],v[84:87],v[176:179]
s_add_u32 m0,s53,0
s_nop 0
buffer_load_dwordx4 v12,s[20:23],s52 offen offset:0 lds
v_mfma_f32_16x16x32_bf16 v[208:211],v[16:19],v[88:91],v[208:211]
v_mfma_f32_16x16x32_bf16 v[240:243],v[16:19],v[92:95],v[240:243]
buffer_load_dwordx4 v13,s[20:23],s52 offen offset:1024 lds
ds_read_b64_tr_b16 v[16:17],v2 offset:4096
ds_read_b64_tr_b16 v[18:19],v2 offset:6144
v_mfma_f32_16x16x32_bf16 v[148:151],v[20:23],v[80:83],v[148:151]
v_mfma_f32_16x16x32_bf16 v[180:183],v[20:23],v[84:87],v[180:183]
buffer_load_dwordx4 v14,s[20:23],s52 offen offset:2048 lds
v_mfma_f32_16x16x32_bf16 v[212:215],v[20:23],v[88:91],v[212:215]
v_mfma_f32_16x16x32_bf16 v[244:247],v[20:23],v[92:95],v[244:247]
buffer_load_dwordx4 v15,s[20:23],s52 offen offset:3072 lds
s_add_u32 s52,s52,262144
ds_read_b64_tr_b16 v[20:21],v3 offset:4096
ds_read_b64_tr_b16 v[22:23],v3 offset:6144
v_mfma_f32_16x16x32_bf16 v[152:155],v[24:27],v[80:83],v[152:155]
v_mfma_f32_16x16x32_bf16 v[184:187],v[24:27],v[84:87],v[184:187]
v_mfma_f32_16x16x32_bf16 v[216:219],v[24:27],v[88:91],v[216:219]
v_mfma_f32_16x16x32_bf16 v[248:251],v[24:27],v[92:95],v[248:251]
ds_read_b64_tr_b16 v[24:25],v4 offset:4096
ds_read_b64_tr_b16 v[26:27],v4 offset:6144
v_mfma_f32_16x16x32_bf16 v[156:159],v[28:31],v[80:83],v[156:159]
buffer_load_dwordx4 v[80:83],v8,s[32:35],s57 offen sc1
v_mfma_f32_16x16x32_bf16 v[188:191],v[28:31],v[84:87],v[188:191]
buffer_load_dwordx4 v[84:87],v9,s[32:35],s57 offen sc1
v_mfma_f32_16x16x32_bf16 v[220:223],v[28:31],v[88:91],v[220:223]
buffer_load_dwordx4 v[88:91],v10,s[32:35],s57 offen sc1
v_mfma_f32_16x16x32_bf16 v[252:255],v[28:31],v[92:95],v[252:255]
buffer_load_dwordx4 v[92:95],v11,s[32:35],s57 offen sc1
s_add_u32 s57,s57,4096
ds_read_b64_tr_b16 v[28:29],v5 offset:4096
ds_read_b64_tr_b16 v[30:31],v5 offset:6144
s_waitcnt vmcnt(37) lgkmcnt(6)
v_mfma_f32_16x16x32_bf16 v[128:131],v[16:19],v[96:99],v[128:131]
v_mfma_f32_16x16x32_bf16 v[160:163],v[16:19],v[100:103],v[160:163]
s_add_u32 m0,s49,4096
s_nop 0
buffer_load_dwordx4 v1,s[32:35],s48 offen offset:0 sc1 lds
v_mfma_f32_16x16x32_bf16 v[192:195],v[16:19],v[104:107],v[192:195]
v_mfma_f32_16x16x32_bf16 v[224:227],v[16:19],v[108:111],v[224:227]
buffer_load_dwordx4 v1,s[32:35],s48 offen offset:1024 sc1 lds
s_waitcnt lgkmcnt(4)
v_mfma_f32_16x16x32_bf16 v[132:135],v[20:23],v[96:99],v[132:135]
v_mfma_f32_16x16x32_bf16 v[164:167],v[20:23],v[100:103],v[164:167]
buffer_load_dwordx4 v1,s[32:35],s48 offen offset:2048 sc1 lds
v_mfma_f32_16x16x32_bf16 v[196:199],v[20:23],v[104:107],v[196:199]
v_mfma_f32_16x16x32_bf16 v[228:231],v[20:23],v[108:111],v[228:231]
buffer_load_dwordx4 v1,s[32:35],s48 offen offset:3072 sc1 lds
s_add_u32 s48,s48,12288
s_and_b32 s48,s48,0x1ffff
s_or_b32 s48,s48,s60
s_waitcnt lgkmcnt(2)
v_mfma_f32_16x16x32_bf16 v[136:139],v[24:27],v[96:99],v[136:139]
v_mfma_f32_16x16x32_bf16 v[168:171],v[24:27],v[100:103],v[168:171]
v_mfma_f32_16x16x32_bf16 v[200:203],v[24:27],v[104:107],v[200:203]
v_mfma_f32_16x16x32_bf16 v[232:235],v[24:27],v[108:111],v[232:235]
s_waitcnt lgkmcnt(0)
v_mfma_f32_16x16x32_bf16 v[140:143],v[28:31],v[96:99],v[140:143]
buffer_load_dwordx4 v[96:99],v8,s[32:35],s51 offen sc1
v_mfma_f32_16x16x32_bf16 v[172:175],v[28:31],v[100:103],v[172:175]
buffer_load_dwordx4 v[100:103],v9,s[32:35],s51 offen sc1
v_mfma_f32_16x16x32_bf16 v[204:207],v[28:31],v[104:107],v[204:207]
buffer_load_dwordx4 v[104:107],v10,s[32:35],s51 offen sc1
v_mfma_f32_16x16x32_bf16 v[236:239],v[28:31],v[108:111],v[236:239]
buffer_load_dwordx4 v[108:111],v11,s[32:35],s51 offen sc1
s_add_u32 s51,s51,4096
s_waitcnt vmcnt(37)
v_mfma_f32_16x16x32_bf16 v[144:147],v[16:19],v[112:115],v[144:147]
v_mfma_f32_16x16x32_bf16 v[176:179],v[16:19],v[116:119],v[176:179]
s_add_u32 m0,s53,4096
s_nop 0
buffer_load_dwordx4 v12,s[20:23],s52 offen offset:0 lds
v_mfma_f32_16x16x32_bf16 v[208:211],v[16:19],v[120:123],v[208:211]
v_mfma_f32_16x16x32_bf16 v[240:243],v[16:19],v[124:127],v[240:243]
buffer_load_dwordx4 v13,s[20:23],s52 offen offset:1024 lds
ds_read_b64_tr_b16 v[16:17],v2 offset:8192
ds_read_b64_tr_b16 v[18:19],v2 offset:10240
v_mfma_f32_16x16x32_bf16 v[148:151],v[20:23],v[112:115],v[148:151]
v_mfma_f32_16x16x32_bf16 v[180:183],v[20:23],v[116:119],v[180:183]
buffer_load_dwordx4 v14,s[20:23],s52 offen offset:2048 lds
v_mfma_f32_16x16x32_bf16 v[212:215],v[20:23],v[120:123],v[212:215]
v_mfma_f32_16x16x32_bf16 v[244:247],v[20:23],v[124:127],v[244:247]
buffer_load_dwordx4 v15,s[20:23],s52 offen offset:3072 lds
s_add_u32 s52,s52,262144
ds_read_b64_tr_b16 v[20:21],v3 offset:8192
ds_read_b64_tr_b16 v[22:23],v3 offset:10240
v_mfma_f32_16x16x32_bf16 v[152:155],v[24:27],v[112:115],v[152:155]
v_mfma_f32_16x16x32_bf16 v[184:187],v[24:27],v[116:119],v[184:187]
v_mfma_f32_16x16x32_bf16 v[216:219],v[24:27],v[120:123],v[216:219]
v_mfma_f32_16x16x32_bf16 v[248:251],v[24:27],v[124:127],v[248:251]
ds_read_b64_tr_b16 v[24:25],v4 offset:8192
ds_read_b64_tr_b16 v[26:27],v4 offset:10240
v_mfma_f32_16x16x32_bf16 v[156:159],v[28:31],v[112:115],v[156:159]
buffer_load_dwordx4 v[112:115],v8,s[32:35],s57 offen sc1
v_mfma_f32_16x16x32_bf16 v[188:191],v[28:31],v[116:119],v[188:191]
buffer_load_dwordx4 v[116:119],v9,s[32:35],s57 offen sc1
v_mfma_f32_16x16x32_bf16 v[220:223],v[28:31],v[120:123],v[220:223]
buffer_load_dwordx4 v[120:123],v10,s[32:35],s57 offen sc1
v_mfma_f32_16x16x32_bf16 v[252:255],v[28:31],v[124:127],v[252:255]
buffer_load_dwordx4 v[124:127],v11,s[32:35],s57 offen sc1
s_add_u32 s57,s57,4096
ds_read_b64_tr_b16 v[28:29],v5 offset:8192
ds_read_b64_tr_b16 v[30:31],v5 offset:10240
s_waitcnt vmcnt(40) lgkmcnt(6)
v_mfma_f32_16x16x32_bf16 v[128:131],v[16:19],v[32:35],v[128:131]
v_mfma_f32_16x16x32_bf16 v[160:163],v[16:19],v[36:39],v[160:163]
v_mfma_f32_16x16x32_bf16 v[192:195],v[16:19],v[40:43],v[192:195]
v_mfma_f32_16x16x32_bf16 v[224:227],v[16:19],v[44:47],v[224:227]
s_waitcnt lgkmcnt(4)
v_mfma_f32_16x16x32_bf16 v[132:135],v[20:23],v[32:35],v[132:135]
v_mfma_f32_16x16x32_bf16 v[164:167],v[20:23],v[36:39],v[164:167]
v_mfma_f32_16x16x32_bf16 v[196:199],v[20:23],v[40:43],v[196:199]
v_mfma_f32_16x16x32_bf16 v[228:231],v[20:23],v[44:47],v[228:231]
s_waitcnt lgkmcnt(2)
v_mfma_f32_16x16x32_bf16 v[136:139],v[24:27],v[32:35],v[136:139]
v_mfma_f32_16x16x32_bf16 v[168:171],v[24:27],v[36:39],v[168:171]
v_mfma_f32_16x16x32_bf16 v[200:203],v[24:27],v[40:43],v[200:203]
v_mfma_f32_16x16x32_bf16 v[232:235],v[24:27],v[44:47],v[232:235]
s_waitcnt lgkmcnt(0)
v_mfma_f32_16x16x32_bf16 v[140:143],v[28:31],v[32:35],v[140:143]
buffer_load_dwordx4 v[32:35],v8,s[32:35],s51 offen sc1
v_mfma_f32_16x16x32_bf16 v[172:175],v[28:31],v[36:39],v[172:175]
buffer_load_dwordx4 v[36:39],v9,s[32:35],s51 offen sc1
v_mfma_f32_16x16x32_bf16 v[204:207],v[28:31],v[40:43],v[204:207]
buffer_load_dwordx4 v[40:43],v10,s[32:35],s51 offen sc1
v_mfma_f32_16x16x32_bf16 v[236:239],v[28:31],v[44:47],v[236:239]
buffer_load_dwordx4 v[44:47],v11,s[32:35],s51 offen sc1
s_add_u32 s51,s51,4096
s_waitcnt vmcnt(36)
v_mfma_f32_16x16x32_bf16 v[144:147],v[16:19],v[48:51],v[144:147]
v_mfma_f32_16x16x32_bf16 v[176:179],v[16:19],v[52:55],v[176:179]
s_add_u32 m0,s53,8192
s_nop 0
buffer_load_dwordx4 v12,s[20:23],s52 offen offset:0 lds
v_mfma_f32_16x16x32_bf16 v[208:211],v[16:19],v[56:59],v[208:211]
v_mfma_f32_16x16x32_bf16 v[240:243],v[16:19],v[60:63],v[240:243]
buffer_load_dwordx4 v13,s[20:23],s52 offen offset:1024 lds
ds_read_b64_tr_b16 v[16:17],v2 offset:12288
ds_read_b64_tr_b16 v[18:19],v2 offset:14336
v_mfma_f32_16x16x32_bf16 v[148:151],v[20:23],v[48:51],v[148:151]
v_mfma_f32_16x16x32_bf16 v[180:183],v[20:23],v[52:55],v[180:183]
buffer_load_dwordx4 v14,s[20:23],s52 offen offset:2048 lds
v_mfma_f32_16x16x32_bf16 v[212:215],v[20:23],v[56:59],v[212:215]
v_mfma_f32_16x16x32_bf16 v[244:247],v[20:23],v[60:63],v[244:247]
buffer_load_dwordx4 v15,s[20:23],s52 offen offset:3072 lds
s_add_u32 s52,s52,262144
ds_read_b64_tr_b16 v[20:21],v3 offset:12288
ds_read_b64_tr_b16 v[22:23],v3 offset:14336
v_mfma_f32_16x16x32_bf16 v[152:155],v[24:27],v[48:51],v[152:155]
v_mfma_f32_16x16x32_bf16 v[184:187],v[24:27],v[52:55],v[184:187]
v_mfma_f32_16x16x32_bf16 v[216:219],v[24:27],v[56:59],v[216:219]
v_mfma_f32_16x16x32_bf16 v[248:251],v[24:27],v[60:63],v[248:251]
ds_read_b64_tr_b16 v[24:25],v4 offset:12288
ds_read_b64_tr_b16 v[26:27],v4 offset:14336
v_mfma_f32_16x16x32_bf16 v[156:159],v[28:31],v[48:51],v[156:159]
buffer_load_dwordx4 v[48:51],v8,s[32:35],s57 offen sc1
v_mfma_f32_16x16x32_bf16 v[188:191],v[28:31],v[52:55],v[188:191]
buffer_load_dwordx4 v[52:55],v9,s[32:35],s57 offen sc1
v_mfma_f32_16x16x32_bf16 v[220:223],v[28:31],v[56:59],v[220:223]
buffer_load_dwordx4 v[56:59],v10,s[32:35],s57 offen sc1
v_mfma_f32_16x16x32_bf16 v[252:255],v[28:31],v[60:63],v[252:255]
buffer_load_dwordx4 v[60:63],v11,s[32:35],s57 offen sc1
s_add_u32 s57,s57,4096
ds_read_b64_tr_b16 v[28:29],v5 offset:12288
ds_read_b64_tr_b16 v[30:31],v5 offset:14336
s_waitcnt vmcnt(36) lgkmcnt(6)
v_mfma_f32_16x16x32_bf16 v[128:131],v[16:19],v[64:67],v[128:131]
v_mfma_f32_16x16x32_bf16 v[160:163],v[16:19],v[68:71],v[160:163]
v_mfma_f32_16x16x32_bf16 v[192:195],v[16:19],v[72:75],v[192:195]
v_mfma_f32_16x16x32_bf16 v[224:227],v[16:19],v[76:79],v[224:227]
s_waitcnt lgkmcnt(4)
v_mfma_f32_16x16x32_bf16 v[132:135],v[20:23],v[64:67],v[132:135]
v_mfma_f32_16x16x32_bf16 v[164:167],v[20:23],v[68:71],v[164:167]
v_mfma_f32_16x16x32_bf16 v[196:199],v[20:23],v[72:75],v[196:199]
v_mfma_f32_16x16x32_bf16 v[228:231],v[20:23],v[76:79],v[228:231]
s_waitcnt lgkmcnt(2)
v_mfma_f32_16x16x32_bf16 v[136:139],v[24:27],v[64:67],v[136:139]
v_mfma_f32_16x16x32_bf16 v[168:171],v[24:27],v[68:71],v[168:171]
v_mfma_f32_16x16x32_bf16 v[200:203],v[24:27],v[72:75],v[200:203]
v_mfma_f32_16x16x32_bf16 v[232:235],v[24:27],v[76:79],v[232:235]
s_waitcnt lgkmcnt(0)
v_mfma_f32_16x16x32_bf16 v[140:143],v[28:31],v[64:67],v[140:143]
buffer_load_dwordx4 v[64:67],v8,s[32:35],s51 offen sc1
v_mfma_f32_16x16x32_bf16 v[172:175],v[28:31],v[68:71],v[172:175]
buffer_load_dwordx4 v[68:71],v9,s[32:35],s51 offen sc1
v_mfma_f32_16x16x32_bf16 v[204:207],v[28:31],v[72:75],v[204:207]
buffer_load_dwordx4 v[72:75],v10,s[32:35],s51 offen sc1
v_mfma_f32_16x16x32_bf16 v[236:239],v[28:31],v[76:79],v[236:239]
buffer_load_dwordx4 v[76:79],v11,s[32:35],s51 offen sc1
s_add_u32 s51,s51,4096
s_waitcnt vmcnt(32)
v_mfma_f32_16x16x32_bf16 v[144:147],v[16:19],v[80:83],v[144:147]
v_mfma_f32_16x16x32_bf16 v[176:179],v[16:19],v[84:87],v[176:179]
s_add_u32 m0,s53,12288
s_nop 0
buffer_load_dwordx4 v12,s[20:23],s52 offen offset:0 lds
v_mfma_f32_16x16x32_bf16 v[208:211],v[16:19],v[88:91],v[208:211]
v_mfma_f32_16x16x32_bf16 v[240:243],v[16:19],v[92:95],v[240:243]
buffer_load_dwordx4 v13,s[20:23],s52 offen offset:1024 lds
ds_read_b64_tr_b16 v[16:17],v2 offset:0
ds_read_b64_tr_b16 v[18:19],v2 offset:2048
v_mfma_f32_16x16x32_bf16 v[148:151],v[20:23],v[80:83],v[148:151]
v_mfma_f32_16x16x32_bf16 v[180:183],v[20:23],v[84:87],v[180:183]
buffer_load_dwordx4 v14,s[20:23],s52 offen offset:2048 lds
v_mfma_f32_16x16x32_bf16 v[212:215],v[20:23],v[88:91],v[212:215]
v_mfma_f32_16x16x32_bf16 v[244:247],v[20:23],v[92:95],v[244:247]
buffer_load_dwordx4 v15,s[20:23],s52 offen offset:3072 lds
s_add_u32 s52,s52,262144
ds_read_b64_tr_b16 v[20:21],v3 offset:0
ds_read_b64_tr_b16 v[22:23],v3 offset:2048
v_mfma_f32_16x16x32_bf16 v[152:155],v[24:27],v[80:83],v[152:155]
v_mfma_f32_16x16x32_bf16 v[184:187],v[24:27],v[84:87],v[184:187]
v_mfma_f32_16x16x32_bf16 v[216:219],v[24:27],v[88:91],v[216:219]
v_mfma_f32_16x16x32_bf16 v[248:251],v[24:27],v[92:95],v[248:251]
ds_read_b64_tr_b16 v[24:25],v4 offset:0
ds_read_b64_tr_b16 v[26:27],v4 offset:2048
v_mfma_f32_16x16x32_bf16 v[156:159],v[28:31],v[80:83],v[156:159]
buffer_load_dwordx4 v[80:83],v8,s[32:35],s57 offen sc1
v_mfma_f32_16x16x32_bf16 v[188:191],v[28:31],v[84:87],v[188:191]
buffer_load_dwordx4 v[84:87],v9,s[32:35],s57 offen sc1
v_mfma_f32_16x16x32_bf16 v[220:223],v[28:31],v[88:91],v[220:223]
buffer_load_dwordx4 v[88:91],v10,s[32:35],s57 offen sc1
v_mfma_f32_16x16x32_bf16 v[252:255],v[28:31],v[92:95],v[252:255]
buffer_load_dwordx4 v[92:95],v11,s[32:35],s57 offen sc1
s_add_u32 s57,s57,4096
ds_read_b64_tr_b16 v[28:29],v5 offset:0
ds_read_b64_tr_b16 v[30:31],v5 offset:2048
s_waitcnt vmcnt(36)
s_barrier
s_waitcnt vmcnt(32) lgkmcnt(6)
v_mfma_f32_16x16x32_bf16 v[128:131],v[16:19],v[96:99],v[128:131]
v_mfma_f32_16x16x32_bf16 v[160:163],v[16:19],v[100:103],v[160:163]
s_add_u32 m0,s49,32768
s_nop 0
buffer_load_dwordx4 v1,s[32:35],s48 offen offset:0 sc1 lds
v_mfma_f32_16x16x32_bf16 v[192:195],v[16:19],v[104:107],v[192:195]
v_mfma_f32_16x16x32_bf16 v[224:227],v[16:19],v[108:111],v[224:227]
buffer_load_dwordx4 v1,s[32:35],s48 offen offset:1024 sc1 lds
s_waitcnt lgkmcnt(4)
v_mfma_f32_16x16x32_bf16 v[132:135],v[20:23],v[96:99],v[132:135]
v_mfma_f32_16x16x32_bf16 v[164:167],v[20:23],v[100:103],v[164:167]
buffer_load_dwordx4 v1,s[32:35],s48 offen offset:2048 sc1 lds
v_mfma_f32_16x16x32_bf16 v[196:199],v[20:23],v[104:107],v[196:199]
v_mfma_f32_16x16x32_bf16 v[228:231],v[20:23],v[108:111],v[228:231]
buffer_load_dwordx4 v1,s[32:35],s48 offen offset:3072 sc1 lds
s_add_u32 s48,s48,4096
s_waitcnt lgkmcnt(2)
v_mfma_f32_16x16x32_bf16 v[136:139],v[24:27],v[96:99],v[136:139]
v_mfma_f32_16x16x32_bf16 v[168:171],v[24:27],v[100:103],v[168:171]
v_mfma_f32_16x16x32_bf16 v[200:203],v[24:27],v[104:107],v[200:203]
v_mfma_f32_16x16x32_bf16 v[232:235],v[24:27],v[108:111],v[232:235]
s_waitcnt lgkmcnt(0)
v_mfma_f32_16x16x32_bf16 v[140:143],v[28:31],v[96:99],v[140:143]
buffer_load_dwordx4 v[96:99],v8,s[32:35],s51 offen sc1
v_mfma_f32_16x16x32_bf16 v[172:175],v[28:31],v[100:103],v[172:175]
buffer_load_dwordx4 v[100:103],v9,s[32:35],s51 offen sc1
v_mfma_f32_16x16x32_bf16 v[204:207],v[28:31],v[104:107],v[204:207]
buffer_load_dwordx4 v[104:107],v10,s[32:35],s51 offen sc1
v_mfma_f32_16x16x32_bf16 v[236:239],v[28:31],v[108:111],v[236:239]
buffer_load_dwordx4 v[108:111],v11,s[32:35],s51 offen sc1
s_add_u32 s51,s51,4096
s_waitcnt vmcnt(32)
v_mfma_f32_16x16x32_bf16 v[144:147],v[16:19],v[112:115],v[144:147]
v_mfma_f32_16x16x32_bf16 v[176:179],v[16:19],v[116:119],v[176:179]
s_add_u32 m0,s53,0
s_nop 0
buffer_load_dwordx4 v12,s[20:23],s52 offen offset:0 lds
v_mfma_f32_16x16x32_bf16 v[208:211],v[16:19],v[120:123],v[208:211]
v_mfma_f32_16x16x32_bf16 v[240:243],v[16:19],v[124:127],v[240:243]
buffer_load_dwordx4 v13,s[20:23],s52 offen offset:1024 lds
ds_read_b64_tr_b16 v[16:17],v2 offset:4096
ds_read_b64_tr_b16 v[18:19],v2 offset:6144
v_mfma_f32_16x16x32_bf16 v[148:151],v[20:23],v[112:115],v[148:151]
v_mfma_f32_16x16x32_bf16 v[180:183],v[20:23],v[116:119],v[180:183]
buffer_load_dwordx4 v14,s[20:23],s52 offen offset:2048 lds
v_mfma_f32_16x16x32_bf16 v[212:215],v[20:23],v[120:123],v[212:215]
v_mfma_f32_16x16x32_bf16 v[244:247],v[20:23],v[124:127],v[244:247]
buffer_load_dwordx4 v15,s[20:23],s52 offen offset:3072 lds
s_add_u32 s52,s52,262144
ds_read_b64_tr_b16 v[20:21],v3 offset:4096
ds_read_b64_tr_b16 v[22:23],v3 offset:6144
v_mfma_f32_16x16x32_bf16 v[152:155],v[24:27],v[112:115],v[152:155]
v_mfma_f32_16x16x32_bf16 v[184:187],v[24:27],v[116:119],v[184:187]
v_mfma_f32_16x16x32_bf16 v[216:219],v[24:27],v[120:123],v[216:219]
v_mfma_f32_16x16x32_bf16 v[248:251],v[24:27],v[124:127],v[248:251]
ds_read_b64_tr_b16 v[24:25],v4 offset:4096
ds_read_b64_tr_b16 v[26:27],v4 offset:6144
v_mfma_f32_16x16x32_bf16 v[156:159],v[28:31],v[112:115],v[156:159]
buffer_load_dwordx4 v[112:115],v8,s[32:35],s57 offen sc1
v_mfma_f32_16x16x32_bf16 v[188:191],v[28:31],v[116:119],v[188:191]
buffer_load_dwordx4 v[116:119],v9,s[32:35],s57 offen sc1
v_mfma_f32_16x16x32_bf16 v[220:223],v[28:31],v[120:123],v[220:223]
buffer_load_dwordx4 v[120:123],v10,s[32:35],s57 offen sc1
v_mfma_f32_16x16x32_bf16 v[252:255],v[28:31],v[124:127],v[252:255]
buffer_load_dwordx4 v[124:127],v11,s[32:35],s57 offen sc1
s_add_u32 s57,s57,4096
ds_read_b64_tr_b16 v[28:29],v5 offset:4096
ds_read_b64_tr_b16 v[30:31],v5 offset:6144
s_waitcnt vmcnt(36) lgkmcnt(6)
v_mfma_f32_16x16x32_bf16 v[128:131],v[16:19],v[32:35],v[128:131]
v_mfma_f32_16x16x32_bf16 v[160:163],v[16:19],v[36:39],v[160:163]
s_add_u32 m0,s49,36864
s_nop 0
buffer_load_dwordx4 v1,s[32:35],s48 offen offset:0 sc1 lds
v_mfma_f32_16x16x32_bf16 v[192:195],v[16:19],v[40:43],v[192:195]
v_mfma_f32_16x16x32_bf16 v[224:227],v[16:19],v[44:47],v[224:227]
buffer_load_dwordx4 v1,s[32:35],s48 offen offset:1024 sc1 lds
s_waitcnt lgkmcnt(4)
v_mfma_f32_16x16x32_bf16 v[132:135],v[20:23],v[32:35],v[132:135]
v_mfma_f32_16x16x32_bf16 v[164:167],v[20:23],v[36:39],v[164:167]
buffer_load_dwordx4 v1,s[32:35],s48 offen offset:2048 sc1 lds
v_mfma_f32_16x16x32_bf16 v[196:199],v[20:23],v[40:43],v[196:199]
v_mfma_f32_16x16x32_bf16 v[228:231],v[20:23],v[44:47],v[228:231]
buffer_load_dwordx4 v1,s[32:35],s48 offen offset:3072 sc1 lds
s_add_u32 s48,s48,12288
s_and_b32 s48,s48,0x1ffff
s_or_b32 s48,s48,s60
s_waitcnt lgkmcnt(2)
v_mfma_f32_16x16x32_bf16 v[136:139],v[24:27],v[32:35],v[136:139]
v_mfma_f32_16x16x32_bf16 v[168:171],v[24:27],v[36:39],v[168:171]
v_mfma_f32_16x16x32_bf16 v[200:203],v[24:27],v[40:43],v[200:203]
v_mfma_f32_16x16x32_bf16 v[232:235],v[24:27],v[44:47],v[232:235]
s_waitcnt lgkmcnt(0)
v_mfma_f32_16x16x32_bf16 v[140:143],v[28:31],v[32:35],v[140:143]
buffer_load_dwordx4 v[32:35],v8,s[32:35],s51 offen sc1
v_mfma_f32_16x16x32_bf16 v[172:175],v[28:31],v[36:39],v[172:175]
buffer_load_dwordx4 v[36:39],v9,s[32:35],s51 offen sc1
v_mfma_f32_16x16x32_bf16 v[204:207],v[28:31],v[40:43],v[204:207]
buffer_load_dwordx4 v[40:43],v10,s[32:35],s51 offen sc1
v_mfma_f32_16x16x32_bf16 v[236:239],v[28:31],v[44:47],v[236:239]
buffer_load_dwordx4 v[44:47],v11,s[32:35],s51 offen sc1
s_add_u32 s51,s51,4096
s_waitcnt vmcnt(36)
v_mfma_f32_16x16x32_bf16 v[144:147],v[16:19],v[48:51],v[144:147]
v_mfma_f32_16x16x32_bf16 v[176:179],v[16:19],v[52:55],v[176:179]
s_add_u32 m0,s53,4096
s_nop 0
buffer_load_dwordx4 v12,s[20:23],s52 offen offset:0 lds
v_mfma_f32_16x16x32_bf16 v[208:211],v[16:19],v[56:59],v[208:211]
v_mfma_f32_16x16x32_bf16 v[240:243],v[16:19],v[60:63],v[240:243]
buffer_load_dwordx4 v13,s[20:23],s52 offen offset:1024 lds
ds_read_b64_tr_b16 v[16:17],v2 offset:8192
ds_read_b64_tr_b16 v[18:19],v2 offset:10240
v_mfma_f32_16x16x32_bf16 v[148:151],v[20:23],v[48:51],v[148:151]
v_mfma_f32_16x16x32_bf16 v[180:183],v[20:23],v[52:55],v[180:183]
buffer_load_dwordx4 v14,s[20:23],s52 offen offset:2048 lds
v_mfma_f32_16x16x32_bf16 v[212:215],v[20:23],v[56:59],v[212:215]
v_mfma_f32_16x16x32_bf16 v[244:247],v[20:23],v[60:63],v[244:247]
buffer_load_dwordx4 v15,s[20:23],s52 offen offset:3072 lds
s_add_u32 s52,s52,262144
s_cmp_eq_u32 s58,16
s_cselect_b32 s43,7340032,0
s_sub_u32 s52,s52,s43
ds_read_b64_tr_b16 v[20:21],v3 offset:8192
ds_read_b64_tr_b16 v[22:23],v3 offset:10240
v_mfma_f32_16x16x32_bf16 v[152:155],v[24:27],v[48:51],v[152:155]
v_mfma_f32_16x16x32_bf16 v[184:187],v[24:27],v[52:55],v[184:187]
v_mfma_f32_16x16x32_bf16 v[216:219],v[24:27],v[56:59],v[216:219]
v_mfma_f32_16x16x32_bf16 v[248:251],v[24:27],v[60:63],v[248:251]
ds_read_b64_tr_b16 v[24:25],v4 offset:8192
ds_read_b64_tr_b16 v[26:27],v4 offset:10240
v_mfma_f32_16x16x32_bf16 v[156:159],v[28:31],v[48:51],v[156:159]
buffer_load_dwordx4 v[48:51],v8,s[32:35],s57 offen sc1
v_mfma_f32_16x16x32_bf16 v[188:191],v[28:31],v[52:55],v[188:191]
buffer_load_dwordx4 v[52:55],v9,s[32:35],s57 offen sc1
v_mfma_f32_16x16x32_bf16 v[220:223],v[28:31],v[56:59],v[220:223]
buffer_load_dwordx4 v[56:59],v10,s[32:35],s57 offen sc1
v_mfma_f32_16x16x32_bf16 v[252:255],v[28:31],v[60:63],v[252:255]
buffer_load_dwordx4 v[60:63],v11,s[32:35],s57 offen sc1
s_add_u32 s57,s57,4096
ds_read_b64_tr_b16 v[28:29],v5 offset:8192
ds_read_b64_tr_b16 v[30:31],v5 offset:10240
s_waitcnt vmcnt(40) lgkmcnt(6)
v_mfma_f32_16x16x32_bf16 v[128:131],v[16:19],v[64:67],v[128:131]
v_mfma_f32_16x16x32_bf16 v[160:163],v[16:19],v[68:71],v[160:163]
v_mfma_f32_16x16x32_bf16 v[192:195],v[16:19],v[72:75],v[192:195]
v_mfma_f32_16x16x32_bf16 v[224:227],v[16:19],v[76:79],v[224:227]
s_waitcnt lgkmcnt(4)
v_mfma_f32_16x16x32_bf16 v[132:135],v[20:23],v[64:67],v[132:135]
v_mfma_f32_16x16x32_bf16 v[164:167],v[20:23],v[68:71],v[164:167]
v_mfma_f32_16x16x32_bf16 v[196:199],v[20:23],v[72:75],v[196:199]
v_mfma_f32_16x16x32_bf16 v[228:231],v[20:23],v[76:79],v[228:231]
s_waitcnt lgkmcnt(2)
v_mfma_f32_16x16x32_bf16 v[136:139],v[24:27],v[64:67],v[136:139]
v_mfma_f32_16x16x32_bf16 v[168:171],v[24:27],v[68:71],v[168:171]
v_mfma_f32_16x16x32_bf16 v[200:203],v[24:27],v[72:75],v[200:203]
v_mfma_f32_16x16x32_bf16 v[232:235],v[24:27],v[76:79],v[232:235]
s_waitcnt lgkmcnt(0)
v_mfma_f32_16x16x32_bf16 v[140:143],v[28:31],v[64:67],v[140:143]
buffer_load_dwordx4 v[64:67],v8,s[32:35],s51 offen sc1
v_mfma_f32_16x16x32_bf16 v[172:175],v[28:31],v[68:71],v[172:175]
buffer_load_dwordx4 v[68:71],v9,s[32:35],s51 offen sc1
v_mfma_f32_16x16x32_bf16 v[204:207],v[28:31],v[72:75],v[204:207]
buffer_load_dwordx4 v[72:75],v10,s[32:35],s51 offen sc1
v_mfma_f32_16x16x32_bf16 v[236:239],v[28:31],v[76:79],v[236:239]
buffer_load_dwordx4 v[76:79],v11,s[32:35],s51 offen sc1
s_add_u32 s51,s51,4096
s_cmp_eq_u32 s58,16
s_cselect_b32 s43,114688,0
s_sub_u32 s51,s51,s43
s_waitcnt vmcnt(36)
v_mfma_f32_16x16x32_bf16 v[144:147],v[16:19],v[80:83],v[144:147]
v_mfma_f32_16x16x32_bf16 v[176:179],v[16:19],v[84:87],v[176:179]
s_add_u32 m0,s53,8192
s_nop 0
buffer_load_dwordx4 v12,s[20:23],s52 offen offset:0 lds
v_mfma_f32_16x16x32_bf16 v[208:211],v[16:19],v[88:91],v[208:211]
v_mfma_f32_16x16x32_bf16 v[240:243],v[16:19],v[92:95],v[240:243]
buffer_load_dwordx4 v13,s[20:23],s52 offen offset:1024 lds
ds_read_b64_tr_b16 v[16:17],v2 offset:12288
ds_read_b64_tr_b16 v[18:19],v2 offset:14336
v_mfma_f32_16x16x32_bf16 v[148:151],v[20:23],v[80:83],v[148:151]
v_mfma_f32_16x16x32_bf16 v[180:183],v[20:23],v[84:87],v[180:183]
buffer_load_dwordx4 v14,s[20:23],s52 offen offset:2048 lds
v_mfma_f32_16x16x32_bf16 v[212:215],v[20:23],v[88:91],v[212:215]
v_mfma_f32_16x16x32_bf16 v[244:247],v[20:23],v[92:95],v[244:247]
buffer_load_dwordx4 v15,s[20:23],s52 offen offset:3072 lds
s_add_u32 s52,s52,262144
ds_read_b64_tr_b16 v[20:21],v3 offset:12288
ds_read_b64_tr_b16 v[22:23],v3 offset:14336
v_mfma_f32_16x16x32_bf16 v[152:155],v[24:27],v[80:83],v[152:155]
v_mfma_f32_16x16x32_bf16 v[184:187],v[24:27],v[84:87],v[184:187]
v_mfma_f32_16x16x32_bf16 v[216:219],v[24:27],v[88:91],v[216:219]
v_mfma_f32_16x16x32_bf16 v[248:251],v[24:27],v[92:95],v[248:251]
ds_read_b64_tr_b16 v[24:25],v4 offset:12288
ds_read_b64_tr_b16 v[26:27],v4 offset:14336
v_mfma_f32_16x16x32_bf16 v[156:159],v[28:31],v[80:83],v[156:159]
buffer_load_dwordx4 v[80:83],v8,s[32:35],s57 offen sc1
v_mfma_f32_16x16x32_bf16 v[188:191],v[28:31],v[84:87],v[188:191]
buffer_load_dwordx4 v[84:87],v9,s[32:35],s57 offen sc1
v_mfma_f32_16x16x32_bf16 v[220:223],v[28:31],v[88:91],v[220:223]
buffer_load_dwordx4 v[88:91],v10,s[32:35],s57 offen sc1
v_mfma_f32_16x16x32_bf16 v[252:255],v[28:31],v[92:95],v[252:255]
buffer_load_dwordx4 v[92:95],v11,s[32:35],s57 offen sc1
s_add_u32 s57,s57,4096
s_cmp_eq_u32 s58,16
s_cselect_b32 s43,114688,0
s_sub_u32 s57,s57,s43
ds_read_b64_tr_b16 v[28:29],v5 offset:12288
ds_read_b64_tr_b16 v[30:31],v5 offset:14336
s_waitcnt vmcnt(36) lgkmcnt(6)
v_mfma_f32_16x16x32_bf16 v[128:131],v[16:19],v[96:99],v[128:131]
v_mfma_f32_16x16x32_bf16 v[160:163],v[16:19],v[100:103],v[160:163]
v_mfma_f32_16x16x32_bf16 v[192:195],v[16:19],v[104:107],v[192:195]
v_mfma_f32_16x16x32_bf16 v[224:227],v[16:19],v[108:111],v[224:227]
s_waitcnt lgkmcnt(4)
v_mfma_f32_16x16x32_bf16 v[132:135],v[20:23],v[96:99],v[132:135]
v_mfma_f32_16x16x32_bf16 v[164:167],v[20:23],v[100:103],v[164:167]
v_mfma_f32_16x16x32_bf16 v[196:199],v[20:23],v[104:107],v[196:199]
v_mfma_f32_16x16x32_bf16 v[228:231],v[20:23],v[108:111],v[228:231]
s_waitcnt lgkmcnt(2)
v_mfma_f32_16x16x32_bf16 v[136:139],v[24:27],v[96:99],v[136:139]
v_mfma_f32_16x16x32_bf16 v[168:171],v[24:27],v[100:103],v[168:171]
v_mfma_f32_16x16x32_bf16 v[200:203],v[24:27],v[104:107],v[200:203]
v_mfma_f32_16x16x32_bf16 v[232:235],v[24:27],v[108:111],v[232:235]
s_waitcnt lgkmcnt(0)
v_mfma_f32_16x16x32_bf16 v[140:143],v[28:31],v[96:99],v[140:143]
buffer_load_dwordx4 v[96:99],v8,s[32:35],s51 offen sc1
v_mfma_f32_16x16x32_bf16 v[172:175],v[28:31],v[100:103],v[172:175]
buffer_load_dwordx4 v[100:103],v9,s[32:35],s51 offen sc1
v_mfma_f32_16x16x32_bf16 v[204:207],v[28:31],v[104:107],v[204:207]
buffer_load_dwordx4 v[104:107],v10,s[32:35],s51 offen sc1
v_mfma_f32_16x16x32_bf16 v[236:239],v[28:31],v[108:111],v[236:239]
buffer_load_dwordx4 v[108:111],v11,s[32:35],s51 offen sc1
s_add_u32 s51,s51,4096
s_waitcnt vmcnt(32)
v_mfma_f32_16x16x32_bf16 v[144:147],v[16:19],v[112:115],v[144:147]
v_mfma_f32_16x16x32_bf16 v[176:179],v[16:19],v[116:119],v[176:179]
s_add_u32 m0,s53,12288
s_nop 0
buffer_load_dwordx4 v12,s[20:23],s52 offen offset:0 lds
v_mfma_f32_16x16x32_bf16 v[208:211],v[16:19],v[120:123],v[208:211]
v_mfma_f32_16x16x32_bf16 v[240:243],v[16:19],v[124:127],v[240:243]
buffer_load_dwordx4 v13,s[20:23],s52 offen offset:1024 lds
ds_read_b64_tr_b16 v[16:17],v2 offset:0
ds_read_b64_tr_b16 v[18:19],v2 offset:2048
v_mfma_f32_16x16x32_bf16 v[148:151],v[20:23],v[112:115],v[148:151]
v_mfma_f32_16x16x32_bf16 v[180:183],v[20:23],v[116:119],v[180:183]
buffer_load_dwordx4 v14,s[20:23],s52 offen offset:2048 lds
v_mfma_f32_16x16x32_bf16 v[212:215],v[20:23],v[120:123],v[212:215]
v_mfma_f32_16x16x32_bf16 v[244:247],v[20:23],v[124:127],v[244:247]
buffer_load_dwordx4 v15,s[20:23],s52 offen offset:3072 lds
s_add_u32 s52,s52,262144
ds_read_b64_tr_b16 v[20:21],v3 offset:0
ds_read_b64_tr_b16 v[22:23],v3 offset:2048
v_mfma_f32_16x16x32_bf16 v[152:155],v[24:27],v[112:115],v[152:155]
v_mfma_f32_16x16x32_bf16 v[184:187],v[24:27],v[116:119],v[184:187]
v_mfma_f32_16x16x32_bf16 v[216:219],v[24:27],v[120:123],v[216:219]
v_mfma_f32_16x16x32_bf16 v[248:251],v[24:27],v[124:127],v[248:251]
ds_read_b64_tr_b16 v[24:25],v4 offset:0
ds_read_b64_tr_b16 v[26:27],v4 offset:2048
v_mfma_f32_16x16x32_bf16 v[156:159],v[28:31],v[112:115],v[156:159]
buffer_load_dwordx4 v[112:115],v8,s[32:35],s57 offen sc1
v_mfma_f32_16x16x32_bf16 v[188:191],v[28:31],v[116:119],v[188:191]
buffer_load_dwordx4 v[116:119],v9,s[32:35],s57 offen sc1
v_mfma_f32_16x16x32_bf16 v[220:223],v[28:31],v[120:123],v[220:223]
buffer_load_dwordx4 v[120:123],v10,s[32:35],s57 offen sc1
v_mfma_f32_16x16x32_bf16 v[252:255],v[28:31],v[124:127],v[252:255]
buffer_load_dwordx4 v[124:127],v11,s[32:35],s57 offen sc1
s_add_u32 s57,s57,4096
ds_read_b64_tr_b16 v[28:29],v5 offset:0
ds_read_b64_tr_b16 v[30:31],v5 offset:2048
s_waitcnt vmcnt(36)
s_barrier
s_waitcnt vmcnt(32) lgkmcnt(6)
v_mfma_f32_16x16x32_bf16 v[128:131],v[16:19],v[32:35],v[128:131]
v_mfma_f32_16x16x32_bf16 v[160:163],v[16:19],v[36:39],v[160:163]
s_add_u32 m0,s49,0
s_nop 0
buffer_load_dwordx4 v1,s[32:35],s48 offen offset:0 sc1 lds
v_mfma_f32_16x16x32_bf16 v[192:195],v[16:19],v[40:43],v[192:195]
v_mfma_f32_16x16x32_bf16 v[224:227],v[16:19],v[44:47],v[224:227]
buffer_load_dwordx4 v1,s[32:35],s48 offen offset:1024 sc1 lds
s_waitcnt lgkmcnt(4)
v_mfma_f32_16x16x32_bf16 v[132:135],v[20:23],v[32:35],v[132:135]
v_mfma_f32_16x16x32_bf16 v[164:167],v[20:23],v[36:39],v[164:167]
buffer_load_dwordx4 v1,s[32:35],s48 offen offset:2048 sc1 lds
v_mfma_f32_16x16x32_bf16 v[196:199],v[20:23],v[40:43],v[196:199]
v_mfma_f32_16x16x32_bf16 v[228:231],v[20:23],v[44:47],v[228:231]
buffer_load_dwordx4 v1,s[32:35],s48 offen offset:3072 sc1 lds
s_add_u32 s48,s48,4096
s_waitcnt lgkmcnt(2)
v_mfma_f32_16x16x32_bf16 v[136:139],v[24:27],v[32:35],v[136:139]
v_mfma_f32_16x16x32_bf16 v[168:171],v[24:27],v[36:39],v[168:171]
v_mfma_f32_16x16x32_bf16 v[200:203],v[24:27],v[40:43],v[200:203]
v_mfma_f32_16x16x32_bf16 v[232:235],v[24:27],v[44:47],v[232:235]
s_waitcnt lgkmcnt(0)
v_mfma_f32_16x16x32_bf16 v[140:143],v[28:31],v[32:35],v[140:143]
buffer_load_dwordx4 v[32:35],v8,s[32:35],s51 offen sc1
v_mfma_f32_16x16x32_bf16 v[172:175],v[28:31],v[36:39],v[172:175]
buffer_load_dwordx4 v[36:39],v9,s[32:35],s51 offen sc1
v_mfma_f32_16x16x32_bf16 v[204:207],v[28:31],v[40:43],v[204:207]
buffer_load_dwordx4 v[40:43],v10,s[32:35],s51 offen sc1
v_mfma_f32_16x16x32_bf16 v[236:239],v[28:31],v[44:47],v[236:239]
buffer_load_dwordx4 v[44:47],v11,s[32:35],s51 offen sc1
s_add_u32 s51,s51,4096
s_waitcnt vmcnt(32)
v_mfma_f32_16x16x32_bf16 v[144:147],v[16:19],v[48:51],v[144:147]
v_mfma_f32_16x16x32_bf16 v[176:179],v[16:19],v[52:55],v[176:179]
s_add_u32 m0,s53,0
s_nop 0
buffer_load_dwordx4 v12,s[20:23],s52 offen offset:0 lds
v_mfma_f32_16x16x32_bf16 v[208:211],v[16:19],v[56:59],v[208:211]
v_mfma_f32_16x16x32_bf16 v[240:243],v[16:19],v[60:63],v[240:243]
buffer_load_dwordx4 v13,s[20:23],s52 offen offset:1024 lds
ds_read_b64_tr_b16 v[16:17],v2 offset:4096
ds_read_b64_tr_b16 v[18:19],v2 offset:6144
v_mfma_f32_16x16x32_bf16 v[148:151],v[20:23],v[48:51],v[148:151]
v_mfma_f32_16x16x32_bf16 v[180:183],v[20:23],v[52:55],v[180:183]
buffer_load_dwordx4 v14,s[20:23],s52 offen offset:2048 lds
v_mfma_f32_16x16x32_bf16 v[212:215],v[20:23],v[56:59],v[212:215]
v_mfma_f32_16x16x32_bf16 v[244:247],v[20:23],v[60:63],v[244:247]
buffer_load_dwordx4 v15,s[20:23],s52 offen offset:3072 lds
s_add_u32 s52,s52,262144
ds_read_b64_tr_b16 v[20:21],v3 offset:4096
ds_read_b64_tr_b16 v[22:23],v3 offset:6144
v_mfma_f32_16x16x32_bf16 v[152:155],v[24:27],v[48:51],v[152:155]
v_mfma_f32_16x16x32_bf16 v[184:187],v[24:27],v[52:55],v[184:187]
v_mfma_f32_16x16x32_bf16 v[216:219],v[24:27],v[56:59],v[216:219]
v_mfma_f32_16x16x32_bf16 v[248:251],v[24:27],v[60:63],v[248:251]
ds_read_b64_tr_b16 v[24:25],v4 offset:4096
ds_read_b64_tr_b16 v[26:27],v4 offset:6144
v_mfma_f32_16x16x32_bf16 v[156:159],v[28:31],v[48:51],v[156:159]
buffer_load_dwordx4 v[48:51],v8,s[32:35],s57 offen sc1
v_mfma_f32_16x16x32_bf16 v[188:191],v[28:31],v[52:55],v[188:191]
buffer_load_dwordx4 v[52:55],v9,s[32:35],s57 offen sc1
v_mfma_f32_16x16x32_bf16 v[220:223],v[28:31],v[56:59],v[220:223]
buffer_load_dwordx4 v[56:59],v10,s[32:35],s57 offen sc1
v_mfma_f32_16x16x32_bf16 v[252:255],v[28:31],v[60:63],v[252:255]
buffer_load_dwordx4 v[60:63],v11,s[32:35],s57 offen sc1
s_add_u32 s57,s57,4096
ds_read_b64_tr_b16 v[28:29],v5 offset:4096
ds_read_b64_tr_b16 v[30:31],v5 offset:6144
s_waitcnt vmcnt(36) lgkmcnt(6)
v_mfma_f32_16x16x32_bf16 v[128:131],v[16:19],v[64:67],v[128:131]
v_mfma_f32_16x16x32_bf16 v[160:163],v[16:19],v[68:71],v[160:163]
s_add_u32 m0,s49,4096
s_nop 0
buffer_load_dwordx4 v1,s[32:35],s48 offen offset:0 sc1 lds
v_mfma_f32_16x16x32_bf16 v[192:195],v[16:19],v[72:75],v[192:195]
v_mfma_f32_16x16x32_bf16 v[224:227],v[16:19],v[76:79],v[224:227]
buffer_load_dwordx4 v1,s[32:35],s48 offen offset:1024 sc1 lds
s_waitcnt lgkmcnt(4)
v_mfma_f32_16x16x32_bf16 v[132:135],v[20:23],v[64:67],v[132:135]
v_mfma_f32_16x16x32_bf16 v[164:167],v[20:23],v[68:71],v[164:167]
buffer_load_dwordx4 v1,s[32:35],s48 offen offset:2048 sc1 lds
v_mfma_f32_16x16x32_bf16 v[196:199],v[20:23],v[72:75],v[196:199]
v_mfma_f32_16x16x32_bf16 v[228:231],v[20:23],v[76:79],v[228:231]
buffer_load_dwordx4 v1,s[32:35],s48 offen offset:3072 sc1 lds
s_add_u32 s48,s48,12288
s_and_b32 s48,s48,0x1ffff
s_or_b32 s48,s48,s60
s_waitcnt lgkmcnt(2)
v_mfma_f32_16x16x32_bf16 v[136:139],v[24:27],v[64:67],v[136:139]
v_mfma_f32_16x16x32_bf16 v[168:171],v[24:27],v[68:71],v[168:171]
v_mfma_f32_16x16x32_bf16 v[200:203],v[24:27],v[72:75],v[200:203]
v_mfma_f32_16x16x32_bf16 v[232:235],v[24:27],v[76:79],v[232:235]
s_waitcnt lgkmcnt(0)
v_mfma_f32_16x16x32_bf16 v[140:143],v[28:31],v[64:67],v[140:143]
buffer_load_dwordx4 v[64:67],v8,s[32:35],s51 offen sc1
v_mfma_f32_16x16x32_bf16 v[172:175],v[28:31],v[68:71],v[172:175]
buffer_load_dwordx4 v[68:71],v9,s[32:35],s51 offen sc1
v_mfma_f32_16x16x32_bf16 v[204:207],v[28:31],v[72:75],v[204:207]
buffer_load_dwordx4 v[72:75],v10,s[32:35],s51 offen sc1
v_mfma_f32_16x16x32_bf16 v[236:239],v[28:31],v[76:79],v[236:239]
buffer_load_dwordx4 v[76:79],v11,s[32:35],s51 offen sc1
s_add_u32 s51,s51,4096
s_waitcnt vmcnt(36)
v_mfma_f32_16x16x32_bf16 v[144:147],v[16:19],v[80:83],v[144:147]
v_mfma_f32_16x16x32_bf16 v[176:179],v[16:19],v[84:87],v[176:179]
s_add_u32 m0,s53,4096
s_nop 0
buffer_load_dwordx4 v12,s[20:23],s52 offen offset:0 lds
v_mfma_f32_16x16x32_bf16 v[208:211],v[16:19],v[88:91],v[208:211]
v_mfma_f32_16x16x32_bf16 v[240:243],v[16:19],v[92:95],v[240:243]
buffer_load_dwordx4 v13,s[20:23],s52 offen offset:1024 lds
ds_read_b64_tr_b16 v[16:17],v2 offset:8192
ds_read_b64_tr_b16 v[18:19],v2 offset:10240
v_mfma_f32_16x16x32_bf16 v[148:151],v[20:23],v[80:83],v[148:151]
v_mfma_f32_16x16x32_bf16 v[180:183],v[20:23],v[84:87],v[180:183]
buffer_load_dwordx4 v14,s[20:23],s52 offen offset:2048 lds
v_mfma_f32_16x16x32_bf16 v[212:215],v[20:23],v[88:91],v[212:215]
v_mfma_f32_16x16x32_bf16 v[244:247],v[20:23],v[92:95],v[244:247]
buffer_load_dwordx4 v15,s[20:23],s52 offen offset:3072 lds
s_add_u32 s52,s52,262144
ds_read_b64_tr_b16 v[20:21],v3 offset:8192
ds_read_b64_tr_b16 v[22:23],v3 offset:10240
v_mfma_f32_16x16x32_bf16 v[152:155],v[24:27],v[80:83],v[152:155]
v_mfma_f32_16x16x32_bf16 v[184:187],v[24:27],v[84:87],v[184:187]
v_mfma_f32_16x16x32_bf16 v[216:219],v[24:27],v[88:91],v[216:219]
v_mfma_f32_16x16x32_bf16 v[248:251],v[24:27],v[92:95],v[248:251]
ds_read_b64_tr_b16 v[24:25],v4 offset:8192
ds_read_b64_tr_b16 v[26:27],v4 offset:10240
v_mfma_f32_16x16x32_bf16 v[156:159],v[28:31],v[80:83],v[156:159]
buffer_load_dwordx4 v[80:83],v8,s[32:35],s57 offen sc1
v_mfma_f32_16x16x32_bf16 v[188:191],v[28:31],v[84:87],v[188:191]
buffer_load_dwordx4 v[84:87],v9,s[32:35],s57 offen sc1
v_mfma_f32_16x16x32_bf16 v[220:223],v[28:31],v[88:91],v[220:223]
buffer_load_dwordx4 v[88:91],v10,s[32:35],s57 offen sc1
v_mfma_f32_16x16x32_bf16 v[252:255],v[28:31],v[92:95],v[252:255]
buffer_load_dwordx4 v[92:95],v11,s[32:35],s57 offen sc1
s_add_u32 s57,s57,4096
ds_read_b64_tr_b16 v[28:29],v5 offset:8192
ds_read_b64_tr_b16 v[30:31],v5 offset:10240
s_waitcnt vmcnt(40) lgkmcnt(6)
v_mfma_f32_16x16x32_bf16 v[128:131],v[16:19],v[96:99],v[128:131]
v_mfma_f32_16x16x32_bf16 v[160:163],v[16:19],v[100:103],v[160:163]
v_mfma_f32_16x16x32_bf16 v[192:195],v[16:19],v[104:107],v[192:195]
v_mfma_f32_16x16x32_bf16 v[224:227],v[16:19],v[108:111],v[224:227]
s_waitcnt lgkmcnt(4)
v_mfma_f32_16x16x32_bf16 v[132:135],v[20:23],v[96:99],v[132:135]
v_mfma_f32_16x16x32_bf16 v[164:167],v[20:23],v[100:103],v[164:167]
v_mfma_f32_16x16x32_bf16 v[196:199],v[20:23],v[104:107],v[196:199]
v_mfma_f32_16x16x32_bf16 v[228:231],v[20:23],v[108:111],v[228:231]
s_waitcnt lgkmcnt(2)
v_mfma_f32_16x16x32_bf16 v[136:139],v[24:27],v[96:99],v[136:139]
v_mfma_f32_16x16x32_bf16 v[168:171],v[24:27],v[100:103],v[168:171]
v_mfma_f32_16x16x32_bf16 v[200:203],v[24:27],v[104:107],v[200:203]
v_mfma_f32_16x16x32_bf16 v[232:235],v[24:27],v[108:111],v[232:235]
s_waitcnt lgkmcnt(0)
v_mfma_f32_16x16x32_bf16 v[140:143],v[28:31],v[96:99],v[140:143]
buffer_load_dwordx4 v[96:99],v8,s[32:35],s51 offen sc1
v_mfma_f32_16x16x32_bf16 v[172:175],v[28:31],v[100:103],v[172:175]
buffer_load_dwordx4 v[100:103],v9,s[32:35],s51 offen sc1
v_mfma_f32_16x16x32_bf16 v[204:207],v[28:31],v[104:107],v[204:207]
buffer_load_dwordx4 v[104:107],v10,s[32:35],s51 offen sc1
v_mfma_f32_16x16x32_bf16 v[236:239],v[28:31],v[108:111],v[236:239]
buffer_load_dwordx4 v[108:111],v11,s[32:35],s51 offen sc1
s_add_u32 s51,s51,4096
s_waitcnt vmcnt(36)
v_mfma_f32_16x16x32_bf16 v[144:147],v[16:19],v[112:115],v[144:147]
v_mfma_f32_16x16x32_bf16 v[176:179],v[16:19],v[116:119],v[176:179]
s_add_u32 m0,s53,8192
s_nop 0
buffer_load_dwordx4 v12,s[20:23],s52 offen offset:0 lds
v_mfma_f32_16x16x32_bf16 v[208:211],v[16:19],v[120:123],v[208:211]
v_mfma_f32_16x16x32_bf16 v[240:243],v[16:19],v[124:127],v[240:243]
buffer_load_dwordx4 v13,s[20:23],s52 offen offset:1024 lds
ds_read_b64_tr_b16 v[16:17],v2 offset:12288
ds_read_b64_tr_b16 v[18:19],v2 offset:14336
v_mfma_f32_16x16x32_bf16 v[148:151],v[20:23],v[112:115],v[148:151]
v_mfma_f32_16x16x32_bf16 v[180:183],v[20:23],v[116:119],v[180:183]
buffer_load_dwordx4 v14,s[20:23],s52 offen offset:2048 lds
v_mfma_f32_16x16x32_bf16 v[212:215],v[20:23],v[120:123],v[212:215]
v_mfma_f32_16x16x32_bf16 v[244:247],v[20:23],v[124:127],v[244:247]
buffer_load_dwordx4 v15,s[20:23],s52 offen offset:3072 lds
s_add_u32 s52,s52,262144
ds_read_b64_tr_b16 v[20:21],v3 offset:12288
ds_read_b64_tr_b16 v[22:23],v3 offset:14336
v_mfma_f32_16x16x32_bf16 v[152:155],v[24:27],v[112:115],v[152:155]
v_mfma_f32_16x16x32_bf16 v[184:187],v[24:27],v[116:119],v[184:187]
v_mfma_f32_16x16x32_bf16 v[216:219],v[24:27],v[120:123],v[216:219]
v_mfma_f32_16x16x32_bf16 v[248:251],v[24:27],v[124:127],v[248:251]
ds_read_b64_tr_b16 v[24:25],v4 offset:12288
ds_read_b64_tr_b16 v[26:27],v4 offset:14336
v_mfma_f32_16x16x32_bf16 v[156:159],v[28:31],v[112:115],v[156:159]
buffer_load_dwordx4 v[112:115],v8,s[32:35],s57 offen sc1
v_mfma_f32_16x16x32_bf16 v[188:191],v[28:31],v[116:119],v[188:191]
buffer_load_dwordx4 v[116:119],v9,s[32:35],s57 offen sc1
v_mfma_f32_16x16x32_bf16 v[220:223],v[28:31],v[120:123],v[220:223]
buffer_load_dwordx4 v[120:123],v10,s[32:35],s57 offen sc1
v_mfma_f32_16x16x32_bf16 v[252:255],v[28:31],v[124:127],v[252:255]
buffer_load_dwordx4 v[124:127],v11,s[32:35],s57 offen sc1
s_add_u32 s57,s57,4096
ds_read_b64_tr_b16 v[28:29],v5 offset:12288
ds_read_b64_tr_b16 v[30:31],v5 offset:14336
s_waitcnt vmcnt(36) lgkmcnt(6)
v_mfma_f32_16x16x32_bf16 v[128:131],v[16:19],v[32:35],v[128:131]
v_mfma_f32_16x16x32_bf16 v[160:163],v[16:19],v[36:39],v[160:163]
v_mfma_f32_16x16x32_bf16 v[192:195],v[16:19],v[40:43],v[192:195]
v_mfma_f32_16x16x32_bf16 v[224:227],v[16:19],v[44:47],v[224:227]
s_waitcnt lgkmcnt(4)
v_mfma_f32_16x16x32_bf16 v[132:135],v[20:23],v[32:35],v[132:135]
v_mfma_f32_16x16x32_bf16 v[164:167],v[20:23],v[36:39],v[164:167]
v_mfma_f32_16x16x32_bf16 v[196:199],v[20:23],v[40:43],v[196:199]
v_mfma_f32_16x16x32_bf16 v[228:231],v[20:23],v[44:47],v[228:231]
s_waitcnt lgkmcnt(2)
v_mfma_f32_16x16x32_bf16 v[136:139],v[24:27],v[32:35],v[136:139]
v_mfma_f32_16x16x32_bf16 v[168:171],v[24:27],v[36:39],v[168:171]
v_mfma_f32_16x16x32_bf16 v[200:203],v[24:27],v[40:43],v[200:203]
v_mfma_f32_16x16x32_bf16 v[232:235],v[24:27],v[44:47],v[232:235]
s_waitcnt lgkmcnt(0)
v_mfma_f32_16x16x32_bf16 v[140:143],v[28:31],v[32:35],v[140:143]
buffer_load_dwordx4 v[32:35],v8,s[32:35],s51 offen sc1
v_mfma_f32_16x16x32_bf16 v[172:175],v[28:31],v[36:39],v[172:175]
buffer_load_dwordx4 v[36:39],v9,s[32:35],s51 offen sc1
v_mfma_f32_16x16x32_bf16 v[204:207],v[28:31],v[40:43],v[204:207]
buffer_load_dwordx4 v[40:43],v10,s[32:35],s51 offen sc1
v_mfma_f32_16x16x32_bf16 v[236:239],v[28:31],v[44:47],v[236:239]
buffer_load_dwordx4 v[44:47],v11,s[32:35],s51 offen sc1
s_add_u32 s51,s51,4096
s_waitcnt vmcnt(32)
v_mfma_f32_16x16x32_bf16 v[144:147],v[16:19],v[48:51],v[144:147]
v_mfma_f32_16x16x32_bf16 v[176:179],v[16:19],v[52:55],v[176:179]
s_add_u32 m0,s53,12288
s_nop 0
buffer_load_dwordx4 v12,s[20:23],s52 offen offset:0 lds
v_mfma_f32_16x16x32_bf16 v[208:211],v[16:19],v[56:59],v[208:211]
v_mfma_f32_16x16x32_bf16 v[240:243],v[16:19],v[60:63],v[240:243]
buffer_load_dwordx4 v13,s[20:23],s52 offen offset:1024 lds
ds_read_b64_tr_b16 v[16:17],v2 offset:0
ds_read_b64_tr_b16 v[18:19],v2 offset:2048
v_mfma_f32_16x16x32_bf16 v[148:151],v[20:23],v[48:51],v[148:151]
v_mfma_f32_16x16x32_bf16 v[180:183],v[20:23],v[52:55],v[180:183]
buffer_load_dwordx4 v14,s[20:23],s52 offen offset:2048 lds
v_mfma_f32_16x16x32_bf16 v[212:215],v[20:23],v[56:59],v[212:215]
v_mfma_f32_16x16x32_bf16 v[244:247],v[20:23],v[60:63],v[244:247]
buffer_load_dwordx4 v15,s[20:23],s52 offen offset:3072 lds
s_add_u32 s52,s52,262144
ds_read_b64_tr_b16 v[20:21],v3 offset:0
ds_read_b64_tr_b16 v[22:23],v3 offset:2048
v_mfma_f32_16x16x32_bf16 v[152:155],v[24:27],v[48:51],v[152:155]
v_mfma_f32_16x16x32_bf16 v[184:187],v[24:27],v[52:55],v[184:187]
v_mfma_f32_16x16x32_bf16 v[216:219],v[24:27],v[56:59],v[216:219]
v_mfma_f32_16x16x32_bf16 v[248:251],v[24:27],v[60:63],v[248:251]
ds_read_b64_tr_b16 v[24:25],v4 offset:0
ds_read_b64_tr_b16 v[26:27],v4 offset:2048
v_mfma_f32_16x16x32_bf16 v[156:159],v[28:31],v[48:51],v[156:159]
buffer_load_dwordx4 v[48:51],v8,s[32:35],s57 offen sc1
v_mfma_f32_16x16x32_bf16 v[188:191],v[28:31],v[52:55],v[188:191]
buffer_load_dwordx4 v[52:55],v9,s[32:35],s57 offen sc1
v_mfma_f32_16x16x32_bf16 v[220:223],v[28:31],v[56:59],v[220:223]
buffer_load_dwordx4 v[56:59],v10,s[32:35],s57 offen sc1
v_mfma_f32_16x16x32_bf16 v[252:255],v[28:31],v[60:63],v[252:255]
buffer_load_dwordx4 v[60:63],v11,s[32:35],s57 offen sc1
s_add_u32 s57,s57,4096
ds_read_b64_tr_b16 v[28:29],v5 offset:0
ds_read_b64_tr_b16 v[30:31],v5 offset:2048
s_waitcnt vmcnt(36)
s_barrier
s_waitcnt vmcnt(32) lgkmcnt(6)
v_mfma_f32_16x16x32_bf16 v[128:131],v[16:19],v[64:67],v[128:131]
v_mfma_f32_16x16x32_bf16 v[160:163],v[16:19],v[68:71],v[160:163]
s_add_u32 m0,s49,32768
s_nop 0
buffer_load_dwordx4 v1,s[32:35],s48 offen offset:0 sc1 lds
v_mfma_f32_16x16x32_bf16 v[192:195],v[16:19],v[72:75],v[192:195]
v_mfma_f32_16x16x32_bf16 v[224:227],v[16:19],v[76:79],v[224:227]
buffer_load_dwordx4 v1,s[32:35],s48 offen offset:1024 sc1 lds
s_waitcnt lgkmcnt(4)
v_mfma_f32_16x16x32_bf16 v[132:135],v[20:23],v[64:67],v[132:135]
v_mfma_f32_16x16x32_bf16 v[164:167],v[20:23],v[68:71],v[164:167]
buffer_load_dwordx4 v1,s[32:35],s48 offen offset:2048 sc1 lds
v_mfma_f32_16x16x32_bf16 v[196:199],v[20:23],v[72:75],v[196:199]
v_mfma_f32_16x16x32_bf16 v[228:231],v[20:23],v[76:79],v[228:231]
buffer_load_dwordx4 v1,s[32:35],s48 offen offset:3072 sc1 lds
s_add_u32 s48,s48,4096
s_waitcnt lgkmcnt(2)
v_mfma_f32_16x16x32_bf16 v[136:139],v[24:27],v[64:67],v[136:139]
v_mfma_f32_16x16x32_bf16 v[168:171],v[24:27],v[68:71],v[168:171]
v_mfma_f32_16x16x32_bf16 v[200:203],v[24:27],v[72:75],v[200:203]
v_mfma_f32_16x16x32_bf16 v[232:235],v[24:27],v[76:79],v[232:235]
s_waitcnt lgkmcnt(0)
v_mfma_f32_16x16x32_bf16 v[140:143],v[28:31],v[64:67],v[140:143]
buffer_load_dwordx4 v[64:67],v8,s[32:35],s51 offen sc1
v_mfma_f32_16x16x32_bf16 v[172:175],v[28:31],v[68:71],v[172:175]
buffer_load_dwordx4 v[68:71],v9,s[32:35],s51 offen sc1
v_mfma_f32_16x16x32_bf16 v[204:207],v[28:31],v[72:75],v[204:207]
buffer_load_dwordx4 v[72:75],v10,s[32:35],s51 offen sc1
v_mfma_f32_16x16x32_bf16 v[236:239],v[28:31],v[76:79],v[236:239]
buffer_load_dwordx4 v[76:79],v11,s[32:35],s51 offen sc1
s_add_u32 s51,s51,4096
s_waitcnt vmcnt(32)
v_mfma_f32_16x16x32_bf16 v[144:147],v[16:19],v[80:83],v[144:147]
v_mfma_f32_16x16x32_bf16 v[176:179],v[16:19],v[84:87],v[176:179]
s_add_u32 m0,s53,0
s_nop 0
buffer_load_dwordx4 v12,s[20:23],s52 offen offset:0 lds
v_mfma_f32_16x16x32_bf16 v[208:211],v[16:19],v[88:91],v[208:211]
v_mfma_f32_16x16x32_bf16 v[240:243],v[16:19],v[92:95],v[240:243]
buffer_load_dwordx4 v13,s[20:23],s52 offen offset:1024 lds
ds_read_b64_tr_b16 v[16:17],v2 offset:4096
ds_read_b64_tr_b16 v[18:19],v2 offset:6144
v_mfma_f32_16x16x32_bf16 v[148:151],v[20:23],v[80:83],v[148:151]
v_mfma_f32_16x16x32_bf16 v[180:183],v[20:23],v[84:87],v[180:183]
buffer_load_dwordx4 v14,s[20:23],s52 offen offset:2048 lds
v_mfma_f32_16x16x32_bf16 v[212:215],v[20:23],v[88:91],v[212:215]
v_mfma_f32_16x16x32_bf16 v[244:247],v[20:23],v[92:95],v[244:247]
buffer_load_dwordx4 v15,s[20:23],s52 offen offset:3072 lds
s_add_u32 s52,s52,262144
s_cmp_eq_u32 s58,8
s_cselect_b32 s43,7340032,0
s_sub_u32 s52,s52,s43
ds_read_b64_tr_b16 v[20:21],v3 offset:4096
ds_read_b64_tr_b16 v[22:23],v3 offset:6144
v_mfma_f32_16x16x32_bf16 v[152:155],v[24:27],v[80:83],v[152:155]
v_mfma_f32_16x16x32_bf16 v[184:187],v[24:27],v[84:87],v[184:187]
v_mfma_f32_16x16x32_bf16 v[216:219],v[24:27],v[88:91],v[216:219]
v_mfma_f32_16x16x32_bf16 v[248:251],v[24:27],v[92:95],v[248:251]
ds_read_b64_tr_b16 v[24:25],v4 offset:4096
ds_read_b64_tr_b16 v[26:27],v4 offset:6144
v_mfma_f32_16x16x32_bf16 v[156:159],v[28:31],v[80:83],v[156:159]
buffer_load_dwordx4 v[80:83],v8,s[32:35],s57 offen sc1
v_mfma_f32_16x16x32_bf16 v[188:191],v[28:31],v[84:87],v[188:191]
buffer_load_dwordx4 v[84:87],v9,s[32:35],s57 offen sc1
v_mfma_f32_16x16x32_bf16 v[220:223],v[28:31],v[88:91],v[220:223]
buffer_load_dwordx4 v[88:91],v10,s[32:35],s57 offen sc1
v_mfma_f32_16x16x32_bf16 v[252:255],v[28:31],v[92:95],v[252:255]
buffer_load_dwordx4 v[92:95],v11,s[32:35],s57 offen sc1
s_add_u32 s57,s57,4096
ds_read_b64_tr_b16 v[28:29],v5 offset:4096
ds_read_b64_tr_b16 v[30:31],v5 offset:6144
s_waitcnt vmcnt(36) lgkmcnt(6)
v_mfma_f32_16x16x32_bf16 v[128:131],v[16:19],v[96:99],v[128:131]
v_mfma_f32_16x16x32_bf16 v[160:163],v[16:19],v[100:103],v[160:163]
s_add_u32 m0,s49,36864
s_nop 0
buffer_load_dwordx4 v1,s[32:35],s48 offen offset:0 sc1 lds
v_mfma_f32_16x16x32_bf16 v[192:195],v[16:19],v[104:107],v[192:195]
v_mfma_f32_16x16x32_bf16 v[224:227],v[16:19],v[108:111],v[224:227]
buffer_load_dwordx4 v1,s[32:35],s48 offen offset:1024 sc1 lds
s_waitcnt lgkmcnt(4)
v_mfma_f32_16x16x32_bf16 v[132:135],v[20:23],v[96:99],v[132:135]
v_mfma_f32_16x16x32_bf16 v[164:167],v[20:23],v[100:103],v[164:167]
buffer_load_dwordx4 v1,s[32:35],s48 offen offset:2048 sc1 lds
v_mfma_f32_16x16x32_bf16 v[196:199],v[20:23],v[104:107],v[196:199]
v_mfma_f32_16x16x32_bf16 v[228:231],v[20:23],v[108:111],v[228:231]
buffer_load_dwordx4 v1,s[32:35],s48 offen offset:3072 sc1 lds
s_add_u32 s48,s48,12288
s_and_b32 s48,s48,0x1ffff
s_or_b32 s48,s48,s60
s_waitcnt lgkmcnt(2)
v_mfma_f32_16x16x32_bf16 v[136:139],v[24:27],v[96:99],v[136:139]
v_mfma_f32_16x16x32_bf16 v[168:171],v[24:27],v[100:103],v[168:171]
v_mfma_f32_16x16x32_bf16 v[200:203],v[24:27],v[104:107],v[200:203]
v_mfma_f32_16x16x32_bf16 v[232:235],v[24:27],v[108:111],v[232:235]
s_waitcnt lgkmcnt(0)
v_mfma_f32_16x16x32_bf16 v[140:143],v[28:31],v[96:99],v[140:143]
buffer_load_dwordx4 v[96:99],v8,s[32:35],s51 offen sc1
v_mfma_f32_16x16x32_bf16 v[172:175],v[28:31],v[100:103],v[172:175]
buffer_load_dwordx4 v[100:103],v9,s[32:35],s51 offen sc1
v_mfma_f32_16x16x32_bf16 v[204:207],v[28:31],v[104:107],v[204:207]
buffer_load_dwordx4 v[104:107],v10,s[32:35],s51 offen sc1
v_mfma_f32_16x16x32_bf16 v[236:239],v[28:31],v[108:111],v[236:239]
buffer_load_dwordx4 v[108:111],v11,s[32:35],s51 offen sc1
s_add_u32 s51,s51,4096
s_cmp_eq_u32 s58,8
s_cselect_b32 s43,114688,0
s_sub_u32 s51,s51,s43
s_waitcnt vmcnt(36)
v_mfma_f32_16x16x32_bf16 v[144:147],v[16:19],v[112:115],v[144:147]
v_mfma_f32_16x16x32_bf16 v[176:179],v[16:19],v[116:119],v[176:179]
s_add_u32 m0,s53,4096
s_nop 0
buffer_load_dwordx4 v12,s[20:23],s52 offen offset:0 lds
v_mfma_f32_16x16x32_bf16 v[208:211],v[16:19],v[120:123],v[208:211]
v_mfma_f32_16x16x32_bf16 v[240:243],v[16:19],v[124:127],v[240:243]
buffer_load_dwordx4 v13,s[20:23],s52 offen offset:1024 lds
ds_read_b64_tr_b16 v[16:17],v2 offset:8192
ds_read_b64_tr_b16 v[18:19],v2 offset:10240
v_mfma_f32_16x16x32_bf16 v[148:151],v[20:23],v[112:115],v[148:151]
v_mfma_f32_16x16x32_bf16 v[180:183],v[20:23],v[116:119],v[180:183]
buffer_load_dwordx4 v14,s[20:23],s52 offen offset:2048 lds
v_mfma_f32_16x16x32_bf16 v[212:215],v[20:23],v[120:123],v[212:215]
v_mfma_f32_16x16x32_bf16 v[244:247],v[20:23],v[124:127],v[244:247]
buffer_load_dwordx4 v15,s[20:23],s52 offen offset:3072 lds
s_add_u32 s52,s52,262144
ds_read_b64_tr_b16 v[20:21],v3 offset:8192
ds_read_b64_tr_b16 v[22:23],v3 offset:10240
v_mfma_f32_16x16x32_bf16 v[152:155],v[24:27],v[112:115],v[152:155]
v_mfma_f32_16x16x32_bf16 v[184:187],v[24:27],v[116:119],v[184:187]
v_mfma_f32_16x16x32_bf16 v[216:219],v[24:27],v[120:123],v[216:219]
v_mfma_f32_16x16x32_bf16 v[248:251],v[24:27],v[124:127],v[248:251]
ds_read_b64_tr_b16 v[24:25],v4 offset:8192
ds_read_b64_tr_b16 v[26:27],v4 offset:10240
v_mfma_f32_16x16x32_bf16 v[156:159],v[28:31],v[112:115],v[156:159]
buffer_load_dwordx4 v[112:115],v8,s[32:35],s57 offen sc1
v_mfma_f32_16x16x32_bf16 v[188:191],v[28:31],v[116:119],v[188:191]
buffer_load_dwordx4 v[116:119],v9,s[32:35],s57 offen sc1
v_mfma_f32_16x16x32_bf16 v[220:223],v[28:31],v[120:123],v[220:223]
buffer_load_dwordx4 v[120:123],v10,s[32:35],s57 offen sc1
v_mfma_f32_16x16x32_bf16 v[252:255],v[28:31],v[124:127],v[252:255]
buffer_load_dwordx4 v[124:127],v11,s[32:35],s57 offen sc1
s_add_u32 s57,s57,4096
s_cmp_eq_u32 s58,8
s_cselect_b32 s43,114688,0
s_sub_u32 s57,s57,s43
ds_read_b64_tr_b16 v[28:29],v5 offset:8192
ds_read_b64_tr_b16 v[30:31],v5 offset:10240
s_waitcnt vmcnt(40) lgkmcnt(6)
v_mfma_f32_16x16x32_bf16 v[128:131],v[16:19],v[32:35],v[128:131]
v_mfma_f32_16x16x32_bf16 v[160:163],v[16:19],v[36:39],v[160:163]
v_mfma_f32_16x16x32_bf16 v[192:195],v[16:19],v[40:43],v[192:195]
v_mfma_f32_16x16x32_bf16 v[224:227],v[16:19],v[44:47],v[224:227]
s_waitcnt lgkmcnt(4)
v_mfma_f32_16x16x32_bf16 v[132:135],v[20:23],v[32:35],v[132:135]
v_mfma_f32_16x16x32_bf16 v[164:167],v[20:23],v[36:39],v[164:167]
v_mfma_f32_16x16x32_bf16 v[196:199],v[20:23],v[40:43],v[196:199]
v_mfma_f32_16x16x32_bf16 v[228:231],v[20:23],v[44:47],v[228:231]
s_waitcnt lgkmcnt(2)
v_mfma_f32_16x16x32_bf16 v[136:139],v[24:27],v[32:35],v[136:139]
v_mfma_f32_16x16x32_bf16 v[168:171],v[24:27],v[36:39],v[168:171]
v_mfma_f32_16x16x32_bf16 v[200:203],v[24:27],v[40:43],v[200:203]
v_mfma_f32_16x16x32_bf16 v[232:235],v[24:27],v[44:47],v[232:235]
s_waitcnt lgkmcnt(0)
v_mfma_f32_16x16x32_bf16 v[140:143],v[28:31],v[32:35],v[140:143]
buffer_load_dwordx4 v[32:35],v8,s[32:35],s51 offen sc1
v_mfma_f32_16x16x32_bf16 v[172:175],v[28:31],v[36:39],v[172:175]
buffer_load_dwordx4 v[36:39],v9,s[32:35],s51 offen sc1
v_mfma_f32_16x16x32_bf16 v[204:207],v[28:31],v[40:43],v[204:207]
buffer_load_dwordx4 v[40:43],v10,s[32:35],s51 offen sc1
v_mfma_f32_16x16x32_bf16 v[236:239],v[28:31],v[44:47],v[236:239]
buffer_load_dwordx4 v[44:47],v11,s[32:35],s51 offen sc1
s_add_u32 s51,s51,4096
s_waitcnt vmcnt(36)
v_mfma_f32_16x16x32_bf16 v[144:147],v[16:19],v[48:51],v[144:147]
v_mfma_f32_16x16x32_bf16 v[176:179],v[16:19],v[52:55],v[176:179]
s_add_u32 m0,s53,8192
s_nop 0
buffer_load_dwordx4 v12,s[20:23],s52 offen offset:0 lds
v_mfma_f32_16x16x32_bf16 v[208:211],v[16:19],v[56:59],v[208:211]
v_mfma_f32_16x16x32_bf16 v[240:243],v[16:19],v[60:63],v[240:243]
buffer_load_dwordx4 v13,s[20:23],s52 offen offset:1024 lds
ds_read_b64_tr_b16 v[16:17],v2 offset:12288
ds_read_b64_tr_b16 v[18:19],v2 offset:14336
v_mfma_f32_16x16x32_bf16 v[148:151],v[20:23],v[48:51],v[148:151]
v_mfma_f32_16x16x32_bf16 v[180:183],v[20:23],v[52:55],v[180:183]
buffer_load_dwordx4 v14,s[20:23],s52 offen offset:2048 lds
v_mfma_f32_16x16x32_bf16 v[212:215],v[20:23],v[56:59],v[212:215]
v_mfma_f32_16x16x32_bf16 v[244:247],v[20:23],v[60:63],v[244:247]
buffer_load_dwordx4 v15,s[20:23],s52 offen offset:3072 lds
s_add_u32 s52,s52,262144
ds_read_b64_tr_b16 v[20:21],v3 offset:12288
ds_read_b64_tr_b16 v[22:23],v3 offset:14336
v_mfma_f32_16x16x32_bf16 v[152:155],v[24:27],v[48:51],v[152:155]
v_mfma_f32_16x16x32_bf16 v[184:187],v[24:27],v[52:55],v[184:187]
v_mfma_f32_16x16x32_bf16 v[216:219],v[24:27],v[56:59],v[216:219]
v_mfma_f32_16x16x32_bf16 v[248:251],v[24:27],v[60:63],v[248:251]
ds_read_b64_tr_b16 v[24:25],v4 offset:12288
ds_read_b64_tr_b16 v[26:27],v4 offset:14336
v_mfma_f32_16x16x32_bf16 v[156:159],v[28:31],v[48:51],v[156:159]
buffer_load_dwordx4 v[48:51],v8,s[32:35],s57 offen sc1
v_mfma_f32_16x16x32_bf16 v[188:191],v[28:31],v[52:55],v[188:191]
buffer_load_dwordx4 v[52:55],v9,s[32:35],s57 offen sc1
v_mfma_f32_16x16x32_bf16 v[220:223],v[28:31],v[56:59],v[220:223]
buffer_load_dwordx4 v[56:59],v10,s[32:35],s57 offen sc1
v_mfma_f32_16x16x32_bf16 v[252:255],v[28:31],v[60:63],v[252:255]
buffer_load_dwordx4 v[60:63],v11,s[32:35],s57 offen sc1
s_add_u32 s57,s57,4096
ds_read_b64_tr_b16 v[28:29],v5 offset:12288
ds_read_b64_tr_b16 v[30:31],v5 offset:14336
s_waitcnt vmcnt(36) lgkmcnt(6)
v_mfma_f32_16x16x32_bf16 v[128:131],v[16:19],v[64:67],v[128:131]
v_mfma_f32_16x16x32_bf16 v[160:163],v[16:19],v[68:71],v[160:163]
v_mfma_f32_16x16x32_bf16 v[192:195],v[16:19],v[72:75],v[192:195]
v_mfma_f32_16x16x32_bf16 v[224:227],v[16:19],v[76:79],v[224:227]
s_waitcnt lgkmcnt(4)
v_mfma_f32_16x16x32_bf16 v[132:135],v[20:23],v[64:67],v[132:135]
v_mfma_f32_16x16x32_bf16 v[164:167],v[20:23],v[68:71],v[164:167]
v_mfma_f32_16x16x32_bf16 v[196:199],v[20:23],v[72:75],v[196:199]
v_mfma_f32_16x16x32_bf16 v[228:231],v[20:23],v[76:79],v[228:231]
s_waitcnt lgkmcnt(2)
v_mfma_f32_16x16x32_bf16 v[136:139],v[24:27],v[64:67],v[136:139]
v_mfma_f32_16x16x32_bf16 v[168:171],v[24:27],v[68:71],v[168:171]
v_mfma_f32_16x16x32_bf16 v[200:203],v[24:27],v[72:75],v[200:203]
v_mfma_f32_16x16x32_bf16 v[232:235],v[24:27],v[76:79],v[232:235]
s_waitcnt lgkmcnt(0)
v_mfma_f32_16x16x32_bf16 v[140:143],v[28:31],v[64:67],v[140:143]
buffer_load_dwordx4 v[64:67],v8,s[32:35],s51 offen sc1
v_mfma_f32_16x16x32_bf16 v[172:175],v[28:31],v[68:71],v[172:175]
buffer_load_dwordx4 v[68:71],v9,s[32:35],s51 offen sc1
v_mfma_f32_16x16x32_bf16 v[204:207],v[28:31],v[72:75],v[204:207]
buffer_load_dwordx4 v[72:75],v10,s[32:35],s51 offen sc1
v_mfma_f32_16x16x32_bf16 v[236:239],v[28:31],v[76:79],v[236:239]
buffer_load_dwordx4 v[76:79],v11,s[32:35],s51 offen sc1
s_add_u32 s51,s51,4096
s_waitcnt vmcnt(32)
v_mfma_f32_16x16x32_bf16 v[144:147],v[16:19],v[80:83],v[144:147]
v_mfma_f32_16x16x32_bf16 v[176:179],v[16:19],v[84:87],v[176:179]
s_add_u32 m0,s53,12288
s_nop 0
buffer_load_dwordx4 v12,s[20:23],s52 offen offset:0 lds
v_mfma_f32_16x16x32_bf16 v[208:211],v[16:19],v[88:91],v[208:211]
v_mfma_f32_16x16x32_bf16 v[240:243],v[16:19],v[92:95],v[240:243]
buffer_load_dwordx4 v13,s[20:23],s52 offen offset:1024 lds
ds_read_b64_tr_b16 v[16:17],v2 offset:0
ds_read_b64_tr_b16 v[18:19],v2 offset:2048
v_mfma_f32_16x16x32_bf16 v[148:151],v[20:23],v[80:83],v[148:151]
v_mfma_f32_16x16x32_bf16 v[180:183],v[20:23],v[84:87],v[180:183]
buffer_load_dwordx4 v14,s[20:23],s52 offen offset:2048 lds
v_mfma_f32_16x16x32_bf16 v[212:215],v[20:23],v[88:91],v[212:215]
v_mfma_f32_16x16x32_bf16 v[244:247],v[20:23],v[92:95],v[244:247]
buffer_load_dwordx4 v15,s[20:23],s52 offen offset:3072 lds
s_add_u32 s52,s52,262144
ds_read_b64_tr_b16 v[20:21],v3 offset:0
ds_read_b64_tr_b16 v[22:23],v3 offset:2048
v_mfma_f32_16x16x32_bf16 v[152:155],v[24:27],v[80:83],v[152:155]
v_mfma_f32_16x16x32_bf16 v[184:187],v[24:27],v[84:87],v[184:187]
v_mfma_f32_16x16x32_bf16 v[216:219],v[24:27],v[88:91],v[216:219]
v_mfma_f32_16x16x32_bf16 v[248:251],v[24:27],v[92:95],v[248:251]
ds_read_b64_tr_b16 v[24:25],v4 offset:0
ds_read_b64_tr_b16 v[26:27],v4 offset:2048
v_mfma_f32_16x16x32_bf16 v[156:159],v[28:31],v[80:83],v[156:159]
buffer_load_dwordx4 v[80:83],v8,s[32:35],s57 offen sc1
v_mfma_f32_16x16x32_bf16 v[188:191],v[28:31],v[84:87],v[188:191]
buffer_load_dwordx4 v[84:87],v9,s[32:35],s57 offen sc1
v_mfma_f32_16x16x32_bf16 v[220:223],v[28:31],v[88:91],v[220:223]
buffer_load_dwordx4 v[88:91],v10,s[32:35],s57 offen sc1
v_mfma_f32_16x16x32_bf16 v[252:255],v[28:31],v[92:95],v[252:255]
buffer_load_dwordx4 v[92:95],v11,s[32:35],s57 offen sc1
s_add_u32 s57,s57,4096
ds_read_b64_tr_b16 v[28:29],v5 offset:0
ds_read_b64_tr_b16 v[30:31],v5 offset:2048
s_waitcnt vmcnt(36)
s_barrier
s_waitcnt vmcnt(32) lgkmcnt(6)
v_mfma_f32_16x16x32_bf16 v[128:131],v[16:19],v[96:99],v[128:131]
v_mfma_f32_16x16x32_bf16 v[160:163],v[16:19],v[100:103],v[160:163]
s_add_u32 m0,s49,0
s_add_u32 s44,s54,458752
buffer_load_dwordx4 v12,s[24:27],s44 offen offset:0 lds
v_mfma_f32_16x16x32_bf16 v[192:195],v[16:19],v[104:107],v[192:195]
v_mfma_f32_16x16x32_bf16 v[224:227],v[16:19],v[108:111],v[224:227]
buffer_load_dwordx4 v13,s[24:27],s44 offen offset:1024 lds
s_waitcnt lgkmcnt(4)
v_mfma_f32_16x16x32_bf16 v[132:135],v[20:23],v[96:99],v[132:135]
v_mfma_f32_16x16x32_bf16 v[164:167],v[20:23],v[100:103],v[164:167]
buffer_load_dwordx4 v14,s[24:27],s44 offen offset:2048 lds
v_mfma_f32_16x16x32_bf16 v[196:199],v[20:23],v[104:107],v[196:199]
v_mfma_f32_16x16x32_bf16 v[228:231],v[20:23],v[108:111],v[228:231]
buffer_load_dwordx4 v15,s[24:27],s44 offen offset:3072 lds
s_waitcnt lgkmcnt(2)
v_mfma_f32_16x16x32_bf16 v[136:139],v[24:27],v[96:99],v[136:139]
v_mfma_f32_16x16x32_bf16 v[168:171],v[24:27],v[100:103],v[168:171]
v_mfma_f32_16x16x32_bf16 v[200:203],v[24:27],v[104:107],v[200:203]
v_mfma_f32_16x16x32_bf16 v[232:235],v[24:27],v[108:111],v[232:235]
s_waitcnt lgkmcnt(0)
v_mfma_f32_16x16x32_bf16 v[140:143],v[28:31],v[96:99],v[140:143]
buffer_load_dwordx4 v[96:99],v8,s[32:35],s51 offen sc1
v_mfma_f32_16x16x32_bf16 v[172:175],v[28:31],v[100:103],v[172:175]
buffer_load_dwordx4 v[100:103],v9,s[32:35],s51 offen sc1
v_mfma_f32_16x16x32_bf16 v[204:207],v[28:31],v[104:107],v[204:207]
buffer_load_dwordx4 v[104:107],v10,s[32:35],s51 offen sc1
v_mfma_f32_16x16x32_bf16 v[236:239],v[28:31],v[108:111],v[236:239]
buffer_load_dwordx4 v[108:111],v11,s[32:35],s51 offen sc1
s_add_u32 s51,s51,4096
s_waitcnt vmcnt(32)
v_mfma_f32_16x16x32_bf16 v[144:147],v[16:19],v[112:115],v[144:147]
v_mfma_f32_16x16x32_bf16 v[176:179],v[16:19],v[116:119],v[176:179]
s_add_u32 m0,s53,0
s_nop 0
buffer_load_dwordx4 v12,s[20:23],s52 offen offset:0 lds
v_mfma_f32_16x16x32_bf16 v[208:211],v[16:19],v[120:123],v[208:211]
v_mfma_f32_16x16x32_bf16 v[240:243],v[16:19],v[124:127],v[240:243]
buffer_load_dwordx4 v13,s[20:23],s52 offen offset:1024 lds
ds_read_b64_tr_b16 v[16:17],v2 offset:4096
ds_read_b64_tr_b16 v[18:19],v2 offset:6144
v_mfma_f32_16x16x32_bf16 v[148:151],v[20:23],v[112:115],v[148:151]
v_mfma_f32_16x16x32_bf16 v[180:183],v[20:23],v[116:119],v[180:183]
buffer_load_dwordx4 v14,s[20:23],s52 offen offset:2048 lds
v_mfma_f32_16x16x32_bf16 v[212:215],v[20:23],v[120:123],v[212:215]
v_mfma_f32_16x16x32_bf16 v[244:247],v[20:23],v[124:127],v[244:247]
buffer_load_dwordx4 v15,s[20:23],s52 offen offset:3072 lds
s_add_u32 s52,s52,262144
ds_read_b64_tr_b16 v[20:21],v3 offset:4096
ds_read_b64_tr_b16 v[22:23],v3 offset:6144
v_mfma_f32_16x16x32_bf16 v[152:155],v[24:27],v[112:115],v[152:155]
v_mfma_f32_16x16x32_bf16 v[184:187],v[24:27],v[116:119],v[184:187]
v_mfma_f32_16x16x32_bf16 v[216:219],v[24:27],v[120:123],v[216:219]
v_mfma_f32_16x16x32_bf16 v[248:251],v[24:27],v[124:127],v[248:251]
ds_read_b64_tr_b16 v[24:25],v4 offset:4096
ds_read_b64_tr_b16 v[26:27],v4 offset:6144
v_mfma_f32_16x16x32_bf16 v[156:159],v[28:31],v[112:115],v[156:159]
buffer_load_dwordx4 v[112:115],v8,s[32:35],s57 offen sc1
v_mfma_f32_16x16x32_bf16 v[188:191],v[28:31],v[116:119],v[188:191]
buffer_load_dwordx4 v[116:119],v9,s[32:35],s57 offen sc1
v_mfma_f32_16x16x32_bf16 v[220:223],v[28:31],v[120:123],v[220:223]
buffer_load_dwordx4 v[120:123],v10,s[32:35],s57 offen sc1
v_mfma_f32_16x16x32_bf16 v[252:255],v[28:31],v[124:127],v[252:255]
buffer_load_dwordx4 v[124:127],v11,s[32:35],s57 offen sc1
s_add_u32 s57,s57,4096
ds_read_b64_tr_b16 v[28:29],v5 offset:4096
ds_read_b64_tr_b16 v[30:31],v5 offset:6144
s_waitcnt vmcnt(36) lgkmcnt(6)
v_mfma_f32_16x16x32_bf16 v[128:131],v[16:19],v[32:35],v[128:131]
v_mfma_f32_16x16x32_bf16 v[160:163],v[16:19],v[36:39],v[160:163]
s_add_u32 m0,s49,4096
s_add_u32 s44,s54,524288
buffer_load_dwordx4 v12,s[24:27],s44 offen offset:0 lds
v_mfma_f32_16x16x32_bf16 v[192:195],v[16:19],v[40:43],v[192:195]
v_mfma_f32_16x16x32_bf16 v[224:227],v[16:19],v[44:47],v[224:227]
buffer_load_dwordx4 v13,s[24:27],s44 offen offset:1024 lds
s_waitcnt lgkmcnt(4)
v_mfma_f32_16x16x32_bf16 v[132:135],v[20:23],v[32:35],v[132:135]
v_mfma_f32_16x16x32_bf16 v[164:167],v[20:23],v[36:39],v[164:167]
buffer_load_dwordx4 v14,s[24:27],s44 offen offset:2048 lds
v_mfma_f32_16x16x32_bf16 v[196:199],v[20:23],v[40:43],v[196:199]
v_mfma_f32_16x16x32_bf16 v[228:231],v[20:23],v[44:47],v[228:231]
buffer_load_dwordx4 v15,s[24:27],s44 offen offset:3072 lds
s_waitcnt lgkmcnt(2)
v_mfma_f32_16x16x32_bf16 v[136:139],v[24:27],v[32:35],v[136:139]
v_mfma_f32_16x16x32_bf16 v[168:171],v[24:27],v[36:39],v[168:171]
v_mfma_f32_16x16x32_bf16 v[200:203],v[24:27],v[40:43],v[200:203]
v_mfma_f32_16x16x32_bf16 v[232:235],v[24:27],v[44:47],v[232:235]
s_waitcnt lgkmcnt(0)
v_mfma_f32_16x16x32_bf16 v[140:143],v[28:31],v[32:35],v[140:143]
buffer_load_dwordx4 v[32:35],v8,s[32:35],s51 offen sc1
v_mfma_f32_16x16x32_bf16 v[172:175],v[28:31],v[36:39],v[172:175]
buffer_load_dwordx4 v[36:39],v9,s[32:35],s51 offen sc1
v_mfma_f32_16x16x32_bf16 v[204:207],v[28:31],v[40:43],v[204:207]
buffer_load_dwordx4 v[40:43],v10,s[32:35],s51 offen sc1
v_mfma_f32_16x16x32_bf16 v[236:239],v[28:31],v[44:47],v[236:239]
buffer_load_dwordx4 v[44:47],v11,s[32:35],s51 offen sc1
s_add_u32 s51,s51,4096
s_waitcnt vmcnt(36)
v_mfma_f32_16x16x32_bf16 v[144:147],v[16:19],v[48:51],v[144:147]
v_mfma_f32_16x16x32_bf16 v[176:179],v[16:19],v[52:55],v[176:179]
s_add_u32 m0,s53,4096
s_nop 0
buffer_load_dwordx4 v12,s[20:23],s52 offen offset:0 lds
v_mfma_f32_16x16x32_bf16 v[208:211],v[16:19],v[56:59],v[208:211]
v_mfma_f32_16x16x32_bf16 v[240:243],v[16:19],v[60:63],v[240:243]
buffer_load_dwordx4 v13,s[20:23],s52 offen offset:1024 lds
ds_read_b64_tr_b16 v[16:17],v2 offset:8192
ds_read_b64_tr_b16 v[18:19],v2 offset:10240
v_mfma_f32_16x16x32_bf16 v[148:151],v[20:23],v[48:51],v[148:151]
v_mfma_f32_16x16x32_bf16 v[180:183],v[20:23],v[52:55],v[180:183]
buffer_load_dwordx4 v14,s[20:23],s52 offen offset:2048 lds
v_mfma_f32_16x16x32_bf16 v[212:215],v[20:23],v[56:59],v[212:215]
v_mfma_f32_16x16x32_bf16 v[244:247],v[20:23],v[60:63],v[244:247]
buffer_load_dwordx4 v15,s[20:23],s52 offen offset:3072 lds
s_add_u32 s52,s52,262144
ds_read_b64_tr_b16 v[20:21],v3 offset:8192
ds_read_b64_tr_b16 v[22:23],v3 offset:10240
v_mfma_f32_16x16x32_bf16 v[152:155],v[24:27],v[48:51],v[152:155]
v_mfma_f32_16x16x32_bf16 v[184:187],v[24:27],v[52:55],v[184:187]
v_mfma_f32_16x16x32_bf16 v[216:219],v[24:27],v[56:59],v[216:219]
v_mfma_f32_16x16x32_bf16 v[248:251],v[24:27],v[60:63],v[248:251]
ds_read_b64_tr_b16 v[24:25],v4 offset:8192
ds_read_b64_tr_b16 v[26:27],v4 offset:10240
v_mfma_f32_16x16x32_bf16 v[156:159],v[28:31],v[48:51],v[156:159]
buffer_load_dwordx4 v[48:51],v8,s[32:35],s57 offen sc1
v_mfma_f32_16x16x32_bf16 v[188:191],v[28:31],v[52:55],v[188:191]
buffer_load_dwordx4 v[52:55],v9,s[32:35],s57 offen sc1
v_mfma_f32_16x16x32_bf16 v[220:223],v[28:31],v[56:59],v[220:223]
buffer_load_dwordx4 v[56:59],v10,s[32:35],s57 offen sc1
v_mfma_f32_16x16x32_bf16 v[252:255],v[28:31],v[60:63],v[252:255]
buffer_load_dwordx4 v[60:63],v11,s[32:35],s57 offen sc1
s_add_u32 s57,s57,4096
ds_read_b64_tr_b16 v[28:29],v5 offset:8192
ds_read_b64_tr_b16 v[30:31],v5 offset:10240
s_waitcnt vmcnt(40) lgkmcnt(6)
v_mfma_f32_16x16x32_bf16 v[128:131],v[16:19],v[64:67],v[128:131]
v_mfma_f32_16x16x32_bf16 v[160:163],v[16:19],v[68:71],v[160:163]
v_mfma_f32_16x16x32_bf16 v[192:195],v[16:19],v[72:75],v[192:195]
v_mfma_f32_16x16x32_bf16 v[224:227],v[16:19],v[76:79],v[224:227]
s_waitcnt lgkmcnt(4)
v_mfma_f32_16x16x32_bf16 v[132:135],v[20:23],v[64:67],v[132:135]
v_mfma_f32_16x16x32_bf16 v[164:167],v[20:23],v[68:71],v[164:167]
v_mfma_f32_16x16x32_bf16 v[196:199],v[20:23],v[72:75],v[196:199]
v_mfma_f32_16x16x32_bf16 v[228:231],v[20:23],v[76:79],v[228:231]
s_waitcnt lgkmcnt(2)
v_mfma_f32_16x16x32_bf16 v[136:139],v[24:27],v[64:67],v[136:139]
v_mfma_f32_16x16x32_bf16 v[168:171],v[24:27],v[68:71],v[168:171]
v_mfma_f32_16x16x32_bf16 v[200:203],v[24:27],v[72:75],v[200:203]
v_mfma_f32_16x16x32_bf16 v[232:235],v[24:27],v[76:79],v[232:235]
s_waitcnt lgkmcnt(0)
v_mfma_f32_16x16x32_bf16 v[140:143],v[28:31],v[64:67],v[140:143]
buffer_load_dwordx4 v[64:67],v8,s[32:35],s51 offen sc1
v_mfma_f32_16x16x32_bf16 v[172:175],v[28:31],v[68:71],v[172:175]
buffer_load_dwordx4 v[68:71],v9,s[32:35],s51 offen sc1
v_mfma_f32_16x16x32_bf16 v[204:207],v[28:31],v[72:75],v[204:207]
buffer_load_dwordx4 v[72:75],v10,s[32:35],s51 offen sc1
v_mfma_f32_16x16x32_bf16 v[236:239],v[28:31],v[76:79],v[236:239]
buffer_load_dwordx4 v[76:79],v11,s[32:35],s51 offen sc1
s_add_u32 s51,s51,4096
s_waitcnt vmcnt(36)
v_mfma_f32_16x16x32_bf16 v[144:147],v[16:19],v[80:83],v[144:147]
v_mfma_f32_16x16x32_bf16 v[176:179],v[16:19],v[84:87],v[176:179]
s_add_u32 m0,s53,8192
s_nop 0
buffer_load_dwordx4 v12,s[20:23],s52 offen offset:0 lds
v_mfma_f32_16x16x32_bf16 v[208:211],v[16:19],v[88:91],v[208:211]
v_mfma_f32_16x16x32_bf16 v[240:243],v[16:19],v[92:95],v[240:243]
buffer_load_dwordx4 v13,s[20:23],s52 offen offset:1024 lds
ds_read_b64_tr_b16 v[16:17],v2 offset:12288
ds_read_b64_tr_b16 v[18:19],v2 offset:14336
v_mfma_f32_16x16x32_bf16 v[148:151],v[20:23],v[80:83],v[148:151]
v_mfma_f32_16x16x32_bf16 v[180:183],v[20:23],v[84:87],v[180:183]
buffer_load_dwordx4 v14,s[20:23],s52 offen offset:2048 lds
v_mfma_f32_16x16x32_bf16 v[212:215],v[20:23],v[88:91],v[212:215]
v_mfma_f32_16x16x32_bf16 v[244:247],v[20:23],v[92:95],v[244:247]
buffer_load_dwordx4 v15,s[20:23],s52 offen offset:3072 lds
s_add_u32 s52,s52,262144
ds_read_b64_tr_b16 v[20:21],v3 offset:12288
ds_read_b64_tr_b16 v[22:23],v3 offset:14336
v_mfma_f32_16x16x32_bf16 v[152:155],v[24:27],v[80:83],v[152:155]
v_mfma_f32_16x16x32_bf16 v[184:187],v[24:27],v[84:87],v[184:187]
v_mfma_f32_16x16x32_bf16 v[216:219],v[24:27],v[88:91],v[216:219]
v_mfma_f32_16x16x32_bf16 v[248:251],v[24:27],v[92:95],v[248:251]
ds_read_b64_tr_b16 v[24:25],v4 offset:12288
ds_read_b64_tr_b16 v[26:27],v4 offset:14336
v_mfma_f32_16x16x32_bf16 v[156:159],v[28:31],v[80:83],v[156:159]
buffer_load_dwordx4 v[80:83],v8,s[32:35],s57 offen sc1
v_mfma_f32_16x16x32_bf16 v[188:191],v[28:31],v[84:87],v[188:191]
buffer_load_dwordx4 v[84:87],v9,s[32:35],s57 offen sc1
v_mfma_f32_16x16x32_bf16 v[220:223],v[28:31],v[88:91],v[220:223]
buffer_load_dwordx4 v[88:91],v10,s[32:35],s57 offen sc1
v_mfma_f32_16x16x32_bf16 v[252:255],v[28:31],v[92:95],v[252:255]
buffer_load_dwordx4 v[92:95],v11,s[32:35],s57 offen sc1
s_add_u32 s57,s57,4096
ds_read_b64_tr_b16 v[28:29],v5 offset:12288
ds_read_b64_tr_b16 v[30:31],v5 offset:14336
s_waitcnt vmcnt(36) lgkmcnt(6)
v_mfma_f32_16x16x32_bf16 v[128:131],v[16:19],v[96:99],v[128:131]
v_mfma_f32_16x16x32_bf16 v[160:163],v[16:19],v[100:103],v[160:163]
v_mfma_f32_16x16x32_bf16 v[192:195],v[16:19],v[104:107],v[192:195]
v_mfma_f32_16x16x32_bf16 v[224:227],v[16:19],v[108:111],v[224:227]
s_waitcnt lgkmcnt(4)
v_mfma_f32_16x16x32_bf16 v[132:135],v[20:23],v[96:99],v[132:135]
v_mfma_f32_16x16x32_bf16 v[164:167],v[20:23],v[100:103],v[164:167]
v_mfma_f32_16x16x32_bf16 v[196:199],v[20:23],v[104:107],v[196:199]
v_mfma_f32_16x16x32_bf16 v[228:231],v[20:23],v[108:111],v[228:231]
s_waitcnt lgkmcnt(2)
v_mfma_f32_16x16x32_bf16 v[136:139],v[24:27],v[96:99],v[136:139]
v_mfma_f32_16x16x32_bf16 v[168:171],v[24:27],v[100:103],v[168:171]
v_mfma_f32_16x16x32_bf16 v[200:203],v[24:27],v[104:107],v[200:203]
v_mfma_f32_16x16x32_bf16 v[232:235],v[24:27],v[108:111],v[232:235]
s_waitcnt lgkmcnt(0)
v_mfma_f32_16x16x32_bf16 v[140:143],v[28:31],v[96:99],v[140:143]
buffer_load_dwordx4 v[96:99],v8,s[32:35],s51 offen sc1
v_mfma_f32_16x16x32_bf16 v[172:175],v[28:31],v[100:103],v[172:175]
buffer_load_dwordx4 v[100:103],v9,s[32:35],s51 offen sc1
v_mfma_f32_16x16x32_bf16 v[204:207],v[28:31],v[104:107],v[204:207]
buffer_load_dwordx4 v[104:107],v10,s[32:35],s51 offen sc1
v_mfma_f32_16x16x32_bf16 v[236:239],v[28:31],v[108:111],v[236:239]
buffer_load_dwordx4 v[108:111],v11,s[32:35],s51 offen sc1
s_add_u32 s51,s51,4096
s_waitcnt vmcnt(32)
v_mfma_f32_16x16x32_bf16 v[144:147],v[16:19],v[112:115],v[144:147]
v_mfma_f32_16x16x32_bf16 v[176:179],v[16:19],v[116:119],v[176:179]
s_add_u32 m0,s53,12288
s_nop 0
buffer_load_dwordx4 v12,s[20:23],s52 offen offset:0 lds
v_mfma_f32_16x16x32_bf16 v[208:211],v[16:19],v[120:123],v[208:211]
v_mfma_f32_16x16x32_bf16 v[240:243],v[16:19],v[124:127],v[240:243]
buffer_load_dwordx4 v13,s[20:23],s52 offen offset:1024 lds
ds_read_b64_tr_b16 v[16:17],v2 offset:0
ds_read_b64_tr_b16 v[18:19],v2 offset:2048
v_mfma_f32_16x16x32_bf16 v[148:151],v[20:23],v[112:115],v[148:151]
v_mfma_f32_16x16x32_bf16 v[180:183],v[20:23],v[116:119],v[180:183]
buffer_load_dwordx4 v14,s[20:23],s52 offen offset:2048 lds
v_mfma_f32_16x16x32_bf16 v[212:215],v[20:23],v[120:123],v[212:215]
v_mfma_f32_16x16x32_bf16 v[244:247],v[20:23],v[124:127],v[244:247]
buffer_load_dwordx4 v15,s[20:23],s52 offen offset:3072 lds
s_add_u32 s52,s52,262144
ds_read_b64_tr_b16 v[20:21],v3 offset:0
ds_read_b64_tr_b16 v[22:23],v3 offset:2048
v_mfma_f32_16x16x32_bf16 v[152:155],v[24:27],v[112:115],v[152:155]
v_mfma_f32_16x16x32_bf16 v[184:187],v[24:27],v[116:119],v[184:187]
v_mfma_f32_16x16x32_bf16 v[216:219],v[24:27],v[120:123],v[216:219]
v_mfma_f32_16x16x32_bf16 v[248:251],v[24:27],v[124:127],v[248:251]
ds_read_b64_tr_b16 v[24:25],v4 offset:0
ds_read_b64_tr_b16 v[26:27],v4 offset:2048
v_mfma_f32_16x16x32_bf16 v[156:159],v[28:31],v[112:115],v[156:159]
buffer_load_dwordx4 v[112:115],v8,s[32:35],s57 offen sc1
v_mfma_f32_16x16x32_bf16 v[188:191],v[28:31],v[116:119],v[188:191]
buffer_load_dwordx4 v[116:119],v9,s[32:35],s57 offen sc1
v_mfma_f32_16x16x32_bf16 v[220:223],v[28:31],v[120:123],v[220:223]
buffer_load_dwordx4 v[120:123],v10,s[32:35],s57 offen sc1
v_mfma_f32_16x16x32_bf16 v[252:255],v[28:31],v[124:127],v[252:255]
buffer_load_dwordx4 v[124:127],v11,s[32:35],s57 offen sc1
s_add_u32 s57,s57,4096
ds_read_b64_tr_b16 v[28:29],v5 offset:0
ds_read_b64_tr_b16 v[30:31],v5 offset:2048
s_waitcnt vmcnt(36)
s_barrier
s_waitcnt vmcnt(32) lgkmcnt(6)
v_mfma_f32_16x16x32_bf16 v[128:131],v[16:19],v[32:35],v[128:131]
v_mfma_f32_16x16x32_bf16 v[160:163],v[16:19],v[36:39],v[160:163]
s_add_u32 m0,s49,32768
s_add_u32 s44,s54,983040
buffer_load_dwordx4 v12,s[24:27],s44 offen offset:0 lds
v_mfma_f32_16x16x32_bf16 v[192:195],v[16:19],v[40:43],v[192:195]
v_mfma_f32_16x16x32_bf16 v[224:227],v[16:19],v[44:47],v[224:227]
buffer_load_dwordx4 v13,s[24:27],s44 offen offset:1024 lds
s_waitcnt lgkmcnt(4)
v_mfma_f32_16x16x32_bf16 v[132:135],v[20:23],v[32:35],v[132:135]
v_mfma_f32_16x16x32_bf16 v[164:167],v[20:23],v[36:39],v[164:167]
buffer_load_dwordx4 v14,s[24:27],s44 offen offset:2048 lds
v_mfma_f32_16x16x32_bf16 v[196:199],v[20:23],v[40:43],v[196:199]
v_mfma_f32_16x16x32_bf16 v[228:231],v[20:23],v[44:47],v[228:231]
buffer_load_dwordx4 v15,s[24:27],s44 offen offset:3072 lds
s_waitcnt lgkmcnt(2)
v_mfma_f32_16x16x32_bf16 v[136:139],v[24:27],v[32:35],v[136:139]
v_mfma_f32_16x16x32_bf16 v[168:171],v[24:27],v[36:39],v[168:171]
v_mfma_f32_16x16x32_bf16 v[200:203],v[24:27],v[40:43],v[200:203]
v_mfma_f32_16x16x32_bf16 v[232:235],v[24:27],v[44:47],v[232:235]
s_waitcnt lgkmcnt(0)
v_mfma_f32_16x16x32_bf16 v[140:143],v[28:31],v[32:35],v[140:143]
buffer_load_dwordx4 v[32:35],v8,s[32:35],s51 offen sc1
v_mfma_f32_16x16x32_bf16 v[172:175],v[28:31],v[36:39],v[172:175]
buffer_load_dwordx4 v[36:39],v9,s[32:35],s51 offen sc1
v_mfma_f32_16x16x32_bf16 v[204:207],v[28:31],v[40:43],v[204:207]
buffer_load_dwordx4 v[40:43],v10,s[32:35],s51 offen sc1
v_mfma_f32_16x16x32_bf16 v[236:239],v[28:31],v[44:47],v[236:239]
buffer_load_dwordx4 v[44:47],v11,s[32:35],s51 offen sc1
s_add_u32 s51,s51,4096
s_waitcnt vmcnt(32)
v_mfma_f32_16x16x32_bf16 v[144:147],v[16:19],v[48:51],v[144:147]
v_mfma_f32_16x16x32_bf16 v[176:179],v[16:19],v[52:55],v[176:179]
s_add_u32 m0,s49,36864
s_add_u32 s44,s54,1048576
buffer_load_dwordx4 v12,s[24:27],s44 offen offset:0 lds
v_mfma_f32_16x16x32_bf16 v[208:211],v[16:19],v[56:59],v[208:211]
v_mfma_f32_16x16x32_bf16 v[240:243],v[16:19],v[60:63],v[240:243]
buffer_load_dwordx4 v13,s[24:27],s44 offen offset:1024 lds
ds_read_b64_tr_b16 v[16:17],v2 offset:4096
ds_read_b64_tr_b16 v[18:19],v2 offset:6144
v_mfma_f32_16x16x32_bf16 v[148:151],v[20:23],v[48:51],v[148:151]
v_mfma_f32_16x16x32_bf16 v[180:183],v[20:23],v[52:55],v[180:183]
buffer_load_dwordx4 v14,s[24:27],s44 offen offset:2048 lds
v_mfma_f32_16x16x32_bf16 v[212:215],v[20:23],v[56:59],v[212:215]
v_mfma_f32_16x16x32_bf16 v[244:247],v[20:23],v[60:63],v[244:247]
buffer_load_dwordx4 v15,s[24:27],s44 offen offset:3072 lds
ds_read_b64_tr_b16 v[20:21],v3 offset:4096
ds_read_b64_tr_b16 v[22:23],v3 offset:6144
v_mfma_f32_16x16x32_bf16 v[152:155],v[24:27],v[48:51],v[152:155]
v_mfma_f32_16x16x32_bf16 v[184:187],v[24:27],v[52:55],v[184:187]
v_mfma_f32_16x16x32_bf16 v[216:219],v[24:27],v[56:59],v[216:219]
v_mfma_f32_16x16x32_bf16 v[248:251],v[24:27],v[60:63],v[248:251]
ds_read_b64_tr_b16 v[24:25],v4 offset:4096
ds_read_b64_tr_b16 v[26:27],v4 offset:6144
v_mfma_f32_16x16x32_bf16 v[156:159],v[28:31],v[48:51],v[156:159]
buffer_load_dwordx4 v[48:51],v8,s[32:35],s57 offen sc1
v_mfma_f32_16x16x32_bf16 v[188:191],v[28:31],v[52:55],v[188:191]
buffer_load_dwordx4 v[52:55],v9,s[32:35],s57 offen sc1
v_mfma_f32_16x16x32_bf16 v[220:223],v[28:31],v[56:59],v[220:223]
buffer_load_dwordx4 v[56:59],v10,s[32:35],s57 offen sc1
v_mfma_f32_16x16x32_bf16 v[252:255],v[28:31],v[60:63],v[252:255]
buffer_load_dwordx4 v[60:63],v11,s[32:35],s57 offen sc1
s_add_u32 s57,s57,4096
ds_read_b64_tr_b16 v[28:29],v5 offset:4096
ds_read_b64_tr_b16 v[30:31],v5 offset:6144
s_waitcnt vmcnt(36) lgkmcnt(6)
v_mfma_f32_16x16x32_bf16 v[128:131],v[16:19],v[64:67],v[128:131]
v_mfma_f32_16x16x32_bf16 v[160:163],v[16:19],v[68:71],v[160:163]
v_mfma_f32_16x16x32_bf16 v[192:195],v[16:19],v[72:75],v[192:195]
v_mfma_f32_16x16x32_bf16 v[224:227],v[16:19],v[76:79],v[224:227]
s_waitcnt lgkmcnt(4)
v_mfma_f32_16x16x32_bf16 v[132:135],v[20:23],v[64:67],v[132:135]
v_mfma_f32_16x16x32_bf16 v[164:167],v[20:23],v[68:71],v[164:167]
v_mfma_f32_16x16x32_bf16 v[196:199],v[20:23],v[72:75],v[196:199]
v_mfma_f32_16x16x32_bf16 v[228:231],v[20:23],v[76:79],v[228:231]
s_waitcnt lgkmcnt(2)
v_mfma_f32_16x16x32_bf16 v[136:139],v[24:27],v[64:67],v[136:139]
v_mfma_f32_16x16x32_bf16 v[168:171],v[24:27],v[68:71],v[168:171]
v_mfma_f32_16x16x32_bf16 v[200:203],v[24:27],v[72:75],v[200:203]
v_mfma_f32_16x16x32_bf16 v[232:235],v[24:27],v[76:79],v[232:235]
s_waitcnt lgkmcnt(0)
v_mfma_f32_16x16x32_bf16 v[140:143],v[28:31],v[64:67],v[140:143]
v_mfma_f32_16x16x32_bf16 v[172:175],v[28:31],v[68:71],v[172:175]
v_mfma_f32_16x16x32_bf16 v[204:207],v[28:31],v[72:75],v[204:207]
v_mfma_f32_16x16x32_bf16 v[236:239],v[28:31],v[76:79],v[236:239]
s_waitcnt vmcnt(28)
v_mfma_f32_16x16x32_bf16 v[144:147],v[16:19],v[80:83],v[144:147]
v_mfma_f32_16x16x32_bf16 v[176:179],v[16:19],v[84:87],v[176:179]
v_mfma_f32_16x16x32_bf16 v[208:211],v[16:19],v[88:91],v[208:211]
v_mfma_f32_16x16x32_bf16 v[240:243],v[16:19],v[92:95],v[240:243]
ds_read_b64_tr_b16 v[16:17],v2 offset:8192
ds_read_b64_tr_b16 v[18:19],v2 offset:10240
v_mfma_f32_16x16x32_bf16 v[148:151],v[20:23],v[80:83],v[148:151]
v_mfma_f32_16x16x32_bf16 v[180:183],v[20:23],v[84:87],v[180:183]
v_mfma_f32_16x16x32_bf16 v[212:215],v[20:23],v[88:91],v[212:215]
v_mfma_f32_16x16x32_bf16 v[244:247],v[20:23],v[92:95],v[244:247]
ds_read_b64_tr_b16 v[20:21],v3 offset:8192
ds_read_b64_tr_b16 v[22:23],v3 offset:10240
v_mfma_f32_16x16x32_bf16 v[152:155],v[24:27],v[80:83],v[152:155]
v_mfma_f32_16x16x32_bf16 v[184:187],v[24:27],v[84:87],v[184:187]
v_mfma_f32_16x16x32_bf16 v[216:219],v[24:27],v[88:91],v[216:219]
v_mfma_f32_16x16x32_bf16 v[248:251],v[24:27],v[92:95],v[248:251]
ds_read_b64_tr_b16 v[24:25],v4 offset:8192
ds_read_b64_tr_b16 v[26:27],v4 offset:10240
v_mfma_f32_16x16x32_bf16 v[156:159],v[28:31],v[80:83],v[156:159]
v_mfma_f32_16x16x32_bf16 v[188:191],v[28:31],v[84:87],v[188:191]
v_mfma_f32_16x16x32_bf16 v[220:223],v[28:31],v[88:91],v[220:223]
v_mfma_f32_16x16x32_bf16 v[252:255],v[28:31],v[92:95],v[252:255]
ds_read_b64_tr_b16 v[28:29],v5 offset:8192
ds_read_b64_tr_b16 v[30:31],v5 offset:10240
s_waitcnt vmcnt(24) lgkmcnt(6)
v_mfma_f32_16x16x32_bf16 v[128:131],v[16:19],v[96:99],v[128:131]
v_mfma_f32_16x16x32_bf16 v[160:163],v[16:19],v[100:103],v[160:163]
v_mfma_f32_16x16x32_bf16 v[192:195],v[16:19],v[104:107],v[192:195]
v_mfma_f32_16x16x32_bf16 v[224:227],v[16:19],v[108:111],v[224:227]
s_waitcnt lgkmcnt(4)
v_mfma_f32_16x16x32_bf16 v[132:135],v[20:23],v[96:99],v[132:135]
v_mfma_f32_16x16x32_bf16 v[164:167],v[20:23],v[100:103],v[164:167]
v_mfma_f32_16x16x32_bf16 v[196:199],v[20:23],v[104:107],v[196:199]
v_mfma_f32_16x16x32_bf16 v[228:231],v[20:23],v[108:111],v[228:231]
s_waitcnt lgkmcnt(2)
v_mfma_f32_16x16x32_bf16 v[136:139],v[24:27],v[96:99],v[136:139]
v_mfma_f32_16x16x32_bf16 v[168:171],v[24:27],v[100:103],v[168:171]
v_mfma_f32_16x16x32_bf16 v[200:203],v[24:27],v[104:107],v[200:203]
v_mfma_f32_16x16x32_bf16 v[232:235],v[24:27],v[108:111],v[232:235]
s_waitcnt lgkmcnt(0)
v_mfma_f32_16x16x32_bf16 v[140:143],v[28:31],v[96:99],v[140:143]
v_mfma_f32_16x16x32_bf16 v[172:175],v[28:31],v[100:103],v[172:175]
v_mfma_f32_16x16x32_bf16 v[204:207],v[28:31],v[104:107],v[204:207]
v_mfma_f32_16x16x32_bf16 v[236:239],v[28:31],v[108:111],v[236:239]
s_waitcnt vmcnt(16)
v_mfma_f32_16x16x32_bf16 v[144:147],v[16:19],v[112:115],v[144:147]
v_mfma_f32_16x16x32_bf16 v[176:179],v[16:19],v[116:119],v[176:179]
v_mfma_f32_16x16x32_bf16 v[208:211],v[16:19],v[120:123],v[208:211]
v_mfma_f32_16x16x32_bf16 v[240:243],v[16:19],v[124:127],v[240:243]
ds_read_b64_tr_b16 v[16:17],v2 offset:12288
ds_read_b64_tr_b16 v[18:19],v2 offset:14336
v_mfma_f32_16x16x32_bf16 v[148:151],v[20:23],v[112:115],v[148:151]
v_mfma_f32_16x16x32_bf16 v[180:183],v[20:23],v[116:119],v[180:183]
v_mfma_f32_16x16x32_bf16 v[212:215],v[20:23],v[120:123],v[212:215]
v_mfma_f32_16x16x32_bf16 v[244:247],v[20:23],v[124:127],v[244:247]
ds_read_b64_tr_b16 v[20:21],v3 offset:12288
ds_read_b64_tr_b16 v[22:23],v3 offset:14336
v_mfma_f32_16x16x32_bf16 v[152:155],v[24:27],v[112:115],v[152:155]
v_mfma_f32_16x16x32_bf16 v[184:187],v[24:27],v[116:119],v[184:187]
v_mfma_f32_16x16x32_bf16 v[216:219],v[24:27],v[120:123],v[216:219]
v_mfma_f32_16x16x32_bf16 v[248:251],v[24:27],v[124:127],v[248:251]
ds_read_b64_tr_b16 v[24:25],v4 offset:12288
ds_read_b64_tr_b16 v[26:27],v4 offset:14336
v_mfma_f32_16x16x32_bf16 v[156:159],v[28:31],v[112:115],v[156:159]
v_mfma_f32_16x16x32_bf16 v[188:191],v[28:31],v[116:119],v[188:191]
v_mfma_f32_16x16x32_bf16 v[220:223],v[28:31],v[120:123],v[220:223]
v_mfma_f32_16x16x32_bf16 v[252:255],v[28:31],v[124:127],v[252:255]
ds_read_b64_tr_b16 v[28:29],v5 offset:12288
ds_read_b64_tr_b16 v[30:31],v5 offset:14336
s_waitcnt vmcnt(8) lgkmcnt(6)
v_mfma_f32_16x16x32_bf16 v[128:131],v[16:19],v[32:35],v[128:131]
v_mfma_f32_16x16x32_bf16 v[160:163],v[16:19],v[36:39],v[160:163]
v_mfma_f32_16x16x32_bf16 v[192:195],v[16:19],v[40:43],v[192:195]
v_mfma_f32_16x16x32_bf16 v[224:227],v[16:19],v[44:47],v[224:227]
s_waitcnt lgkmcnt(4)
v_mfma_f32_16x16x32_bf16 v[132:135],v[20:23],v[32:35],v[132:135]
v_mfma_f32_16x16x32_bf16 v[164:167],v[20:23],v[36:39],v[164:167]
v_mfma_f32_16x16x32_bf16 v[196:199],v[20:23],v[40:43],v[196:199]
v_mfma_f32_16x16x32_bf16 v[228:231],v[20:23],v[44:47],v[228:231]
s_waitcnt lgkmcnt(2)
v_mfma_f32_16x16x32_bf16 v[136:139],v[24:27],v[32:35],v[136:139]
v_mfma_f32_16x16x32_bf16 v[168:171],v[24:27],v[36:39],v[168:171]
v_mfma_f32_16x16x32_bf16 v[200:203],v[24:27],v[40:43],v[200:203]
v_mfma_f32_16x16x32_bf16 v[232:235],v[24:27],v[44:47],v[232:235]
s_waitcnt lgkmcnt(0)
v_mfma_f32_16x16x32_bf16 v[140:143],v[28:31],v[32:35],v[140:143]
v_mfma_f32_16x16x32_bf16 v[172:175],v[28:31],v[36:39],v[172:175]
v_mfma_f32_16x16x32_bf16 v[204:207],v[28:31],v[40:43],v[204:207]
v_mfma_f32_16x16x32_bf16 v[236:239],v[28:31],v[44:47],v[236:239]
s_waitcnt vmcnt(0)
v_mov_b32 v6,161792
v_mov_b32 v7,1
s_mov_b64 exec,1
ds_add_u32 v6,v7 offset:8
s_mov_b64 exec,-1
s_waitcnt lgkmcnt(0)
v_mfma_f32_16x16x32_bf16 v[144:147],v[16:19],v[48:51],v[144:147]
v_mfma_f32_16x16x32_bf16 v[176:179],v[16:19],v[52:55],v[176:179]
v_mfma_f32_16x16x32_bf16 v[208:211],v[16:19],v[56:59],v[208:211]
v_mfma_f32_16x16x32_bf16 v[240:243],v[16:19],v[60:63],v[240:243]
v_mfma_f32_16x16x32_bf16 v[148:151],v[20:23],v[48:51],v[148:151]
v_mfma_f32_16x16x32_bf16 v[180:183],v[20:23],v[52:55],v[180:183]
v_mfma_f32_16x16x32_bf16 v[212:215],v[20:23],v[56:59],v[212:215]
v_mfma_f32_16x16x32_bf16 v[244:247],v[20:23],v[60:63],v[244:247]
v_mfma_f32_16x16x32_bf16 v[152:155],v[24:27],v[48:51],v[152:155]
v_mfma_f32_16x16x32_bf16 v[184:187],v[24:27],v[52:55],v[184:187]
v_mfma_f32_16x16x32_bf16 v[216:219],v[24:27],v[56:59],v[216:219]
v_mfma_f32_16x16x32_bf16 v[248:251],v[24:27],v[60:63],v[248:251]
v_mfma_f32_16x16x32_bf16 v[156:159],v[28:31],v[48:51],v[156:159]
v_mfma_f32_16x16x32_bf16 v[188:191],v[28:31],v[52:55],v[188:191]
v_mfma_f32_16x16x32_bf16 v[220:223],v[28:31],v[56:59],v[220:223]
v_mfma_f32_16x16x32_bf16 v[252:255],v[28:31],v[60:63],v[252:255]
v_mov_b32 v6,161792
v_mov_b32 v7,1
v_add_u32 v4,s53,v1
v_add_u32 v5,s55,v1
s_lshl_b32 s43,s47,2
v_add_u32 v8,s43,v6
v_xor_b32 v9,8,v8
v_xor_b32 v10,4,v8
s_xor_b32 s56,s55,0x4000
v_add_u32 v11,s56,v1
s_nop 1
ds_write_b128 v4,v[192:195] offset:0
ds_write_b128 v4,v[196:199] offset:1024
ds_write_b128 v4,v[200:203] offset:2048
ds_write_b128 v4,v[204:207] offset:3072
ds_write_b128 v4,v[208:211] offset:4096
ds_write_b128 v4,v[212:215] offset:5120
ds_write_b128 v4,v[216:219] offset:6144
ds_write_b128 v4,v[220:223] offset:7168
ds_write_b128 v4,v[224:227] offset:8192
ds_write_b128 v4,v[228:231] offset:9216
ds_write_b128 v4,v[232:235] offset:10240
ds_write_b128 v4,v[236:239] offset:11264
ds_write_b128 v4,v[240:243] offset:12288
ds_write_b128 v4,v[244:247] offset:13312
ds_write_b128 v4,v[248:251] offset:14336
ds_write_b128 v4,v[252:255] offset:15360
s_waitcnt lgkmcnt(0)
ds_write_b32 v8,v7 offset:16
af_r1:
ds_read_b32 v7,v9 offset:16
s_waitcnt lgkmcnt(0)
v_readfirstlane_b32 s44,v7
s_nop 0
s_cmp_lt_u32 s44,1
s_cbranch_scc1 af_r1
ds_read_b128 v[224:227],v5 offset:8192
ds_read_b128 v[228:231],v5 offset:9216
ds_read_b128 v[232:235],v5 offset:10240
ds_read_b128 v[236:239],v5 offset:11264
ds_read_b128 v[240:243],v5 offset:12288
ds_read_b128 v[244:247],v5 offset:13312
ds_read_b128 v[248:251],v5 offset:14336
ds_read_b128 v[252:255],v5 offset:15360
ds_read_b128 v[192:195],v5 offset:0
ds_read_b128 v[196:199],v5 offset:1024
ds_read_b128 v[200:203],v5 offset:2048
ds_read_b128 v[204:207],v5 offset:3072
ds_read_b128 v[208:211],v5 offset:4096
ds_read_b128 v[212:215],v5 offset:5120
ds_read_b128 v[216:219],v5 offset:6144
ds_read_b128 v[220:223],v5 offset:7168
s_waitcnt lgkmcnt(15)
v_add_f32 v160,v160,v224
v_add_f32 v161,v161,v225
v_add_f32 v162,v162,v226
v_add_f32 v163,v163,v227
s_waitcnt lgkmcnt(14)
v_add_f32 v164,v164,v228
v_add_f32 v165,v165,v229
v_add_f32 v166,v166,v230
v_add_f32 v167,v167,v231
s_waitcnt lgkmcnt(13)
v_add_f32 v168,v168,v232
v_add_f32 v169,v169,v233
v_add_f32 v170,v170,v234
v_add_f32 v171,v171,v235
s_waitcnt lgkmcnt(12)
v_add_f32 v172,v172,v236
v_add_f32 v173,v173,v237
v_add_f32 v174,v174,v238
v_add_f32 v175,v175,v239
s_waitcnt lgkmcnt(11)
v_add_f32 v176,v176,v240
v_add_f32 v177,v177,v241
v_add_f32 v178,v178,v242
v_add_f32 v179,v179,v243
s_waitcnt lgkmcnt(10)
v_add_f32 v180,v180,v244
v_add_f32 v181,v181,v245
v_add_f32 v182,v182,v246
v_add_f32 v183,v183,v247
s_waitcnt lgkmcnt(9)
v_add_f32 v184,v184,v248
v_add_f32 v185,v185,v249
v_add_f32 v186,v186,v250
v_add_f32 v187,v187,v251
s_waitcnt lgkmcnt(8)
v_add_f32 v188,v188,v252
v_add_f32 v189,v189,v253
v_add_f32 v190,v190,v254
v_add_f32 v191,v191,v255
s_waitcnt lgkmcnt(0)
ds_write_b128 v5,v[160:163] offset:0
ds_write_b128 v5,v[164:167] offset:1024
ds_write_b128 v5,v[168:171] offset:2048
ds_write_b128 v5,v[172:175] offset:3072
ds_write_b128 v5,v[176:179] offset:4096
ds_write_b128 v5,v[180:183] offset:5120
ds_write_b128 v5,v[184:187] offset:6144
ds_write_b128 v5,v[188:191] offset:7168
s_add_u32 m0,s55,8192
s_add_u32 s44,s54,1507328
buffer_load_dwordx4 v12,s[24:27],s44 offen offset:0 lds
buffer_load_dwordx4 v13,s[24:27],s44 offen offset:1024 lds
buffer_load_dwordx4 v14,s[24:27],s44 offen offset:2048 lds
buffer_load_dwordx4 v15,s[24:27],s44 offen offset:3072 lds
s_add_u32 m0,s55,12288
s_add_u32 s44,s54,1572864
buffer_load_dwordx4 v12,s[24:27],s44 offen offset:0 lds
buffer_load_dwordx4 v13,s[24:27],s44 offen offset:1024 lds
buffer_load_dwordx4 v14,s[24:27],s44 offen offset:2048 lds
buffer_load_dwordx4 v15,s[24:27],s44 offen offset:3072 lds
v_mov_b32 v7,1
s_waitcnt lgkmcnt(0)
ds_write_b32 v8,v7 offset:32
v_add_f32 v128,v128,v192
v_add_f32 v129,v129,v193
v_add_f32 v130,v130,v194
v_add_f32 v131,v131,v195
v_add_f32 v132,v132,v196
v_add_f32 v133,v133,v197
v_add_f32 v134,v134,v198
v_add_f32 v135,v135,v199
v_add_f32 v136,v136,v200
v_add_f32 v137,v137,v201
v_add_f32 v138,v138,v202
v_add_f32 v139,v139,v203
v_add_f32 v140,v140,v204
v_add_f32 v141,v141,v205
v_add_f32 v142,v142,v206
v_add_f32 v143,v143,v207
v_add_f32 v144,v144,v208
v_add_f32 v145,v145,v209
v_add_f32 v146,v146,v210
v_add_f32 v147,v147,v211
v_add_f32 v148,v148,v212
v_add_f32 v149,v149,v213
v_add_f32 v150,v150,v214
v_add_f32 v151,v151,v215
v_add_f32 v152,v152,v216
v_add_f32 v153,v153,v217
v_add_f32 v154,v154,v218
v_add_f32 v155,v155,v219
v_add_f32 v156,v156,v220
v_add_f32 v157,v157,v221
v_add_f32 v158,v158,v222
v_add_f32 v159,v159,v223
af_r2:
ds_read_b32 v7,v10 offset:32
s_waitcnt lgkmcnt(0)
v_readfirstlane_b32 s44,v7
s_nop 0
s_cmp_lt_u32 s44,1
s_cbranch_scc1 af_r2
ds_read_b128 v[160:163],v11 offset:0
ds_read_b128 v[164:167],v11 offset:1024
ds_read_b128 v[168:171],v11 offset:2048
ds_read_b128 v[172:175],v11 offset:3072
ds_read_b128 v[176:179],v11 offset:4096
ds_read_b128 v[180:183],v11 offset:5120
ds_read_b128 v[184:187],v11 offset:6144
ds_read_b128 v[188:191],v11 offset:7168
s_waitcnt lgkmcnt(7)
v_add_f32 v128,v128,v160
v_add_f32 v129,v129,v161
v_add_f32 v130,v130,v162
v_add_f32 v131,v131,v163
v_cvt_pk_bf16_f32 v16,v128,v129
v_cvt_pk_bf16_f32 v17,v130,v131
s_waitcnt lgkmcnt(6)
v_add_f32 v132,v132,v164
v_add_f32 v133,v133,v165
v_add_f32 v134,v134,v166
v_add_f32 v135,v135,v167
v_cvt_pk_bf16_f32 v18,v132,v133
v_cvt_pk_bf16_f32 v19,v134,v135
s_waitcnt lgkmcnt(5)
v_add_f32 v136,v136,v168
v_add_f32 v137,v137,v169
v_add_f32 v138,v138,v170
v_add_f32 v139,v139,v171
v_cvt_pk_bf16_f32 v20,v136,v137
v_cvt_pk_bf16_f32 v21,v138,v139
s_waitcnt lgkmcnt(4)
v_add_f32 v140,v140,v172
v_add_f32 v141,v141,v173
v_add_f32 v142,v142,v174
v_add_f32 v143,v143,v175
v_cvt_pk_bf16_f32 v22,v140,v141
v_cvt_pk_bf16_f32 v23,v142,v143
s_waitcnt lgkmcnt(3)
v_add_f32 v144,v144,v176
v_add_f32 v145,v145,v177
v_add_f32 v146,v146,v178
v_add_f32 v147,v147,v179
v_cvt_pk_bf16_f32 v24,v144,v145
v_cvt_pk_bf16_f32 v25,v146,v147
s_waitcnt lgkmcnt(2)
v_add_f32 v148,v148,v180
v_add_f32 v149,v149,v181
v_add_f32 v150,v150,v182
v_add_f32 v151,v151,v183
v_cvt_pk_bf16_f32 v26,v148,v149
v_cvt_pk_bf16_f32 v27,v150,v151
s_waitcnt lgkmcnt(1)
v_add_f32 v152,v152,v184
v_add_f32 v153,v153,v185
v_add_f32 v154,v154,v186
v_add_f32 v155,v155,v187
v_cvt_pk_bf16_f32 v28,v152,v153
v_cvt_pk_bf16_f32 v29,v154,v155
s_waitcnt lgkmcnt(0)
s_cmp_lg_u32 s47,3
s_cbranch_scc1 af_gl9
s_add_u32 m0,s56,4096
s_add_u32 s44,s54,1638400
buffer_load_dwordx4 v12,s[24:27],s44 offen offset:0 lds
buffer_load_dwordx4 v13,s[24:27],s44 offen offset:1024 lds
buffer_load_dwordx4 v14,s[24:27],s44 offen offset:2048 lds
buffer_load_dwordx4 v15,s[24:27],s44 offen offset:3072 lds
af_gl9:
v_add_f32 v156,v156,v188
v_add_f32 v157,v157,v189
v_add_f32 v158,v158,v190
v_add_f32 v159,v159,v191
v_cvt_pk_bf16_f32 v30,v156,v157
v_cvt_pk_bf16_f32 v31,v158,v159
v_lshrrev_b32 v4,5,v0
v_lshlrev_b32 v4,9,v4
v_and_b32 v5,15,v0
v_lshl_add_u32 v4,v5,4,v4
v_bfe_u32 v5,v0,4,1
v_lshl_add_u32 v4,v5,3,v4
v_add_u32 v4,s56,v4
ds_write_b64 v4,v[16:17] offset:0
ds_write_b64 v4,v[18:19] offset:1024
ds_write_b64 v4,v[20:21] offset:2048
ds_write_b64 v4,v[22:23] offset:3072
ds_write_b64 v4,v[24:25] offset:256
ds_write_b64 v4,v[26:27] offset:1280
ds_write_b64 v4,v[28:29] offset:2304
ds_write_b64 v4,v[30:31] offset:3328
v_mov_b32 v7,1
s_mov_b64 exec,1
s_waitcnt vmcnt(0) lgkmcnt(0)
ds_add_u32 v6,v7 offset:12
s_mov_b64 exec,-1
s_waitcnt lgkmcnt(0)
s_branch af_fin
af_hwait:
s_sleep 1
s_sub_u32 s45,s45,1
s_cbranch_scc0 af_hpoll
v_mov_b32 v7,161792
ds_write_b32 v7,v7 offset:56
s_branch af_hok
af_kwait:
s_sleep 1
s_sub_u32 s45,s45,1
s_cbranch_scc0 af_kpoll
v_mov_b32 v7,161792
ds_write_b32 v7,v7 offset:56
s_branch af_kst
af_h2:
s_cmp_lg_u32 s100,-1
s_cbranch_scc1 af_h2r
buffer_load_dword v7,v6,s[32:35],s59 offen sc1
s_waitcnt vmcnt(0)
v_cmp_eq_u32 vcc,0,v7
s_nop 1
s_cbranch_vccz af_h2r
s_sleep 1
s_sub_u32 s45,s45,1
s_cbranch_scc0 af_h2
v_mov_b32 v7,161792
ds_write_b32 v7,v7 offset:56
s_branch af_h2r
af_fin:
s_waitcnt lgkmcnt(0)
s_barrier
v_mov_b32 v6,161792
ds_read_b32 v7,v6 offset:56
s_waitcnt lgkmcnt(0)
v_readfirstlane_b32 s43,v7
s_nop 0
s_cmp_lg_u32 s43,0
s_cbranch_scc1 m_help
s_endpgm
text_end:
.section .rodata,"a"
.p2align 6
.amdhsa_kernel mg_kernel
  .amdhsa_next_free_vgpr 256
  .amdhsa_next_free_sgpr 102
  .amdhsa_accum_offset 256
  .amdhsa_group_segment_fixed_size 0
  .amdhsa_kernarg_size 80
  .amdhsa_user_sgpr_count 2
  .amdhsa_user_sgpr_kernarg_segment_ptr 1
  .amdhsa_system_sgpr_workgroup_id_x 1
.end_amdhsa_kernel
```
